```python
import torch

def _softmax(x, axis=-1):
    return torch.softmax(x, dim=axis)
def _gelu(x):
    return torch.nn.functional.gelu(x, approximate="tanh")
def _silu(x):
    return torch.nn.functional.silu(x)
def _sigmoid(x):
    return torch.sigmoid(x)
def _layernorm(x, axis=-1, eps=1e-5):
    m = x.mean(dim=axis, keepdim=True)
    v = x.var(dim=axis, keepdim=True, unbiased=False)
    return (x - m) / torch.sqrt(v + eps)
def _scatter_add(tgt, idx, src, axis=0):
    return tgt.clone().index_add_(axis, idx, src)
def _segment_sum(src, seg, n):
    out = torch.zeros((n,) + src.shape[1:], dtype=src.dtype)
    return out.index_add_(0, seg, src)
def _pad(x, pw):
    flat = tuple(v for pair in reversed(pw) for v in pair)
    return torch.nn.functional.pad(x, flat)

kernel_name = 'sequential_preLN__grouped_kv_mqa__glu_gated_bilinear__prompt'

def setup_inputs():

    _w = (lambda a: (lambda t: t.to(torch.bfloat16) if t.is_floating_point() else t)(torch.as_tensor(a)))
    def _A_setup():
        B, S, D, H = 1, 2048, 576, 32
        Dh = D // H
        return {
            "x": _w((lambda *s: torch.randn(*s, dtype=torch.bfloat16) * 0.05)(B, S, D)),
            "wq": _w((lambda *s: torch.randn(*s, dtype=torch.bfloat16) * 0.05)(D, H * Dh)),
            "wk": _w((lambda *s: torch.randn(*s, dtype=torch.bfloat16) * 0.05)(D, Dh)),
            "wv": _w((lambda *s: torch.randn(*s, dtype=torch.bfloat16) * 0.05)(D, Dh)),
            "wo": _w((lambda *s: torch.randn(*s, dtype=torch.bfloat16) * 0.05)(H * Dh, D)),
        }
    _A_in = _A_setup()

    def _B_setup():
        B, S, D, F = 1, 2048, 576, 4608
        return {
            "x": _w((lambda *s: torch.randn(*s, dtype=torch.bfloat16) * 0.05)(B, S, D)),
            "w_gate": _w((lambda *s: torch.randn(*s, dtype=torch.bfloat16) * 0.4)(D, F) * (D ** -0.5)),
            "w_up": _w((lambda *s: torch.randn(*s, dtype=torch.bfloat16) * 0.4)(D, F) * (D ** -0.5)),
            "w_down": _w((lambda *s: torch.randn(*s, dtype=torch.bfloat16) * 0.4)(F, D) * (F ** -0.5)),
        }
    _B_in = _B_setup()

    return {
        "A_x": _A_in["x"],
        "A_wq": _A_in["wq"],
        "A_wk": _A_in["wk"],
        "A_wv": _A_in["wv"],
        "A_wo": _A_in["wo"],
        "B_x": _B_in["x"],
        "B_w_gate": _B_in["w_gate"],
        "B_w_up": _B_in["w_up"],
        "B_w_down": _B_in["w_down"],
    }

def reference(A_x, A_wq, A_wk, A_wv, A_wo, B_x, B_w_gate, B_w_up, B_w_down):
    def _A_ref(x, wq, wk, wv, wo):
        B, S, D = x.shape
        H = 32
        Dh = D // H
        q = (lambda x, *d: x.permute(*d))((x @ wq).reshape(B, S, H, Dh), 0, 2, 1, 3)
        k = x @ wk
        v = x @ wv
        scores = torch.einsum("bhqd,bkd->bhqk", q, k) * (Dh ** -0.5)
        p = _softmax(scores, axis=-1)
        o = torch.einsum("bhqk,bkd->bhqd", p, v)
        return (lambda x, *d: x.permute(*d))(o, 0, 2, 1, 3).reshape(B, S, H * Dh) @ wo

    def _B_ref(x, w_gate, w_up, w_down):
        g = torch.einsum("bsd,df->bsf", x, w_gate)
        u = torch.einsum("bsd,df->bsf", x, w_up)
        h = g * u
        return torch.einsum("bsf,fd->bsd", h, w_down)

    x = A_x
    h = x + _A_ref(_layernorm(x, axis=-1), A_wq, A_wk, A_wv, A_wo)
    h2 = h + _B_ref(_layernorm(h, axis=-1), B_w_gate, B_w_up, B_w_down)
    return h2
```

```asm
; @launch grid=(256,1,1) block=(256,1,1) lds=163840
.amdgcn_target "amdgcn-amd-amdhsa--gfx950"
.text
.globl sequential_preLN__grouped_kv_mqa__glu_gated_bilinear__prompt_kernel
.p2align 8
.type sequential_preLN__grouped_kv_mqa__glu_gated_bilinear__prompt_kernel,@function
sequential_preLN__grouped_kv_mqa__glu_gated_bilinear__prompt_kernel:
    s_cmp_ge_u32 s2, 256
    s_cbranch_scc1 MEGA_END
    s_load_dwordx16 s[64:79], s[0:1], 0
    s_load_dwordx8 s[80:87], s[0:1], 64
    v_lshrrev_b32 v2, 6, v0
    s_nop 0
    v_readfirstlane_b32 s62, v2
    s_and_b32 s3, s2, 7
    s_lshr_b32 s6, s2, 3
    s_lshr_b32 s4, s3, 1
    s_and_b32 s5, s3, 1
    s_and_b32 s7, s6, 7
    s_lshl_b32 s4, s4, 3
    s_add_u32 s60, s4, s7
    s_lshr_b32 s6, s6, 3
    s_lshl_b32 s5, s5, 2
    s_add_u32 s61, s5, s6
    v_and_b32 v1, 63, v0
    s_getpc_b64 s[8:9]
PCREF:
    s_lshr_b32 s10, s2, 3
    s_lshl_b32 s10, s10, 2
    s_add_u32 s10, s10, s62
    s_lshl_b32 s10, s10, 10
    v_lshl_add_u32 v250, v1, 4, s10
    v_min_u32 v250, MEGA_END-PCREF-16, v250
    v_mov_b32 v251, s9
    v_add_co_u32 v250, vcc, s8, v250
    s_nop 1
    v_addc_co_u32 v251, vcc, 0, v251, vcc
    global_load_dwordx4 v[252:255], v[250:251], off
    s_waitcnt lgkmcnt(0)
    s_load_dword s63, s[86:87], 0
    s_cmp_lg_u32 s61, 0
    s_cbranch_scc1 WOL_1
    s_cmp_ge_u32 s60, 27
    s_cbranch_scc1 WOL_1
    s_lshl_b32 s43, s60, 2
    s_add_u32 s43, s43, s62
    s_mul_hi_u32 s44, s43, 0xe38e38f
    s_mul_i32 s45, s44, 18
    s_sub_u32 s45, s43, s45
    s_mov_b32 s16, s72
    s_mov_b32 s17, s73
    s_mov_b32 s18, 663552
    s_mov_b32 s19, 0x20000
    v_and_b32 v5, 15, v1
    v_lshrrev_b32 v6, 4, v1
    v_mul_u32_u24 v7, 12, v5
    s_mul_i32 s46, s44, 192
    v_add_u32 v7, s46, v7
    v_lshrrev_b32 v8, 1, v6
    v_mul_u32_u24 v8, 18, v8
    v_and_b32 v9, 1, v6
    v_lshl_add_u32 v8, v9, 3, v8
    v_mul_u32_u24 v9, 72, v6
    s_cmp_lt_u32 s45, 16
    s_cselect_b64 s[46:47], -1, 0
    s_mul_i32 s48, s45, 36
    s_sub_u32 s49, s45, 16
    s_mul_i32 s49, s49, 288
    s_cmp_lt_u32 s45, 16
    s_cselect_b32 s48, s48, s49
    v_cndmask_b32 v8, v9, v8, s[46:47]
    v_add_u32 v8, s48, v8
    v_mul_u32_u24 v8, 1152, v8
    v_add_u32 v8, v8, v7
    s_cmp_lt_u32 s45, 16
    s_mov_b32 s48, 18432
    s_cmov_b32 s48, 0
    buffer_load_dwordx3 v[200:202], v8, s[16:19], s48 offen
    s_cmp_lt_u32 s45, 16
    s_mov_b32 s48, 19584
    s_cmov_b32 s48, 1152
    buffer_load_dwordx3 v[204:206], v8, s[16:19], s48 offen
    s_cmp_lt_u32 s45, 16
    s_mov_b32 s48, 39168
    s_cmov_b32 s48, 2304
    buffer_load_dwordx3 v[208:210], v8, s[16:19], s48 offen
    s_cmp_lt_u32 s45, 16
    s_mov_b32 s48, 40320
    s_cmov_b32 s48, 3456
    buffer_load_dwordx3 v[212:214], v8, s[16:19], s48 offen
    s_cmp_lt_u32 s45, 16
    s_mov_b32 s48, 59904
    s_cmov_b32 s48, 4608
    buffer_load_dwordx3 v[216:218], v8, s[16:19], s48 offen
    s_cmp_lt_u32 s45, 16
    s_mov_b32 s48, 61056
    s_cmov_b32 s48, 5760
    buffer_load_dwordx3 v[220:222], v8, s[16:19], s48 offen
    s_cmp_lt_u32 s45, 16
    s_mov_b32 s48, 80640
    s_cmov_b32 s48, 6912
    buffer_load_dwordx3 v[224:226], v8, s[16:19], s48 offen
    s_cmp_lt_u32 s45, 16
    s_mov_b32 s48, 81792
    s_cmov_b32 s48, 8064
    buffer_load_dwordx3 v[228:230], v8, s[16:19], s48 offen
WOL_1:
    s_mov_b32 s8, s64
    s_mov_b32 s9, s65
    s_mov_b32 s10, 2359296
    s_mov_b32 s11, 0x20000
    s_lshl_b32 s34, s60, 6
    s_movk_i32 s36, 1152
    v_lshrrev_b32 v5, 3, v1
    v_and_b32 v6, 7, v1
    v_lshrrev_b32 v7, 1, v5
    v_xor_b32 v8, v6, v7
    v_xor_b32 v9, 4, v8
    s_lshl_b32 s37, s62, 4
    s_add_u32 s37, s37, s34
    v_add_u32 v5, s37, v5
    v_lshlrev_b32 v8, 4, v8
    v_lshlrev_b32 v9, 4, v9
    v_mad_u32_u24 v8, v5, s36, v8
    v_add_u32 v5, 8, v5
    v_mad_u32_u24 v9, v5, s36, v9
    s_mul_i32 s45, s62, 18432
    s_mov_b32 m0, s45
    s_movk_i32 s46, 0
    buffer_load_dwordx4 v8, s[8:11], s46 offen lds
    s_add_u32 s45, s45, 1024
    s_mov_b32 m0, s45
    s_movk_i32 s46, 128
    buffer_load_dwordx4 v8, s[8:11], s46 offen lds
    s_add_u32 s45, s45, 1024
    s_mov_b32 m0, s45
    s_movk_i32 s46, 256
    buffer_load_dwordx4 v8, s[8:11], s46 offen lds
    s_add_u32 s45, s45, 1024
    s_mov_b32 m0, s45
    s_movk_i32 s46, 384
    buffer_load_dwordx4 v8, s[8:11], s46 offen lds
    s_add_u32 s45, s45, 1024
    s_mov_b32 m0, s45
    s_movk_i32 s46, 512
    buffer_load_dwordx4 v8, s[8:11], s46 offen lds
    s_add_u32 s45, s45, 1024
    s_mov_b32 m0, s45
    s_movk_i32 s46, 640
    buffer_load_dwordx4 v8, s[8:11], s46 offen lds
    s_add_u32 s45, s45, 1024
    s_mov_b32 m0, s45
    s_movk_i32 s46, 768
    buffer_load_dwordx4 v8, s[8:11], s46 offen lds
    s_add_u32 s45, s45, 1024
    s_mov_b32 m0, s45
    s_movk_i32 s46, 896
    buffer_load_dwordx4 v8, s[8:11], s46 offen lds
    s_add_u32 s45, s45, 1024
    s_mov_b32 m0, s45
    s_movk_i32 s46, 1024
    buffer_load_dwordx4 v8, s[8:11], s46 offen lds
    s_add_u32 s45, s45, 1024
    s_mov_b32 m0, s45
    s_movk_i32 s46, 0
    buffer_load_dwordx4 v9, s[8:11], s46 offen lds
    s_add_u32 s45, s45, 1024
    s_mov_b32 m0, s45
    s_movk_i32 s46, 128
    buffer_load_dwordx4 v9, s[8:11], s46 offen lds
    s_add_u32 s45, s45, 1024
    s_mov_b32 m0, s45
    s_movk_i32 s46, 256
    buffer_load_dwordx4 v9, s[8:11], s46 offen lds
    s_add_u32 s45, s45, 1024
    s_mov_b32 m0, s45
    s_movk_i32 s46, 384
    buffer_load_dwordx4 v9, s[8:11], s46 offen lds
    s_add_u32 s45, s45, 1024
    s_mov_b32 m0, s45
    s_movk_i32 s46, 512
    buffer_load_dwordx4 v9, s[8:11], s46 offen lds
    s_add_u32 s45, s45, 1024
    s_mov_b32 m0, s45
    s_movk_i32 s46, 640
    buffer_load_dwordx4 v9, s[8:11], s46 offen lds
    s_add_u32 s45, s45, 1024
    s_mov_b32 m0, s45
    s_movk_i32 s46, 768
    buffer_load_dwordx4 v9, s[8:11], s46 offen lds
    s_add_u32 s45, s45, 1024
    s_mov_b32 m0, s45
    s_movk_i32 s46, 896
    buffer_load_dwordx4 v9, s[8:11], s46 offen lds
    s_add_u32 s45, s45, 1024
    s_mov_b32 m0, s45
    s_movk_i32 s46, 1024
    buffer_load_dwordx4 v9, s[8:11], s46 offen lds
    s_add_u32 s45, s45, 1024
    s_cmp_lt_u32 s61, 6
    s_cbranch_scc1 P1_NOKVD
    s_cmp_eq_u32 s61, 6
    s_cselect_b32 s16, s68, s70
    s_cselect_b32 s17, s69, s71
    s_mov_b32 s18, 20736
    s_mov_b32 s19, 0x20000
    v_add_u32 v13, 0, v1
    v_mul_u32_u24 v14, 21846, v13
    v_lshrrev_b32 v14, 16, v14
    v_mul_u32_u24 v15, 3, v14
    v_sub_u32 v15, v13, v15
    v_mul_u32_u24 v14, 36, v14
    v_lshl_add_u32 v116, v15, 4, v14
    v_add_u32 v13, 64, v1
    v_mul_u32_u24 v14, 21846, v13
    v_lshrrev_b32 v14, 16, v14
    v_mul_u32_u24 v15, 3, v14
    v_sub_u32 v15, v13, v15
    v_mul_u32_u24 v14, 36, v14
    v_lshl_add_u32 v117, v15, 4, v14
    v_add_u32 v13, 128, v1
    v_mul_u32_u24 v14, 21846, v13
    v_lshrrev_b32 v14, 16, v14
    v_mul_u32_u24 v15, 3, v14
    v_sub_u32 v15, v13, v15
    v_mul_u32_u24 v14, 36, v14
    v_lshl_add_u32 v118, v15, 4, v14
    s_add_u32 s39, s62, 0
    s_mul_i32 s40, s39, 2304
    s_mul_i32 s39, s39, 3072
    s_add_u32 s39, s39, 129024
    s_mov_b32 m0, s39
    s_nop 0
    buffer_load_dwordx4 v116, s[16:19], s40 offen lds
    s_add_u32 s39, s39, 1024
    s_mov_b32 m0, s39
    s_nop 0
    buffer_load_dwordx4 v117, s[16:19], s40 offen lds
    s_add_u32 s39, s39, 1024
    s_mov_b32 m0, s39
    s_nop 0
    buffer_load_dwordx4 v118, s[16:19], s40 offen lds
    s_add_u32 s39, s39, 1024
WKV_2:
    s_add_u32 s39, s62, 4
    s_mul_i32 s40, s39, 2304
    s_mul_i32 s39, s39, 3072
    s_add_u32 s39, s39, 129024
    s_mov_b32 m0, s39
    s_nop 0
    buffer_load_dwordx4 v116, s[16:19], s40 offen lds
    s_add_u32 s39, s39, 1024
    s_mov_b32 m0, s39
    s_nop 0
    buffer_load_dwordx4 v117, s[16:19], s40 offen lds
    s_add_u32 s39, s39, 1024
    s_mov_b32 m0, s39
    s_nop 0
    buffer_load_dwordx4 v118, s[16:19], s40 offen lds
    s_add_u32 s39, s39, 1024
WKV_3:
    s_cmp_lg_u32 s62, 0
    s_cbranch_scc1 WKV_4
    s_add_u32 s39, s62, 8
    s_mul_i32 s40, s39, 2304
    s_mul_i32 s39, s39, 3072
    s_add_u32 s39, s39, 129024
    s_mov_b32 m0, s39
    s_nop 0
    buffer_load_dwordx4 v116, s[16:19], s40 offen lds
    s_add_u32 s39, s39, 1024
    s_mov_b32 m0, s39
    s_nop 0
    buffer_load_dwordx4 v117, s[16:19], s40 offen lds
    s_add_u32 s39, s39, 1024
    s_mov_b32 m0, s39
    s_nop 0
    buffer_load_dwordx4 v118, s[16:19], s40 offen lds
    s_add_u32 s39, s39, 1024
WKV_4:
P1_NOKVD:
    s_mov_b32 s12, s66
    s_mov_b32 s13, s67
    s_mov_b32 s14, 663552
    s_mov_b32 s15, 0x20000
    s_mul_i32 s38, s61, 144
    s_lshl_b32 s39, s62, 7
    v_add_u32 v13, s39, v1
    v_mul_u32_u24 v14, 7282, v13
    v_lshrrev_b32 v14, 16, v14
    v_mul_u32_u24 v15, 9, v14
    v_sub_u32 v15, v13, v15
    v_mul_u32_u24 v14, 1152, v14
    v_lshl_add_u32 v126, v15, 4, v14
    v_add_u32 v126, s38, v126
    s_lshl_b32 s39, s62, 7
    s_add_u32 s39, s39, 64
    v_add_u32 v13, s39, v1
    v_mul_u32_u24 v14, 7282, v13
    v_lshrrev_b32 v14, 16, v14
    v_mul_u32_u24 v15, 9, v14
    v_sub_u32 v15, v13, v15
    v_mul_u32_u24 v14, 1152, v14
    v_lshl_add_u32 v127, v15, 4, v14
    v_add_u32 v127, s38, v127
    v_add_u32 v13, 512, v1
    v_mul_u32_u24 v14, 7282, v13
    v_lshrrev_b32 v14, 16, v14
    v_mul_u32_u24 v15, 9, v14
    v_sub_u32 v15, v13, v15
    v_mul_u32_u24 v14, 1152, v14
    v_lshl_add_u32 v128, v15, 4, v14
    v_add_u32 v128, s38, v128
    v_subrev_u32 v127, 1024, v127
    s_lshl_b32 s57, s62, 11
    s_add_u32 s57, s57, 73728
    s_mov_b32 s56, 0
    v_mov_b32 v116, 0x3f803f80
    v_mov_b32 v117, 0x3f803f80
    v_mov_b32 v118, 0x3f803f80
    v_mov_b32 v119, 0x3f803f80
    v_lshlrev_b32 v120, 4, v1
    v_add_u32 v120, 156672, v120
    ds_write_b128 v120, v[116:119]
    s_cmp_ge_u32 s61, 6
    s_cbranch_scc1 P1_PROD
    s_cmp_lg_u32 s62, 0
    s_cbranch_scc1 WQ8_5
    s_mov_b32 m0, 81920
    s_nop 0
    buffer_load_dwordx4 v128, s[12:15], s56 offen lds
WQ8_5:
    s_mov_b32 m0, s57
    s_add_u32 s57, s57, 9216
    buffer_load_dwordx4 v126, s[12:15], s56 offen lds
    buffer_load_dwordx4 v127, s[12:15], s56 offen offset:1024 lds
    s_add_u32 s56, s56, 73728
    s_cmp_lg_u32 s62, 1
    s_cbranch_scc1 WQ8_6
    s_mov_b32 m0, 91136
    s_nop 0
    buffer_load_dwordx4 v128, s[12:15], s56 offen lds
WQ8_6:
    s_mov_b32 m0, s57
    s_add_u32 s57, s57, 9216
    buffer_load_dwordx4 v126, s[12:15], s56 offen lds
    buffer_load_dwordx4 v127, s[12:15], s56 offen offset:1024 lds
    s_add_u32 s56, s56, 73728
    s_cmp_lg_u32 s62, 2
    s_cbranch_scc1 WQ8_7
    s_mov_b32 m0, 100352
    s_nop 0
    buffer_load_dwordx4 v128, s[12:15], s56 offen lds
WQ8_7:
    s_mov_b32 m0, s57
    s_add_u32 s57, s57, 9216
    buffer_load_dwordx4 v126, s[12:15], s56 offen lds
    buffer_load_dwordx4 v127, s[12:15], s56 offen offset:1024 lds
    s_add_u32 s56, s56, 73728
    s_cmp_lg_u32 s62, 3
    s_cbranch_scc1 WQ8_8
    s_mov_b32 m0, 109568
    s_nop 0
    buffer_load_dwordx4 v128, s[12:15], s56 offen lds
WQ8_8:
    s_mov_b32 m0, s57
    s_add_u32 s57, s57, 9216
    buffer_load_dwordx4 v126, s[12:15], s56 offen lds
    buffer_load_dwordx4 v127, s[12:15], s56 offen offset:1024 lds
    s_add_u32 s56, s56, 73728
    s_lshl_b32 s5, s60, 3
    s_add_u32 s5, s5, s61
    s_lshl_b32 s5, s5, 2
    s_add_u32 s5, s5, s62
    s_mul_hi_u32 s42, s5, 0x38e38e4
    s_mul_i32 s41, s42, 72
    s_sub_u32 s41, s5, s41
    s_mul_hi_u32 s45, s42, 0x55555556
    s_mul_i32 s46, s45, 3
    s_sub_u32 s46, s42, s46
    s_mul_i32 s45, s45, 96
    s_lshl_b32 s46, s46, 1
    s_add_u32 s45, s45, s46
    s_mul_i32 s45, s45, 9216
    s_lshl_b32 s46, s41, 7
    s_add_u32 s45, s45, s46
    v_and_b32 v244, 63, v0
    v_bfe_u32 v245, v244, 4, 1
    v_mul_u32_u24 v245, 48, v245
    v_lshrrev_b32 v246, 5, v244
    v_add_u32 v245, v245, v246
    v_mul_u32_u24 v245, 9216, v245
    v_bfe_u32 v246, v244, 2, 2
    v_lshlrev_b32 v246, 1, v246
    v_and_b32 v247, 1, v244
    v_add_u32 v246, v246, v247
    v_lshl_add_u32 v245, v246, 4, v245
    v_add_u32 v245, s45, v245
    v_and_b32 v246, 2, v244
    v_cmp_eq_u32 vcc, 0, v246
    v_mov_b32 v246, s78
    v_mov_b32 v247, s76
    v_cndmask_b32 v144, v246, v247, vcc
    v_mov_b32 v246, s79
    v_mov_b32 v247, s77
    v_cndmask_b32 v145, v246, v247, vcc
    v_mov_b32 v246, v245
    v_mov_b32 v247, 0
    v_lshl_add_u64 v[144:145], v[246:247], 0, v[144:145]
    s_mul_hi_u32 s45, s41, 0x1c71c71d
    s_mul_i32 s46, s45, 9
    s_sub_u32 s46, s41, s46
    s_mul_i32 s45, s45, 1327104
    s_mul_i32 s47, s42, 5
    s_min_u32 s48, s46, 4
    s_add_u32 s47, s47, s48
    s_lshl_b32 s48, s42, 2
    s_add_u32 s48, s48, s46
    s_add_u32 s48, s48, 86
    s_sub_u32 s49, s46, 4
    s_cmp_lt_u32 s49, 4
    s_cselect_b32 s47, s48, s47
    s_lshl_b32 s47, s47, 10
    s_add_u32 s33, s45, s47
    s_mov_b32 s34, 165888
    s_mov_b32 s35, 165888
    s_mov_b32 s36, 165888
    v_and_b32 v244, 63, v0
    v_lshlrev_b32 v22, 4, v244
    s_mov_b32 s68, 55296
    s_mov_b32 s69, 0
    s_cmp_ge_u32 s5, 272
    s_cbranch_scc1 PKW_9
    s_add_u32 s5, s5, 1024
    s_mul_hi_u32 s42, s5, 0x38e38e4
    s_mul_i32 s41, s42, 72
    s_sub_u32 s41, s5, s41
    s_mul_hi_u32 s45, s42, 0x55555556
    s_mul_i32 s46, s45, 3
    s_sub_u32 s46, s42, s46
    s_mul_i32 s45, s45, 96
    s_lshl_b32 s46, s46, 1
    s_add_u32 s45, s45, s46
    s_mul_i32 s45, s45, 9216
    s_lshl_b32 s46, s41, 7
    s_add_u32 s45, s45, s46
    v_and_b32 v244, 63, v0
    v_bfe_u32 v245, v244, 4, 1
    v_mul_u32_u24 v245, 48, v245
    v_lshrrev_b32 v246, 5, v244
    v_add_u32 v245, v245, v246
    v_mul_u32_u24 v245, 9216, v245
    v_bfe_u32 v246, v244, 2, 2
    v_lshlrev_b32 v246, 1, v246
    v_and_b32 v247, 1, v244
    v_add_u32 v246, v246, v247
    v_lshl_add_u32 v245, v246, 4, v245
    v_add_u32 v245, s45, v245
    v_and_b32 v246, 2, v244
    v_cmp_eq_u32 vcc, 0, v246
    v_mov_b32 v246, s78
    v_mov_b32 v247, s76
    v_cndmask_b32 v146, v246, v247, vcc
    v_mov_b32 v246, s79
    v_mov_b32 v247, s77
    v_cndmask_b32 v147, v246, v247, vcc
    v_mov_b32 v246, v245
    v_mov_b32 v247, 0
    v_lshl_add_u64 v[146:147], v[246:247], 0, v[146:147]
    s_mul_hi_u32 s45, s41, 0x1c71c71d
    s_mul_i32 s46, s45, 9
    s_sub_u32 s46, s41, s46
    s_mul_i32 s45, s45, 1327104
    s_mul_i32 s47, s42, 5
    s_min_u32 s48, s46, 4
    s_add_u32 s47, s47, s48
    s_lshl_b32 s48, s42, 2
    s_add_u32 s48, s48, s46
    s_add_u32 s48, s48, 86
    s_sub_u32 s49, s46, 4
    s_cmp_lt_u32 s49, 4
    s_cselect_b32 s47, s48, s47
    s_lshl_b32 s47, s47, 10
    s_add_u32 s52, s45, s47
    s_mov_b32 s53, 165888
    s_mov_b32 s54, 165888
    s_mov_b32 s55, 165888
    v_and_b32 v244, 63, v0
    v_lshlrev_b32 v23, 4, v244
    s_mov_b32 s70, 55296
    s_mov_b32 s71, 0
    s_mov_b32 s72, 55296
    s_mov_b32 s73, 0
    s_branch PKE_10
PKW_9:
    s_sub_u32 s5, s5, 272
    s_mul_hi_u32 s41, s5, 0x2aaaaaab
    s_mul_i32 s42, s41, 6
    s_sub_u32 s42, s5, s42
    s_mul_hi_u32 s43, s41, 0x1c71c71d
    s_mul_i32 s44, s43, 9
    s_sub_u32 s44, s41, s44
    s_and_b32 s41, s43, 1
    s_lshr_b32 s43, s43, 1
    s_and_b32 s45, s44, 1
    s_lshl_b32 s45, s45, 8
    s_lshr_b32 s46, s44, 1
    s_add_u32 s45, s45, s46
    s_cmp_lt_u32 s44, 8
    s_cselect_b32 s45, s45, 512
    s_mul_i32 s46, s43, 576
    s_add_u32 s45, s45, s46
    s_lshl_b32 s46, s41, 2
    s_add_u32 s45, s45, s46
    v_and_b32 v244, 63, v0
    v_and_b32 v245, 15, v244
    v_lshrrev_b32 v246, 4, v244
    s_cmp_lt_u32 s44, 8
    s_cselect_b32 s46, 4, 0
    v_lshlrev_b32 v247, s46, v246
    v_add_u32 v247, s45, v247
    v_mul_u32_u24 v247, 1152, v247
    v_mul_u32_u24 v248, 12, v245
    v_add_u32 v247, v247, v248
    s_mul_i32 s49, s42, 192
    v_add_u32 v246, s49, v247
    v_mov_b32 v247, 0
    v_lshl_add_u64 v[146:147], v[246:247], 0, s[80:81]
    s_mov_b32 s70, 9216
    s_mov_b32 s71, 0
    s_mov_b32 s72, 64512
    s_cmp_lt_u32 s44, 8
    s_cselect_b32 s72, s72, 9216
    s_mov_b32 s73, 0
    s_lshl_b32 s45, s43, 2
    s_and_b32 s46, s42, 1
    s_lshl_b32 s46, s46, 1
    s_add_u32 s45, s45, s46
    s_mul_i32 s45, s45, 165888
    s_mul_i32 s46, s41, 9
    s_add_u32 s46, s46, s44
    s_mul_i32 s46, s46, 9
    s_lshr_b32 s47, s42, 1
    s_mul_i32 s47, s47, 3
    s_add_u32 s46, s46, s47
    s_lshl_b32 s46, s46, 10
    s_add_u32 s45, s45, s46
    s_add_u32 s52, s45, 10616832
    s_movk_i32 s53, 1024
    s_mov_b32 s54, 163840
    s_mov_b32 s55, 0x40000000
    v_and_b32 v244, 63, v0
    v_lshlrev_b32 v23, 4, v244
PKE_10:
    s_waitcnt lgkmcnt(0)
    s_mul_i32 s63, s63, 0x9e3779b1
    s_add_u32 s63, s63, 0x7f4a7c15
    s_waitcnt vmcnt(6)
    s_barrier
    s_branch P1_Q
P1_PROD:
    v_and_b32 v3, 15, v1
    v_lshrrev_b32 v4, 4, v1
    v_mov_b32 v48, 0x3f803f80
    v_mov_b32 v49, 0x3f803f80
    v_mov_b32 v50, 0x3f803f80
    v_mov_b32 v51, 0x3f803f80
    v_bfe_u32 v5, v1, 3, 1
    s_lshl_b32 s37, s62, 1
    v_add_u32 v5, s37, v5
    v_mul_u32_u24 v5, 9216, v5
    v_and_b32 v6, 7, v1
    v_lshl_add_u32 v5, v6, 7, v5
    v_lshrrev_b32 v6, 1, v3
    v_xor_b32 v7, v6, v4
    v_lshl_add_u32 v89, v7, 4, v5
    v_xor_b32 v90, 64, v89
    v_bfe_u32 v5, v1, 2, 2
    v_lshl_add_u32 v5, v4, 3, v5
    v_mul_u32_u24 v5, 48, v5
    v_and_b32 v6, 3, v1
    v_lshl_add_u32 v91, v6, 3, v5
    v_add_u32 v91, 129024, v91
    v_add_u32 v92, 129056, v5
    v_cmp_eq_u32 vcc, 0, v6
    v_mov_b32 v7, 156672
    s_nop 0
    v_cndmask_b32 v92, v7, v92, vcc
    v_mov_b32 v7, 1536
    v_cndmask_b32 v93, 0, v7, vcc
    s_add_u32 s20, s86, 2686976
    s_addc_u32 s21, s87, 0
    s_mov_b32 s22, 151552
    s_mov_b32 s23, 0x20000
    s_add_u32 s24, s86, 2850816
    s_addc_u32 s25, s87, 0
    s_mov_b32 s26, 1024
    s_mov_b32 s27, 0x20000
    s_add_u32 s16, s86, 2854912
    s_addc_u32 s17, s87, 0
    s_mov_b32 s18, 16384
    s_mov_b32 s19, 0x20000
    s_lshr_b32 s37, s60, 3
    s_mul_i32 s37, s37, 37888
    s_and_b32 s38, s60, 7
    v_mov_b32 v15, 0x7fffffff
    s_lshl_b32 s39, s38, 1
    s_lshr_b32 s40, s62, 1
    s_add_u32 s39, s39, s40
    s_and_b32 s40, s62, 1
    s_lshl_b32 s40, s40, 4
    v_add_u32 v13, s40, v3
    v_and_b32 v14, 1, v4
    v_lshl_add_u32 v14, v14, 5, v13
    v_lshlrev_b32 v14, 4, v14
    v_lshrrev_b32 v12, 1, v4
    v_lshl_add_u32 v14, v12, 3, v14
    s_lshl_b32 s41, s39, 10
    s_add_u32 s41, s41, s37
    v_add_u32 v134, s41, v14
    v_lshlrev_b32 v13, 2, v13
    s_lshl_b32 s41, s39, 7
    s_add_u32 s41, s41, s37
    s_add_u32 s41, s41, 16384
    v_add_u32 v13, s41, v13
    v_cmp_eq_u32 vcc, 0, v4
    s_nop 1
    v_cndmask_b32 v135, v15, v13, vcc
    s_lshl_b32 s39, s60, 6
    s_lshl_b32 s40, s62, 4
    s_add_u32 s39, s39, s40
    v_add_u32 v13, s39, v3
    v_lshlrev_b32 v13, 3, v13
    v_cndmask_b32 v136, v15, v13, vcc
    s_lshl_b32 s39, s38, 2
    s_add_u32 s39, s39, s62
    s_mul_i32 s39, s39, 608
    s_add_u32 s39, s39, s37
    s_add_u32 s39, s39, 18432
    v_and_b32 v14, 1, v4
    v_mul_u32_u24 v14, 304, v14
    v_lshl_add_u32 v14, v3, 4, v14
    v_lshl_add_u32 v14, v12, 3, v14
    v_add_u32 v137, s39, v14
    v_add_u32 v14, 256, v137
    v_cmp_gt_u32 vcc, 3, v3
    s_nop 1
    v_cndmask_b32 v138, v15, v14, vcc
    s_lshl_b32 s39, s60, 2
    s_add_u32 s39, s39, s62
    s_lshl_b32 s39, s39, 2
    v_mov_b32 v14, s39
    v_cmp_eq_u32 vcc, 0, v1
    s_nop 1
    v_cndmask_b32 v139, v15, v14, vcc
    s_lshl_b32 s39, s62, 6
    s_add_u32 s39, s39, 157696
    v_lshl_add_u32 v140, v3, 2, s39
    v_lshl_add_u32 v141, v4, 4, s39
    s_lshl_b32 s5, s60, 3
    s_add_u32 s5, s5, s61
    s_lshl_b32 s5, s5, 2
    s_add_u32 s5, s5, s62
    s_mul_hi_u32 s42, s5, 0x38e38e4
    s_mul_i32 s41, s42, 72
    s_sub_u32 s41, s5, s41
    s_mul_hi_u32 s45, s42, 0x55555556
    s_mul_i32 s46, s45, 3
    s_sub_u32 s46, s42, s46
    s_mul_i32 s45, s45, 96
    s_lshl_b32 s46, s46, 1
    s_add_u32 s45, s45, s46
    s_mul_i32 s45, s45, 9216
    s_lshl_b32 s46, s41, 7
    s_add_u32 s45, s45, s46
    v_and_b32 v244, 63, v0
    v_bfe_u32 v245, v244, 4, 1
    v_mul_u32_u24 v245, 48, v245
    v_lshrrev_b32 v246, 5, v244
    v_add_u32 v245, v245, v246
    v_mul_u32_u24 v245, 9216, v245
    v_bfe_u32 v246, v244, 2, 2
    v_lshlrev_b32 v246, 1, v246
    v_and_b32 v247, 1, v244
    v_add_u32 v246, v246, v247
    v_lshl_add_u32 v245, v246, 4, v245
    v_add_u32 v245, s45, v245
    v_and_b32 v246, 2, v244
    v_cmp_eq_u32 vcc, 0, v246
    v_mov_b32 v246, s78
    v_mov_b32 v247, s76
    v_cndmask_b32 v144, v246, v247, vcc
    v_mov_b32 v246, s79
    v_mov_b32 v247, s77
    v_cndmask_b32 v145, v246, v247, vcc
    v_mov_b32 v246, v245
    v_mov_b32 v247, 0
    v_lshl_add_u64 v[144:145], v[246:247], 0, v[144:145]
    s_mul_hi_u32 s45, s41, 0x1c71c71d
    s_mul_i32 s46, s45, 9
    s_sub_u32 s46, s41, s46
    s_mul_i32 s45, s45, 1327104
    s_mul_i32 s47, s42, 5
    s_min_u32 s48, s46, 4
    s_add_u32 s47, s47, s48
    s_lshl_b32 s48, s42, 2
    s_add_u32 s48, s48, s46
    s_add_u32 s48, s48, 86
    s_sub_u32 s49, s46, 4
    s_cmp_lt_u32 s49, 4
    s_cselect_b32 s47, s48, s47
    s_lshl_b32 s47, s47, 10
    s_add_u32 s33, s45, s47
    s_mov_b32 s34, 165888
    s_mov_b32 s35, 165888
    s_mov_b32 s36, 165888
    v_and_b32 v244, 63, v0
    v_lshlrev_b32 v22, 4, v244
    s_mov_b32 s68, 55296
    s_mov_b32 s69, 0
    s_cmp_ge_u32 s5, 272
    s_cbranch_scc1 PKW_11
    s_add_u32 s5, s5, 1024
    s_mul_hi_u32 s42, s5, 0x38e38e4
    s_mul_i32 s41, s42, 72
    s_sub_u32 s41, s5, s41
    s_mul_hi_u32 s45, s42, 0x55555556
    s_mul_i32 s46, s45, 3
    s_sub_u32 s46, s42, s46
    s_mul_i32 s45, s45, 96
    s_lshl_b32 s46, s46, 1
    s_add_u32 s45, s45, s46
    s_mul_i32 s45, s45, 9216
    s_lshl_b32 s46, s41, 7
    s_add_u32 s45, s45, s46
    v_and_b32 v244, 63, v0
    v_bfe_u32 v245, v244, 4, 1
    v_mul_u32_u24 v245, 48, v245
    v_lshrrev_b32 v246, 5, v244
    v_add_u32 v245, v245, v246
    v_mul_u32_u24 v245, 9216, v245
    v_bfe_u32 v246, v244, 2, 2
    v_lshlrev_b32 v246, 1, v246
    v_and_b32 v247, 1, v244
    v_add_u32 v246, v246, v247
    v_lshl_add_u32 v245, v246, 4, v245
    v_add_u32 v245, s45, v245
    v_and_b32 v246, 2, v244
    v_cmp_eq_u32 vcc, 0, v246
    v_mov_b32 v246, s78
    v_mov_b32 v247, s76
    v_cndmask_b32 v146, v246, v247, vcc
    v_mov_b32 v246, s79
    v_mov_b32 v247, s77
    v_cndmask_b32 v147, v246, v247, vcc
    v_mov_b32 v246, v245
    v_mov_b32 v247, 0
    v_lshl_add_u64 v[146:147], v[246:247], 0, v[146:147]
    s_mul_hi_u32 s45, s41, 0x1c71c71d
    s_mul_i32 s46, s45, 9
    s_sub_u32 s46, s41, s46
    s_mul_i32 s45, s45, 1327104
    s_mul_i32 s47, s42, 5
    s_min_u32 s48, s46, 4
    s_add_u32 s47, s47, s48
    s_lshl_b32 s48, s42, 2
    s_add_u32 s48, s48, s46
    s_add_u32 s48, s48, 86
    s_sub_u32 s49, s46, 4
    s_cmp_lt_u32 s49, 4
    s_cselect_b32 s47, s48, s47
    s_lshl_b32 s47, s47, 10
    s_add_u32 s52, s45, s47
    s_mov_b32 s53, 165888
    s_mov_b32 s54, 165888
    s_mov_b32 s55, 165888
    v_and_b32 v244, 63, v0
    v_lshlrev_b32 v23, 4, v244
    s_mov_b32 s70, 55296
    s_mov_b32 s71, 0
    s_mov_b32 s72, 55296
    s_mov_b32 s73, 0
    s_branch PKE_12
PKW_11:
    s_sub_u32 s5, s5, 272
    s_mul_hi_u32 s41, s5, 0x2aaaaaab
    s_mul_i32 s42, s41, 6
    s_sub_u32 s42, s5, s42
    s_mul_hi_u32 s43, s41, 0x1c71c71d
    s_mul_i32 s44, s43, 9
    s_sub_u32 s44, s41, s44
    s_and_b32 s41, s43, 1
    s_lshr_b32 s43, s43, 1
    s_and_b32 s45, s44, 1
    s_lshl_b32 s45, s45, 8
    s_lshr_b32 s46, s44, 1
    s_add_u32 s45, s45, s46
    s_cmp_lt_u32 s44, 8
    s_cselect_b32 s45, s45, 512
    s_mul_i32 s46, s43, 576
    s_add_u32 s45, s45, s46
    s_lshl_b32 s46, s41, 2
    s_add_u32 s45, s45, s46
    v_and_b32 v244, 63, v0
    v_and_b32 v245, 15, v244
    v_lshrrev_b32 v246, 4, v244
    s_cmp_lt_u32 s44, 8
    s_cselect_b32 s46, 4, 0
    v_lshlrev_b32 v247, s46, v246
    v_add_u32 v247, s45, v247
    v_mul_u32_u24 v247, 1152, v247
    v_mul_u32_u24 v248, 12, v245
    v_add_u32 v247, v247, v248
    s_mul_i32 s49, s42, 192
    v_add_u32 v246, s49, v247
    v_mov_b32 v247, 0
    v_lshl_add_u64 v[146:147], v[246:247], 0, s[80:81]
    s_mov_b32 s70, 9216
    s_mov_b32 s71, 0
    s_mov_b32 s72, 64512
    s_cmp_lt_u32 s44, 8
    s_cselect_b32 s72, s72, 9216
    s_mov_b32 s73, 0
    s_lshl_b32 s45, s43, 2
    s_and_b32 s46, s42, 1
    s_lshl_b32 s46, s46, 1
    s_add_u32 s45, s45, s46
    s_mul_i32 s45, s45, 165888
    s_mul_i32 s46, s41, 9
    s_add_u32 s46, s46, s44
    s_mul_i32 s46, s46, 9
    s_lshr_b32 s47, s42, 1
    s_mul_i32 s47, s47, 3
    s_add_u32 s46, s46, s47
    s_lshl_b32 s46, s46, 10
    s_add_u32 s45, s45, s46
    s_add_u32 s52, s45, 10616832
    s_movk_i32 s53, 1024
    s_mov_b32 s54, 163840
    s_mov_b32 s55, 0x40000000
    v_and_b32 v244, 63, v0
    v_lshlrev_b32 v23, 4, v244
PKE_12:
    s_waitcnt lgkmcnt(0)
    s_mul_i32 s63, s63, 0x9e3779b1
    s_add_u32 s63, s63, 0x7f4a7c15
    s_waitcnt vmcnt(0)
    s_barrier
    s_cmp_eq_u32 s61, 7
    s_cbranch_scc1 P1_V
    ds_read_b128 v[52:55], v89 offset:0
    ds_read_b64_tr_b16 v[64:65], v91 offset:0
    ds_read_b64_tr_b16 v[66:67], v91 offset:192
    ds_read_b64_tr_b16 v[76:77], v92
    ds_read_b64_tr_b16 v[78:79], v92 offset:192
    v_add_u32 v92, v92, v93
    ds_read_b128 v[56:59], v90 offset:0
    ds_read_b64_tr_b16 v[68:69], v91 offset:1536
    ds_read_b64_tr_b16 v[70:71], v91 offset:1728
    ds_read_b64_tr_b16 v[80:81], v92
    ds_read_b64_tr_b16 v[82:83], v92 offset:192
    v_add_u32 v92, v92, v93
    s_waitcnt lgkmcnt(5)
    v_mfma_f32_16x16x32_bf16 v[32:35], v[64:67], v[52:55], 0
    ds_read_b128 v[60:63], v89 offset:1024
    v_mfma_f32_16x16x32_bf16 v[36:39], v[76:79], v[52:55], 0
    ds_read_b64_tr_b16 v[72:73], v91 offset:3072
    ds_read_b64_tr_b16 v[74:75], v91 offset:3264
    v_mfma_f32_16x16x32_bf16 v[112:115], v[52:55], v[52:55], 0
    ds_read_b64_tr_b16 v[84:85], v92
    ds_read_b64_tr_b16 v[86:87], v92 offset:192
    v_mfma_f32_16x16x32_bf16 v[40:43], v[64:67], v[48:51], 0
    v_add_u32 v92, v92, v93
    v_mfma_f32_16x16x32_bf16 v[44:47], v[76:79], v[48:51], 0
    s_cmp_lg_u32 s62, 0
    s_cbranch_scc1 WQ8_13
    s_mov_b32 m0, 81920
    s_nop 0
    buffer_load_dwordx4 v128, s[12:15], s56 offen lds
WQ8_13:
    s_mov_b32 m0, s57
    s_add_u32 s57, s57, 9216
    buffer_load_dwordx4 v126, s[12:15], s56 offen lds
    s_waitcnt lgkmcnt(5)
    v_mfma_f32_16x16x32_bf16 v[32:35], v[68:71], v[56:59], v[32:35]
    ds_read_b128 v[52:55], v90 offset:1024
    v_mfma_f32_16x16x32_bf16 v[36:39], v[80:83], v[56:59], v[36:39]
    ds_read_b64_tr_b16 v[64:65], v91 offset:4608
    ds_read_b64_tr_b16 v[66:67], v91 offset:4800
    v_mfma_f32_16x16x32_bf16 v[112:115], v[56:59], v[56:59], v[112:115]
    ds_read_b64_tr_b16 v[76:77], v92
    ds_read_b64_tr_b16 v[78:79], v92 offset:192
    v_mfma_f32_16x16x32_bf16 v[40:43], v[68:71], v[48:51], v[40:43]
    v_add_u32 v92, v92, v93
    v_mfma_f32_16x16x32_bf16 v[44:47], v[80:83], v[48:51], v[44:47]
    buffer_load_dwordx4 v127, s[12:15], s56 offen offset:1024 lds
    s_add_u32 s56, s56, 73728
    s_waitcnt lgkmcnt(5)
    v_mfma_f32_16x16x32_bf16 v[32:35], v[72:75], v[60:63], v[32:35]
    ds_read_b128 v[56:59], v89 offset:2048
    v_mfma_f32_16x16x32_bf16 v[36:39], v[84:87], v[60:63], v[36:39]
    ds_read_b64_tr_b16 v[68:69], v91 offset:6144
    ds_read_b64_tr_b16 v[70:71], v91 offset:6336
    v_mfma_f32_16x16x32_bf16 v[112:115], v[60:63], v[60:63], v[112:115]
    ds_read_b64_tr_b16 v[80:81], v92
    ds_read_b64_tr_b16 v[82:83], v92 offset:192
    v_mfma_f32_16x16x32_bf16 v[40:43], v[72:75], v[48:51], v[40:43]
    v_add_u32 v92, v92, v93
    v_mfma_f32_16x16x32_bf16 v[44:47], v[84:87], v[48:51], v[44:47]
    s_cmp_lg_u32 s62, 1
    s_cbranch_scc1 WQ8_14
    s_mov_b32 m0, 91136
    s_nop 0
    buffer_load_dwordx4 v128, s[12:15], s56 offen lds
WQ8_14:
    s_mov_b32 m0, s57
    s_add_u32 s57, s57, 9216
    buffer_load_dwordx4 v126, s[12:15], s56 offen lds
    s_waitcnt lgkmcnt(5)
    v_mfma_f32_16x16x32_bf16 v[32:35], v[64:67], v[52:55], v[32:35]
    ds_read_b128 v[60:63], v90 offset:2048
    v_mfma_f32_16x16x32_bf16 v[36:39], v[76:79], v[52:55], v[36:39]
    ds_read_b64_tr_b16 v[72:73], v91 offset:7680
    ds_read_b64_tr_b16 v[74:75], v91 offset:7872
    v_mfma_f32_16x16x32_bf16 v[112:115], v[52:55], v[52:55], v[112:115]
    ds_read_b64_tr_b16 v[84:85], v92
    ds_read_b64_tr_b16 v[86:87], v92 offset:192
    v_mfma_f32_16x16x32_bf16 v[40:43], v[64:67], v[48:51], v[40:43]
    v_add_u32 v92, v92, v93
    v_mfma_f32_16x16x32_bf16 v[44:47], v[76:79], v[48:51], v[44:47]
    buffer_load_dwordx4 v127, s[12:15], s56 offen offset:1024 lds
    s_add_u32 s56, s56, 73728
    s_waitcnt lgkmcnt(5)
    v_mfma_f32_16x16x32_bf16 v[32:35], v[68:71], v[56:59], v[32:35]
    ds_read_b128 v[52:55], v89 offset:3072
    v_mfma_f32_16x16x32_bf16 v[36:39], v[80:83], v[56:59], v[36:39]
    ds_read_b64_tr_b16 v[64:65], v91 offset:9216
    ds_read_b64_tr_b16 v[66:67], v91 offset:9408
    v_mfma_f32_16x16x32_bf16 v[112:115], v[56:59], v[56:59], v[112:115]
    ds_read_b64_tr_b16 v[76:77], v92
    ds_read_b64_tr_b16 v[78:79], v92 offset:192
    v_mfma_f32_16x16x32_bf16 v[40:43], v[68:71], v[48:51], v[40:43]
    v_add_u32 v92, v92, v93
    v_mfma_f32_16x16x32_bf16 v[44:47], v[80:83], v[48:51], v[44:47]
    s_cmp_lg_u32 s62, 2
    s_cbranch_scc1 WQ8_15
    s_mov_b32 m0, 100352
    s_nop 0
    buffer_load_dwordx4 v128, s[12:15], s56 offen lds
WQ8_15:
    s_mov_b32 m0, s57
    s_add_u32 s57, s57, 9216
    buffer_load_dwordx4 v126, s[12:15], s56 offen lds
    s_waitcnt lgkmcnt(5)
    v_mfma_f32_16x16x32_bf16 v[32:35], v[72:75], v[60:63], v[32:35]
    ds_read_b128 v[56:59], v90 offset:3072
    v_mfma_f32_16x16x32_bf16 v[36:39], v[84:87], v[60:63], v[36:39]
    ds_read_b64_tr_b16 v[68:69], v91 offset:10752
    ds_read_b64_tr_b16 v[70:71], v91 offset:10944
    v_mfma_f32_16x16x32_bf16 v[112:115], v[60:63], v[60:63], v[112:115]
    ds_read_b64_tr_b16 v[80:81], v92
    ds_read_b64_tr_b16 v[82:83], v92 offset:192
    v_mfma_f32_16x16x32_bf16 v[40:43], v[72:75], v[48:51], v[40:43]
    v_add_u32 v92, v92, v93
    v_mfma_f32_16x16x32_bf16 v[44:47], v[84:87], v[48:51], v[44:47]
    buffer_load_dwordx4 v127, s[12:15], s56 offen offset:1024 lds
    s_add_u32 s56, s56, 73728
    s_waitcnt lgkmcnt(5)
    v_mfma_f32_16x16x32_bf16 v[32:35], v[64:67], v[52:55], v[32:35]
    ds_read_b128 v[60:63], v89 offset:4096
    v_mfma_f32_16x16x32_bf16 v[36:39], v[76:79], v[52:55], v[36:39]
    ds_read_b64_tr_b16 v[72:73], v91 offset:12288
    ds_read_b64_tr_b16 v[74:75], v91 offset:12480
    v_mfma_f32_16x16x32_bf16 v[112:115], v[52:55], v[52:55], v[112:115]
    ds_read_b64_tr_b16 v[84:85], v92
    ds_read_b64_tr_b16 v[86:87], v92 offset:192
    v_mfma_f32_16x16x32_bf16 v[40:43], v[64:67], v[48:51], v[40:43]
    v_add_u32 v92, v92, v93
    v_mfma_f32_16x16x32_bf16 v[44:47], v[76:79], v[48:51], v[44:47]
    s_cmp_lg_u32 s62, 3
    s_cbranch_scc1 WQ8_16
    s_mov_b32 m0, 109568
    s_nop 0
    buffer_load_dwordx4 v128, s[12:15], s56 offen lds
WQ8_16:
    s_mov_b32 m0, s57
    s_add_u32 s57, s57, 9216
    buffer_load_dwordx4 v126, s[12:15], s56 offen lds
    s_waitcnt lgkmcnt(5)
    v_mfma_f32_16x16x32_bf16 v[32:35], v[68:71], v[56:59], v[32:35]
    ds_read_b128 v[52:55], v90 offset:4096
    v_mfma_f32_16x16x32_bf16 v[36:39], v[80:83], v[56:59], v[36:39]
    ds_read_b64_tr_b16 v[64:65], v91 offset:13824
    ds_read_b64_tr_b16 v[66:67], v91 offset:14016
    v_mfma_f32_16x16x32_bf16 v[112:115], v[56:59], v[56:59], v[112:115]
    ds_read_b64_tr_b16 v[76:77], v92
    ds_read_b64_tr_b16 v[78:79], v92 offset:192
    v_mfma_f32_16x16x32_bf16 v[40:43], v[68:71], v[48:51], v[40:43]
    v_add_u32 v92, v92, v93
    v_mfma_f32_16x16x32_bf16 v[44:47], v[80:83], v[48:51], v[44:47]
    buffer_load_dwordx4 v127, s[12:15], s56 offen offset:1024 lds
    s_add_u32 s56, s56, 73728
    s_waitcnt lgkmcnt(5)
    v_mfma_f32_16x16x32_bf16 v[32:35], v[72:75], v[60:63], v[32:35]
    ds_read_b128 v[56:59], v89 offset:5120
    v_mfma_f32_16x16x32_bf16 v[36:39], v[84:87], v[60:63], v[36:39]
    ds_read_b64_tr_b16 v[68:69], v91 offset:15360
    ds_read_b64_tr_b16 v[70:71], v91 offset:15552
    v_mfma_f32_16x16x32_bf16 v[112:115], v[60:63], v[60:63], v[112:115]
    ds_read_b64_tr_b16 v[80:81], v92
    ds_read_b64_tr_b16 v[82:83], v92 offset:192
    v_mfma_f32_16x16x32_bf16 v[40:43], v[72:75], v[48:51], v[40:43]
    v_add_u32 v92, v92, v93
    v_mfma_f32_16x16x32_bf16 v[44:47], v[84:87], v[48:51], v[44:47]
    s_waitcnt lgkmcnt(5)
    v_mfma_f32_16x16x32_bf16 v[32:35], v[64:67], v[52:55], v[32:35]
    ds_read_b128 v[60:63], v90 offset:5120
    v_mfma_f32_16x16x32_bf16 v[36:39], v[76:79], v[52:55], v[36:39]
    ds_read_b64_tr_b16 v[72:73], v91 offset:16896
    ds_read_b64_tr_b16 v[74:75], v91 offset:17088
    v_mfma_f32_16x16x32_bf16 v[112:115], v[52:55], v[52:55], v[112:115]
    ds_read_b64_tr_b16 v[84:85], v92
    ds_read_b64_tr_b16 v[86:87], v92 offset:192
    v_mfma_f32_16x16x32_bf16 v[40:43], v[64:67], v[48:51], v[40:43]
    v_add_u32 v92, v92, v93
    v_mfma_f32_16x16x32_bf16 v[44:47], v[76:79], v[48:51], v[44:47]
    s_waitcnt lgkmcnt(5)
    v_mfma_f32_16x16x32_bf16 v[32:35], v[68:71], v[56:59], v[32:35]
    ds_read_b128 v[52:55], v89 offset:6144
    v_mfma_f32_16x16x32_bf16 v[36:39], v[80:83], v[56:59], v[36:39]
    ds_read_b64_tr_b16 v[64:65], v91 offset:18432
    ds_read_b64_tr_b16 v[66:67], v91 offset:18624
    v_mfma_f32_16x16x32_bf16 v[112:115], v[56:59], v[56:59], v[112:115]
    ds_read_b64_tr_b16 v[76:77], v92
    ds_read_b64_tr_b16 v[78:79], v92 offset:192
    v_mfma_f32_16x16x32_bf16 v[40:43], v[68:71], v[48:51], v[40:43]
    v_add_u32 v92, v92, v93
    v_mfma_f32_16x16x32_bf16 v[44:47], v[80:83], v[48:51], v[44:47]
    s_waitcnt lgkmcnt(5)
    v_mfma_f32_16x16x32_bf16 v[32:35], v[72:75], v[60:63], v[32:35]
    ds_read_b128 v[56:59], v90 offset:6144
    v_mfma_f32_16x16x32_bf16 v[36:39], v[84:87], v[60:63], v[36:39]
    ds_read_b64_tr_b16 v[68:69], v91 offset:19968
    ds_read_b64_tr_b16 v[70:71], v91 offset:20160
    v_mfma_f32_16x16x32_bf16 v[112:115], v[60:63], v[60:63], v[112:115]
    ds_read_b64_tr_b16 v[80:81], v92
    ds_read_b64_tr_b16 v[82:83], v92 offset:192
    v_mfma_f32_16x16x32_bf16 v[40:43], v[72:75], v[48:51], v[40:43]
    v_add_u32 v92, v92, v93
    v_mfma_f32_16x16x32_bf16 v[44:47], v[84:87], v[48:51], v[44:47]
    s_waitcnt lgkmcnt(5)
    v_mfma_f32_16x16x32_bf16 v[32:35], v[64:67], v[52:55], v[32:35]
    ds_read_b128 v[60:63], v89 offset:7168
    v_mfma_f32_16x16x32_bf16 v[36:39], v[76:79], v[52:55], v[36:39]
    ds_read_b64_tr_b16 v[72:73], v91 offset:21504
    ds_read_b64_tr_b16 v[74:75], v91 offset:21696
    v_mfma_f32_16x16x32_bf16 v[112:115], v[52:55], v[52:55], v[112:115]
    ds_read_b64_tr_b16 v[84:85], v92
    ds_read_b64_tr_b16 v[86:87], v92 offset:192
    v_mfma_f32_16x16x32_bf16 v[40:43], v[64:67], v[48:51], v[40:43]
    v_add_u32 v92, v92, v93
    v_mfma_f32_16x16x32_bf16 v[44:47], v[76:79], v[48:51], v[44:47]
    s_waitcnt lgkmcnt(5)
    v_mfma_f32_16x16x32_bf16 v[32:35], v[68:71], v[56:59], v[32:35]
    ds_read_b128 v[52:55], v90 offset:7168
    v_mfma_f32_16x16x32_bf16 v[36:39], v[80:83], v[56:59], v[36:39]
    ds_read_b64_tr_b16 v[64:65], v91 offset:23040
    ds_read_b64_tr_b16 v[66:67], v91 offset:23232
    v_mfma_f32_16x16x32_bf16 v[112:115], v[56:59], v[56:59], v[112:115]
    ds_read_b64_tr_b16 v[76:77], v92
    ds_read_b64_tr_b16 v[78:79], v92 offset:192
    v_mfma_f32_16x16x32_bf16 v[40:43], v[68:71], v[48:51], v[40:43]
    v_add_u32 v92, v92, v93
    v_mfma_f32_16x16x32_bf16 v[44:47], v[80:83], v[48:51], v[44:47]
    s_waitcnt lgkmcnt(5)
    v_mfma_f32_16x16x32_bf16 v[32:35], v[72:75], v[60:63], v[32:35]
    ds_read_b128 v[56:59], v89 offset:8192
    v_mfma_f32_16x16x32_bf16 v[36:39], v[84:87], v[60:63], v[36:39]
    ds_read_b64_tr_b16 v[68:69], v91 offset:24576
    ds_read_b64_tr_b16 v[70:71], v91 offset:24768
    v_mfma_f32_16x16x32_bf16 v[112:115], v[60:63], v[60:63], v[112:115]
    ds_read_b64_tr_b16 v[80:81], v92
    ds_read_b64_tr_b16 v[82:83], v92 offset:192
    v_mfma_f32_16x16x32_bf16 v[40:43], v[72:75], v[48:51], v[40:43]
    v_add_u32 v92, v92, v93
    v_mfma_f32_16x16x32_bf16 v[44:47], v[84:87], v[48:51], v[44:47]
    s_waitcnt lgkmcnt(5)
    v_mfma_f32_16x16x32_bf16 v[32:35], v[64:67], v[52:55], v[32:35]
    ds_read_b128 v[60:63], v90 offset:8192
    v_mfma_f32_16x16x32_bf16 v[36:39], v[76:79], v[52:55], v[36:39]
    ds_read_b64_tr_b16 v[72:73], v91 offset:26112
    ds_read_b64_tr_b16 v[74:75], v91 offset:26304
    v_mfma_f32_16x16x32_bf16 v[112:115], v[52:55], v[52:55], v[112:115]
    ds_read_b64_tr_b16 v[84:85], v92
    ds_read_b64_tr_b16 v[86:87], v92 offset:192
    v_mfma_f32_16x16x32_bf16 v[40:43], v[64:67], v[48:51], v[40:43]
    v_add_u32 v92, v92, v93
    v_mfma_f32_16x16x32_bf16 v[44:47], v[76:79], v[48:51], v[44:47]
    s_waitcnt lgkmcnt(5)
    v_mfma_f32_16x16x32_bf16 v[32:35], v[68:71], v[56:59], v[32:35]
    v_mfma_f32_16x16x32_bf16 v[36:39], v[80:83], v[56:59], v[36:39]
    v_mfma_f32_16x16x32_bf16 v[112:115], v[56:59], v[56:59], v[112:115]
    v_mfma_f32_16x16x32_bf16 v[40:43], v[68:71], v[48:51], v[40:43]
    v_mfma_f32_16x16x32_bf16 v[44:47], v[80:83], v[48:51], v[44:47]
    s_waitcnt lgkmcnt(0)
    v_mfma_f32_16x16x32_bf16 v[32:35], v[72:75], v[60:63], v[32:35]
    v_mfma_f32_16x16x32_bf16 v[36:39], v[84:87], v[60:63], v[36:39]
    v_mfma_f32_16x16x32_bf16 v[112:115], v[60:63], v[60:63], v[112:115]
    v_mfma_f32_16x16x32_bf16 v[40:43], v[72:75], v[48:51], v[40:43]
    v_mfma_f32_16x16x32_bf16 v[44:47], v[84:87], v[48:51], v[44:47]
    v_and_b32 v5, 3, v1
    s_nop 4
    v_mov_b32 v88, v112
    v_cmp_eq_u32 vcc, 1, v5
    s_nop 1
    v_cndmask_b32 v88, v88, v113, vcc
    v_cmp_eq_u32 vcc, 2, v5
    s_nop 1
    v_cndmask_b32 v88, v88, v114, vcc
    v_cmp_eq_u32 vcc, 3, v5
    s_nop 1
    v_cndmask_b32 v88, v88, v115, vcc
    v_lshrrev_b32 v5, 2, v3
    v_cmp_eq_u32 vcc, v5, v4
    s_nop 1
    v_cndmask_b32 v88, 0, v88, vcc
    v_mov_b32 v5, v88
    s_nop 1
    v_permlane16_swap_b32 v88, v5
    v_add_f32 v88, v88, v5
    v_mov_b32 v5, v88
    s_nop 1
    v_permlane32_swap_b32 v88, v5
    v_add_f32 v88, v88, v5
    v_mov_b32 v5, v36
    v_mov_b32 v6, v36
    s_nop 1
    v_permlane32_swap_b32 v5, v6
    s_mov_b32 s59, 987991609
    v_mul_f32 v98, s59, v6
    v_mul_f32 v99, s59, v88
    v_fma_f32 v99, -v98, v98, v99
    v_max_f32 v99, 0, v99
    v_add_f32 v99, 925353388, v99
    v_rsq_f32 v99, v99
    buffer_store_dwordx2 v[98:99], v136, s[16:19], 0 offen sc1
    v_fma_f32 v32, -v98, v40, v32
    v_fma_f32 v33, -v98, v41, v33
    v_fma_f32 v34, -v98, v42, v34
    v_fma_f32 v35, -v98, v43, v35
    v_fma_f32 v36, -v98, v44, v36
    v_fma_f32 v37, -v98, v45, v37
    v_mul_f32 v32, v99, v32
    v_mul_f32 v33, v99, v33
    v_mul_f32 v34, v99, v34
    v_mul_f32 v35, v99, v35
    v_mul_f32 v36, v99, v36
    v_mul_f32 v37, v99, v37
    v_cvt_pk_bf16_f32 v10, v32, v33
    v_cvt_pk_bf16_f32 v11, v34, v35
    v_cvt_pk_bf16_f32 v12, v36, v37
    buffer_store_dwordx2 v[10:11], v134, s[20:23], 0 offen sc1
    buffer_store_dword v12, v135, s[20:23], 0 offen sc1
    v_cmp_eq_u32 vcc, 0, v4
    v_mul_f32 v9, v36, v36
    v_fma_f32 v9, v37, v37, v9
    v_cndmask_b32 v9, 0, v9, vcc
    v_fma_f32 v9, v32, v32, v9
    v_fma_f32 v9, v33, v33, v9
    v_fma_f32 v9, v34, v34, v9
    v_fma_f32 v9, v35, v35, v9
    v_mov_b32 v5, v9
    s_nop 1
    v_permlane16_swap_b32 v9, v5
    v_add_f32 v9, v9, v5
    v_mov_b32 v5, v9
    s_nop 1
    v_permlane32_swap_b32 v9, v5
    v_add_f32 v9, v9, v5
    s_nop 1
    v_mov_b32_dpp v5, v9 row_ror:8 row_mask:0xf bank_mask:0xf
    v_max_f32 v9, v9, v5
    s_nop 1
    v_mov_b32_dpp v5, v9 row_ror:4 row_mask:0xf bank_mask:0xf
    v_max_f32 v9, v9, v5
    s_nop 1
    v_mov_b32_dpp v5, v9 row_ror:2 row_mask:0xf bank_mask:0xf
    v_max_f32 v9, v9, v5
    s_nop 1
    v_mov_b32_dpp v5, v9 row_ror:1 row_mask:0xf bank_mask:0xf
    v_max_f32 v9, v9, v5
    buffer_store_dword v9, v139, s[24:27], 0 offen offset:0 sc1
    s_branch P1_KVD
P1_V:
    ds_read_b128 v[52:55], v89 offset:0
    ds_read_b64_tr_b16 v[64:65], v91 offset:0
    ds_read_b64_tr_b16 v[66:67], v91 offset:192
    ds_read_b64_tr_b16 v[76:77], v92
    ds_read_b64_tr_b16 v[78:79], v92 offset:192
    v_add_u32 v92, v92, v93
    ds_read_b128 v[56:59], v90 offset:0
    ds_read_b64_tr_b16 v[68:69], v91 offset:1536
    ds_read_b64_tr_b16 v[70:71], v91 offset:1728
    ds_read_b64_tr_b16 v[80:81], v92
    ds_read_b64_tr_b16 v[82:83], v92 offset:192
    v_add_u32 v92, v92, v93
    s_waitcnt lgkmcnt(5)
    v_mfma_f32_16x16x32_bf16 v[32:35], v[52:55], v[64:67], 0
    ds_read_b128 v[60:63], v89 offset:1024
    v_mfma_f32_16x16x32_bf16 v[36:39], v[52:55], v[76:79], 0
    ds_read_b64_tr_b16 v[72:73], v91 offset:3072
    ds_read_b64_tr_b16 v[74:75], v91 offset:3264
    v_mfma_f32_16x16x32_bf16 v[112:115], v[52:55], v[52:55], 0
    ds_read_b64_tr_b16 v[84:85], v92
    ds_read_b64_tr_b16 v[86:87], v92 offset:192
    v_mfma_f32_16x16x32_bf16 v[40:43], v[48:51], v[64:67], 0
    v_add_u32 v92, v92, v93
    v_mfma_f32_16x16x32_bf16 v[44:47], v[48:51], v[76:79], 0
    s_cmp_lg_u32 s62, 0
    s_cbranch_scc1 WQ8_17
    s_mov_b32 m0, 81920
    s_nop 0
    buffer_load_dwordx4 v128, s[12:15], s56 offen lds
WQ8_17:
    s_mov_b32 m0, s57
    s_add_u32 s57, s57, 9216
    buffer_load_dwordx4 v126, s[12:15], s56 offen lds
    s_waitcnt lgkmcnt(5)
    v_mfma_f32_16x16x32_bf16 v[32:35], v[56:59], v[68:71], v[32:35]
    ds_read_b128 v[52:55], v90 offset:1024
    v_mfma_f32_16x16x32_bf16 v[36:39], v[56:59], v[80:83], v[36:39]
    ds_read_b64_tr_b16 v[64:65], v91 offset:4608
    ds_read_b64_tr_b16 v[66:67], v91 offset:4800
    v_mfma_f32_16x16x32_bf16 v[112:115], v[56:59], v[56:59], v[112:115]
    ds_read_b64_tr_b16 v[76:77], v92
    ds_read_b64_tr_b16 v[78:79], v92 offset:192
    v_mfma_f32_16x16x32_bf16 v[40:43], v[48:51], v[68:71], v[40:43]
    v_add_u32 v92, v92, v93
    v_mfma_f32_16x16x32_bf16 v[44:47], v[48:51], v[80:83], v[44:47]
    buffer_load_dwordx4 v127, s[12:15], s56 offen offset:1024 lds
    s_add_u32 s56, s56, 73728
    s_waitcnt lgkmcnt(5)
    v_mfma_f32_16x16x32_bf16 v[32:35], v[60:63], v[72:75], v[32:35]
    ds_read_b128 v[56:59], v89 offset:2048
    v_mfma_f32_16x16x32_bf16 v[36:39], v[60:63], v[84:87], v[36:39]
    ds_read_b64_tr_b16 v[68:69], v91 offset:6144
    ds_read_b64_tr_b16 v[70:71], v91 offset:6336
    v_mfma_f32_16x16x32_bf16 v[112:115], v[60:63], v[60:63], v[112:115]
    ds_read_b64_tr_b16 v[80:81], v92
    ds_read_b64_tr_b16 v[82:83], v92 offset:192
    v_mfma_f32_16x16x32_bf16 v[40:43], v[48:51], v[72:75], v[40:43]
    v_add_u32 v92, v92, v93
    v_mfma_f32_16x16x32_bf16 v[44:47], v[48:51], v[84:87], v[44:47]
    s_cmp_lg_u32 s62, 1
    s_cbranch_scc1 WQ8_18
    s_mov_b32 m0, 91136
    s_nop 0
    buffer_load_dwordx4 v128, s[12:15], s56 offen lds
WQ8_18:
    s_mov_b32 m0, s57
    s_add_u32 s57, s57, 9216
    buffer_load_dwordx4 v126, s[12:15], s56 offen lds
    s_waitcnt lgkmcnt(5)
    v_mfma_f32_16x16x32_bf16 v[32:35], v[52:55], v[64:67], v[32:35]
    ds_read_b128 v[60:63], v90 offset:2048
    v_mfma_f32_16x16x32_bf16 v[36:39], v[52:55], v[76:79], v[36:39]
    ds_read_b64_tr_b16 v[72:73], v91 offset:7680
    ds_read_b64_tr_b16 v[74:75], v91 offset:7872
    v_mfma_f32_16x16x32_bf16 v[112:115], v[52:55], v[52:55], v[112:115]
    ds_read_b64_tr_b16 v[84:85], v92
    ds_read_b64_tr_b16 v[86:87], v92 offset:192
    v_mfma_f32_16x16x32_bf16 v[40:43], v[48:51], v[64:67], v[40:43]
    v_add_u32 v92, v92, v93
    v_mfma_f32_16x16x32_bf16 v[44:47], v[48:51], v[76:79], v[44:47]
    buffer_load_dwordx4 v127, s[12:15], s56 offen offset:1024 lds
    s_add_u32 s56, s56, 73728
    s_waitcnt lgkmcnt(5)
    v_mfma_f32_16x16x32_bf16 v[32:35], v[56:59], v[68:71], v[32:35]
    ds_read_b128 v[52:55], v89 offset:3072
    v_mfma_f32_16x16x32_bf16 v[36:39], v[56:59], v[80:83], v[36:39]
    ds_read_b64_tr_b16 v[64:65], v91 offset:9216
    ds_read_b64_tr_b16 v[66:67], v91 offset:9408
    v_mfma_f32_16x16x32_bf16 v[112:115], v[56:59], v[56:59], v[112:115]
    ds_read_b64_tr_b16 v[76:77], v92
    ds_read_b64_tr_b16 v[78:79], v92 offset:192
    v_mfma_f32_16x16x32_bf16 v[40:43], v[48:51], v[68:71], v[40:43]
    v_add_u32 v92, v92, v93
    v_mfma_f32_16x16x32_bf16 v[44:47], v[48:51], v[80:83], v[44:47]
    s_cmp_lg_u32 s62, 2
    s_cbranch_scc1 WQ8_19
    s_mov_b32 m0, 100352
    s_nop 0
    buffer_load_dwordx4 v128, s[12:15], s56 offen lds
WQ8_19:
    s_mov_b32 m0, s57
    s_add_u32 s57, s57, 9216
    buffer_load_dwordx4 v126, s[12:15], s56 offen lds
    s_waitcnt lgkmcnt(5)
    v_mfma_f32_16x16x32_bf16 v[32:35], v[60:63], v[72:75], v[32:35]
    ds_read_b128 v[56:59], v90 offset:3072
    v_mfma_f32_16x16x32_bf16 v[36:39], v[60:63], v[84:87], v[36:39]
    ds_read_b64_tr_b16 v[68:69], v91 offset:10752
    ds_read_b64_tr_b16 v[70:71], v91 offset:10944
    v_mfma_f32_16x16x32_bf16 v[112:115], v[60:63], v[60:63], v[112:115]
    ds_read_b64_tr_b16 v[80:81], v92
    ds_read_b64_tr_b16 v[82:83], v92 offset:192
    v_mfma_f32_16x16x32_bf16 v[40:43], v[48:51], v[72:75], v[40:43]
    v_add_u32 v92, v92, v93
    v_mfma_f32_16x16x32_bf16 v[44:47], v[48:51], v[84:87], v[44:47]
    buffer_load_dwordx4 v127, s[12:15], s56 offen offset:1024 lds
    s_add_u32 s56, s56, 73728
    s_waitcnt lgkmcnt(5)
    v_mfma_f32_16x16x32_bf16 v[32:35], v[52:55], v[64:67], v[32:35]
    ds_read_b128 v[60:63], v89 offset:4096
    v_mfma_f32_16x16x32_bf16 v[36:39], v[52:55], v[76:79], v[36:39]
    ds_read_b64_tr_b16 v[72:73], v91 offset:12288
    ds_read_b64_tr_b16 v[74:75], v91 offset:12480
    v_mfma_f32_16x16x32_bf16 v[112:115], v[52:55], v[52:55], v[112:115]
    ds_read_b64_tr_b16 v[84:85], v92
    ds_read_b64_tr_b16 v[86:87], v92 offset:192
    v_mfma_f32_16x16x32_bf16 v[40:43], v[48:51], v[64:67], v[40:43]
    v_add_u32 v92, v92, v93
    v_mfma_f32_16x16x32_bf16 v[44:47], v[48:51], v[76:79], v[44:47]
    s_cmp_lg_u32 s62, 3
    s_cbranch_scc1 WQ8_20
    s_mov_b32 m0, 109568
    s_nop 0
    buffer_load_dwordx4 v128, s[12:15], s56 offen lds
WQ8_20:
    s_mov_b32 m0, s57
    s_add_u32 s57, s57, 9216
    buffer_load_dwordx4 v126, s[12:15], s56 offen lds
    s_waitcnt lgkmcnt(5)
    v_mfma_f32_16x16x32_bf16 v[32:35], v[56:59], v[68:71], v[32:35]
    ds_read_b128 v[52:55], v90 offset:4096
    v_mfma_f32_16x16x32_bf16 v[36:39], v[56:59], v[80:83], v[36:39]
    ds_read_b64_tr_b16 v[64:65], v91 offset:13824
    ds_read_b64_tr_b16 v[66:67], v91 offset:14016
    v_mfma_f32_16x16x32_bf16 v[112:115], v[56:59], v[56:59], v[112:115]
    ds_read_b64_tr_b16 v[76:77], v92
    ds_read_b64_tr_b16 v[78:79], v92 offset:192
    v_mfma_f32_16x16x32_bf16 v[40:43], v[48:51], v[68:71], v[40:43]
    v_add_u32 v92, v92, v93
    v_mfma_f32_16x16x32_bf16 v[44:47], v[48:51], v[80:83], v[44:47]
    buffer_load_dwordx4 v127, s[12:15], s56 offen offset:1024 lds
    s_add_u32 s56, s56, 73728
    s_waitcnt lgkmcnt(5)
    v_mfma_f32_16x16x32_bf16 v[32:35], v[60:63], v[72:75], v[32:35]
    ds_read_b128 v[56:59], v89 offset:5120
    v_mfma_f32_16x16x32_bf16 v[36:39], v[60:63], v[84:87], v[36:39]
    ds_read_b64_tr_b16 v[68:69], v91 offset:15360
    ds_read_b64_tr_b16 v[70:71], v91 offset:15552
    v_mfma_f32_16x16x32_bf16 v[112:115], v[60:63], v[60:63], v[112:115]
    ds_read_b64_tr_b16 v[80:81], v92
    ds_read_b64_tr_b16 v[82:83], v92 offset:192
    v_mfma_f32_16x16x32_bf16 v[40:43], v[48:51], v[72:75], v[40:43]
    v_add_u32 v92, v92, v93
    v_mfma_f32_16x16x32_bf16 v[44:47], v[48:51], v[84:87], v[44:47]
    s_waitcnt lgkmcnt(5)
    v_mfma_f32_16x16x32_bf16 v[32:35], v[52:55], v[64:67], v[32:35]
    ds_read_b128 v[60:63], v90 offset:5120
    v_mfma_f32_16x16x32_bf16 v[36:39], v[52:55], v[76:79], v[36:39]
    ds_read_b64_tr_b16 v[72:73], v91 offset:16896
    ds_read_b64_tr_b16 v[74:75], v91 offset:17088
    v_mfma_f32_16x16x32_bf16 v[112:115], v[52:55], v[52:55], v[112:115]
    ds_read_b64_tr_b16 v[84:85], v92
    ds_read_b64_tr_b16 v[86:87], v92 offset:192
    v_mfma_f32_16x16x32_bf16 v[40:43], v[48:51], v[64:67], v[40:43]
    v_add_u32 v92, v92, v93
    v_mfma_f32_16x16x32_bf16 v[44:47], v[48:51], v[76:79], v[44:47]
    s_waitcnt lgkmcnt(5)
    v_mfma_f32_16x16x32_bf16 v[32:35], v[56:59], v[68:71], v[32:35]
    ds_read_b128 v[52:55], v89 offset:6144
    v_mfma_f32_16x16x32_bf16 v[36:39], v[56:59], v[80:83], v[36:39]
    ds_read_b64_tr_b16 v[64:65], v91 offset:18432
    ds_read_b64_tr_b16 v[66:67], v91 offset:18624
    v_mfma_f32_16x16x32_bf16 v[112:115], v[56:59], v[56:59], v[112:115]
    ds_read_b64_tr_b16 v[76:77], v92
    ds_read_b64_tr_b16 v[78:79], v92 offset:192
    v_mfma_f32_16x16x32_bf16 v[40:43], v[48:51], v[68:71], v[40:43]
    v_add_u32 v92, v92, v93
    v_mfma_f32_16x16x32_bf16 v[44:47], v[48:51], v[80:83], v[44:47]
    s_waitcnt lgkmcnt(5)
    v_mfma_f32_16x16x32_bf16 v[32:35], v[60:63], v[72:75], v[32:35]
    ds_read_b128 v[56:59], v90 offset:6144
    v_mfma_f32_16x16x32_bf16 v[36:39], v[60:63], v[84:87], v[36:39]
    ds_read_b64_tr_b16 v[68:69], v91 offset:19968
    ds_read_b64_tr_b16 v[70:71], v91 offset:20160
    v_mfma_f32_16x16x32_bf16 v[112:115], v[60:63], v[60:63], v[112:115]
    ds_read_b64_tr_b16 v[80:81], v92
    ds_read_b64_tr_b16 v[82:83], v92 offset:192
    v_mfma_f32_16x16x32_bf16 v[40:43], v[48:51], v[72:75], v[40:43]
    v_add_u32 v92, v92, v93
    v_mfma_f32_16x16x32_bf16 v[44:47], v[48:51], v[84:87], v[44:47]
    s_waitcnt lgkmcnt(5)
    v_mfma_f32_16x16x32_bf16 v[32:35], v[52:55], v[64:67], v[32:35]
    ds_read_b128 v[60:63], v89 offset:7168
    v_mfma_f32_16x16x32_bf16 v[36:39], v[52:55], v[76:79], v[36:39]
    ds_read_b64_tr_b16 v[72:73], v91 offset:21504
    ds_read_b64_tr_b16 v[74:75], v91 offset:21696
    v_mfma_f32_16x16x32_bf16 v[112:115], v[52:55], v[52:55], v[112:115]
    ds_read_b64_tr_b16 v[84:85], v92
    ds_read_b64_tr_b16 v[86:87], v92 offset:192
    v_mfma_f32_16x16x32_bf16 v[40:43], v[48:51], v[64:67], v[40:43]
    v_add_u32 v92, v92, v93
    v_mfma_f32_16x16x32_bf16 v[44:47], v[48:51], v[76:79], v[44:47]
    s_waitcnt lgkmcnt(5)
    v_mfma_f32_16x16x32_bf16 v[32:35], v[56:59], v[68:71], v[32:35]
    ds_read_b128 v[52:55], v90 offset:7168
    v_mfma_f32_16x16x32_bf16 v[36:39], v[56:59], v[80:83], v[36:39]
    ds_read_b64_tr_b16 v[64:65], v91 offset:23040
    ds_read_b64_tr_b16 v[66:67], v91 offset:23232
    v_mfma_f32_16x16x32_bf16 v[112:115], v[56:59], v[56:59], v[112:115]
    ds_read_b64_tr_b16 v[76:77], v92
    ds_read_b64_tr_b16 v[78:79], v92 offset:192
    v_mfma_f32_16x16x32_bf16 v[40:43], v[48:51], v[68:71], v[40:43]
    v_add_u32 v92, v92, v93
    v_mfma_f32_16x16x32_bf16 v[44:47], v[48:51], v[80:83], v[44:47]
    s_waitcnt lgkmcnt(5)
    v_mfma_f32_16x16x32_bf16 v[32:35], v[60:63], v[72:75], v[32:35]
    ds_read_b128 v[56:59], v89 offset:8192
    v_mfma_f32_16x16x32_bf16 v[36:39], v[60:63], v[84:87], v[36:39]
    ds_read_b64_tr_b16 v[68:69], v91 offset:24576
    ds_read_b64_tr_b16 v[70:71], v91 offset:24768
    v_mfma_f32_16x16x32_bf16 v[112:115], v[60:63], v[60:63], v[112:115]
    ds_read_b64_tr_b16 v[80:81], v92
    ds_read_b64_tr_b16 v[82:83], v92 offset:192
    v_mfma_f32_16x16x32_bf16 v[40:43], v[48:51], v[72:75], v[40:43]
    v_add_u32 v92, v92, v93
    v_mfma_f32_16x16x32_bf16 v[44:47], v[48:51], v[84:87], v[44:47]
    s_waitcnt lgkmcnt(5)
    v_mfma_f32_16x16x32_bf16 v[32:35], v[52:55], v[64:67], v[32:35]
    ds_read_b128 v[60:63], v90 offset:8192
    v_mfma_f32_16x16x32_bf16 v[36:39], v[52:55], v[76:79], v[36:39]
    ds_read_b64_tr_b16 v[72:73], v91 offset:26112
    ds_read_b64_tr_b16 v[74:75], v91 offset:26304
    v_mfma_f32_16x16x32_bf16 v[112:115], v[52:55], v[52:55], v[112:115]
    ds_read_b64_tr_b16 v[84:85], v92
    ds_read_b64_tr_b16 v[86:87], v92 offset:192
    v_mfma_f32_16x16x32_bf16 v[40:43], v[48:51], v[64:67], v[40:43]
    v_add_u32 v92, v92, v93
    v_mfma_f32_16x16x32_bf16 v[44:47], v[48:51], v[76:79], v[44:47]
    s_waitcnt lgkmcnt(5)
    v_mfma_f32_16x16x32_bf16 v[32:35], v[56:59], v[68:71], v[32:35]
    v_mfma_f32_16x16x32_bf16 v[36:39], v[56:59], v[80:83], v[36:39]
    v_mfma_f32_16x16x32_bf16 v[112:115], v[56:59], v[56:59], v[112:115]
    v_mfma_f32_16x16x32_bf16 v[40:43], v[48:51], v[68:71], v[40:43]
    v_mfma_f32_16x16x32_bf16 v[44:47], v[48:51], v[80:83], v[44:47]
    s_waitcnt lgkmcnt(0)
    v_mfma_f32_16x16x32_bf16 v[32:35], v[60:63], v[72:75], v[32:35]
    v_mfma_f32_16x16x32_bf16 v[36:39], v[60:63], v[84:87], v[36:39]
    v_mfma_f32_16x16x32_bf16 v[112:115], v[60:63], v[60:63], v[112:115]
    v_mfma_f32_16x16x32_bf16 v[40:43], v[48:51], v[72:75], v[40:43]
    v_mfma_f32_16x16x32_bf16 v[44:47], v[48:51], v[84:87], v[44:47]
    v_and_b32 v5, 3, v1
    s_nop 4
    v_mov_b32 v88, v112
    v_cmp_eq_u32 vcc, 1, v5
    s_nop 1
    v_cndmask_b32 v88, v88, v113, vcc
    v_cmp_eq_u32 vcc, 2, v5
    s_nop 1
    v_cndmask_b32 v88, v88, v114, vcc
    v_cmp_eq_u32 vcc, 3, v5
    s_nop 1
    v_cndmask_b32 v88, v88, v115, vcc
    v_lshrrev_b32 v5, 2, v3
    v_cmp_eq_u32 vcc, v5, v4
    s_nop 1
    v_cndmask_b32 v88, 0, v88, vcc
    v_mov_b32 v5, v88
    s_nop 1
    v_permlane16_swap_b32 v88, v5
    v_add_f32 v88, v88, v5
    v_mov_b32 v5, v88
    s_nop 1
    v_permlane32_swap_b32 v88, v5
    v_add_f32 v88, v88, v5
    ds_write_b32 v140, v88
    v_cmp_gt_u32 vcc, 4, v3
    v_mov_b32_dpp v5, v36 row_ror:8 row_mask:0xf bank_mask:0xf
    s_nop 0
    v_cndmask_b32 v94, v36, v5, vcc
    v_mov_b32_dpp v5, v37 row_ror:8 row_mask:0xf bank_mask:0xf
    v_cndmask_b32 v95, v37, v5, vcc
    s_nop 0
    v_mov_b32_dpp v5, v38 row_ror:8 row_mask:0xf bank_mask:0xf
    v_cndmask_b32 v96, v38, v5, vcc
    s_nop 0
    v_mov_b32_dpp v5, v39 row_ror:8 row_mask:0xf bank_mask:0xf
    v_cndmask_b32 v97, v39, v5, vcc
    s_waitcnt lgkmcnt(0)
    ds_read_b128 v[100:103], v141
    s_waitcnt lgkmcnt(0)
    s_mov_b32 s59, 987991609
    v_mul_f32 v104, s59, v94
    v_mul_f32 v108, s59, v100
    v_fma_f32 v108, -v104, v104, v108
    v_max_f32 v108, 0, v108
    v_add_f32 v108, 925353388, v108
    v_rsq_f32 v108, v108
    s_mov_b32 s59, 987991609
    v_mul_f32 v105, s59, v95
    v_mul_f32 v109, s59, v101
    v_fma_f32 v109, -v105, v105, v109
    v_max_f32 v109, 0, v109
    v_add_f32 v109, 925353388, v109
    v_rsq_f32 v109, v109
    s_mov_b32 s59, 987991609
    v_mul_f32 v106, s59, v96
    v_mul_f32 v110, s59, v102
    v_fma_f32 v110, -v106, v106, v110
    v_max_f32 v110, 0, v110
    v_add_f32 v110, 925353388, v110
    v_rsq_f32 v110, v110
    s_mov_b32 s59, 987991609
    v_mul_f32 v107, s59, v97
    v_mul_f32 v111, s59, v103
    v_fma_f32 v111, -v107, v107, v111
    v_max_f32 v111, 0, v111
    v_add_f32 v111, 925353388, v111
    v_rsq_f32 v111, v111
    v_fma_f32 v32, -v104, v40, v32
    v_fma_f32 v36, -v104, v44, v36
    v_fma_f32 v33, -v105, v41, v33
    v_fma_f32 v37, -v105, v45, v37
    v_fma_f32 v34, -v106, v42, v34
    v_fma_f32 v38, -v106, v46, v38
    v_fma_f32 v35, -v107, v43, v35
    v_fma_f32 v39, -v107, v47, v39
    v_mul_f32 v32, v108, v32
    v_mul_f32 v36, v108, v36
    v_mul_f32 v33, v109, v33
    v_mul_f32 v37, v109, v37
    v_mul_f32 v34, v110, v34
    v_mul_f32 v38, v110, v38
    v_mul_f32 v35, v111, v35
    v_mul_f32 v39, v111, v39
    v_cmp_eq_u32 vcc, 2, v3
    s_nop 1
    v_cndmask_b32 v36, v36, 1.0, vcc
    v_cndmask_b32 v37, v37, 1.0, vcc
    v_cndmask_b32 v38, v38, 1.0, vcc
    v_cndmask_b32 v39, v39, 1.0, vcc
    v_cvt_pk_bf16_f32 v10, v32, v33
    v_cvt_pk_bf16_f32 v11, v34, v35
    v_cvt_pk_bf16_f32 v12, v36, v37
    v_cvt_pk_bf16_f32 v13, v38, v39
    buffer_store_dwordx2 v[10:11], v137, s[20:23], 0 offen sc1
    buffer_store_dwordx2 v[12:13], v138, s[20:23], 0 offen sc1
    v_max3_f32 v9, |v32|, |v33|, |v34|
    v_max_f32 v9, |v35|, v9
    v_max3_f32 v5, |v36|, |v37|, |v38|
    v_max_f32 v5, |v39|, v5
    v_cmp_gt_u32 vcc, 2, v3
    s_nop 1
    v_cndmask_b32 v5, 0, v5, vcc
    v_max_f32 v9, v9, v5
    v_mov_b32 v5, v9
    s_nop 1
    v_permlane16_swap_b32 v9, v5
    v_max_f32 v9, v9, v5
    v_mov_b32 v5, v9
    s_nop 1
    v_permlane32_swap_b32 v9, v5
    v_max_f32 v9, v9, v5
    s_nop 1
    v_mov_b32_dpp v5, v9 row_ror:8 row_mask:0xf bank_mask:0xf
    v_max_f32 v9, v9, v5
    s_nop 1
    v_mov_b32_dpp v5, v9 row_ror:4 row_mask:0xf bank_mask:0xf
    v_max_f32 v9, v9, v5
    s_nop 1
    v_mov_b32_dpp v5, v9 row_ror:2 row_mask:0xf bank_mask:0xf
    v_max_f32 v9, v9, v5
    s_nop 1
    v_mov_b32_dpp v5, v9 row_ror:1 row_mask:0xf bank_mask:0xf
    v_max_f32 v9, v9, v5
    buffer_store_dword v9, v139, s[24:27], 0 offen offset:512 sc1
P1_KVD:
    s_waitcnt vmcnt(7) lgkmcnt(0)
    s_barrier
P1_Q:
    v_and_b32 v3, 15, v1
    v_lshrrev_b32 v4, 4, v1
    v_and_b32 v5, 1, v4
    v_cmp_eq_u32 vcc, v3, v5
    v_mov_b32 v6, 0x3f803f80
    s_nop 0
    v_cndmask_b32 v68, 0, v6, vcc
    v_cndmask_b32 v69, 0, v6, vcc
    v_cndmask_b32 v70, 0, v6, vcc
    v_cndmask_b32 v71, 0, v6, vcc
    v_and_b32 v5, 31, v1
    v_lshrrev_b32 v6, 5, v1
    v_lshrrev_b32 v7, 3, v5
    v_mul_u32_u24 v7, 9216, v7
    v_and_b32 v8, 7, v1
    v_lshl_add_u32 v7, v8, 7, v7
    v_bfe_u32 v8, v5, 1, 3
    v_xor_b32 v8, v8, v6
    v_xor_b32 v9, 0, v8
    v_lshl_add_u32 v120, v9, 4, v7
    v_xor_b32 v9, 2, v8
    v_lshl_add_u32 v121, v9, 4, v7
    v_xor_b32 v9, 4, v8
    v_lshl_add_u32 v122, v9, 4, v7
    v_xor_b32 v9, 6, v8
    v_lshl_add_u32 v123, v9, 4, v7
    v_bfe_u32 v7, v1, 2, 2
    v_lshl_add_u32 v7, v6, 3, v7
    v_mul_u32_u24 v7, 144, v7
    v_and_b32 v8, 3, v1
    v_lshl_add_u32 v7, v8, 3, v7
    v_bfe_u32 v9, v1, 4, 1
    v_lshl_add_u32 v7, v9, 5, v7
    s_mul_i32 s37, s62, 36
    s_and_b32 s38, s62, 1
    s_lshl_b32 s38, s38, 2
    s_sub_u32 s37, s37, s38
    s_add_u32 s37, s37, 73728
    v_add_u32 v124, s37, v7
    v_add_u32 v125, 41472, v124
    ds_read_b64_tr_b16 v[72:73], v124 offset:0
    ds_read_b64_tr_b16 v[74:75], v124 offset:576
    ds_read_b128 v[96:99], v120 offset:0
    ds_read_b128 v[100:103], v120 offset:36864
    ds_read_b64_tr_b16 v[76:77], v124 offset:2304
    ds_read_b64_tr_b16 v[78:79], v124 offset:2880
    ds_read_b128 v[104:107], v121 offset:0
    ds_read_b128 v[108:111], v121 offset:36864
    s_waitcnt lgkmcnt(4)
    v_mfma_f32_32x32x16_bf16 v[32:47], v[72:75], v[96:99], 0
    ds_read_b64_tr_b16 v[80:81], v124 offset:4608
    ds_read_b64_tr_b16 v[82:83], v124 offset:5184
    v_mfma_f32_32x32x16_bf16 v[48:63], v[72:75], v[100:103], 0
    ds_read_b128 v[112:115], v122 offset:0
    ds_read_b128 v[116:119], v122 offset:36864
    v_mfma_f32_16x16x32_bf16 v[64:67], v[72:75], v[68:71], 0
    s_waitcnt lgkmcnt(4)
    v_mfma_f32_32x32x16_bf16 v[32:47], v[76:79], v[104:107], v[32:47]
    ds_read_b64_tr_b16 v[72:73], v124 offset:6912
    ds_read_b64_tr_b16 v[74:75], v124 offset:7488
    v_mfma_f32_32x32x16_bf16 v[48:63], v[76:79], v[108:111], v[48:63]
    ds_read_b128 v[96:99], v123 offset:0
    ds_read_b128 v[100:103], v123 offset:36864
    v_mfma_f32_16x16x32_bf16 v[64:67], v[76:79], v[68:71], v[64:67]
    s_cmp_ge_u32 s61, 6
    s_cbranch_scc1 QW_21
    s_waitcnt vmcnt(4)
    s_branch QW_22
QW_21:
    s_waitcnt vmcnt(7)
QW_22:
    s_barrier
    s_waitcnt lgkmcnt(4)
    v_mfma_f32_32x32x16_bf16 v[32:47], v[80:83], v[112:115], v[32:47]
    ds_read_b64_tr_b16 v[76:77], v124 offset:9216
    ds_read_b64_tr_b16 v[78:79], v124 offset:9792
    v_mfma_f32_32x32x16_bf16 v[48:63], v[80:83], v[116:119], v[48:63]
    ds_read_b128 v[104:107], v120 offset:1024
    ds_read_b128 v[108:111], v120 offset:37888
    v_mfma_f32_16x16x32_bf16 v[64:67], v[80:83], v[68:71], v[64:67]
    s_cmp_lg_u32 s62, 0
    s_cbranch_scc1 WQ8_23
    s_mov_b32 m0, 118784
    s_nop 0
    buffer_load_dwordx4 v128, s[12:15], s56 offen lds
WQ8_23:
    s_mov_b32 m0, s57
    s_add_u32 s57, s57, 9216
    buffer_load_dwordx4 v126, s[12:15], s56 offen lds
    s_waitcnt lgkmcnt(4)
    v_mfma_f32_32x32x16_bf16 v[32:47], v[72:75], v[96:99], v[32:47]
    ds_read_b64_tr_b16 v[80:81], v124 offset:11520
    ds_read_b64_tr_b16 v[82:83], v124 offset:12096
    v_mfma_f32_32x32x16_bf16 v[48:63], v[72:75], v[100:103], v[48:63]
    ds_read_b128 v[112:115], v121 offset:1024
    ds_read_b128 v[116:119], v121 offset:37888
    v_mfma_f32_16x16x32_bf16 v[64:67], v[72:75], v[68:71], v[64:67]
    buffer_load_dwordx4 v127, s[12:15], s56 offen offset:1024 lds
    s_add_u32 s56, s56, 73728
    s_waitcnt lgkmcnt(4)
    v_mfma_f32_32x32x16_bf16 v[32:47], v[76:79], v[104:107], v[32:47]
    ds_read_b64_tr_b16 v[72:73], v124 offset:13824
    ds_read_b64_tr_b16 v[74:75], v124 offset:14400
    v_mfma_f32_32x32x16_bf16 v[48:63], v[76:79], v[108:111], v[48:63]
    ds_read_b128 v[96:99], v122 offset:1024
    ds_read_b128 v[100:103], v122 offset:37888
    v_mfma_f32_16x16x32_bf16 v[64:67], v[76:79], v[68:71], v[64:67]
    s_waitcnt lgkmcnt(4)
    v_mfma_f32_32x32x16_bf16 v[32:47], v[80:83], v[112:115], v[32:47]
    ds_read_b64_tr_b16 v[76:77], v124 offset:16128
    ds_read_b64_tr_b16 v[78:79], v124 offset:16704
    v_mfma_f32_32x32x16_bf16 v[48:63], v[80:83], v[116:119], v[48:63]
    ds_read_b128 v[104:107], v123 offset:1024
    ds_read_b128 v[108:111], v123 offset:37888
    v_mfma_f32_16x16x32_bf16 v[64:67], v[80:83], v[68:71], v[64:67]
    s_waitcnt vmcnt(2)
    s_barrier
    s_cmp_lt_u32 s61, 6
    s_cbranch_scc1 MS_24
    s_lshl_b32 s6, s60, 1
    s_add_u32 s6, s6, s61
    s_sub_u32 s6, s6, 6
    s_lshl_b32 s6, s6, 7
    s_add_u32 s6, s6, 294912
    s_cmp_lg_u32 s62, 0
    s_cbranch_scc1 SIG_25
    s_mov_b32 s28, s86
    s_mov_b32 s29, s87
    s_mov_b32 s30, 327680
    s_mov_b32 s31, 0x20000
    v_mov_b32 v250, s6
    v_mov_b32 v251, s63
    s_mov_b64 exec, 1
    buffer_store_dword v251, v250, s[28:31], 0 offen sc1
    s_mov_b64 exec, -1
SIG_25:
MS_24:
    s_waitcnt lgkmcnt(4)
    v_mfma_f32_32x32x16_bf16 v[32:47], v[72:75], v[96:99], v[32:47]
    ds_read_b64_tr_b16 v[80:81], v124 offset:18432
    ds_read_b64_tr_b16 v[82:83], v124 offset:19008
    v_mfma_f32_32x32x16_bf16 v[48:63], v[72:75], v[100:103], v[48:63]
    ds_read_b128 v[112:115], v120 offset:2048
    ds_read_b128 v[116:119], v120 offset:38912
    v_mfma_f32_16x16x32_bf16 v[64:67], v[72:75], v[68:71], v[64:67]
    s_cmp_lg_u32 s62, 1
    s_cbranch_scc1 WQ8_26
    s_mov_b32 m0, 128000
    s_nop 0
    buffer_load_dwordx4 v128, s[12:15], s56 offen lds
WQ8_26:
    s_mov_b32 m0, s57
    s_add_u32 s57, s57, 9216
    buffer_load_dwordx4 v126, s[12:15], s56 offen lds
    s_waitcnt lgkmcnt(4)
    v_mfma_f32_32x32x16_bf16 v[32:47], v[76:79], v[104:107], v[32:47]
    ds_read_b64_tr_b16 v[72:73], v124 offset:20736
    ds_read_b64_tr_b16 v[74:75], v124 offset:21312
    v_mfma_f32_32x32x16_bf16 v[48:63], v[76:79], v[108:111], v[48:63]
    ds_read_b128 v[96:99], v121 offset:2048
    ds_read_b128 v[100:103], v121 offset:38912
    v_mfma_f32_16x16x32_bf16 v[64:67], v[76:79], v[68:71], v[64:67]
    buffer_load_dwordx4 v127, s[12:15], s56 offen offset:1024 lds
    s_add_u32 s56, s56, 73728
    s_waitcnt lgkmcnt(4)
    v_mfma_f32_32x32x16_bf16 v[32:47], v[80:83], v[112:115], v[32:47]
    ds_read_b64_tr_b16 v[76:77], v124 offset:23040
    ds_read_b64_tr_b16 v[78:79], v124 offset:23616
    v_mfma_f32_32x32x16_bf16 v[48:63], v[80:83], v[116:119], v[48:63]
    ds_read_b128 v[104:107], v122 offset:2048
    ds_read_b128 v[108:111], v122 offset:38912
    v_mfma_f32_16x16x32_bf16 v[64:67], v[80:83], v[68:71], v[64:67]
    s_waitcnt lgkmcnt(4)
    v_mfma_f32_32x32x16_bf16 v[32:47], v[72:75], v[96:99], v[32:47]
    ds_read_b64_tr_b16 v[80:81], v124 offset:25344
    ds_read_b64_tr_b16 v[82:83], v124 offset:25920
    v_mfma_f32_32x32x16_bf16 v[48:63], v[72:75], v[100:103], v[48:63]
    ds_read_b128 v[112:115], v123 offset:2048
    ds_read_b128 v[116:119], v123 offset:38912
    v_mfma_f32_16x16x32_bf16 v[64:67], v[72:75], v[68:71], v[64:67]
    s_waitcnt vmcnt(4)
    s_barrier
    s_waitcnt lgkmcnt(4)
    v_mfma_f32_32x32x16_bf16 v[32:47], v[76:79], v[104:107], v[32:47]
    ds_read_b64_tr_b16 v[72:73], v124 offset:27648
    ds_read_b64_tr_b16 v[74:75], v124 offset:28224
    v_mfma_f32_32x32x16_bf16 v[48:63], v[76:79], v[108:111], v[48:63]
    ds_read_b128 v[96:99], v120 offset:3072
    ds_read_b128 v[100:103], v120 offset:39936
    v_mfma_f32_16x16x32_bf16 v[64:67], v[76:79], v[68:71], v[64:67]
    s_cmp_lg_u32 s62, 2
    s_cbranch_scc1 WQ8_27
    s_mov_b32 m0, 137216
    s_nop 0
    buffer_load_dwordx4 v128, s[12:15], s56 offen lds
WQ8_27:
    s_mov_b32 m0, s57
    s_add_u32 s57, s57, 9216
    buffer_load_dwordx4 v126, s[12:15], s56 offen lds
    s_waitcnt lgkmcnt(4)
    v_mfma_f32_32x32x16_bf16 v[32:47], v[80:83], v[112:115], v[32:47]
    ds_read_b64_tr_b16 v[76:77], v124 offset:29952
    ds_read_b64_tr_b16 v[78:79], v124 offset:30528
    v_mfma_f32_32x32x16_bf16 v[48:63], v[80:83], v[116:119], v[48:63]
    ds_read_b128 v[104:107], v121 offset:3072
    ds_read_b128 v[108:111], v121 offset:39936
    v_mfma_f32_16x16x32_bf16 v[64:67], v[80:83], v[68:71], v[64:67]
    buffer_load_dwordx4 v127, s[12:15], s56 offen offset:1024 lds
    s_add_u32 s56, s56, 73728
    s_waitcnt lgkmcnt(4)
    v_mfma_f32_32x32x16_bf16 v[32:47], v[72:75], v[96:99], v[32:47]
    ds_read_b64_tr_b16 v[80:81], v124 offset:32256
    ds_read_b64_tr_b16 v[82:83], v124 offset:32832
    v_mfma_f32_32x32x16_bf16 v[48:63], v[72:75], v[100:103], v[48:63]
    ds_read_b128 v[112:115], v122 offset:3072
    ds_read_b128 v[116:119], v122 offset:39936
    v_mfma_f32_16x16x32_bf16 v[64:67], v[72:75], v[68:71], v[64:67]
    s_waitcnt lgkmcnt(4)
    v_mfma_f32_32x32x16_bf16 v[32:47], v[76:79], v[104:107], v[32:47]
    ds_read_b64_tr_b16 v[72:73], v124 offset:34560
    ds_read_b64_tr_b16 v[74:75], v124 offset:35136
    v_mfma_f32_32x32x16_bf16 v[48:63], v[76:79], v[108:111], v[48:63]
    ds_read_b128 v[96:99], v123 offset:3072
    ds_read_b128 v[100:103], v123 offset:39936
    v_mfma_f32_16x16x32_bf16 v[64:67], v[76:79], v[68:71], v[64:67]
    s_waitcnt vmcnt(4)
    s_barrier
    s_waitcnt lgkmcnt(4)
    v_mfma_f32_32x32x16_bf16 v[32:47], v[80:83], v[112:115], v[32:47]
    ds_read_b64_tr_b16 v[76:77], v124 offset:36864
    ds_read_b64_tr_b16 v[78:79], v124 offset:37440
    v_mfma_f32_32x32x16_bf16 v[48:63], v[80:83], v[116:119], v[48:63]
    ds_read_b128 v[104:107], v120 offset:4096
    ds_read_b128 v[108:111], v120 offset:40960
    v_mfma_f32_16x16x32_bf16 v[64:67], v[80:83], v[68:71], v[64:67]
    s_cmp_lg_u32 s62, 3
    s_cbranch_scc1 WQ8_28
    s_mov_b32 m0, 146432
    s_nop 0
    buffer_load_dwordx4 v128, s[12:15], s56 offen lds
WQ8_28:
    s_mov_b32 m0, s57
    s_add_u32 s57, s57, 9216
    buffer_load_dwordx4 v126, s[12:15], s56 offen lds
    s_waitcnt lgkmcnt(4)
    v_mfma_f32_32x32x16_bf16 v[32:47], v[72:75], v[96:99], v[32:47]
    ds_read_b64_tr_b16 v[80:81], v124 offset:39168
    ds_read_b64_tr_b16 v[82:83], v124 offset:39744
    v_mfma_f32_32x32x16_bf16 v[48:63], v[72:75], v[100:103], v[48:63]
    ds_read_b128 v[112:115], v121 offset:4096
    ds_read_b128 v[116:119], v121 offset:40960
    v_mfma_f32_16x16x32_bf16 v[64:67], v[72:75], v[68:71], v[64:67]
    buffer_load_dwordx4 v127, s[12:15], s56 offen offset:1024 lds
    s_add_u32 s56, s56, 73728
    s_waitcnt lgkmcnt(4)
    v_mfma_f32_32x32x16_bf16 v[32:47], v[76:79], v[104:107], v[32:47]
    ds_read_b64_tr_b16 v[72:73], v125 offset:0
    ds_read_b64_tr_b16 v[74:75], v125 offset:576
    v_mfma_f32_32x32x16_bf16 v[48:63], v[76:79], v[108:111], v[48:63]
    ds_read_b128 v[96:99], v122 offset:4096
    ds_read_b128 v[100:103], v122 offset:40960
    v_mfma_f32_16x16x32_bf16 v[64:67], v[76:79], v[68:71], v[64:67]
    s_waitcnt lgkmcnt(4)
    v_mfma_f32_32x32x16_bf16 v[32:47], v[80:83], v[112:115], v[32:47]
    ds_read_b64_tr_b16 v[76:77], v125 offset:2304
    ds_read_b64_tr_b16 v[78:79], v125 offset:2880
    v_mfma_f32_32x32x16_bf16 v[48:63], v[80:83], v[116:119], v[48:63]
    ds_read_b128 v[104:107], v123 offset:4096
    ds_read_b128 v[108:111], v123 offset:40960
    v_mfma_f32_16x16x32_bf16 v[64:67], v[80:83], v[68:71], v[64:67]
    s_waitcnt vmcnt(4)
    s_barrier
    s_waitcnt lgkmcnt(4)
    v_mfma_f32_32x32x16_bf16 v[32:47], v[72:75], v[96:99], v[32:47]
    ds_read_b64_tr_b16 v[80:81], v125 offset:4608
    ds_read_b64_tr_b16 v[82:83], v125 offset:5184
    v_mfma_f32_32x32x16_bf16 v[48:63], v[72:75], v[100:103], v[48:63]
    ds_read_b128 v[112:115], v120 offset:5120
    ds_read_b128 v[116:119], v120 offset:41984
    v_mfma_f32_16x16x32_bf16 v[64:67], v[72:75], v[68:71], v[64:67]
    s_cmp_lg_u32 s62, 0
    s_cbranch_scc1 WQ8_29
    s_mov_b32 m0, 155648
    s_nop 0
    buffer_load_dwordx4 v128, s[12:15], s56 offen lds
WQ8_29:
    s_mov_b32 m0, s57
    s_add_u32 s57, s57, 9216
    buffer_load_dwordx4 v126, s[12:15], s56 offen lds
    s_waitcnt lgkmcnt(4)
    v_mfma_f32_32x32x16_bf16 v[32:47], v[76:79], v[104:107], v[32:47]
    ds_read_b64_tr_b16 v[72:73], v125 offset:6912
    ds_read_b64_tr_b16 v[74:75], v125 offset:7488
    v_mfma_f32_32x32x16_bf16 v[48:63], v[76:79], v[108:111], v[48:63]
    ds_read_b128 v[96:99], v121 offset:5120
    ds_read_b128 v[100:103], v121 offset:41984
    v_mfma_f32_16x16x32_bf16 v[64:67], v[76:79], v[68:71], v[64:67]
    buffer_load_dwordx4 v127, s[12:15], s56 offen offset:1024 lds
    s_add_u32 s56, s56, 73728
    s_waitcnt lgkmcnt(4)
    v_mfma_f32_32x32x16_bf16 v[32:47], v[80:83], v[112:115], v[32:47]
    ds_read_b64_tr_b16 v[76:77], v125 offset:9216
    ds_read_b64_tr_b16 v[78:79], v125 offset:9792
    v_mfma_f32_32x32x16_bf16 v[48:63], v[80:83], v[116:119], v[48:63]
    ds_read_b128 v[104:107], v122 offset:5120
    ds_read_b128 v[108:111], v122 offset:41984
    v_mfma_f32_16x16x32_bf16 v[64:67], v[80:83], v[68:71], v[64:67]
    s_waitcnt lgkmcnt(4)
    v_mfma_f32_32x32x16_bf16 v[32:47], v[72:75], v[96:99], v[32:47]
    ds_read_b64_tr_b16 v[80:81], v125 offset:11520
    ds_read_b64_tr_b16 v[82:83], v125 offset:12096
    v_mfma_f32_32x32x16_bf16 v[48:63], v[72:75], v[100:103], v[48:63]
    ds_read_b128 v[112:115], v123 offset:5120
    ds_read_b128 v[116:119], v123 offset:41984
    v_mfma_f32_16x16x32_bf16 v[64:67], v[72:75], v[68:71], v[64:67]
    s_waitcnt vmcnt(4)
    s_barrier
    s_waitcnt lgkmcnt(4)
    v_mfma_f32_32x32x16_bf16 v[32:47], v[76:79], v[104:107], v[32:47]
    ds_read_b64_tr_b16 v[72:73], v125 offset:13824
    ds_read_b64_tr_b16 v[74:75], v125 offset:14400
    v_mfma_f32_32x32x16_bf16 v[48:63], v[76:79], v[108:111], v[48:63]
    ds_read_b128 v[96:99], v120 offset:6144
    ds_read_b128 v[100:103], v120 offset:43008
    v_mfma_f32_16x16x32_bf16 v[64:67], v[76:79], v[68:71], v[64:67]
    s_waitcnt lgkmcnt(4)
    v_mfma_f32_32x32x16_bf16 v[32:47], v[80:83], v[112:115], v[32:47]
    ds_read_b64_tr_b16 v[76:77], v125 offset:16128
    ds_read_b64_tr_b16 v[78:79], v125 offset:16704
    v_mfma_f32_32x32x16_bf16 v[48:63], v[80:83], v[116:119], v[48:63]
    ds_read_b128 v[104:107], v121 offset:6144
    ds_read_b128 v[108:111], v121 offset:43008
    v_mfma_f32_16x16x32_bf16 v[64:67], v[80:83], v[68:71], v[64:67]
    s_waitcnt lgkmcnt(4)
    v_mfma_f32_32x32x16_bf16 v[32:47], v[72:75], v[96:99], v[32:47]
    ds_read_b64_tr_b16 v[80:81], v125 offset:18432
    ds_read_b64_tr_b16 v[82:83], v125 offset:19008
    v_mfma_f32_32x32x16_bf16 v[48:63], v[72:75], v[100:103], v[48:63]
    ds_read_b128 v[112:115], v122 offset:6144
    ds_read_b128 v[116:119], v122 offset:43008
    v_mfma_f32_16x16x32_bf16 v[64:67], v[72:75], v[68:71], v[64:67]
    s_waitcnt lgkmcnt(4)
    v_mfma_f32_32x32x16_bf16 v[32:47], v[76:79], v[104:107], v[32:47]
    ds_read_b64_tr_b16 v[72:73], v125 offset:20736
    ds_read_b64_tr_b16 v[74:75], v125 offset:21312
    v_mfma_f32_32x32x16_bf16 v[48:63], v[76:79], v[108:111], v[48:63]
    ds_read_b128 v[96:99], v123 offset:6144
    ds_read_b128 v[100:103], v123 offset:43008
    v_mfma_f32_16x16x32_bf16 v[64:67], v[76:79], v[68:71], v[64:67]
    s_waitcnt vmcnt(2)
    s_barrier
    s_waitcnt lgkmcnt(4)
    v_mfma_f32_32x32x16_bf16 v[32:47], v[80:83], v[112:115], v[32:47]
    ds_read_b64_tr_b16 v[76:77], v125 offset:23040
    ds_read_b64_tr_b16 v[78:79], v125 offset:23616
    v_mfma_f32_32x32x16_bf16 v[48:63], v[80:83], v[116:119], v[48:63]
    ds_read_b128 v[104:107], v120 offset:7168
    ds_read_b128 v[108:111], v120 offset:44032
    v_mfma_f32_16x16x32_bf16 v[64:67], v[80:83], v[68:71], v[64:67]
    s_waitcnt lgkmcnt(4)
    v_mfma_f32_32x32x16_bf16 v[32:47], v[72:75], v[96:99], v[32:47]
    ds_read_b64_tr_b16 v[80:81], v125 offset:25344
    ds_read_b64_tr_b16 v[82:83], v125 offset:25920
    v_mfma_f32_32x32x16_bf16 v[48:63], v[72:75], v[100:103], v[48:63]
    ds_read_b128 v[112:115], v121 offset:7168
    ds_read_b128 v[116:119], v121 offset:44032
    v_mfma_f32_16x16x32_bf16 v[64:67], v[72:75], v[68:71], v[64:67]
    s_waitcnt lgkmcnt(4)
    v_mfma_f32_32x32x16_bf16 v[32:47], v[76:79], v[104:107], v[32:47]
    ds_read_b64_tr_b16 v[72:73], v125 offset:27648
    ds_read_b64_tr_b16 v[74:75], v125 offset:28224
    v_mfma_f32_32x32x16_bf16 v[48:63], v[76:79], v[108:111], v[48:63]
    ds_read_b128 v[96:99], v122 offset:7168
    ds_read_b128 v[100:103], v122 offset:44032
    v_mfma_f32_16x16x32_bf16 v[64:67], v[76:79], v[68:71], v[64:67]
    s_waitcnt lgkmcnt(4)
    v_mfma_f32_32x32x16_bf16 v[32:47], v[80:83], v[112:115], v[32:47]
    ds_read_b64_tr_b16 v[76:77], v125 offset:29952
    ds_read_b64_tr_b16 v[78:79], v125 offset:30528
    v_mfma_f32_32x32x16_bf16 v[48:63], v[80:83], v[116:119], v[48:63]
    ds_read_b128 v[104:107], v123 offset:7168
    ds_read_b128 v[108:111], v123 offset:44032
    v_mfma_f32_16x16x32_bf16 v[64:67], v[80:83], v[68:71], v[64:67]
    s_waitcnt vmcnt(0)
    s_barrier
    s_waitcnt lgkmcnt(4)
    v_mfma_f32_32x32x16_bf16 v[32:47], v[72:75], v[96:99], v[32:47]
    ds_read_b64_tr_b16 v[80:81], v125 offset:32256
    ds_read_b64_tr_b16 v[82:83], v125 offset:32832
    v_mfma_f32_32x32x16_bf16 v[48:63], v[72:75], v[100:103], v[48:63]
    ds_read_b128 v[112:115], v120 offset:8192
    ds_read_b128 v[116:119], v120 offset:45056
    v_mfma_f32_16x16x32_bf16 v[64:67], v[72:75], v[68:71], v[64:67]
    s_waitcnt lgkmcnt(4)
    v_mfma_f32_32x32x16_bf16 v[32:47], v[76:79], v[104:107], v[32:47]
    ds_read_b64_tr_b16 v[72:73], v125 offset:34560
    ds_read_b64_tr_b16 v[74:75], v125 offset:35136
    v_mfma_f32_32x32x16_bf16 v[48:63], v[76:79], v[108:111], v[48:63]
    ds_read_b128 v[96:99], v121 offset:8192
    ds_read_b128 v[100:103], v121 offset:45056
    v_mfma_f32_16x16x32_bf16 v[64:67], v[76:79], v[68:71], v[64:67]
    s_waitcnt lgkmcnt(4)
    v_mfma_f32_32x32x16_bf16 v[32:47], v[80:83], v[112:115], v[32:47]
    ds_read_b64_tr_b16 v[76:77], v125 offset:36864
    ds_read_b64_tr_b16 v[78:79], v125 offset:37440
    v_mfma_f32_32x32x16_bf16 v[48:63], v[80:83], v[116:119], v[48:63]
    ds_read_b128 v[104:107], v122 offset:8192
    ds_read_b128 v[108:111], v122 offset:45056
    v_mfma_f32_16x16x32_bf16 v[64:67], v[80:83], v[68:71], v[64:67]
    s_waitcnt lgkmcnt(4)
    v_mfma_f32_32x32x16_bf16 v[32:47], v[72:75], v[96:99], v[32:47]
    ds_read_b64_tr_b16 v[80:81], v125 offset:39168
    ds_read_b64_tr_b16 v[82:83], v125 offset:39744
    v_mfma_f32_32x32x16_bf16 v[48:63], v[72:75], v[100:103], v[48:63]
    ds_read_b128 v[112:115], v123 offset:8192
    ds_read_b128 v[116:119], v123 offset:45056
    v_mfma_f32_16x16x32_bf16 v[64:67], v[72:75], v[68:71], v[64:67]
    s_waitcnt lgkmcnt(4)
    v_mfma_f32_32x32x16_bf16 v[32:47], v[76:79], v[104:107], v[32:47]
    v_mfma_f32_32x32x16_bf16 v[48:63], v[76:79], v[108:111], v[48:63]
    v_mfma_f32_16x16x32_bf16 v[64:67], v[76:79], v[68:71], v[64:67]
    s_waitcnt lgkmcnt(0)
    v_mfma_f32_32x32x16_bf16 v[32:47], v[80:83], v[112:115], v[32:47]
    v_mfma_f32_32x32x16_bf16 v[48:63], v[80:83], v[116:119], v[48:63]
    v_mfma_f32_16x16x32_bf16 v[64:67], v[80:83], v[68:71], v[64:67]
    s_lshl_b32 s37, s62, 7
    s_add_u32 s37, s37, 159744
    v_lshlrev_b32 v7, 6, v3
    v_lshl_add_u32 v7, v4, 4, v7
    v_add_u32 v7, s37, v7
    v_cmp_gt_u32 vcc, 2, v3
    s_nop 1
    s_and_saveexec_b64 s[40:41], vcc
    ds_write_b128 v7, v[64:67]
    s_mov_b64 exec, s[40:41]
    v_lshrrev_b32 v6, 5, v1
    v_lshl_add_u32 v6, v6, 4, s37
    s_waitcnt lgkmcnt(0)
    ds_read_b128 v[84:87], v6 offset:0
    ds_read_b128 v[88:91], v6 offset:32
    ds_read_b128 v[92:95], v6 offset:64
    s_waitcnt lgkmcnt(0)
    s_barrier
    s_cmp_lg_u32 s61, 0
    s_cbranch_scc1 WOS_30
    s_cmp_ge_u32 s60, 27
    s_cbranch_scc1 WOS_30
    s_lshl_b32 s43, s60, 2
    s_add_u32 s43, s43, s62
    s_mul_hi_u32 s44, s43, 0xe38e38f
    s_mul_i32 s45, s44, 18
    s_sub_u32 s45, s43, s45
    s_mov_b32 s50, 0x05040100
    s_mov_b32 s51, 0x07060302
    v_perm_b32 v160, v204, v200, s50
    v_perm_b32 v161, v212, v208, s50
    v_perm_b32 v162, v220, v216, s50
    v_perm_b32 v163, v228, v224, s50
    v_perm_b32 v164, v204, v200, s51
    v_perm_b32 v165, v212, v208, s51
    v_perm_b32 v166, v220, v216, s51
    v_perm_b32 v167, v228, v224, s51
    v_perm_b32 v168, v205, v201, s50
    v_perm_b32 v169, v213, v209, s50
    v_perm_b32 v170, v221, v217, s50
    v_perm_b32 v171, v229, v225, s50
    v_perm_b32 v172, v205, v201, s51
    v_perm_b32 v173, v213, v209, s51
    v_perm_b32 v174, v221, v217, s51
    v_perm_b32 v175, v229, v225, s51
    v_perm_b32 v176, v206, v202, s50
    v_perm_b32 v177, v214, v210, s50
    v_perm_b32 v178, v222, v218, s50
    v_perm_b32 v179, v230, v226, s50
    v_perm_b32 v180, v206, v202, s51
    v_perm_b32 v181, v214, v210, s51
    v_perm_b32 v182, v222, v218, s51
    v_perm_b32 v183, v230, v226, s51
    s_add_u32 s16, s86, 10113024
    s_addc_u32 s17, s87, 0
    s_mov_b32 s18, 663552
    s_mov_b32 s19, 0x20000
    v_lshlrev_b32 v5, 4, v1
    s_mul_i32 s46, s44, 36
    s_add_u32 s46, s46, s45
    s_mul_i32 s46, s46, 3072
    s_add_u32 s47, s46, 55296
    buffer_store_dwordx4 v[160:163], v5, s[16:19], s46 offen offset:0 sc1
    buffer_store_dwordx4 v[164:167], v5, s[16:19], s46 offen offset:1024 sc1
    buffer_store_dwordx4 v[168:171], v5, s[16:19], s46 offen offset:2048 sc1
    buffer_store_dwordx4 v[172:175], v5, s[16:19], s47 offen offset:0 sc1
    buffer_store_dwordx4 v[176:179], v5, s[16:19], s47 offen offset:1024 sc1
    buffer_store_dwordx4 v[180:183], v5, s[16:19], s47 offen offset:2048 sc1
    v_mov_b32 v232, 0x3f803f80
    v_mov_b32 v184, 0
    v_mov_b32 v185, 0
    v_mov_b32 v186, 0
    v_mov_b32 v187, 0
    v_mov_b32 v188, 0
    v_mov_b32 v189, 0
    v_mov_b32 v190, 0
    v_mov_b32 v191, 0
    v_dot2c_f32_bf16 v184, v200, v232
    v_dot2c_f32_bf16 v185, v204, v232
    v_dot2c_f32_bf16 v186, v208, v232
    v_dot2c_f32_bf16 v187, v212, v232
    v_dot2c_f32_bf16 v188, v216, v232
    v_dot2c_f32_bf16 v189, v220, v232
    v_dot2c_f32_bf16 v190, v224, v232
    v_dot2c_f32_bf16 v191, v228, v232
    v_dot2c_f32_bf16 v184, v201, v232
    v_dot2c_f32_bf16 v185, v205, v232
    v_dot2c_f32_bf16 v186, v209, v232
    v_dot2c_f32_bf16 v187, v213, v232
    v_dot2c_f32_bf16 v188, v217, v232
    v_dot2c_f32_bf16 v189, v221, v232
    v_dot2c_f32_bf16 v190, v225, v232
    v_dot2c_f32_bf16 v191, v229, v232
    v_dot2c_f32_bf16 v184, v202, v232
    v_dot2c_f32_bf16 v185, v206, v232
    v_dot2c_f32_bf16 v186, v210, v232
    v_dot2c_f32_bf16 v187, v214, v232
    v_dot2c_f32_bf16 v188, v218, v232
    v_dot2c_f32_bf16 v189, v222, v232
    v_dot2c_f32_bf16 v190, v226, v232
    v_dot2c_f32_bf16 v191, v230, v232
    v_add_f32_dpp v184, v184, v184 row_ror:8 row_mask:0xf bank_mask:0xf
    v_add_f32_dpp v185, v185, v185 row_ror:8 row_mask:0xf bank_mask:0xf
    v_add_f32_dpp v186, v186, v186 row_ror:8 row_mask:0xf bank_mask:0xf
    v_add_f32_dpp v187, v187, v187 row_ror:8 row_mask:0xf bank_mask:0xf
    v_add_f32_dpp v188, v188, v188 row_ror:8 row_mask:0xf bank_mask:0xf
    v_add_f32_dpp v189, v189, v189 row_ror:8 row_mask:0xf bank_mask:0xf
    v_add_f32_dpp v190, v190, v190 row_ror:8 row_mask:0xf bank_mask:0xf
    v_add_f32_dpp v191, v191, v191 row_ror:8 row_mask:0xf bank_mask:0xf
    v_add_f32_dpp v184, v184, v184 row_ror:4 row_mask:0xf bank_mask:0xf
    v_add_f32_dpp v185, v185, v185 row_ror:4 row_mask:0xf bank_mask:0xf
    v_add_f32_dpp v186, v186, v186 row_ror:4 row_mask:0xf bank_mask:0xf
    v_add_f32_dpp v187, v187, v187 row_ror:4 row_mask:0xf bank_mask:0xf
    v_add_f32_dpp v188, v188, v188 row_ror:4 row_mask:0xf bank_mask:0xf
    v_add_f32_dpp v189, v189, v189 row_ror:4 row_mask:0xf bank_mask:0xf
    v_add_f32_dpp v190, v190, v190 row_ror:4 row_mask:0xf bank_mask:0xf
    v_add_f32_dpp v191, v191, v191 row_ror:4 row_mask:0xf bank_mask:0xf
    v_add_f32_dpp v184, v184, v184 row_ror:2 row_mask:0xf bank_mask:0xf
    v_add_f32_dpp v185, v185, v185 row_ror:2 row_mask:0xf bank_mask:0xf
    v_add_f32_dpp v186, v186, v186 row_ror:2 row_mask:0xf bank_mask:0xf
    v_add_f32_dpp v187, v187, v187 row_ror:2 row_mask:0xf bank_mask:0xf
    v_add_f32_dpp v188, v188, v188 row_ror:2 row_mask:0xf bank_mask:0xf
    v_add_f32_dpp v189, v189, v189 row_ror:2 row_mask:0xf bank_mask:0xf
    v_add_f32_dpp v190, v190, v190 row_ror:2 row_mask:0xf bank_mask:0xf
    v_add_f32_dpp v191, v191, v191 row_ror:2 row_mask:0xf bank_mask:0xf
    v_add_f32_dpp v184, v184, v184 row_ror:1 row_mask:0xf bank_mask:0xf
    v_add_f32_dpp v185, v185, v185 row_ror:1 row_mask:0xf bank_mask:0xf
    v_add_f32_dpp v186, v186, v186 row_ror:1 row_mask:0xf bank_mask:0xf
    v_add_f32_dpp v187, v187, v187 row_ror:1 row_mask:0xf bank_mask:0xf
    v_add_f32_dpp v188, v188, v188 row_ror:1 row_mask:0xf bank_mask:0xf
    v_add_f32_dpp v189, v189, v189 row_ror:1 row_mask:0xf bank_mask:0xf
    v_add_f32_dpp v190, v190, v190 row_ror:1 row_mask:0xf bank_mask:0xf
    v_add_f32_dpp v191, v191, v191 row_ror:1 row_mask:0xf bank_mask:0xf
    v_cvt_pk_bf16_f32 v192, v184, v185
    v_cvt_pk_bf16_f32 v193, v186, v187
    v_cvt_pk_bf16_f32 v194, v188, v189
    v_cvt_pk_bf16_f32 v195, v190, v191
    v_lshlrev_b32 v233, 16, v192
    v_and_b32 v234, 0xffff0000, v192
    v_sub_f32 v184, v184, v233
    v_sub_f32 v185, v185, v234
    v_lshlrev_b32 v233, 16, v193
    v_and_b32 v234, 0xffff0000, v193
    v_sub_f32 v186, v186, v233
    v_sub_f32 v187, v187, v234
    v_lshlrev_b32 v233, 16, v194
    v_and_b32 v234, 0xffff0000, v194
    v_sub_f32 v188, v188, v233
    v_sub_f32 v189, v189, v234
    v_lshlrev_b32 v233, 16, v195
    v_and_b32 v234, 0xffff0000, v195
    v_sub_f32 v190, v190, v233
    v_sub_f32 v191, v191, v234
    v_cvt_pk_bf16_f32 v196, v184, v185
    v_cvt_pk_bf16_f32 v197, v186, v187
    v_cvt_pk_bf16_f32 v198, v188, v189
    v_cvt_pk_bf16_f32 v199, v190, v191
    v_and_b32 v5, 15, v1
    v_lshrrev_b32 v6, 4, v1
    v_cmp_eq_u32 vcc, 1, v5
    s_nop 1
    v_cndmask_b32 v192, v192, v196, vcc
    v_cndmask_b32 v193, v193, v197, vcc
    v_cndmask_b32 v194, v194, v198, vcc
    v_cndmask_b32 v195, v195, v199, vcc
    v_cmp_gt_u32 vcc, 2, v5
    s_nop 1
    v_cndmask_b32 v192, 0, v192, vcc
    v_cndmask_b32 v193, 0, v193, vcc
    v_cndmask_b32 v194, 0, v194, vcc
    v_cndmask_b32 v195, 0, v195, vcc
    s_lshl_b32 s46, s44, 1
    v_add_u32 v7, s46, v5
    v_add_u32 v8, 10, v5
    v_cndmask_b32 v7, v8, v7, vcc
    v_lshl_add_u32 v7, v6, 4, v7
    v_lshlrev_b32 v7, 4, v7
    s_lshl_b32 s47, s45, 10
    v_add_u32 v7, s47, v7
    s_cmp_eq_u32 s44, 0
    s_cselect_b32 s46, 6, 2
    v_cmp_gt_u32 vcc, s46, v5
    v_mov_b32 v8, 0x7fffffff
    s_nop 0
    v_cndmask_b32 v7, v8, v7, vcc
    s_add_u32 s20, s86, 9949184
    s_addc_u32 s21, s87, 0
    s_mov_b32 s22, 18432
    s_mov_b32 s23, 0x20000
    buffer_store_dwordx4 v[192:195], v7, s[20:23], 0 offen sc1
WOS_30:
    s_cmp_lg_u32 s61, 0
    s_cbranch_scc1 WOF_31
    s_cmp_ge_u32 s60, 27
    s_cbranch_scc1 WOF_31
    s_lshl_b32 s6, s60, 6
    s_add_u32 s6, s6, 4096
    s_waitcnt vmcnt(0) lgkmcnt(0)
    s_barrier
    s_cmp_lg_u32 s62, 0
    s_cbranch_scc1 SIG_32
    s_mov_b32 s28, s86
    s_mov_b32 s29, s87
    s_mov_b32 s30, 327680
    s_mov_b32 s31, 0x20000
    v_mov_b32 v250, s6
    v_mov_b32 v251, s63
    s_mov_b64 exec, 1
    buffer_store_dword v251, v250, s[28:31], 0 offen sc1
    s_mov_b64 exec, -1
SIG_32:
WOF_31:
    v_and_b32 v1, 63, v0
    v_and_b32 v3, 31, v0
    v_bfe_u32 v4, v0, 5, 1
    s_lshl_b32 s32, s61, 2
    s_add_u32 s32, s32, s62
    s_add_u32 s8, s86, 2686976
    s_addc_u32 s9, s87, 0
    s_mov_b32 s10, 151552
    s_mov_b32 s11, 0x20000
    s_mov_b32 s28, s86
    s_mov_b32 s29, s87
    s_mov_b32 s30, 327680
    s_mov_b32 s31, 0x20000
    v_min_u32 v179, 26, v1
    v_lshlrev_b32 v179, 6, v179
    v_add_u32 v179, 4096, v179
    v_lshlrev_b32 v8, 4, v1
    s_mul_i32 s40, s62, 10240
    v_mov_b32 v121, 0x3f803f80
    v_mov_b32 v123, 0x3f803f80
    v_mov_b32 v14, v8
    v_lshlrev_b32 v15, 2, v3
    v_add_u32 v15, 16384, v15
    v_mov_b32 v140, v3
    v_cmp_le_u32 vcc, 19, v3
    s_nop 1
    v_cndmask_b32 v140, v140, 4, vcc
    v_subrev_u32 v141, 20, v3
    v_cmp_gt_u32 vcc, 8, v141
    s_nop 1
    v_cndmask_b32 v140, v140, 0, vcc
    v_lshlrev_b32 v140, 4, v140
    v_mul_u32_u24 v141, 304, v4
    v_add_u32 v140, v140, v141
    v_add_u32 v140, 18432, v140
    v_lshlrev_b32 v2, 3, v1
    v_lshlrev_b32 v9, 7, v1
    v_add_u32 v9, 294912, v9
    s_cmp_lg_u32 s62, 0
    s_cbranch_scc1 POLE_34
    s_mov_b32 s28, s86
    s_mov_b32 s29, s87
    s_mov_b32 s30, 327680
    s_mov_b32 s31, 0x20000
    s_mov_b32 s3, 0
POL_33:
    buffer_load_dword v244, v9, s[28:31], 0 offen sc1
    s_waitcnt vmcnt(0)
    v_xor_b32 v244, s63, v244
    v_cmp_ne_u32 vcc, 0, v244
    s_add_u32 s3, s3, 1
    s_cmp_gt_u32 s3, 0x200000
    s_cbranch_scc1 POLE_34
    s_nop 1
    s_cbranch_vccnz POL_33
POLE_34:
    s_barrier
    s_add_u32 s4, s86, 2854912
    s_addc_u32 s5, s87, 0
    s_mov_b32 s6, 16384
    s_mov_b32 s7, 0x20000
    s_lshl_b32 s38, s60, 9
    v_and_b32 v5, 31, v1
    v_lshlrev_b32 v5, 3, v5
    v_add_u32 v5, s38, v5
    buffer_load_dwordx2 v[96:97], v5, s[4:7], 0 offen sc1
    buffer_load_dwordx2 v[98:99], v5, s[4:7], 0 offen offset:256 sc1
    s_add_u32 s4, s86, 2850816
    s_addc_u32 s5, s87, 0
    s_movk_i32 s6, 1024
    s_mov_b32 s7, 0x20000
    s_mov_b32 m0, s40
    s_nop 0
    buffer_load_dwordx4 v8, s[8:11], s40 offen offset:0 sc1 lds
    buffer_load_dwordx4 v8, s[8:11], s40 offen offset:1024 sc1 lds
    buffer_load_dwordx4 v8, s[8:11], s40 offen offset:2048 sc1 lds
    buffer_load_dwordx4 v8, s[8:11], s40 offen offset:3072 sc1 lds
    s_add_u32 s40, s40, 4096
    s_mov_b32 m0, s40
    s_nop 0
    buffer_load_dwordx4 v8, s[8:11], s40 offen offset:0 sc1 lds
    buffer_load_dwordx4 v8, s[8:11], s40 offen offset:1024 sc1 lds
    buffer_load_dwordx4 v8, s[8:11], s40 offen offset:2048 sc1 lds
    buffer_load_dwordx4 v8, s[8:11], s40 offen offset:3072 sc1 lds
    s_add_u32 s40, s40, 4096
    s_mov_b32 m0, s40
    s_nop 0
    buffer_load_dwordx4 v8, s[8:11], s40 offen offset:0 sc1 lds
    buffer_load_dwordx4 v8, s[8:11], s40 offen offset:1024 sc1 lds
    s_add_u32 s40, s40, 29696
    buffer_load_dwordx2 v[10:11], v2, s[4:7], 0 offen sc1
    buffer_load_dwordx2 v[12:13], v2, s[4:7], 0 offen offset:512 sc1
    s_waitcnt vmcnt(12)
    v_cmp_gt_u32 s[46:47], 32, v1
    s_and_b32 s38, s62, 1
    s_mov_b32 s59, 1051597459
    v_mul_f32 v97, s59, v97
    v_fma_f32 v32, -v96, v84, v32
    v_fma_f32 v33, -v96, v85, v33
    v_fma_f32 v34, -v96, v86, v34
    v_fma_f32 v35, -v96, v87, v35
    v_fma_f32 v36, -v96, v88, v36
    v_fma_f32 v37, -v96, v89, v37
    v_fma_f32 v38, -v96, v90, v38
    v_fma_f32 v39, -v96, v91, v39
    v_fma_f32 v40, -v96, v92, v40
    v_fma_f32 v41, -v96, v93, v41
    v_fma_f32 v42, -v96, v94, v42
    v_fma_f32 v43, -v96, v95, v43
    v_mul_f32 v32, v97, v32
    v_mul_f32 v33, v97, v33
    v_mul_f32 v34, v97, v34
    v_mul_f32 v35, v97, v35
    v_mul_f32 v36, v97, v36
    v_mul_f32 v37, v97, v37
    v_mul_f32 v38, v97, v38
    v_mul_f32 v39, v97, v39
    v_mul_f32 v40, v97, v40
    v_mul_f32 v41, v97, v41
    v_mul_f32 v42, v97, v42
    v_mul_f32 v43, v97, v43
    v_cvt_pk_bf16_f32 v100, v32, v33
    v_cvt_pk_bf16_f32 v101, v34, v35
    v_cvt_pk_bf16_f32 v102, v36, v37
    v_cvt_pk_bf16_f32 v103, v38, v39
    v_cvt_pk_bf16_f32 v104, v40, v41
    v_cvt_pk_bf16_f32 v105, v42, v43
    s_cmp_lg_u32 s38, 0
    s_cbranch_scc1 QODD_35
    v_mov_b32 v16, v100
    v_mov_b32 v17, v101
    v_mov_b32 v18, v102
    v_mov_b32 v19, v103
    v_cndmask_b32 v20, 0, v104, s[46:47]
    s_branch QEND_36
QODD_35:
    v_mov_b32 v16, v101
    v_mov_b32 v18, v103
    v_mov_b32 v106, v102
    v_permlane32_swap_b32 v100, v102
    v_cndmask_b32 v17, v100, v102, s[46:47]
    v_permlane32_swap_b32 v106, v104
    v_cndmask_b32 v19, v106, v104, s[46:47]
    v_cndmask_b32 v20, 0, v105, s[46:47]
QEND_36:
    v_mov_b32 v21, 0
    v_mul_f32 v99, s59, v99
    v_fma_f32 v48, -v98, v84, v48
    v_fma_f32 v49, -v98, v85, v49
    v_fma_f32 v50, -v98, v86, v50
    v_fma_f32 v51, -v98, v87, v51
    v_fma_f32 v52, -v98, v88, v52
    v_fma_f32 v53, -v98, v89, v53
    v_fma_f32 v54, -v98, v90, v54
    v_fma_f32 v55, -v98, v91, v55
    v_fma_f32 v56, -v98, v92, v56
    v_fma_f32 v57, -v98, v93, v57
    v_fma_f32 v58, -v98, v94, v58
    v_fma_f32 v59, -v98, v95, v59
    v_mul_f32 v48, v99, v48
    v_mul_f32 v49, v99, v49
    v_mul_f32 v50, v99, v50
    v_mul_f32 v51, v99, v51
    v_mul_f32 v52, v99, v52
    v_mul_f32 v53, v99, v53
    v_mul_f32 v54, v99, v54
    v_mul_f32 v55, v99, v55
    v_mul_f32 v56, v99, v56
    v_mul_f32 v57, v99, v57
    v_mul_f32 v58, v99, v58
    v_mul_f32 v59, v99, v59
    v_cvt_pk_bf16_f32 v100, v48, v49
    v_cvt_pk_bf16_f32 v101, v50, v51
    v_cvt_pk_bf16_f32 v102, v52, v53
    v_cvt_pk_bf16_f32 v103, v54, v55
    v_cvt_pk_bf16_f32 v104, v56, v57
    v_cvt_pk_bf16_f32 v105, v58, v59
    s_cmp_lg_u32 s38, 0
    s_cbranch_scc1 QODD_37
    v_mov_b32 v24, v100
    v_mov_b32 v25, v101
    v_mov_b32 v26, v102
    v_mov_b32 v27, v103
    v_cndmask_b32 v28, 0, v104, s[46:47]
    s_branch QEND_38
QODD_37:
    v_mov_b32 v24, v101
    v_mov_b32 v26, v103
    v_mov_b32 v106, v102
    v_permlane32_swap_b32 v100, v102
    v_cndmask_b32 v25, v100, v102, s[46:47]
    v_permlane32_swap_b32 v106, v104
    v_cndmask_b32 v27, v106, v104, s[46:47]
    v_cndmask_b32 v28, 0, v105, s[46:47]
QEND_38:
    v_mov_b32 v29, 0
    v_mov_b32 v142, 0
    v_mov_b32 v143, 0
    v_dot2c_f32_bf16 v142, v16, v16
    v_dot2c_f32_bf16 v143, v24, v24
    v_dot2c_f32_bf16 v142, v17, v17
    v_dot2c_f32_bf16 v143, v25, v25
    v_dot2c_f32_bf16 v142, v18, v18
    v_dot2c_f32_bf16 v143, v26, v26
    v_dot2c_f32_bf16 v142, v19, v19
    v_dot2c_f32_bf16 v143, v27, v27
    v_dot2c_f32_bf16 v142, v20, v20
    v_dot2c_f32_bf16 v143, v28, v28
    s_nop 1
    v_mov_b32 v141, v142
    s_nop 1
    v_permlane32_swap_b32 v142, v141
    v_add_f32 v142, v142, v141
    v_mov_b32 v141, v143
    s_nop 1
    v_permlane32_swap_b32 v143, v141
    v_add_f32 v143, v143, v141
    v_max_f32 v142, v142, v143
    s_waitcnt vmcnt(0)
    v_max_f32 v10, v10, v11
    v_max_f32 v12, v12, v13
    s_nop 0
    v_mov_b32_dpp v11, v10 row_ror:8 row_mask:0xf bank_mask:0xf
    v_mov_b32_dpp v13, v12 row_ror:8 row_mask:0xf bank_mask:0xf
    v_max_f32 v10, v10, v11
    v_max_f32 v12, v12, v13
    s_nop 0
    v_mov_b32_dpp v11, v10 row_ror:4 row_mask:0xf bank_mask:0xf
    v_mov_b32_dpp v13, v12 row_ror:4 row_mask:0xf bank_mask:0xf
    v_max_f32 v10, v10, v11
    v_max_f32 v12, v12, v13
    s_nop 0
    v_mov_b32_dpp v11, v10 row_ror:2 row_mask:0xf bank_mask:0xf
    v_mov_b32_dpp v13, v12 row_ror:2 row_mask:0xf bank_mask:0xf
    v_max_f32 v10, v10, v11
    v_max_f32 v12, v12, v13
    s_nop 0
    v_mov_b32_dpp v11, v10 row_ror:1 row_mask:0xf bank_mask:0xf
    v_mov_b32_dpp v13, v12 row_ror:1 row_mask:0xf bank_mask:0xf
    v_max_f32 v10, v10, v11
    v_max_f32 v12, v12, v13
    v_mov_b32 v11, v10
    s_nop 1
    v_permlane16_swap_b32 v10, v11
    v_max_f32 v10, v10, v11
    v_mov_b32 v13, v12
    s_nop 1
    v_permlane16_swap_b32 v12, v13
    v_max_f32 v12, v12, v13
    v_mov_b32 v11, v10
    s_nop 1
    v_permlane32_swap_b32 v10, v11
    v_max_f32 v10, v10, v11
    v_mov_b32 v13, v12
    s_nop 1
    v_permlane32_swap_b32 v12, v13
    v_max_f32 v12, v12, v13
    v_mul_f32 v142, v142, v10
    s_mov_b32 s42, 1163555413
    v_cmp_nle_f32 vcc, v142, s42
    s_mov_b32 s43, 1399379109
    v_cmp_nle_f32 s[46:47], v12, s43
    s_nop 1
    s_or_b64 s[46:47], vcc, s[46:47]
    s_cmp_lg_u64 s[46:47], 0
    s_cselect_b32 s45, 1, 0
    v_mov_b32 v10, s45
    s_lshl_b32 s45, s62, 2
    s_add_u32 s45, s45, 155648
    v_mov_b32 v11, s45
    ds_write_b32 v11, v10
    s_waitcnt lgkmcnt(0)
    s_barrier
    v_mov_b32 v11, 155648
    ds_read_b128 v[10:13], v11
    s_waitcnt lgkmcnt(0)
    v_or_b32 v10, v10, v11
    v_or_b32 v12, v12, v13
    v_or_b32 v10, v10, v12
    s_nop 0
    v_readfirstlane_b32 s45, v10
    s_nop 1
    s_cmp_eq_u32 s45, 0
    s_cbranch_scc1 ATT_GO
    s_mov_b32 s48, s40
    s_mov_b32 m0, s40
    s_nop 0
    buffer_load_dwordx4 v8, s[8:11], s40 offen offset:0 sc1 lds
    buffer_load_dwordx4 v8, s[8:11], s40 offen offset:1024 sc1 lds
    buffer_load_dwordx4 v8, s[8:11], s40 offen offset:2048 sc1 lds
    buffer_load_dwordx4 v8, s[8:11], s40 offen offset:3072 sc1 lds
    s_add_u32 s40, s40, 4096
    s_mov_b32 m0, s40
    s_nop 0
    buffer_load_dwordx4 v8, s[8:11], s40 offen offset:0 sc1 lds
    buffer_load_dwordx4 v8, s[8:11], s40 offen offset:1024 sc1 lds
    buffer_load_dwordx4 v8, s[8:11], s40 offen offset:2048 sc1 lds
    buffer_load_dwordx4 v8, s[8:11], s40 offen offset:3072 sc1 lds
    s_add_u32 s40, s40, 4096
    s_mov_b32 m0, s40
    s_nop 0
    buffer_load_dwordx4 v8, s[8:11], s40 offen offset:0 sc1 lds
    buffer_load_dwordx4 v8, s[8:11], s40 offen offset:1024 sc1 lds
    s_add_u32 s40, s40, 29696
    s_mov_b32 m0, s40
    s_nop 0
    buffer_load_dwordx4 v8, s[8:11], s40 offen offset:0 sc1 lds
    buffer_load_dwordx4 v8, s[8:11], s40 offen offset:1024 sc1 lds
    buffer_load_dwordx4 v8, s[8:11], s40 offen offset:2048 sc1 lds
    buffer_load_dwordx4 v8, s[8:11], s40 offen offset:3072 sc1 lds
    s_add_u32 s40, s40, 4096
    s_mov_b32 m0, s40
    s_nop 0
    buffer_load_dwordx4 v8, s[8:11], s40 offen offset:0 sc1 lds
    buffer_load_dwordx4 v8, s[8:11], s40 offen offset:1024 sc1 lds
    buffer_load_dwordx4 v8, s[8:11], s40 offen offset:2048 sc1 lds
    buffer_load_dwordx4 v8, s[8:11], s40 offen offset:3072 sc1 lds
    s_add_u32 s40, s40, 4096
    s_mov_b32 m0, s40
    s_nop 0
    buffer_load_dwordx4 v8, s[8:11], s40 offen offset:0 sc1 lds
    buffer_load_dwordx4 v8, s[8:11], s40 offen offset:1024 sc1 lds
    s_add_u32 s40, s40, 29696
    s_mov_b32 m0, s40
    s_nop 0
    buffer_load_dwordx4 v8, s[8:11], s40 offen offset:0 sc1 lds
    buffer_load_dwordx4 v8, s[8:11], s40 offen offset:1024 sc1 lds
    buffer_load_dwordx4 v8, s[8:11], s40 offen offset:2048 sc1 lds
    buffer_load_dwordx4 v8, s[8:11], s40 offen offset:3072 sc1 lds
    s_add_u32 s40, s40, 4096
    s_mov_b32 m0, s40
    s_nop 0
    buffer_load_dwordx4 v8, s[8:11], s40 offen offset:0 sc1 lds
    buffer_load_dwordx4 v8, s[8:11], s40 offen offset:1024 sc1 lds
    buffer_load_dwordx4 v8, s[8:11], s40 offen offset:2048 sc1 lds
    buffer_load_dwordx4 v8, s[8:11], s40 offen offset:3072 sc1 lds
    s_add_u32 s40, s40, 4096
    s_mov_b32 m0, s40
    s_nop 0
    buffer_load_dwordx4 v8, s[8:11], s40 offen offset:0 sc1 lds
    buffer_load_dwordx4 v8, s[8:11], s40 offen offset:1024 sc1 lds
    s_add_u32 s40, s40, 29696
    s_mov_b32 s40, s48
    s_waitcnt vmcnt(0)
    s_barrier
    v_mov_b32 v142, v14
    v_mov_b32 v143, v15
    v_mov_b32 v176, 0xff800000
    v_mov_b32 v177, 0xff800000
    s_mov_b32 s44, 0
ATT_FB:
    ds_read_b128 v[112:115], v142
    ds_read_b32 v120, v143
    s_waitcnt lgkmcnt(0)
    v_mfma_f32_32x32x16_bf16 v[64:79], v[112:115], v[16:19], 0
    v_mfma_f32_32x32x16_bf16 v[80:95], v[112:115], v[24:27], 0
    s_nop 9
    v_mfma_f32_32x32x8_bf16 v[64:79], v[120:121], v[20:21], v[64:79]
    v_mfma_f32_32x32x8_bf16 v[80:95], v[120:121], v[28:29], v[80:95]
    v_add_u32 v142, 1024, v142
    v_add_u32 v143, 128, v143
    s_add_u32 s44, s44, 1
    s_and_b32 s45, s44, 15
    s_cmp_lg_u32 s45, 0
    s_cselect_b32 s48, 0, 1
    s_mul_i32 s49, s48, 21504
    s_mul_i32 s48, s48, 35840
    v_add_u32 v142, s49, v142
    v_add_u32 v143, s48, v143
    s_nop 7
    v_max3_f32 v176, v64, v65, v176
    v_max3_f32 v176, v66, v67, v176
    v_max3_f32 v176, v68, v69, v176
    v_max3_f32 v176, v70, v71, v176
    v_max3_f32 v176, v72, v73, v176
    v_max3_f32 v176, v74, v75, v176
    v_max3_f32 v176, v76, v77, v176
    v_max3_f32 v176, v78, v79, v176
    v_max3_f32 v177, v80, v81, v177
    v_max3_f32 v177, v82, v83, v177
    v_max3_f32 v177, v84, v85, v177
    v_max3_f32 v177, v86, v87, v177
    v_max3_f32 v177, v88, v89, v177
    v_max3_f32 v177, v90, v91, v177
    v_max3_f32 v177, v92, v93, v177
    v_max3_f32 v177, v94, v95, v177
    s_cmp_lt_u32 s44, 64
    s_cbranch_scc1 ATT_FB
    v_mov_b32 v142, v176
    s_nop 1
    v_permlane32_swap_b32 v176, v142
    v_max_f32 v176, v176, v142
    v_mov_b32 v142, v177
    s_nop 1
    v_permlane32_swap_b32 v177, v142
    v_max_f32 v177, v177, v142
    v_cmp_gt_u32 vcc, 32, v1
    v_sub_f32 v176, 0, v176
    v_cvt_pk_bf16_f32 v142, v176, v176
    v_lshlrev_b32 v142, 16, v142
    v_sub_f32 v142, v176, v142
    v_cvt_pk_bf16_f32 v142, v176, v142
    v_cndmask_b32 v21, 0, v142, vcc
    v_sub_f32 v177, 0, v177
    v_cvt_pk_bf16_f32 v142, v177, v177
    v_lshlrev_b32 v142, 16, v142
    v_sub_f32 v142, v177, v142
    v_cvt_pk_bf16_f32 v142, v177, v142
    v_cndmask_b32 v29, 0, v142, vcc
ATT_GO:
    ds_read_b128 v[112:115], v14
    ds_read_b32 v120, v15
    s_waitcnt lgkmcnt(0)
    v_mfma_f32_32x32x16_bf16 v[64:79], v[112:115], v[16:19], 0
    s_nop 9
    v_mfma_f32_32x32x8_bf16 v[64:79], v[120:121], v[20:21], v[64:79]
    s_nop 7
    v_mfma_f32_32x32x16_bf16 v[80:95], v[112:115], v[24:27], 0
    ds_read_b128 v[116:119], v14 offset:1024
    s_nop 1
    v_exp_f32 v64, v64
    v_exp_f32 v65, v65
    v_exp_f32 v66, v66
    v_exp_f32 v67, v67
    v_exp_f32 v68, v68
    v_exp_f32 v69, v69
    ds_read_b128 v[124:127], v140 offset:0
    s_mov_b32 m0, s40
    s_nop 0
    buffer_load_dwordx4 v8, s[8:11], s40 offen offset:0 sc1 lds
    v_exp_f32 v70, v70
    v_cvt_pk_bf16_f32 v96, v64, v65
    v_exp_f32 v71, v71
    v_cvt_pk_bf16_f32 v97, v66, v67
    v_exp_f32 v72, v72
    v_exp_f32 v73, v73
    v_mfma_f32_32x32x8_bf16 v[80:95], v[120:121], v[28:29], v[80:95]
    ds_read_b32 v122, v15 offset:128
    v_exp_f32 v74, v74
    v_cvt_pk_bf16_f32 v98, v68, v69
    v_exp_f32 v75, v75
    v_cvt_pk_bf16_f32 v99, v70, v71
    v_exp_f32 v76, v76
    v_exp_f32 v77, v77
    ds_read_b128 v[128:131], v140 offset:608
    buffer_load_dwordx4 v8, s[8:11], s40 offen offset:1024 sc1 lds
    v_exp_f32 v78, v78
    v_exp_f32 v79, v79
    v_cvt_pk_bf16_f32 v100, v72, v73
    v_cvt_pk_bf16_f32 v101, v74, v75
    v_cvt_pk_bf16_f32 v102, v76, v77
    v_cvt_pk_bf16_f32 v103, v78, v79
    s_waitcnt lgkmcnt(0)
    v_mfma_f32_32x32x16_bf16 v[64:79], v[116:119], v[16:19], 0
    v_exp_f32 v80, v80
    v_exp_f32 v81, v81
    v_exp_f32 v82, v82
    v_exp_f32 v83, v83
    v_exp_f32 v84, v84
    v_exp_f32 v85, v85
    v_mfma_f32_32x32x16_bf16 v[32:47], v[124:127], v[96:99], 0
    s_add_u32 s48, s86, 10776576
    s_addc_u32 s49, s87, 0
    s_mov_b32 s50, 15925248
    s_mov_b32 s51, 0x20000
    s_mov_b32 s42, 0x05040100
    s_mov_b32 s43, 0x07060302
    v_exp_f32 v86, v86
    v_cvt_pk_bf16_f32 v104, v80, v81
    v_exp_f32 v87, v87
    v_cvt_pk_bf16_f32 v105, v82, v83
    v_exp_f32 v88, v88
    v_exp_f32 v89, v89
    v_mfma_f32_32x32x8_bf16 v[64:79], v[122:123], v[20:21], v[64:79]
    v_exp_f32 v90, v90
    v_cvt_pk_bf16_f32 v106, v84, v85
    v_exp_f32 v91, v91
    v_cvt_pk_bf16_f32 v107, v86, v87
    v_exp_f32 v92, v92
    v_exp_f32 v93, v93
    v_mfma_f32_32x32x16_bf16 v[32:47], v[128:131], v[100:103], v[32:47]
    v_exp_f32 v94, v94
    v_exp_f32 v95, v95
    v_cvt_pk_bf16_f32 v108, v88, v89
    v_cvt_pk_bf16_f32 v109, v90, v91
    v_cvt_pk_bf16_f32 v110, v92, v93
    v_cvt_pk_bf16_f32 v111, v94, v95
    v_mfma_f32_32x32x16_bf16 v[80:95], v[116:119], v[24:27], 0
    ds_read_b128 v[112:115], v14 offset:2048
    v_exp_f32 v64, v64
    v_exp_f32 v65, v65
    v_exp_f32 v66, v66
    v_exp_f32 v67, v67
    v_exp_f32 v68, v68
    v_exp_f32 v69, v69
    v_mfma_f32_32x32x16_bf16 v[48:63], v[124:127], v[104:107], 0
    ds_read_b128 v[132:135], v140 offset:1216
    buffer_load_dwordx4 v8, s[8:11], s40 offen offset:2048 sc1 lds
    v_exp_f32 v70, v70
    v_cvt_pk_bf16_f32 v96, v64, v65
    v_exp_f32 v71, v71
    v_cvt_pk_bf16_f32 v97, v66, v67
    v_exp_f32 v72, v72
    v_exp_f32 v73, v73
    v_mfma_f32_32x32x8_bf16 v[80:95], v[122:123], v[28:29], v[80:95]
    ds_read_b32 v120, v15 offset:256
    v_exp_f32 v74, v74
    v_cvt_pk_bf16_f32 v98, v68, v69
    v_exp_f32 v75, v75
    v_cvt_pk_bf16_f32 v99, v70, v71
    v_exp_f32 v76, v76
    v_exp_f32 v77, v77
    v_mfma_f32_32x32x16_bf16 v[48:63], v[128:131], v[108:111], v[48:63]
    ds_read_b128 v[136:139], v140 offset:1824
    buffer_load_dwordx4 v8, s[8:11], s40 offen offset:3072 sc1 lds
    s_add_u32 s40, s40, 4096
    v_exp_f32 v78, v78
    v_exp_f32 v79, v79
    v_cvt_pk_bf16_f32 v100, v72, v73
    v_cvt_pk_bf16_f32 v101, v74, v75
    v_cvt_pk_bf16_f32 v102, v76, v77
    v_cvt_pk_bf16_f32 v103, v78, v79
    s_waitcnt lgkmcnt(0)
    v_mfma_f32_32x32x16_bf16 v[64:79], v[112:115], v[16:19], 0
    v_exp_f32 v80, v80
    v_exp_f32 v81, v81
    v_exp_f32 v82, v82
    v_exp_f32 v83, v83
    v_exp_f32 v84, v84
    v_exp_f32 v85, v85
    v_mfma_f32_32x32x16_bf16 v[32:47], v[132:135], v[96:99], v[32:47]
    global_load_dwordx4 v[180:183], v[144:145], off
    v_lshl_add_u64 v[144:145], v[144:145], 0, s[68:69]
    v_exp_f32 v86, v86
    v_cvt_pk_bf16_f32 v104, v80, v81
    v_exp_f32 v87, v87
    v_cvt_pk_bf16_f32 v105, v82, v83
    v_exp_f32 v88, v88
    v_exp_f32 v89, v89
    v_mfma_f32_32x32x8_bf16 v[64:79], v[120:121], v[20:21], v[64:79]
    v_exp_f32 v90, v90
    v_cvt_pk_bf16_f32 v106, v84, v85
    v_exp_f32 v91, v91
    v_cvt_pk_bf16_f32 v107, v86, v87
    v_exp_f32 v92, v92
    v_exp_f32 v93, v93
    v_mfma_f32_32x32x16_bf16 v[32:47], v[136:139], v[100:103], v[32:47]
    v_exp_f32 v94, v94
    v_exp_f32 v95, v95
    v_cvt_pk_bf16_f32 v108, v88, v89
    v_cvt_pk_bf16_f32 v109, v90, v91
    v_cvt_pk_bf16_f32 v110, v92, v93
    v_cvt_pk_bf16_f32 v111, v94, v95
    v_mfma_f32_32x32x16_bf16 v[80:95], v[112:115], v[24:27], 0
    ds_read_b128 v[116:119], v14 offset:3072
    v_exp_f32 v64, v64
    v_exp_f32 v65, v65
    v_exp_f32 v66, v66
    v_exp_f32 v67, v67
    v_exp_f32 v68, v68
    v_exp_f32 v69, v69
    v_mfma_f32_32x32x16_bf16 v[48:63], v[132:135], v[104:107], v[48:63]
    ds_read_b128 v[124:127], v140 offset:2432
    s_mov_b32 m0, s40
    s_nop 0
    buffer_load_dwordx4 v8, s[8:11], s40 offen offset:0 sc1 lds
    v_exp_f32 v70, v70
    v_cvt_pk_bf16_f32 v96, v64, v65
    v_exp_f32 v71, v71
    v_cvt_pk_bf16_f32 v97, v66, v67
    v_exp_f32 v72, v72
    v_exp_f32 v73, v73
    v_mfma_f32_32x32x8_bf16 v[80:95], v[120:121], v[28:29], v[80:95]
    ds_read_b32 v122, v15 offset:384
    v_exp_f32 v74, v74
    v_cvt_pk_bf16_f32 v98, v68, v69
    v_exp_f32 v75, v75
    v_cvt_pk_bf16_f32 v99, v70, v71
    v_exp_f32 v76, v76
    v_exp_f32 v77, v77
    v_mfma_f32_32x32x16_bf16 v[48:63], v[136:139], v[108:111], v[48:63]
    ds_read_b128 v[128:131], v140 offset:3040
    buffer_load_dwordx4 v8, s[8:11], s40 offen offset:1024 sc1 lds
    v_exp_f32 v78, v78
    v_exp_f32 v79, v79
    v_cvt_pk_bf16_f32 v100, v72, v73
    v_cvt_pk_bf16_f32 v101, v74, v75
    v_cvt_pk_bf16_f32 v102, v76, v77
    v_cvt_pk_bf16_f32 v103, v78, v79
    s_waitcnt lgkmcnt(0)
    v_mfma_f32_32x32x16_bf16 v[64:79], v[116:119], v[16:19], 0
    v_exp_f32 v80, v80
    v_exp_f32 v81, v81
    v_exp_f32 v82, v82
    v_exp_f32 v83, v83
    v_exp_f32 v84, v84
    v_exp_f32 v85, v85
    v_mfma_f32_32x32x16_bf16 v[32:47], v[124:127], v[96:99], v[32:47]
    global_load_dwordx4 v[184:187], v[144:145], off
    v_lshl_add_u64 v[144:145], v[144:145], 0, s[68:69]
    v_exp_f32 v86, v86
    v_cvt_pk_bf16_f32 v104, v80, v81
    v_exp_f32 v87, v87
    v_cvt_pk_bf16_f32 v105, v82, v83
    v_exp_f32 v88, v88
    v_exp_f32 v89, v89
    v_mfma_f32_32x32x8_bf16 v[64:79], v[122:123], v[20:21], v[64:79]
    v_exp_f32 v90, v90
    v_cvt_pk_bf16_f32 v106, v84, v85
    v_exp_f32 v91, v91
    v_cvt_pk_bf16_f32 v107, v86, v87
    v_exp_f32 v92, v92
    v_exp_f32 v93, v93
    v_mfma_f32_32x32x16_bf16 v[32:47], v[128:131], v[100:103], v[32:47]
    v_exp_f32 v94, v94
    v_exp_f32 v95, v95
    v_cvt_pk_bf16_f32 v108, v88, v89
    v_cvt_pk_bf16_f32 v109, v90, v91
    v_cvt_pk_bf16_f32 v110, v92, v93
    v_cvt_pk_bf16_f32 v111, v94, v95
    v_mfma_f32_32x32x16_bf16 v[80:95], v[116:119], v[24:27], 0
    ds_read_b128 v[112:115], v14 offset:4096
    v_exp_f32 v64, v64
    v_exp_f32 v65, v65
    v_exp_f32 v66, v66
    v_exp_f32 v67, v67
    v_exp_f32 v68, v68
    v_exp_f32 v69, v69
    v_mfma_f32_32x32x16_bf16 v[48:63], v[124:127], v[104:107], v[48:63]
    ds_read_b128 v[132:135], v140 offset:3648
    buffer_load_dwordx4 v8, s[8:11], s40 offen offset:2048 sc1 lds
    v_exp_f32 v70, v70
    v_cvt_pk_bf16_f32 v96, v64, v65
    v_exp_f32 v71, v71
    v_cvt_pk_bf16_f32 v97, v66, v67
    v_exp_f32 v72, v72
    v_exp_f32 v73, v73
    v_mfma_f32_32x32x8_bf16 v[80:95], v[122:123], v[28:29], v[80:95]
    ds_read_b32 v120, v15 offset:512
    v_exp_f32 v74, v74
    v_cvt_pk_bf16_f32 v98, v68, v69
    v_exp_f32 v75, v75
    v_cvt_pk_bf16_f32 v99, v70, v71
    v_exp_f32 v76, v76
    v_exp_f32 v77, v77
    v_mfma_f32_32x32x16_bf16 v[48:63], v[128:131], v[108:111], v[48:63]
    ds_read_b128 v[136:139], v140 offset:4256
    buffer_load_dwordx4 v8, s[8:11], s40 offen offset:3072 sc1 lds
    s_add_u32 s40, s40, 4096
    v_exp_f32 v78, v78
    v_exp_f32 v79, v79
    v_cvt_pk_bf16_f32 v100, v72, v73
    v_cvt_pk_bf16_f32 v101, v74, v75
    v_cvt_pk_bf16_f32 v102, v76, v77
    v_cvt_pk_bf16_f32 v103, v78, v79
    s_waitcnt lgkmcnt(0)
    v_mfma_f32_32x32x16_bf16 v[64:79], v[112:115], v[16:19], 0
    v_exp_f32 v80, v80
    v_exp_f32 v81, v81
    v_exp_f32 v82, v82
    v_exp_f32 v83, v83
    v_exp_f32 v84, v84
    v_exp_f32 v85, v85
    v_mfma_f32_32x32x16_bf16 v[32:47], v[132:135], v[96:99], v[32:47]
    global_load_dwordx4 v[188:191], v[144:145], off
    v_lshl_add_u64 v[144:145], v[144:145], 0, s[68:69]
    v_exp_f32 v86, v86
    v_cvt_pk_bf16_f32 v104, v80, v81
    v_exp_f32 v87, v87
    v_cvt_pk_bf16_f32 v105, v82, v83
    v_exp_f32 v88, v88
    v_exp_f32 v89, v89
    v_mfma_f32_32x32x8_bf16 v[64:79], v[120:121], v[20:21], v[64:79]
    v_exp_f32 v90, v90
    v_cvt_pk_bf16_f32 v106, v84, v85
    v_exp_f32 v91, v91
    v_cvt_pk_bf16_f32 v107, v86, v87
    v_exp_f32 v92, v92
    v_exp_f32 v93, v93
    v_mfma_f32_32x32x16_bf16 v[32:47], v[136:139], v[100:103], v[32:47]
    v_exp_f32 v94, v94
    v_exp_f32 v95, v95
    v_cvt_pk_bf16_f32 v108, v88, v89
    v_cvt_pk_bf16_f32 v109, v90, v91
    v_cvt_pk_bf16_f32 v110, v92, v93
    v_cvt_pk_bf16_f32 v111, v94, v95
    v_mfma_f32_32x32x16_bf16 v[80:95], v[112:115], v[24:27], 0
    ds_read_b128 v[116:119], v14 offset:5120
    v_exp_f32 v64, v64
    v_exp_f32 v65, v65
    v_exp_f32 v66, v66
    v_exp_f32 v67, v67
    v_exp_f32 v68, v68
    v_exp_f32 v69, v69
    v_mfma_f32_32x32x16_bf16 v[48:63], v[132:135], v[104:107], v[48:63]
    ds_read_b128 v[124:127], v140 offset:4864
    s_mov_b32 m0, s40
    s_nop 0
    buffer_load_dwordx4 v8, s[8:11], s40 offen offset:0 sc1 lds
    v_exp_f32 v70, v70
    v_cvt_pk_bf16_f32 v96, v64, v65
    v_exp_f32 v71, v71
    v_cvt_pk_bf16_f32 v97, v66, v67
    v_exp_f32 v72, v72
    v_exp_f32 v73, v73
    v_mfma_f32_32x32x8_bf16 v[80:95], v[120:121], v[28:29], v[80:95]
    ds_read_b32 v122, v15 offset:640
    v_exp_f32 v74, v74
    v_cvt_pk_bf16_f32 v98, v68, v69
    v_exp_f32 v75, v75
    v_cvt_pk_bf16_f32 v99, v70, v71
    v_exp_f32 v76, v76
    v_exp_f32 v77, v77
    v_mfma_f32_32x32x16_bf16 v[48:63], v[136:139], v[108:111], v[48:63]
    ds_read_b128 v[128:131], v140 offset:5472
    buffer_load_dwordx4 v8, s[8:11], s40 offen offset:1024 sc1 lds
    s_add_u32 s40, s40, 29696
    v_exp_f32 v78, v78
    v_exp_f32 v79, v79
    v_cvt_pk_bf16_f32 v100, v72, v73
    v_cvt_pk_bf16_f32 v101, v74, v75
    v_cvt_pk_bf16_f32 v102, v76, v77
    v_cvt_pk_bf16_f32 v103, v78, v79
    s_waitcnt lgkmcnt(0)
    v_mfma_f32_32x32x16_bf16 v[64:79], v[116:119], v[16:19], 0
    v_exp_f32 v80, v80
    v_exp_f32 v81, v81
    v_exp_f32 v82, v82
    v_exp_f32 v83, v83
    v_exp_f32 v84, v84
    v_exp_f32 v85, v85
    v_mfma_f32_32x32x16_bf16 v[32:47], v[124:127], v[96:99], v[32:47]
    global_load_dwordx4 v[192:195], v[144:145], off
    v_lshl_add_u64 v[144:145], v[144:145], 0, s[68:69]
    v_exp_f32 v86, v86
    v_cvt_pk_bf16_f32 v104, v80, v81
    v_exp_f32 v87, v87
    v_cvt_pk_bf16_f32 v105, v82, v83
    v_exp_f32 v88, v88
    v_exp_f32 v89, v89
    v_mfma_f32_32x32x8_bf16 v[64:79], v[122:123], v[20:21], v[64:79]
    v_exp_f32 v90, v90
    v_cvt_pk_bf16_f32 v106, v84, v85
    v_exp_f32 v91, v91
    v_cvt_pk_bf16_f32 v107, v86, v87
    v_exp_f32 v92, v92
    v_exp_f32 v93, v93
    v_mfma_f32_32x32x16_bf16 v[32:47], v[128:131], v[100:103], v[32:47]
    v_exp_f32 v94, v94
    v_exp_f32 v95, v95
    v_cvt_pk_bf16_f32 v108, v88, v89
    v_cvt_pk_bf16_f32 v109, v90, v91
    v_cvt_pk_bf16_f32 v110, v92, v93
    v_cvt_pk_bf16_f32 v111, v94, v95
    v_mfma_f32_32x32x16_bf16 v[80:95], v[116:119], v[24:27], 0
    ds_read_b128 v[112:115], v14 offset:6144
    v_exp_f32 v64, v64
    v_exp_f32 v65, v65
    v_exp_f32 v66, v66
    v_exp_f32 v67, v67
    v_exp_f32 v68, v68
    v_exp_f32 v69, v69
    v_mfma_f32_32x32x16_bf16 v[48:63], v[124:127], v[104:107], v[48:63]
    ds_read_b128 v[132:135], v140 offset:6080
    v_exp_f32 v70, v70
    v_cvt_pk_bf16_f32 v96, v64, v65
    v_exp_f32 v71, v71
    v_cvt_pk_bf16_f32 v97, v66, v67
    v_exp_f32 v72, v72
    v_exp_f32 v73, v73
    v_mfma_f32_32x32x8_bf16 v[80:95], v[122:123], v[28:29], v[80:95]
    ds_read_b32 v120, v15 offset:768
    v_exp_f32 v74, v74
    v_cvt_pk_bf16_f32 v98, v68, v69
    v_exp_f32 v75, v75
    v_cvt_pk_bf16_f32 v99, v70, v71
    v_exp_f32 v76, v76
    v_exp_f32 v77, v77
    v_mfma_f32_32x32x16_bf16 v[48:63], v[128:131], v[108:111], v[48:63]
    ds_read_b128 v[136:139], v140 offset:6688
    v_exp_f32 v78, v78
    v_exp_f32 v79, v79
    v_cvt_pk_bf16_f32 v100, v72, v73
    v_cvt_pk_bf16_f32 v101, v74, v75
    v_cvt_pk_bf16_f32 v102, v76, v77
    v_cvt_pk_bf16_f32 v103, v78, v79
    s_waitcnt lgkmcnt(0)
    v_mfma_f32_32x32x16_bf16 v[64:79], v[112:115], v[16:19], 0
    v_exp_f32 v80, v80
    v_exp_f32 v81, v81
    v_exp_f32 v82, v82
    v_exp_f32 v83, v83
    v_exp_f32 v84, v84
    v_exp_f32 v85, v85
    v_mfma_f32_32x32x16_bf16 v[32:47], v[132:135], v[96:99], v[32:47]
    global_load_dwordx4 v[196:199], v[144:145], off
    v_lshl_add_u64 v[144:145], v[144:145], 0, s[68:69]
    v_exp_f32 v86, v86
    v_cvt_pk_bf16_f32 v104, v80, v81
    v_exp_f32 v87, v87
    v_cvt_pk_bf16_f32 v105, v82, v83
    v_exp_f32 v88, v88
    v_exp_f32 v89, v89
    v_mfma_f32_32x32x8_bf16 v[64:79], v[120:121], v[20:21], v[64:79]
    v_exp_f32 v90, v90
    v_cvt_pk_bf16_f32 v106, v84, v85
    v_exp_f32 v91, v91
    v_cvt_pk_bf16_f32 v107, v86, v87
    v_exp_f32 v92, v92
    v_exp_f32 v93, v93
    v_mfma_f32_32x32x16_bf16 v[32:47], v[136:139], v[100:103], v[32:47]
    v_exp_f32 v94, v94
    v_exp_f32 v95, v95
    v_cvt_pk_bf16_f32 v108, v88, v89
    v_cvt_pk_bf16_f32 v109, v90, v91
    v_cvt_pk_bf16_f32 v110, v92, v93
    v_cvt_pk_bf16_f32 v111, v94, v95
    v_mfma_f32_32x32x16_bf16 v[80:95], v[112:115], v[24:27], 0
    ds_read_b128 v[116:119], v14 offset:7168
    v_exp_f32 v64, v64
    v_exp_f32 v65, v65
    v_exp_f32 v66, v66
    v_exp_f32 v67, v67
    v_exp_f32 v68, v68
    v_exp_f32 v69, v69
    v_mfma_f32_32x32x16_bf16 v[48:63], v[132:135], v[104:107], v[48:63]
    ds_read_b128 v[124:127], v140 offset:7296
    v_exp_f32 v70, v70
    v_cvt_pk_bf16_f32 v96, v64, v65
    v_exp_f32 v71, v71
    v_cvt_pk_bf16_f32 v97, v66, v67
    v_exp_f32 v72, v72
    v_exp_f32 v73, v73
    v_mfma_f32_32x32x8_bf16 v[80:95], v[120:121], v[28:29], v[80:95]
    ds_read_b32 v122, v15 offset:896
    v_exp_f32 v74, v74
    v_cvt_pk_bf16_f32 v98, v68, v69
    v_exp_f32 v75, v75
    v_cvt_pk_bf16_f32 v99, v70, v71
    v_exp_f32 v76, v76
    v_exp_f32 v77, v77
    v_mfma_f32_32x32x16_bf16 v[48:63], v[136:139], v[108:111], v[48:63]
    ds_read_b128 v[128:131], v140 offset:7904
    v_exp_f32 v78, v78
    v_exp_f32 v79, v79
    v_cvt_pk_bf16_f32 v100, v72, v73
    v_cvt_pk_bf16_f32 v101, v74, v75
    v_cvt_pk_bf16_f32 v102, v76, v77
    v_cvt_pk_bf16_f32 v103, v78, v79
    s_waitcnt lgkmcnt(0)
    v_mfma_f32_32x32x16_bf16 v[64:79], v[116:119], v[16:19], 0
    v_exp_f32 v80, v80
    v_exp_f32 v81, v81
    v_exp_f32 v82, v82
    v_exp_f32 v83, v83
    v_exp_f32 v84, v84
    v_exp_f32 v85, v85
    v_mfma_f32_32x32x16_bf16 v[32:47], v[124:127], v[96:99], v[32:47]
    global_load_dwordx4 v[200:203], v[144:145], off
    v_lshl_add_u64 v[144:145], v[144:145], 0, s[68:69]
    v_exp_f32 v86, v86
    v_cvt_pk_bf16_f32 v104, v80, v81
    v_exp_f32 v87, v87
    v_cvt_pk_bf16_f32 v105, v82, v83
    v_exp_f32 v88, v88
    v_exp_f32 v89, v89
    v_mfma_f32_32x32x8_bf16 v[64:79], v[122:123], v[20:21], v[64:79]
    v_exp_f32 v90, v90
    v_cvt_pk_bf16_f32 v106, v84, v85
    v_exp_f32 v91, v91
    v_cvt_pk_bf16_f32 v107, v86, v87
    v_exp_f32 v92, v92
    v_exp_f32 v93, v93
    v_mfma_f32_32x32x16_bf16 v[32:47], v[128:131], v[100:103], v[32:47]
    v_exp_f32 v94, v94
    v_exp_f32 v95, v95
    v_cvt_pk_bf16_f32 v108, v88, v89
    v_cvt_pk_bf16_f32 v109, v90, v91
    v_cvt_pk_bf16_f32 v110, v92, v93
    v_cvt_pk_bf16_f32 v111, v94, v95
    v_mfma_f32_32x32x16_bf16 v[80:95], v[116:119], v[24:27], 0
    ds_read_b128 v[112:115], v14 offset:8192
    v_exp_f32 v64, v64
    v_exp_f32 v65, v65
    v_exp_f32 v66, v66
    v_exp_f32 v67, v67
    v_exp_f32 v68, v68
    v_exp_f32 v69, v69
    v_mfma_f32_32x32x16_bf16 v[48:63], v[124:127], v[104:107], v[48:63]
    ds_read_b128 v[132:135], v140 offset:8512
    v_exp_f32 v70, v70
    v_cvt_pk_bf16_f32 v96, v64, v65
    v_exp_f32 v71, v71
    v_cvt_pk_bf16_f32 v97, v66, v67
    v_exp_f32 v72, v72
    v_exp_f32 v73, v73
    v_mfma_f32_32x32x8_bf16 v[80:95], v[122:123], v[28:29], v[80:95]
    ds_read_b32 v120, v15 offset:1024
    v_exp_f32 v74, v74
    v_cvt_pk_bf16_f32 v98, v68, v69
    v_exp_f32 v75, v75
    v_cvt_pk_bf16_f32 v99, v70, v71
    v_exp_f32 v76, v76
    v_exp_f32 v77, v77
    v_mfma_f32_32x32x16_bf16 v[48:63], v[128:131], v[108:111], v[48:63]
    ds_read_b128 v[136:139], v140 offset:9120
    v_exp_f32 v78, v78
    v_exp_f32 v79, v79
    v_cvt_pk_bf16_f32 v100, v72, v73
    v_cvt_pk_bf16_f32 v101, v74, v75
    v_cvt_pk_bf16_f32 v102, v76, v77
    v_cvt_pk_bf16_f32 v103, v78, v79
    s_waitcnt lgkmcnt(0)
    v_mfma_f32_32x32x16_bf16 v[64:79], v[112:115], v[16:19], 0
    v_exp_f32 v80, v80
    v_exp_f32 v81, v81
    v_exp_f32 v82, v82
    v_exp_f32 v83, v83
    v_exp_f32 v84, v84
    v_exp_f32 v85, v85
    v_mfma_f32_32x32x16_bf16 v[32:47], v[132:135], v[96:99], v[32:47]
    global_load_dwordx4 v[204:207], v[144:145], off
    v_lshl_add_u64 v[144:145], v[144:145], 0, s[68:69]
    v_exp_f32 v86, v86
    v_cvt_pk_bf16_f32 v104, v80, v81
    v_exp_f32 v87, v87
    v_cvt_pk_bf16_f32 v105, v82, v83
    v_exp_f32 v88, v88
    v_exp_f32 v89, v89
    v_mfma_f32_32x32x8_bf16 v[64:79], v[120:121], v[20:21], v[64:79]
    v_exp_f32 v90, v90
    v_cvt_pk_bf16_f32 v106, v84, v85
    v_exp_f32 v91, v91
    v_cvt_pk_bf16_f32 v107, v86, v87
    v_exp_f32 v92, v92
    v_exp_f32 v93, v93
    v_mfma_f32_32x32x16_bf16 v[32:47], v[136:139], v[100:103], v[32:47]
    v_exp_f32 v94, v94
    v_exp_f32 v95, v95
    v_cvt_pk_bf16_f32 v108, v88, v89
    v_cvt_pk_bf16_f32 v109, v90, v91
    v_cvt_pk_bf16_f32 v110, v92, v93
    v_cvt_pk_bf16_f32 v111, v94, v95
    v_mfma_f32_32x32x16_bf16 v[80:95], v[112:115], v[24:27], 0
    ds_read_b128 v[116:119], v14 offset:9216
    v_exp_f32 v64, v64
    v_exp_f32 v65, v65
    v_exp_f32 v66, v66
    v_exp_f32 v67, v67
    v_exp_f32 v68, v68
    v_exp_f32 v69, v69
    v_mfma_f32_32x32x16_bf16 v[48:63], v[132:135], v[104:107], v[48:63]
    ds_read_b128 v[124:127], v140 offset:9728
    v_exp_f32 v70, v70
    v_cvt_pk_bf16_f32 v96, v64, v65
    v_exp_f32 v71, v71
    v_cvt_pk_bf16_f32 v97, v66, v67
    v_exp_f32 v72, v72
    v_exp_f32 v73, v73
    v_mfma_f32_32x32x8_bf16 v[80:95], v[120:121], v[28:29], v[80:95]
    ds_read_b32 v122, v15 offset:1152
    v_exp_f32 v74, v74
    v_cvt_pk_bf16_f32 v98, v68, v69
    v_exp_f32 v75, v75
    v_cvt_pk_bf16_f32 v99, v70, v71
    v_exp_f32 v76, v76
    v_exp_f32 v77, v77
    v_mfma_f32_32x32x16_bf16 v[48:63], v[136:139], v[108:111], v[48:63]
    ds_read_b128 v[128:131], v140 offset:10336
    v_exp_f32 v78, v78
    v_exp_f32 v79, v79
    v_cvt_pk_bf16_f32 v100, v72, v73
    v_cvt_pk_bf16_f32 v101, v74, v75
    v_cvt_pk_bf16_f32 v102, v76, v77
    v_cvt_pk_bf16_f32 v103, v78, v79
    s_waitcnt lgkmcnt(0)
    v_mfma_f32_32x32x16_bf16 v[64:79], v[116:119], v[16:19], 0
    v_exp_f32 v80, v80
    v_exp_f32 v81, v81
    v_exp_f32 v82, v82
    v_exp_f32 v83, v83
    v_exp_f32 v84, v84
    v_exp_f32 v85, v85
    v_mfma_f32_32x32x16_bf16 v[32:47], v[124:127], v[96:99], v[32:47]
    global_load_dwordx4 v[208:211], v[144:145], off
    v_exp_f32 v86, v86
    v_cvt_pk_bf16_f32 v104, v80, v81
    v_exp_f32 v87, v87
    v_cvt_pk_bf16_f32 v105, v82, v83
    v_exp_f32 v88, v88
    v_exp_f32 v89, v89
    v_mfma_f32_32x32x8_bf16 v[64:79], v[122:123], v[20:21], v[64:79]
    v_exp_f32 v90, v90
    v_cvt_pk_bf16_f32 v106, v84, v85
    v_exp_f32 v91, v91
    v_cvt_pk_bf16_f32 v107, v86, v87
    v_exp_f32 v92, v92
    v_exp_f32 v93, v93
    v_mfma_f32_32x32x16_bf16 v[32:47], v[128:131], v[100:103], v[32:47]
    v_exp_f32 v94, v94
    v_exp_f32 v95, v95
    v_cvt_pk_bf16_f32 v108, v88, v89
    v_cvt_pk_bf16_f32 v109, v90, v91
    v_cvt_pk_bf16_f32 v110, v92, v93
    v_cvt_pk_bf16_f32 v111, v94, v95
    v_mfma_f32_32x32x16_bf16 v[80:95], v[116:119], v[24:27], 0
    ds_read_b128 v[112:115], v14 offset:10240
    v_exp_f32 v64, v64
    v_exp_f32 v65, v65
    v_exp_f32 v66, v66
    v_exp_f32 v67, v67
    v_exp_f32 v68, v68
    v_exp_f32 v69, v69
    v_mfma_f32_32x32x16_bf16 v[48:63], v[124:127], v[104:107], v[48:63]
    ds_read_b128 v[132:135], v140 offset:10944
    v_exp_f32 v70, v70
    v_cvt_pk_bf16_f32 v96, v64, v65
    v_exp_f32 v71, v71
    v_cvt_pk_bf16_f32 v97, v66, v67
    v_exp_f32 v72, v72
    v_exp_f32 v73, v73
    v_mfma_f32_32x32x8_bf16 v[80:95], v[122:123], v[28:29], v[80:95]
    ds_read_b32 v120, v15 offset:1280
    v_exp_f32 v74, v74
    v_cvt_pk_bf16_f32 v98, v68, v69
    v_exp_f32 v75, v75
    v_cvt_pk_bf16_f32 v99, v70, v71
    v_exp_f32 v76, v76
    v_exp_f32 v77, v77
    v_mfma_f32_32x32x16_bf16 v[48:63], v[128:131], v[108:111], v[48:63]
    ds_read_b128 v[136:139], v140 offset:11552
    v_exp_f32 v78, v78
    v_exp_f32 v79, v79
    v_cvt_pk_bf16_f32 v100, v72, v73
    v_cvt_pk_bf16_f32 v101, v74, v75
    v_cvt_pk_bf16_f32 v102, v76, v77
    v_cvt_pk_bf16_f32 v103, v78, v79
    s_waitcnt lgkmcnt(0)
    v_mfma_f32_32x32x16_bf16 v[64:79], v[112:115], v[16:19], 0
    v_exp_f32 v80, v80
    v_exp_f32 v81, v81
    v_exp_f32 v82, v82
    v_exp_f32 v83, v83
    v_exp_f32 v84, v84
    v_exp_f32 v85, v85
    v_mfma_f32_32x32x16_bf16 v[32:47], v[132:135], v[96:99], v[32:47]
    global_load_dwordx4 v[212:215], v[146:147], off
    v_lshl_add_u64 v[146:147], v[146:147], 0, s[70:71]
    v_exp_f32 v86, v86
    v_cvt_pk_bf16_f32 v104, v80, v81
    v_exp_f32 v87, v87
    v_cvt_pk_bf16_f32 v105, v82, v83
    v_exp_f32 v88, v88
    v_exp_f32 v89, v89
    v_mfma_f32_32x32x8_bf16 v[64:79], v[120:121], v[20:21], v[64:79]
    v_exp_f32 v90, v90
    v_cvt_pk_bf16_f32 v106, v84, v85
    v_exp_f32 v91, v91
    v_cvt_pk_bf16_f32 v107, v86, v87
    v_exp_f32 v92, v92
    v_exp_f32 v93, v93
    v_mfma_f32_32x32x16_bf16 v[32:47], v[136:139], v[100:103], v[32:47]
    v_exp_f32 v94, v94
    v_exp_f32 v95, v95
    v_cvt_pk_bf16_f32 v108, v88, v89
    v_cvt_pk_bf16_f32 v109, v90, v91
    v_cvt_pk_bf16_f32 v110, v92, v93
    v_cvt_pk_bf16_f32 v111, v94, v95
    v_mfma_f32_32x32x16_bf16 v[80:95], v[112:115], v[24:27], 0
    ds_read_b128 v[116:119], v14 offset:11264
    v_exp_f32 v64, v64
    v_exp_f32 v65, v65
    v_exp_f32 v66, v66
    v_exp_f32 v67, v67
    v_exp_f32 v68, v68
    v_exp_f32 v69, v69
    v_mfma_f32_32x32x16_bf16 v[48:63], v[132:135], v[104:107], v[48:63]
    ds_read_b128 v[124:127], v140 offset:12160
    v_exp_f32 v70, v70
    v_cvt_pk_bf16_f32 v96, v64, v65
    v_exp_f32 v71, v71
    v_cvt_pk_bf16_f32 v97, v66, v67
    v_exp_f32 v72, v72
    v_exp_f32 v73, v73
    v_mfma_f32_32x32x8_bf16 v[80:95], v[120:121], v[28:29], v[80:95]
    ds_read_b32 v122, v15 offset:1408
    v_exp_f32 v74, v74
    v_cvt_pk_bf16_f32 v98, v68, v69
    v_exp_f32 v75, v75
    v_cvt_pk_bf16_f32 v99, v70, v71
    v_exp_f32 v76, v76
    v_exp_f32 v77, v77
    v_mfma_f32_32x32x16_bf16 v[48:63], v[136:139], v[108:111], v[48:63]
    ds_read_b128 v[128:131], v140 offset:12768
    v_exp_f32 v78, v78
    v_exp_f32 v79, v79
    v_cvt_pk_bf16_f32 v100, v72, v73
    v_cvt_pk_bf16_f32 v101, v74, v75
    v_cvt_pk_bf16_f32 v102, v76, v77
    v_cvt_pk_bf16_f32 v103, v78, v79
    s_waitcnt lgkmcnt(0)
    v_mfma_f32_32x32x16_bf16 v[64:79], v[116:119], v[16:19], 0
    v_exp_f32 v80, v80
    v_exp_f32 v81, v81
    v_exp_f32 v82, v82
    v_exp_f32 v83, v83
    v_exp_f32 v84, v84
    v_exp_f32 v85, v85
    v_mfma_f32_32x32x16_bf16 v[32:47], v[124:127], v[96:99], v[32:47]
    global_load_dwordx4 v[216:219], v[146:147], off
    v_lshl_add_u64 v[146:147], v[146:147], 0, s[72:73]
    v_exp_f32 v86, v86
    v_cvt_pk_bf16_f32 v104, v80, v81
    v_exp_f32 v87, v87
    v_cvt_pk_bf16_f32 v105, v82, v83
    v_exp_f32 v88, v88
    v_exp_f32 v89, v89
    v_mfma_f32_32x32x8_bf16 v[64:79], v[122:123], v[20:21], v[64:79]
    v_exp_f32 v90, v90
    v_cvt_pk_bf16_f32 v106, v84, v85
    v_exp_f32 v91, v91
    v_cvt_pk_bf16_f32 v107, v86, v87
    v_exp_f32 v92, v92
    v_exp_f32 v93, v93
    v_mfma_f32_32x32x16_bf16 v[32:47], v[128:131], v[100:103], v[32:47]
    v_exp_f32 v94, v94
    v_exp_f32 v95, v95
    v_cvt_pk_bf16_f32 v108, v88, v89
    v_cvt_pk_bf16_f32 v109, v90, v91
    v_cvt_pk_bf16_f32 v110, v92, v93
    v_cvt_pk_bf16_f32 v111, v94, v95
    v_mfma_f32_32x32x16_bf16 v[80:95], v[116:119], v[24:27], 0
    ds_read_b128 v[112:115], v14 offset:12288
    v_exp_f32 v64, v64
    v_exp_f32 v65, v65
    v_exp_f32 v66, v66
    v_exp_f32 v67, v67
    v_exp_f32 v68, v68
    v_exp_f32 v69, v69
    v_mfma_f32_32x32x16_bf16 v[48:63], v[124:127], v[104:107], v[48:63]
    ds_read_b128 v[132:135], v140 offset:13376
    v_exp_f32 v70, v70
    v_cvt_pk_bf16_f32 v96, v64, v65
    v_exp_f32 v71, v71
    v_cvt_pk_bf16_f32 v97, v66, v67
    v_exp_f32 v72, v72
    v_exp_f32 v73, v73
    v_mfma_f32_32x32x8_bf16 v[80:95], v[122:123], v[28:29], v[80:95]
    ds_read_b32 v120, v15 offset:1536
    v_exp_f32 v74, v74
    v_cvt_pk_bf16_f32 v98, v68, v69
    v_exp_f32 v75, v75
    v_cvt_pk_bf16_f32 v99, v70, v71
    v_exp_f32 v76, v76
    v_exp_f32 v77, v77
    v_mfma_f32_32x32x16_bf16 v[48:63], v[128:131], v[108:111], v[48:63]
    ds_read_b128 v[136:139], v140 offset:13984
    v_exp_f32 v78, v78
    v_exp_f32 v79, v79
    v_cvt_pk_bf16_f32 v100, v72, v73
    v_cvt_pk_bf16_f32 v101, v74, v75
    v_cvt_pk_bf16_f32 v102, v76, v77
    v_cvt_pk_bf16_f32 v103, v78, v79
    s_waitcnt lgkmcnt(0)
    v_mfma_f32_32x32x16_bf16 v[64:79], v[112:115], v[16:19], 0
    v_exp_f32 v80, v80
    v_exp_f32 v81, v81
    v_exp_f32 v82, v82
    v_exp_f32 v83, v83
    v_exp_f32 v84, v84
    v_exp_f32 v85, v85
    v_mfma_f32_32x32x16_bf16 v[32:47], v[132:135], v[96:99], v[32:47]
    global_load_dwordx4 v[220:223], v[146:147], off
    v_lshl_add_u64 v[146:147], v[146:147], 0, s[70:71]
    v_exp_f32 v86, v86
    v_cvt_pk_bf16_f32 v104, v80, v81
    v_exp_f32 v87, v87
    v_cvt_pk_bf16_f32 v105, v82, v83
    v_exp_f32 v88, v88
    v_exp_f32 v89, v89
    v_mfma_f32_32x32x8_bf16 v[64:79], v[120:121], v[20:21], v[64:79]
    v_exp_f32 v90, v90
    v_cvt_pk_bf16_f32 v106, v84, v85
    v_exp_f32 v91, v91
    v_cvt_pk_bf16_f32 v107, v86, v87
    v_exp_f32 v92, v92
    v_exp_f32 v93, v93
    v_mfma_f32_32x32x16_bf16 v[32:47], v[136:139], v[100:103], v[32:47]
    v_exp_f32 v94, v94
    v_exp_f32 v95, v95
    v_cvt_pk_bf16_f32 v108, v88, v89
    v_cvt_pk_bf16_f32 v109, v90, v91
    v_cvt_pk_bf16_f32 v110, v92, v93
    v_cvt_pk_bf16_f32 v111, v94, v95
    v_mfma_f32_32x32x16_bf16 v[80:95], v[112:115], v[24:27], 0
    ds_read_b128 v[116:119], v14 offset:13312
    v_exp_f32 v64, v64
    v_exp_f32 v65, v65
    v_exp_f32 v66, v66
    v_exp_f32 v67, v67
    v_exp_f32 v68, v68
    v_exp_f32 v69, v69
    v_mfma_f32_32x32x16_bf16 v[48:63], v[132:135], v[104:107], v[48:63]
    ds_read_b128 v[124:127], v140 offset:14592
    v_exp_f32 v70, v70
    v_cvt_pk_bf16_f32 v96, v64, v65
    v_exp_f32 v71, v71
    v_cvt_pk_bf16_f32 v97, v66, v67
    v_exp_f32 v72, v72
    v_exp_f32 v73, v73
    v_mfma_f32_32x32x8_bf16 v[80:95], v[120:121], v[28:29], v[80:95]
    ds_read_b32 v122, v15 offset:1664
    v_exp_f32 v74, v74
    v_cvt_pk_bf16_f32 v98, v68, v69
    v_exp_f32 v75, v75
    v_cvt_pk_bf16_f32 v99, v70, v71
    v_exp_f32 v76, v76
    v_exp_f32 v77, v77
    v_mfma_f32_32x32x16_bf16 v[48:63], v[136:139], v[108:111], v[48:63]
    ds_read_b128 v[128:131], v140 offset:15200
    v_exp_f32 v78, v78
    v_exp_f32 v79, v79
    v_cvt_pk_bf16_f32 v100, v72, v73
    v_cvt_pk_bf16_f32 v101, v74, v75
    v_cvt_pk_bf16_f32 v102, v76, v77
    v_cvt_pk_bf16_f32 v103, v78, v79
    s_waitcnt lgkmcnt(0)
    v_mfma_f32_32x32x16_bf16 v[64:79], v[116:119], v[16:19], 0
    v_exp_f32 v80, v80
    v_exp_f32 v81, v81
    v_exp_f32 v82, v82
    v_exp_f32 v83, v83
    v_exp_f32 v84, v84
    v_exp_f32 v85, v85
    v_mfma_f32_32x32x16_bf16 v[32:47], v[124:127], v[96:99], v[32:47]
    global_load_dwordx4 v[224:227], v[146:147], off
    v_lshl_add_u64 v[146:147], v[146:147], 0, s[72:73]
    v_exp_f32 v86, v86
    v_cvt_pk_bf16_f32 v104, v80, v81
    v_exp_f32 v87, v87
    v_cvt_pk_bf16_f32 v105, v82, v83
    v_exp_f32 v88, v88
    v_exp_f32 v89, v89
    v_mfma_f32_32x32x8_bf16 v[64:79], v[122:123], v[20:21], v[64:79]
    v_exp_f32 v90, v90
    v_cvt_pk_bf16_f32 v106, v84, v85
    v_exp_f32 v91, v91
    v_cvt_pk_bf16_f32 v107, v86, v87
    v_exp_f32 v92, v92
    v_exp_f32 v93, v93
    v_mfma_f32_32x32x16_bf16 v[32:47], v[128:131], v[100:103], v[32:47]
    v_exp_f32 v94, v94
    v_exp_f32 v95, v95
    v_cvt_pk_bf16_f32 v108, v88, v89
    v_cvt_pk_bf16_f32 v109, v90, v91
    v_cvt_pk_bf16_f32 v110, v92, v93
    v_cvt_pk_bf16_f32 v111, v94, v95
    v_mfma_f32_32x32x16_bf16 v[80:95], v[116:119], v[24:27], 0
    ds_read_b128 v[112:115], v14 offset:14336
    v_exp_f32 v64, v64
    v_exp_f32 v65, v65
    v_exp_f32 v66, v66
    v_exp_f32 v67, v67
    v_exp_f32 v68, v68
    v_exp_f32 v69, v69
    v_mfma_f32_32x32x16_bf16 v[48:63], v[124:127], v[104:107], v[48:63]
    ds_read_b128 v[132:135], v140 offset:15808
    v_exp_f32 v70, v70
    v_cvt_pk_bf16_f32 v96, v64, v65
    v_exp_f32 v71, v71
    v_cvt_pk_bf16_f32 v97, v66, v67
    v_exp_f32 v72, v72
    v_exp_f32 v73, v73
    v_mfma_f32_32x32x8_bf16 v[80:95], v[122:123], v[28:29], v[80:95]
    ds_read_b32 v120, v15 offset:1792
    v_exp_f32 v74, v74
    v_cvt_pk_bf16_f32 v98, v68, v69
    v_exp_f32 v75, v75
    v_cvt_pk_bf16_f32 v99, v70, v71
    v_exp_f32 v76, v76
    v_exp_f32 v77, v77
    v_mfma_f32_32x32x16_bf16 v[48:63], v[128:131], v[108:111], v[48:63]
    ds_read_b128 v[136:139], v140 offset:16416
    v_exp_f32 v78, v78
    v_exp_f32 v79, v79
    v_cvt_pk_bf16_f32 v100, v72, v73
    v_cvt_pk_bf16_f32 v101, v74, v75
    v_cvt_pk_bf16_f32 v102, v76, v77
    v_cvt_pk_bf16_f32 v103, v78, v79
    s_waitcnt lgkmcnt(0)
    v_mfma_f32_32x32x16_bf16 v[64:79], v[112:115], v[16:19], 0
    v_exp_f32 v80, v80
    v_exp_f32 v81, v81
    v_exp_f32 v82, v82
    v_exp_f32 v83, v83
    v_exp_f32 v84, v84
    v_exp_f32 v85, v85
    v_mfma_f32_32x32x16_bf16 v[32:47], v[132:135], v[96:99], v[32:47]
    global_load_dwordx4 v[228:231], v[146:147], off
    v_lshl_add_u64 v[146:147], v[146:147], 0, s[70:71]
    v_exp_f32 v86, v86
    v_cvt_pk_bf16_f32 v104, v80, v81
    v_exp_f32 v87, v87
    v_cvt_pk_bf16_f32 v105, v82, v83
    v_exp_f32 v88, v88
    v_exp_f32 v89, v89
    v_mfma_f32_32x32x8_bf16 v[64:79], v[120:121], v[20:21], v[64:79]
    v_exp_f32 v90, v90
    v_cvt_pk_bf16_f32 v106, v84, v85
    v_exp_f32 v91, v91
    v_cvt_pk_bf16_f32 v107, v86, v87
    v_exp_f32 v92, v92
    v_exp_f32 v93, v93
    v_mfma_f32_32x32x16_bf16 v[32:47], v[136:139], v[100:103], v[32:47]
    v_exp_f32 v94, v94
    v_exp_f32 v95, v95
    v_cvt_pk_bf16_f32 v108, v88, v89
    v_cvt_pk_bf16_f32 v109, v90, v91
    v_cvt_pk_bf16_f32 v110, v92, v93
    v_cvt_pk_bf16_f32 v111, v94, v95
    v_mfma_f32_32x32x16_bf16 v[80:95], v[112:115], v[24:27], 0
    ds_read_b128 v[116:119], v14 offset:15360
    v_exp_f32 v64, v64
    v_exp_f32 v65, v65
    v_exp_f32 v66, v66
    v_exp_f32 v67, v67
    v_exp_f32 v68, v68
    v_exp_f32 v69, v69
    v_mfma_f32_32x32x16_bf16 v[48:63], v[132:135], v[104:107], v[48:63]
    ds_read_b128 v[124:127], v140 offset:17024
    v_exp_f32 v70, v70
    v_cvt_pk_bf16_f32 v96, v64, v65
    v_exp_f32 v71, v71
    v_cvt_pk_bf16_f32 v97, v66, v67
    v_exp_f32 v72, v72
    v_exp_f32 v73, v73
    v_mfma_f32_32x32x8_bf16 v[80:95], v[120:121], v[28:29], v[80:95]
    ds_read_b32 v122, v15 offset:1920
    v_exp_f32 v74, v74
    v_cvt_pk_bf16_f32 v98, v68, v69
    v_exp_f32 v75, v75
    v_cvt_pk_bf16_f32 v99, v70, v71
    v_exp_f32 v76, v76
    v_exp_f32 v77, v77
    v_mfma_f32_32x32x16_bf16 v[48:63], v[136:139], v[108:111], v[48:63]
    ds_read_b128 v[128:131], v140 offset:17632
    v_exp_f32 v78, v78
    v_exp_f32 v79, v79
    v_cvt_pk_bf16_f32 v100, v72, v73
    v_cvt_pk_bf16_f32 v101, v74, v75
    v_cvt_pk_bf16_f32 v102, v76, v77
    v_cvt_pk_bf16_f32 v103, v78, v79
    s_waitcnt lgkmcnt(0)
    v_mfma_f32_32x32x16_bf16 v[64:79], v[116:119], v[16:19], 0
    v_exp_f32 v80, v80
    v_exp_f32 v81, v81
    v_exp_f32 v82, v82
    v_exp_f32 v83, v83
    v_exp_f32 v84, v84
    v_exp_f32 v85, v85
    v_mfma_f32_32x32x16_bf16 v[32:47], v[124:127], v[96:99], v[32:47]
    global_load_dwordx4 v[232:235], v[146:147], off
    v_lshl_add_u64 v[146:147], v[146:147], 0, s[72:73]
    v_exp_f32 v86, v86
    v_cvt_pk_bf16_f32 v104, v80, v81
    v_exp_f32 v87, v87
    v_cvt_pk_bf16_f32 v105, v82, v83
    v_exp_f32 v88, v88
    v_exp_f32 v89, v89
    v_mfma_f32_32x32x8_bf16 v[64:79], v[122:123], v[20:21], v[64:79]
    v_exp_f32 v90, v90
    v_cvt_pk_bf16_f32 v106, v84, v85
    v_exp_f32 v91, v91
    v_cvt_pk_bf16_f32 v107, v86, v87
    v_exp_f32 v92, v92
    v_exp_f32 v93, v93
    v_mfma_f32_32x32x16_bf16 v[32:47], v[128:131], v[100:103], v[32:47]
    v_exp_f32 v94, v94
    v_exp_f32 v95, v95
    v_cvt_pk_bf16_f32 v108, v88, v89
    v_cvt_pk_bf16_f32 v109, v90, v91
    v_cvt_pk_bf16_f32 v110, v92, v93
    v_cvt_pk_bf16_f32 v111, v94, v95
    s_waitcnt vmcnt(11)
    s_barrier
    v_mfma_f32_32x32x16_bf16 v[80:95], v[116:119], v[24:27], 0
    ds_read_b128 v[112:115], v14 offset:37888
    v_exp_f32 v64, v64
    v_exp_f32 v65, v65
    v_exp_f32 v66, v66
    v_exp_f32 v67, v67
    v_exp_f32 v68, v68
    v_exp_f32 v69, v69
    v_mfma_f32_32x32x16_bf16 v[48:63], v[124:127], v[104:107], v[48:63]
    ds_read_b128 v[132:135], v140 offset:18240
    v_exp_f32 v70, v70
    v_cvt_pk_bf16_f32 v96, v64, v65
    v_exp_f32 v71, v71
    v_cvt_pk_bf16_f32 v97, v66, v67
    v_exp_f32 v72, v72
    v_exp_f32 v73, v73
    v_mfma_f32_32x32x8_bf16 v[80:95], v[122:123], v[28:29], v[80:95]
    ds_read_b32 v120, v15 offset:37888
    v_exp_f32 v74, v74
    v_cvt_pk_bf16_f32 v98, v68, v69
    v_exp_f32 v75, v75
    v_cvt_pk_bf16_f32 v99, v70, v71
    v_exp_f32 v76, v76
    v_exp_f32 v77, v77
    v_mfma_f32_32x32x16_bf16 v[48:63], v[128:131], v[108:111], v[48:63]
    ds_read_b128 v[136:139], v140 offset:18848
    v_exp_f32 v78, v78
    v_exp_f32 v79, v79
    v_cvt_pk_bf16_f32 v100, v72, v73
    v_cvt_pk_bf16_f32 v101, v74, v75
    v_cvt_pk_bf16_f32 v102, v76, v77
    v_cvt_pk_bf16_f32 v103, v78, v79
    s_waitcnt lgkmcnt(0)
    v_mfma_f32_32x32x16_bf16 v[64:79], v[112:115], v[16:19], 0
    v_add_u32 v14, 37888, v14
    v_exp_f32 v80, v80
    v_exp_f32 v81, v81
    v_exp_f32 v82, v82
    v_exp_f32 v83, v83
    v_exp_f32 v84, v84
    v_exp_f32 v85, v85
    v_mfma_f32_32x32x16_bf16 v[32:47], v[132:135], v[96:99], v[32:47]
    v_add_u32 v15, 37888, v15
    global_load_dwordx4 v[236:239], v[146:147], off
    v_lshl_add_u64 v[146:147], v[146:147], 0, s[70:71]
    v_exp_f32 v86, v86
    v_cvt_pk_bf16_f32 v104, v80, v81
    v_exp_f32 v87, v87
    v_cvt_pk_bf16_f32 v105, v82, v83
    v_exp_f32 v88, v88
    v_exp_f32 v89, v89
    v_mfma_f32_32x32x8_bf16 v[64:79], v[120:121], v[20:21], v[64:79]
    v_add_u32 v140, 37888, v140
    v_exp_f32 v90, v90
    v_cvt_pk_bf16_f32 v106, v84, v85
    v_exp_f32 v91, v91
    v_cvt_pk_bf16_f32 v107, v86, v87
    v_exp_f32 v92, v92
    v_exp_f32 v93, v93
    v_mfma_f32_32x32x16_bf16 v[32:47], v[136:139], v[100:103], v[32:47]
    global_load_dwordx4 v[240:243], v[146:147], off
    v_exp_f32 v94, v94
    v_exp_f32 v95, v95
    v_cvt_pk_bf16_f32 v108, v88, v89
    v_cvt_pk_bf16_f32 v109, v90, v91
    v_cvt_pk_bf16_f32 v110, v92, v93
    v_cvt_pk_bf16_f32 v111, v94, v95
    s_mov_b32 s44, 0
ATT_LOOP:
    v_mfma_f32_32x32x16_bf16 v[80:95], v[112:115], v[24:27], 0
    ds_read_b128 v[116:119], v14 offset:1024
    buffer_load_dword v178, v179, s[28:31], 0 offen sc1
    v_exp_f32 v64, v64
    v_exp_f32 v65, v65
    v_exp_f32 v66, v66
    v_exp_f32 v67, v67
    v_exp_f32 v68, v68
    v_exp_f32 v69, v69
    v_mfma_f32_32x32x16_bf16 v[48:63], v[132:135], v[104:107], v[48:63]
    ds_read_b128 v[124:127], v140 offset:0
    s_mov_b32 m0, s40
    s_nop 0
    buffer_load_dwordx4 v8, s[8:11], s40 offen offset:0 sc1 lds
    v_exp_f32 v70, v70
    v_cvt_pk_bf16_f32 v96, v64, v65
    v_exp_f32 v71, v71
    v_cvt_pk_bf16_f32 v97, v66, v67
    v_exp_f32 v72, v72
    v_exp_f32 v73, v73
    v_mfma_f32_32x32x8_bf16 v[80:95], v[120:121], v[28:29], v[80:95]
    ds_read_b32 v122, v15 offset:128
    v_exp_f32 v74, v74
    v_cvt_pk_bf16_f32 v98, v68, v69
    v_exp_f32 v75, v75
    v_cvt_pk_bf16_f32 v99, v70, v71
    v_exp_f32 v76, v76
    v_exp_f32 v77, v77
    v_mfma_f32_32x32x16_bf16 v[48:63], v[136:139], v[108:111], v[48:63]
    ds_read_b128 v[128:131], v140 offset:608
    v_exp_f32 v78, v78
    v_exp_f32 v79, v79
    v_cvt_pk_bf16_f32 v100, v72, v73
    v_cvt_pk_bf16_f32 v101, v74, v75
    v_cvt_pk_bf16_f32 v102, v76, v77
    v_cvt_pk_bf16_f32 v103, v78, v79
    s_waitcnt lgkmcnt(0)
    v_mfma_f32_32x32x16_bf16 v[64:79], v[116:119], v[16:19], 0
    v_exp_f32 v80, v80
    v_exp_f32 v81, v81
    v_exp_f32 v82, v82
    v_exp_f32 v83, v83
    v_exp_f32 v84, v84
    v_exp_f32 v85, v85
    v_mfma_f32_32x32x16_bf16 v[32:47], v[124:127], v[96:99], v[32:47]
    v_exp_f32 v86, v86
    v_cvt_pk_bf16_f32 v104, v80, v81
    v_exp_f32 v87, v87
    v_cvt_pk_bf16_f32 v105, v82, v83
    v_exp_f32 v88, v88
    v_exp_f32 v89, v89
    v_mfma_f32_32x32x8_bf16 v[64:79], v[122:123], v[20:21], v[64:79]
    v_exp_f32 v90, v90
    v_cvt_pk_bf16_f32 v106, v84, v85
    v_exp_f32 v91, v91
    v_cvt_pk_bf16_f32 v107, v86, v87
    v_exp_f32 v92, v92
    v_exp_f32 v93, v93
    v_mfma_f32_32x32x16_bf16 v[32:47], v[128:131], v[100:103], v[32:47]
    v_exp_f32 v94, v94
    v_exp_f32 v95, v95
    v_cvt_pk_bf16_f32 v108, v88, v89
    v_cvt_pk_bf16_f32 v109, v90, v91
    v_cvt_pk_bf16_f32 v110, v92, v93
    v_cvt_pk_bf16_f32 v111, v94, v95
    s_waitcnt vmcnt(10)
    v_mfma_f32_32x32x16_bf16 v[80:95], v[116:119], v[24:27], 0
    ds_read_b128 v[112:115], v14 offset:2048
    v_exp_f32 v64, v64
    v_exp_f32 v65, v65
    v_exp_f32 v66, v66
    v_exp_f32 v67, v67
    v_exp_f32 v68, v68
    v_exp_f32 v69, v69
    v_mfma_f32_32x32x16_bf16 v[48:63], v[124:127], v[104:107], v[48:63]
    ds_read_b128 v[132:135], v140 offset:1216
    buffer_load_dwordx4 v8, s[8:11], s40 offen offset:1024 sc1 lds
    v_exp_f32 v70, v70
    v_cvt_pk_bf16_f32 v96, v64, v65
    v_exp_f32 v71, v71
    v_cvt_pk_bf16_f32 v97, v66, v67
    v_exp_f32 v72, v72
    v_exp_f32 v73, v73
    v_mfma_f32_32x32x8_bf16 v[80:95], v[122:123], v[28:29], v[80:95]
    ds_read_b32 v120, v15 offset:256
    v_exp_f32 v74, v74
    v_cvt_pk_bf16_f32 v98, v68, v69
    v_exp_f32 v75, v75
    v_cvt_pk_bf16_f32 v99, v70, v71
    v_exp_f32 v76, v76
    v_exp_f32 v77, v77
    v_mfma_f32_32x32x16_bf16 v[48:63], v[128:131], v[108:111], v[48:63]
    ds_read_b128 v[136:139], v140 offset:1824
    v_perm_b32 v244, v184, v180, s42
    v_perm_b32 v245, v192, v188, s42
    v_exp_f32 v78, v78
    v_exp_f32 v79, v79
    v_cvt_pk_bf16_f32 v100, v72, v73
    v_cvt_pk_bf16_f32 v101, v74, v75
    v_cvt_pk_bf16_f32 v102, v76, v77
    v_cvt_pk_bf16_f32 v103, v78, v79
    s_waitcnt lgkmcnt(0)
    v_mfma_f32_32x32x16_bf16 v[64:79], v[112:115], v[16:19], 0
    v_exp_f32 v80, v80
    v_exp_f32 v81, v81
    v_exp_f32 v82, v82
    v_exp_f32 v83, v83
    v_exp_f32 v84, v84
    v_exp_f32 v85, v85
    v_mfma_f32_32x32x16_bf16 v[32:47], v[132:135], v[96:99], v[32:47]
    v_exp_f32 v86, v86
    v_cvt_pk_bf16_f32 v104, v80, v81
    v_exp_f32 v87, v87
    v_cvt_pk_bf16_f32 v105, v82, v83
    v_exp_f32 v88, v88
    v_exp_f32 v89, v89
    v_mfma_f32_32x32x8_bf16 v[64:79], v[120:121], v[20:21], v[64:79]
    v_exp_f32 v90, v90
    v_cvt_pk_bf16_f32 v106, v84, v85
    v_exp_f32 v91, v91
    v_cvt_pk_bf16_f32 v107, v86, v87
    v_exp_f32 v92, v92
    v_exp_f32 v93, v93
    v_mfma_f32_32x32x16_bf16 v[32:47], v[136:139], v[100:103], v[32:47]
    v_perm_b32 v246, v200, v196, s42
    v_perm_b32 v247, v208, v204, s42
    buffer_store_dwordx4 v[244:247], v22, s[48:51], s33 offen sc1
    s_add_u32 s33, s33, s34
    v_exp_f32 v94, v94
    v_exp_f32 v95, v95
    v_cvt_pk_bf16_f32 v108, v88, v89
    v_cvt_pk_bf16_f32 v109, v90, v91
    v_cvt_pk_bf16_f32 v110, v92, v93
    v_cvt_pk_bf16_f32 v111, v94, v95
    v_mfma_f32_32x32x16_bf16 v[80:95], v[112:115], v[24:27], 0
    ds_read_b128 v[116:119], v14 offset:3072
    v_exp_f32 v64, v64
    v_exp_f32 v65, v65
    v_exp_f32 v66, v66
    v_exp_f32 v67, v67
    v_exp_f32 v68, v68
    v_exp_f32 v69, v69
    v_mfma_f32_32x32x16_bf16 v[48:63], v[132:135], v[104:107], v[48:63]
    ds_read_b128 v[124:127], v140 offset:2432
    buffer_load_dwordx4 v8, s[8:11], s40 offen offset:2048 sc1 lds
    v_exp_f32 v70, v70
    v_cvt_pk_bf16_f32 v96, v64, v65
    v_exp_f32 v71, v71
    v_cvt_pk_bf16_f32 v97, v66, v67
    v_exp_f32 v72, v72
    v_exp_f32 v73, v73
    v_mfma_f32_32x32x8_bf16 v[80:95], v[120:121], v[28:29], v[80:95]
    ds_read_b32 v122, v15 offset:384
    v_exp_f32 v74, v74
    v_cvt_pk_bf16_f32 v98, v68, v69
    v_exp_f32 v75, v75
    v_cvt_pk_bf16_f32 v99, v70, v71
    v_exp_f32 v76, v76
    v_exp_f32 v77, v77
    v_mfma_f32_32x32x16_bf16 v[48:63], v[136:139], v[108:111], v[48:63]
    ds_read_b128 v[128:131], v140 offset:3040
    v_perm_b32 v248, v184, v180, s43
    v_perm_b32 v249, v192, v188, s43
    v_exp_f32 v78, v78
    v_exp_f32 v79, v79
    v_cvt_pk_bf16_f32 v100, v72, v73
    v_cvt_pk_bf16_f32 v101, v74, v75
    v_cvt_pk_bf16_f32 v102, v76, v77
    v_cvt_pk_bf16_f32 v103, v78, v79
    s_waitcnt lgkmcnt(0)
    v_mfma_f32_32x32x16_bf16 v[64:79], v[116:119], v[16:19], 0
    v_exp_f32 v80, v80
    v_exp_f32 v81, v81
    v_exp_f32 v82, v82
    v_exp_f32 v83, v83
    v_exp_f32 v84, v84
    v_exp_f32 v85, v85
    v_mfma_f32_32x32x16_bf16 v[32:47], v[124:127], v[96:99], v[32:47]
    v_exp_f32 v86, v86
    v_cvt_pk_bf16_f32 v104, v80, v81
    v_exp_f32 v87, v87
    v_cvt_pk_bf16_f32 v105, v82, v83
    v_exp_f32 v88, v88
    v_exp_f32 v89, v89
    v_mfma_f32_32x32x8_bf16 v[64:79], v[122:123], v[20:21], v[64:79]
    v_exp_f32 v90, v90
    v_cvt_pk_bf16_f32 v106, v84, v85
    v_exp_f32 v91, v91
    v_cvt_pk_bf16_f32 v107, v86, v87
    v_exp_f32 v92, v92
    v_exp_f32 v93, v93
    v_mfma_f32_32x32x16_bf16 v[32:47], v[128:131], v[100:103], v[32:47]
    v_perm_b32 v250, v200, v196, s43
    v_perm_b32 v251, v208, v204, s43
    buffer_store_dwordx4 v[248:251], v22, s[48:51], s33 offen sc1
    s_add_u32 s33, s33, s34
    v_exp_f32 v94, v94
    v_exp_f32 v95, v95
    v_cvt_pk_bf16_f32 v108, v88, v89
    v_cvt_pk_bf16_f32 v109, v90, v91
    v_cvt_pk_bf16_f32 v110, v92, v93
    v_cvt_pk_bf16_f32 v111, v94, v95
    v_mfma_f32_32x32x16_bf16 v[80:95], v[116:119], v[24:27], 0
    ds_read_b128 v[112:115], v14 offset:4096
    v_exp_f32 v64, v64
    v_exp_f32 v65, v65
    v_exp_f32 v66, v66
    v_exp_f32 v67, v67
    v_exp_f32 v68, v68
    v_exp_f32 v69, v69
    v_mfma_f32_32x32x16_bf16 v[48:63], v[124:127], v[104:107], v[48:63]
    ds_read_b128 v[132:135], v140 offset:3648
    buffer_load_dwordx4 v8, s[8:11], s40 offen offset:3072 sc1 lds
    s_add_u32 s40, s40, 4096
    v_exp_f32 v70, v70
    v_cvt_pk_bf16_f32 v96, v64, v65
    v_exp_f32 v71, v71
    v_cvt_pk_bf16_f32 v97, v66, v67
    v_exp_f32 v72, v72
    v_exp_f32 v73, v73
    v_mfma_f32_32x32x8_bf16 v[80:95], v[122:123], v[28:29], v[80:95]
    ds_read_b32 v120, v15 offset:512
    v_exp_f32 v74, v74
    v_cvt_pk_bf16_f32 v98, v68, v69
    v_exp_f32 v75, v75
    v_cvt_pk_bf16_f32 v99, v70, v71
    v_exp_f32 v76, v76
    v_exp_f32 v77, v77
    v_mfma_f32_32x32x16_bf16 v[48:63], v[128:131], v[108:111], v[48:63]
    ds_read_b128 v[136:139], v140 offset:4256
    v_perm_b32 v252, v185, v181, s42
    v_perm_b32 v253, v193, v189, s42
    v_exp_f32 v78, v78
    v_exp_f32 v79, v79
    v_cvt_pk_bf16_f32 v100, v72, v73
    v_cvt_pk_bf16_f32 v101, v74, v75
    v_cvt_pk_bf16_f32 v102, v76, v77
    v_cvt_pk_bf16_f32 v103, v78, v79
    s_waitcnt lgkmcnt(0)
    v_mfma_f32_32x32x16_bf16 v[64:79], v[112:115], v[16:19], 0
    v_exp_f32 v80, v80
    v_exp_f32 v81, v81
    v_exp_f32 v82, v82
    v_exp_f32 v83, v83
    v_exp_f32 v84, v84
    v_exp_f32 v85, v85
    v_mfma_f32_32x32x16_bf16 v[32:47], v[132:135], v[96:99], v[32:47]
    v_exp_f32 v86, v86
    v_cvt_pk_bf16_f32 v104, v80, v81
    v_exp_f32 v87, v87
    v_cvt_pk_bf16_f32 v105, v82, v83
    v_exp_f32 v88, v88
    v_exp_f32 v89, v89
    v_mfma_f32_32x32x8_bf16 v[64:79], v[120:121], v[20:21], v[64:79]
    v_exp_f32 v90, v90
    v_cvt_pk_bf16_f32 v106, v84, v85
    v_exp_f32 v91, v91
    v_cvt_pk_bf16_f32 v107, v86, v87
    v_exp_f32 v92, v92
    v_exp_f32 v93, v93
    v_mfma_f32_32x32x16_bf16 v[32:47], v[136:139], v[100:103], v[32:47]
    v_perm_b32 v254, v201, v197, s42
    v_perm_b32 v255, v209, v205, s42
    buffer_store_dwordx4 v[252:255], v22, s[48:51], s33 offen sc1
    s_add_u32 s33, s33, s35
    v_exp_f32 v94, v94
    v_exp_f32 v95, v95
    v_cvt_pk_bf16_f32 v108, v88, v89
    v_cvt_pk_bf16_f32 v109, v90, v91
    v_cvt_pk_bf16_f32 v110, v92, v93
    v_cvt_pk_bf16_f32 v111, v94, v95
    v_mfma_f32_32x32x16_bf16 v[80:95], v[112:115], v[24:27], 0
    ds_read_b128 v[116:119], v14 offset:5120
    v_exp_f32 v64, v64
    v_exp_f32 v65, v65
    v_exp_f32 v66, v66
    v_exp_f32 v67, v67
    v_exp_f32 v68, v68
    v_exp_f32 v69, v69
    v_mfma_f32_32x32x16_bf16 v[48:63], v[132:135], v[104:107], v[48:63]
    ds_read_b128 v[124:127], v140 offset:4864
    s_mov_b32 m0, s40
    s_nop 0
    buffer_load_dwordx4 v8, s[8:11], s40 offen offset:0 sc1 lds
    v_exp_f32 v70, v70
    v_cvt_pk_bf16_f32 v96, v64, v65
    v_exp_f32 v71, v71
    v_cvt_pk_bf16_f32 v97, v66, v67
    v_exp_f32 v72, v72
    v_exp_f32 v73, v73
    v_mfma_f32_32x32x8_bf16 v[80:95], v[120:121], v[28:29], v[80:95]
    ds_read_b32 v122, v15 offset:640
    v_exp_f32 v74, v74
    v_cvt_pk_bf16_f32 v98, v68, v69
    v_exp_f32 v75, v75
    v_cvt_pk_bf16_f32 v99, v70, v71
    v_exp_f32 v76, v76
    v_exp_f32 v77, v77
    v_mfma_f32_32x32x16_bf16 v[48:63], v[136:139], v[108:111], v[48:63]
    ds_read_b128 v[128:131], v140 offset:5472
    v_perm_b32 v244, v185, v181, s43
    v_perm_b32 v245, v193, v189, s43
    v_exp_f32 v78, v78
    v_exp_f32 v79, v79
    v_cvt_pk_bf16_f32 v100, v72, v73
    v_cvt_pk_bf16_f32 v101, v74, v75
    v_cvt_pk_bf16_f32 v102, v76, v77
    v_cvt_pk_bf16_f32 v103, v78, v79
    s_waitcnt lgkmcnt(0)
    v_mfma_f32_32x32x16_bf16 v[64:79], v[116:119], v[16:19], 0
    v_exp_f32 v80, v80
    v_exp_f32 v81, v81
    v_exp_f32 v82, v82
    v_exp_f32 v83, v83
    v_exp_f32 v84, v84
    v_exp_f32 v85, v85
    v_mfma_f32_32x32x16_bf16 v[32:47], v[124:127], v[96:99], v[32:47]
    v_exp_f32 v86, v86
    v_cvt_pk_bf16_f32 v104, v80, v81
    v_exp_f32 v87, v87
    v_cvt_pk_bf16_f32 v105, v82, v83
    v_exp_f32 v88, v88
    v_exp_f32 v89, v89
    v_mfma_f32_32x32x8_bf16 v[64:79], v[122:123], v[20:21], v[64:79]
    v_exp_f32 v90, v90
    v_cvt_pk_bf16_f32 v106, v84, v85
    v_exp_f32 v91, v91
    v_cvt_pk_bf16_f32 v107, v86, v87
    v_exp_f32 v92, v92
    v_exp_f32 v93, v93
    v_mfma_f32_32x32x16_bf16 v[32:47], v[128:131], v[100:103], v[32:47]
    v_perm_b32 v246, v201, v197, s43
    v_perm_b32 v247, v209, v205, s43
    buffer_store_dwordx4 v[244:247], v22, s[48:51], s33 offen sc1
    s_add_u32 s33, s33, s34
    v_exp_f32 v94, v94
    v_exp_f32 v95, v95
    v_cvt_pk_bf16_f32 v108, v88, v89
    v_cvt_pk_bf16_f32 v109, v90, v91
    v_cvt_pk_bf16_f32 v110, v92, v93
    v_cvt_pk_bf16_f32 v111, v94, v95
    v_mfma_f32_32x32x16_bf16 v[80:95], v[116:119], v[24:27], 0
    ds_read_b128 v[112:115], v14 offset:6144
    v_exp_f32 v64, v64
    v_exp_f32 v65, v65
    v_exp_f32 v66, v66
    v_exp_f32 v67, v67
    v_exp_f32 v68, v68
    v_exp_f32 v69, v69
    v_mfma_f32_32x32x16_bf16 v[48:63], v[124:127], v[104:107], v[48:63]
    ds_read_b128 v[132:135], v140 offset:6080
    buffer_load_dwordx4 v8, s[8:11], s40 offen offset:1024 sc1 lds
    v_exp_f32 v70, v70
    v_cvt_pk_bf16_f32 v96, v64, v65
    v_exp_f32 v71, v71
    v_cvt_pk_bf16_f32 v97, v66, v67
    v_exp_f32 v72, v72
    v_exp_f32 v73, v73
    v_mfma_f32_32x32x8_bf16 v[80:95], v[122:123], v[28:29], v[80:95]
    ds_read_b32 v120, v15 offset:768
    v_exp_f32 v74, v74
    v_cvt_pk_bf16_f32 v98, v68, v69
    v_exp_f32 v75, v75
    v_cvt_pk_bf16_f32 v99, v70, v71
    v_exp_f32 v76, v76
    v_exp_f32 v77, v77
    v_mfma_f32_32x32x16_bf16 v[48:63], v[128:131], v[108:111], v[48:63]
    ds_read_b128 v[136:139], v140 offset:6688
    v_perm_b32 v248, v186, v182, s42
    v_perm_b32 v249, v194, v190, s42
    v_exp_f32 v78, v78
    v_exp_f32 v79, v79
    v_cvt_pk_bf16_f32 v100, v72, v73
    v_cvt_pk_bf16_f32 v101, v74, v75
    v_cvt_pk_bf16_f32 v102, v76, v77
    v_cvt_pk_bf16_f32 v103, v78, v79
    s_waitcnt lgkmcnt(0)
    v_mfma_f32_32x32x16_bf16 v[64:79], v[112:115], v[16:19], 0
    v_exp_f32 v80, v80
    v_exp_f32 v81, v81
    v_exp_f32 v82, v82
    v_exp_f32 v83, v83
    v_exp_f32 v84, v84
    v_exp_f32 v85, v85
    v_mfma_f32_32x32x16_bf16 v[32:47], v[132:135], v[96:99], v[32:47]
    v_exp_f32 v86, v86
    v_cvt_pk_bf16_f32 v104, v80, v81
    v_exp_f32 v87, v87
    v_cvt_pk_bf16_f32 v105, v82, v83
    v_exp_f32 v88, v88
    v_exp_f32 v89, v89
    v_mfma_f32_32x32x8_bf16 v[64:79], v[120:121], v[20:21], v[64:79]
    v_exp_f32 v90, v90
    v_cvt_pk_bf16_f32 v106, v84, v85
    v_exp_f32 v91, v91
    v_cvt_pk_bf16_f32 v107, v86, v87
    v_exp_f32 v92, v92
    v_exp_f32 v93, v93
    v_mfma_f32_32x32x16_bf16 v[32:47], v[136:139], v[100:103], v[32:47]
    v_perm_b32 v250, v202, v198, s42
    v_perm_b32 v251, v210, v206, s42
    buffer_store_dwordx4 v[248:251], v22, s[48:51], s33 offen sc1
    s_add_u32 s33, s33, s34
    v_exp_f32 v94, v94
    v_exp_f32 v95, v95
    v_cvt_pk_bf16_f32 v108, v88, v89
    v_cvt_pk_bf16_f32 v109, v90, v91
    v_cvt_pk_bf16_f32 v110, v92, v93
    v_cvt_pk_bf16_f32 v111, v94, v95
    v_mfma_f32_32x32x16_bf16 v[80:95], v[112:115], v[24:27], 0
    ds_read_b128 v[116:119], v14 offset:7168
    v_exp_f32 v64, v64
    v_exp_f32 v65, v65
    v_exp_f32 v66, v66
    v_exp_f32 v67, v67
    v_exp_f32 v68, v68
    v_exp_f32 v69, v69
    v_mfma_f32_32x32x16_bf16 v[48:63], v[132:135], v[104:107], v[48:63]
    ds_read_b128 v[124:127], v140 offset:7296
    buffer_load_dwordx4 v8, s[8:11], s40 offen offset:2048 sc1 lds
    v_exp_f32 v70, v70
    v_cvt_pk_bf16_f32 v96, v64, v65
    v_exp_f32 v71, v71
    v_cvt_pk_bf16_f32 v97, v66, v67
    v_exp_f32 v72, v72
    v_exp_f32 v73, v73
    v_mfma_f32_32x32x8_bf16 v[80:95], v[120:121], v[28:29], v[80:95]
    ds_read_b32 v122, v15 offset:896
    v_exp_f32 v74, v74
    v_cvt_pk_bf16_f32 v98, v68, v69
    v_exp_f32 v75, v75
    v_cvt_pk_bf16_f32 v99, v70, v71
    v_exp_f32 v76, v76
    v_exp_f32 v77, v77
    v_mfma_f32_32x32x16_bf16 v[48:63], v[136:139], v[108:111], v[48:63]
    ds_read_b128 v[128:131], v140 offset:7904
    v_perm_b32 v252, v186, v182, s43
    v_perm_b32 v253, v194, v190, s43
    v_exp_f32 v78, v78
    v_exp_f32 v79, v79
    v_cvt_pk_bf16_f32 v100, v72, v73
    v_cvt_pk_bf16_f32 v101, v74, v75
    v_cvt_pk_bf16_f32 v102, v76, v77
    v_cvt_pk_bf16_f32 v103, v78, v79
    s_waitcnt lgkmcnt(0)
    v_mfma_f32_32x32x16_bf16 v[64:79], v[116:119], v[16:19], 0
    v_exp_f32 v80, v80
    v_exp_f32 v81, v81
    v_exp_f32 v82, v82
    v_exp_f32 v83, v83
    v_exp_f32 v84, v84
    v_exp_f32 v85, v85
    v_mfma_f32_32x32x16_bf16 v[32:47], v[124:127], v[96:99], v[32:47]
    v_exp_f32 v86, v86
    v_cvt_pk_bf16_f32 v104, v80, v81
    v_exp_f32 v87, v87
    v_cvt_pk_bf16_f32 v105, v82, v83
    v_exp_f32 v88, v88
    v_exp_f32 v89, v89
    v_mfma_f32_32x32x8_bf16 v[64:79], v[122:123], v[20:21], v[64:79]
    v_exp_f32 v90, v90
    v_cvt_pk_bf16_f32 v106, v84, v85
    v_exp_f32 v91, v91
    v_cvt_pk_bf16_f32 v107, v86, v87
    v_exp_f32 v92, v92
    v_exp_f32 v93, v93
    v_mfma_f32_32x32x16_bf16 v[32:47], v[128:131], v[100:103], v[32:47]
    v_perm_b32 v254, v202, v198, s43
    v_perm_b32 v255, v210, v206, s43
    buffer_store_dwordx4 v[252:255], v22, s[48:51], s33 offen sc1
    s_add_u32 s33, s33, s36
    v_exp_f32 v94, v94
    v_exp_f32 v95, v95
    v_cvt_pk_bf16_f32 v108, v88, v89
    v_cvt_pk_bf16_f32 v109, v90, v91
    v_cvt_pk_bf16_f32 v110, v92, v93
    v_cvt_pk_bf16_f32 v111, v94, v95
    v_mfma_f32_32x32x16_bf16 v[80:95], v[116:119], v[24:27], 0
    ds_read_b128 v[112:115], v14 offset:8192
    v_exp_f32 v64, v64
    v_exp_f32 v65, v65
    v_exp_f32 v66, v66
    v_exp_f32 v67, v67
    v_exp_f32 v68, v68
    v_exp_f32 v69, v69
    v_mfma_f32_32x32x16_bf16 v[48:63], v[124:127], v[104:107], v[48:63]
    ds_read_b128 v[132:135], v140 offset:8512
    buffer_load_dwordx4 v8, s[8:11], s40 offen offset:3072 sc1 lds
    s_add_u32 s40, s40, 4096
    v_exp_f32 v70, v70
    v_cvt_pk_bf16_f32 v96, v64, v65
    v_exp_f32 v71, v71
    v_cvt_pk_bf16_f32 v97, v66, v67
    v_exp_f32 v72, v72
    v_exp_f32 v73, v73
    v_mfma_f32_32x32x8_bf16 v[80:95], v[122:123], v[28:29], v[80:95]
    ds_read_b32 v120, v15 offset:1024
    v_exp_f32 v74, v74
    v_cvt_pk_bf16_f32 v98, v68, v69
    v_exp_f32 v75, v75
    v_cvt_pk_bf16_f32 v99, v70, v71
    v_exp_f32 v76, v76
    v_exp_f32 v77, v77
    v_mfma_f32_32x32x16_bf16 v[48:63], v[128:131], v[108:111], v[48:63]
    ds_read_b128 v[136:139], v140 offset:9120
    v_perm_b32 v244, v187, v183, s42
    v_perm_b32 v245, v195, v191, s42
    v_exp_f32 v78, v78
    v_exp_f32 v79, v79
    v_cvt_pk_bf16_f32 v100, v72, v73
    v_cvt_pk_bf16_f32 v101, v74, v75
    v_cvt_pk_bf16_f32 v102, v76, v77
    v_cvt_pk_bf16_f32 v103, v78, v79
    s_waitcnt lgkmcnt(0)
    v_mfma_f32_32x32x16_bf16 v[64:79], v[112:115], v[16:19], 0
    v_exp_f32 v80, v80
    v_exp_f32 v81, v81
    v_exp_f32 v82, v82
    v_exp_f32 v83, v83
    v_exp_f32 v84, v84
    v_exp_f32 v85, v85
    v_mfma_f32_32x32x16_bf16 v[32:47], v[132:135], v[96:99], v[32:47]
    v_exp_f32 v86, v86
    v_cvt_pk_bf16_f32 v104, v80, v81
    v_exp_f32 v87, v87
    v_cvt_pk_bf16_f32 v105, v82, v83
    v_exp_f32 v88, v88
    v_exp_f32 v89, v89
    v_mfma_f32_32x32x8_bf16 v[64:79], v[120:121], v[20:21], v[64:79]
    v_exp_f32 v90, v90
    v_cvt_pk_bf16_f32 v106, v84, v85
    v_exp_f32 v91, v91
    v_cvt_pk_bf16_f32 v107, v86, v87
    v_exp_f32 v92, v92
    v_exp_f32 v93, v93
    v_mfma_f32_32x32x16_bf16 v[32:47], v[136:139], v[100:103], v[32:47]
    v_perm_b32 v246, v203, v199, s42
    v_perm_b32 v247, v211, v207, s42
    buffer_store_dwordx4 v[244:247], v22, s[48:51], s33 offen sc1
    s_add_u32 s33, s33, s34
    v_exp_f32 v94, v94
    v_exp_f32 v95, v95
    v_cvt_pk_bf16_f32 v108, v88, v89
    v_cvt_pk_bf16_f32 v109, v90, v91
    v_cvt_pk_bf16_f32 v110, v92, v93
    v_cvt_pk_bf16_f32 v111, v94, v95
    v_mfma_f32_32x32x16_bf16 v[80:95], v[112:115], v[24:27], 0
    ds_read_b128 v[116:119], v14 offset:9216
    v_exp_f32 v64, v64
    v_exp_f32 v65, v65
    v_exp_f32 v66, v66
    v_exp_f32 v67, v67
    v_exp_f32 v68, v68
    v_exp_f32 v69, v69
    v_mfma_f32_32x32x16_bf16 v[48:63], v[132:135], v[104:107], v[48:63]
    ds_read_b128 v[124:127], v140 offset:9728
    s_mov_b32 m0, s40
    s_nop 0
    buffer_load_dwordx4 v8, s[8:11], s40 offen offset:0 sc1 lds
    v_exp_f32 v70, v70
    v_cvt_pk_bf16_f32 v96, v64, v65
    v_exp_f32 v71, v71
    v_cvt_pk_bf16_f32 v97, v66, v67
    v_exp_f32 v72, v72
    v_exp_f32 v73, v73
    v_mfma_f32_32x32x8_bf16 v[80:95], v[120:121], v[28:29], v[80:95]
    ds_read_b32 v122, v15 offset:1152
    v_exp_f32 v74, v74
    v_cvt_pk_bf16_f32 v98, v68, v69
    v_exp_f32 v75, v75
    v_cvt_pk_bf16_f32 v99, v70, v71
    v_exp_f32 v76, v76
    v_exp_f32 v77, v77
    v_mfma_f32_32x32x16_bf16 v[48:63], v[136:139], v[108:111], v[48:63]
    ds_read_b128 v[128:131], v140 offset:10336
    v_perm_b32 v248, v187, v183, s43
    v_perm_b32 v249, v195, v191, s43
    v_exp_f32 v78, v78
    v_exp_f32 v79, v79
    v_cvt_pk_bf16_f32 v100, v72, v73
    v_cvt_pk_bf16_f32 v101, v74, v75
    v_cvt_pk_bf16_f32 v102, v76, v77
    v_cvt_pk_bf16_f32 v103, v78, v79
    s_waitcnt lgkmcnt(0)
    v_mfma_f32_32x32x16_bf16 v[64:79], v[116:119], v[16:19], 0
    v_exp_f32 v80, v80
    v_exp_f32 v81, v81
    v_exp_f32 v82, v82
    v_exp_f32 v83, v83
    v_exp_f32 v84, v84
    v_exp_f32 v85, v85
    v_mfma_f32_32x32x16_bf16 v[32:47], v[124:127], v[96:99], v[32:47]
    v_exp_f32 v86, v86
    v_cvt_pk_bf16_f32 v104, v80, v81
    v_exp_f32 v87, v87
    v_cvt_pk_bf16_f32 v105, v82, v83
    v_exp_f32 v88, v88
    v_exp_f32 v89, v89
    v_mfma_f32_32x32x8_bf16 v[64:79], v[122:123], v[20:21], v[64:79]
    v_exp_f32 v90, v90
    v_cvt_pk_bf16_f32 v106, v84, v85
    v_exp_f32 v91, v91
    v_cvt_pk_bf16_f32 v107, v86, v87
    v_exp_f32 v92, v92
    v_exp_f32 v93, v93
    v_mfma_f32_32x32x16_bf16 v[32:47], v[128:131], v[100:103], v[32:47]
    v_perm_b32 v250, v203, v199, s43
    v_perm_b32 v251, v211, v207, s43
    buffer_store_dwordx4 v[248:251], v22, s[48:51], s33 offen sc1
    v_exp_f32 v94, v94
    v_exp_f32 v95, v95
    v_cvt_pk_bf16_f32 v108, v88, v89
    v_cvt_pk_bf16_f32 v109, v90, v91
    v_cvt_pk_bf16_f32 v110, v92, v93
    v_cvt_pk_bf16_f32 v111, v94, v95
    v_mfma_f32_32x32x16_bf16 v[80:95], v[116:119], v[24:27], 0
    ds_read_b128 v[112:115], v14 offset:10240
    v_exp_f32 v64, v64
    v_exp_f32 v65, v65
    v_exp_f32 v66, v66
    v_exp_f32 v67, v67
    v_exp_f32 v68, v68
    v_exp_f32 v69, v69
    v_mfma_f32_32x32x16_bf16 v[48:63], v[124:127], v[104:107], v[48:63]
    ds_read_b128 v[132:135], v140 offset:10944
    buffer_load_dwordx4 v8, s[8:11], s40 offen offset:1024 sc1 lds
    s_add_u32 s40, s40, 29696
    v_exp_f32 v70, v70
    v_cvt_pk_bf16_f32 v96, v64, v65
    v_exp_f32 v71, v71
    v_cvt_pk_bf16_f32 v97, v66, v67
    v_exp_f32 v72, v72
    v_exp_f32 v73, v73
    v_mfma_f32_32x32x8_bf16 v[80:95], v[122:123], v[28:29], v[80:95]
    ds_read_b32 v120, v15 offset:1280
    v_exp_f32 v74, v74
    v_cvt_pk_bf16_f32 v98, v68, v69
    v_exp_f32 v75, v75
    v_cvt_pk_bf16_f32 v99, v70, v71
    v_exp_f32 v76, v76
    v_exp_f32 v77, v77
    v_mfma_f32_32x32x16_bf16 v[48:63], v[128:131], v[108:111], v[48:63]
    ds_read_b128 v[136:139], v140 offset:11552
    v_exp_f32 v78, v78
    v_exp_f32 v79, v79
    v_cvt_pk_bf16_f32 v100, v72, v73
    v_cvt_pk_bf16_f32 v101, v74, v75
    v_cvt_pk_bf16_f32 v102, v76, v77
    v_cvt_pk_bf16_f32 v103, v78, v79
    s_waitcnt lgkmcnt(0)
    v_mfma_f32_32x32x16_bf16 v[64:79], v[112:115], v[16:19], 0
    v_exp_f32 v80, v80
    v_exp_f32 v81, v81
    v_exp_f32 v82, v82
    v_exp_f32 v83, v83
    v_exp_f32 v84, v84
    v_exp_f32 v85, v85
    v_mfma_f32_32x32x16_bf16 v[32:47], v[132:135], v[96:99], v[32:47]
    v_exp_f32 v86, v86
    v_cvt_pk_bf16_f32 v104, v80, v81
    v_exp_f32 v87, v87
    v_cvt_pk_bf16_f32 v105, v82, v83
    v_exp_f32 v88, v88
    v_exp_f32 v89, v89
    v_mfma_f32_32x32x8_bf16 v[64:79], v[120:121], v[20:21], v[64:79]
    v_exp_f32 v90, v90
    v_cvt_pk_bf16_f32 v106, v84, v85
    v_exp_f32 v91, v91
    v_cvt_pk_bf16_f32 v107, v86, v87
    v_exp_f32 v92, v92
    v_exp_f32 v93, v93
    v_mfma_f32_32x32x16_bf16 v[32:47], v[136:139], v[100:103], v[32:47]
    v_exp_f32 v94, v94
    v_exp_f32 v95, v95
    v_cvt_pk_bf16_f32 v108, v88, v89
    v_cvt_pk_bf16_f32 v109, v90, v91
    v_cvt_pk_bf16_f32 v110, v92, v93
    v_cvt_pk_bf16_f32 v111, v94, v95
    v_mfma_f32_32x32x16_bf16 v[80:95], v[112:115], v[24:27], 0
    ds_read_b128 v[116:119], v14 offset:11264
    v_exp_f32 v64, v64
    v_exp_f32 v65, v65
    v_exp_f32 v66, v66
    v_exp_f32 v67, v67
    v_exp_f32 v68, v68
    v_exp_f32 v69, v69
    v_mfma_f32_32x32x16_bf16 v[48:63], v[132:135], v[104:107], v[48:63]
    ds_read_b128 v[124:127], v140 offset:12160
    v_exp_f32 v70, v70
    v_cvt_pk_bf16_f32 v96, v64, v65
    v_exp_f32 v71, v71
    v_cvt_pk_bf16_f32 v97, v66, v67
    v_exp_f32 v72, v72
    v_exp_f32 v73, v73
    v_mfma_f32_32x32x8_bf16 v[80:95], v[120:121], v[28:29], v[80:95]
    ds_read_b32 v122, v15 offset:1408
    v_exp_f32 v74, v74
    v_cvt_pk_bf16_f32 v98, v68, v69
    v_exp_f32 v75, v75
    v_cvt_pk_bf16_f32 v99, v70, v71
    v_exp_f32 v76, v76
    v_exp_f32 v77, v77
    v_mfma_f32_32x32x16_bf16 v[48:63], v[136:139], v[108:111], v[48:63]
    ds_read_b128 v[128:131], v140 offset:12768
    v_exp_f32 v78, v78
    v_exp_f32 v79, v79
    v_cvt_pk_bf16_f32 v100, v72, v73
    v_cvt_pk_bf16_f32 v101, v74, v75
    v_cvt_pk_bf16_f32 v102, v76, v77
    v_cvt_pk_bf16_f32 v103, v78, v79
    s_waitcnt lgkmcnt(0)
    v_mfma_f32_32x32x16_bf16 v[64:79], v[116:119], v[16:19], 0
    v_exp_f32 v80, v80
    v_exp_f32 v81, v81
    v_exp_f32 v82, v82
    v_exp_f32 v83, v83
    v_exp_f32 v84, v84
    v_exp_f32 v85, v85
    v_mfma_f32_32x32x16_bf16 v[32:47], v[124:127], v[96:99], v[32:47]
    v_exp_f32 v86, v86
    v_cvt_pk_bf16_f32 v104, v80, v81
    v_exp_f32 v87, v87
    v_cvt_pk_bf16_f32 v105, v82, v83
    v_exp_f32 v88, v88
    v_exp_f32 v89, v89
    v_mfma_f32_32x32x8_bf16 v[64:79], v[122:123], v[20:21], v[64:79]
    v_exp_f32 v90, v90
    v_cvt_pk_bf16_f32 v106, v84, v85
    v_exp_f32 v91, v91
    v_cvt_pk_bf16_f32 v107, v86, v87
    v_exp_f32 v92, v92
    v_exp_f32 v93, v93
    v_mfma_f32_32x32x16_bf16 v[32:47], v[128:131], v[100:103], v[32:47]
    v_exp_f32 v94, v94
    v_exp_f32 v95, v95
    v_cvt_pk_bf16_f32 v108, v88, v89
    v_cvt_pk_bf16_f32 v109, v90, v91
    v_cvt_pk_bf16_f32 v110, v92, v93
    v_cvt_pk_bf16_f32 v111, v94, v95
    v_mfma_f32_32x32x16_bf16 v[80:95], v[116:119], v[24:27], 0
    ds_read_b128 v[112:115], v14 offset:12288
    v_exp_f32 v64, v64
    v_exp_f32 v65, v65
    v_exp_f32 v66, v66
    v_exp_f32 v67, v67
    v_exp_f32 v68, v68
    v_exp_f32 v69, v69
    v_mfma_f32_32x32x16_bf16 v[48:63], v[124:127], v[104:107], v[48:63]
    ds_read_b128 v[132:135], v140 offset:13376
    v_exp_f32 v70, v70
    v_cvt_pk_bf16_f32 v96, v64, v65
    v_exp_f32 v71, v71
    v_cvt_pk_bf16_f32 v97, v66, v67
    v_exp_f32 v72, v72
    v_exp_f32 v73, v73
    v_mfma_f32_32x32x8_bf16 v[80:95], v[122:123], v[28:29], v[80:95]
    ds_read_b32 v120, v15 offset:1536
    v_exp_f32 v74, v74
    v_cvt_pk_bf16_f32 v98, v68, v69
    v_exp_f32 v75, v75
    v_cvt_pk_bf16_f32 v99, v70, v71
    v_exp_f32 v76, v76
    v_exp_f32 v77, v77
    v_mfma_f32_32x32x16_bf16 v[48:63], v[128:131], v[108:111], v[48:63]
    ds_read_b128 v[136:139], v140 offset:13984
    v_exp_f32 v78, v78
    v_exp_f32 v79, v79
    v_cvt_pk_bf16_f32 v100, v72, v73
    v_cvt_pk_bf16_f32 v101, v74, v75
    v_cvt_pk_bf16_f32 v102, v76, v77
    v_cvt_pk_bf16_f32 v103, v78, v79
    s_waitcnt lgkmcnt(0)
    v_mfma_f32_32x32x16_bf16 v[64:79], v[112:115], v[16:19], 0
    v_exp_f32 v80, v80
    v_exp_f32 v81, v81
    v_exp_f32 v82, v82
    v_exp_f32 v83, v83
    v_exp_f32 v84, v84
    v_exp_f32 v85, v85
    v_mfma_f32_32x32x16_bf16 v[32:47], v[132:135], v[96:99], v[32:47]
    v_exp_f32 v86, v86
    v_cvt_pk_bf16_f32 v104, v80, v81
    v_exp_f32 v87, v87
    v_cvt_pk_bf16_f32 v105, v82, v83
    v_exp_f32 v88, v88
    v_exp_f32 v89, v89
    v_mfma_f32_32x32x8_bf16 v[64:79], v[120:121], v[20:21], v[64:79]
    v_exp_f32 v90, v90
    v_cvt_pk_bf16_f32 v106, v84, v85
    v_exp_f32 v91, v91
    v_cvt_pk_bf16_f32 v107, v86, v87
    v_exp_f32 v92, v92
    v_exp_f32 v93, v93
    v_mfma_f32_32x32x16_bf16 v[32:47], v[136:139], v[100:103], v[32:47]
    v_exp_f32 v94, v94
    v_exp_f32 v95, v95
    v_cvt_pk_bf16_f32 v108, v88, v89
    v_cvt_pk_bf16_f32 v109, v90, v91
    v_cvt_pk_bf16_f32 v110, v92, v93
    v_cvt_pk_bf16_f32 v111, v94, v95
    v_mfma_f32_32x32x16_bf16 v[80:95], v[112:115], v[24:27], 0
    ds_read_b128 v[116:119], v14 offset:13312
    v_exp_f32 v64, v64
    v_exp_f32 v65, v65
    v_exp_f32 v66, v66
    v_exp_f32 v67, v67
    v_exp_f32 v68, v68
    v_exp_f32 v69, v69
    v_mfma_f32_32x32x16_bf16 v[48:63], v[132:135], v[104:107], v[48:63]
    ds_read_b128 v[124:127], v140 offset:14592
    v_exp_f32 v70, v70
    v_cvt_pk_bf16_f32 v96, v64, v65
    v_exp_f32 v71, v71
    v_cvt_pk_bf16_f32 v97, v66, v67
    v_exp_f32 v72, v72
    v_exp_f32 v73, v73
    v_mfma_f32_32x32x8_bf16 v[80:95], v[120:121], v[28:29], v[80:95]
    ds_read_b32 v122, v15 offset:1664
    v_exp_f32 v74, v74
    v_cvt_pk_bf16_f32 v98, v68, v69
    v_exp_f32 v75, v75
    v_cvt_pk_bf16_f32 v99, v70, v71
    v_exp_f32 v76, v76
    v_exp_f32 v77, v77
    v_mfma_f32_32x32x16_bf16 v[48:63], v[136:139], v[108:111], v[48:63]
    ds_read_b128 v[128:131], v140 offset:15200
    v_exp_f32 v78, v78
    v_exp_f32 v79, v79
    v_cvt_pk_bf16_f32 v100, v72, v73
    v_cvt_pk_bf16_f32 v101, v74, v75
    v_cvt_pk_bf16_f32 v102, v76, v77
    v_cvt_pk_bf16_f32 v103, v78, v79
    s_waitcnt lgkmcnt(0)
    v_mfma_f32_32x32x16_bf16 v[64:79], v[116:119], v[16:19], 0
    v_exp_f32 v80, v80
    v_exp_f32 v81, v81
    v_exp_f32 v82, v82
    v_exp_f32 v83, v83
    v_exp_f32 v84, v84
    v_exp_f32 v85, v85
    v_mfma_f32_32x32x16_bf16 v[32:47], v[124:127], v[96:99], v[32:47]
    v_exp_f32 v86, v86
    v_cvt_pk_bf16_f32 v104, v80, v81
    v_exp_f32 v87, v87
    v_cvt_pk_bf16_f32 v105, v82, v83
    v_exp_f32 v88, v88
    v_exp_f32 v89, v89
    v_mfma_f32_32x32x8_bf16 v[64:79], v[122:123], v[20:21], v[64:79]
    v_exp_f32 v90, v90
    v_cvt_pk_bf16_f32 v106, v84, v85
    v_exp_f32 v91, v91
    v_cvt_pk_bf16_f32 v107, v86, v87
    v_exp_f32 v92, v92
    v_exp_f32 v93, v93
    v_mfma_f32_32x32x16_bf16 v[32:47], v[128:131], v[100:103], v[32:47]
    v_exp_f32 v94, v94
    v_exp_f32 v95, v95
    v_cvt_pk_bf16_f32 v108, v88, v89
    v_cvt_pk_bf16_f32 v109, v90, v91
    v_cvt_pk_bf16_f32 v110, v92, v93
    v_cvt_pk_bf16_f32 v111, v94, v95
    s_waitcnt vmcnt(19)
    v_mfma_f32_32x32x16_bf16 v[80:95], v[116:119], v[24:27], 0
    ds_read_b128 v[112:115], v14 offset:14336
    v_exp_f32 v64, v64
    v_exp_f32 v65, v65
    v_exp_f32 v66, v66
    v_exp_f32 v67, v67
    v_exp_f32 v68, v68
    v_exp_f32 v69, v69
    v_mfma_f32_32x32x16_bf16 v[48:63], v[124:127], v[104:107], v[48:63]
    ds_read_b128 v[132:135], v140 offset:15808
    v_mov_b32 v180, v212
    v_mov_b32 v181, v213
    v_mov_b32 v182, v214
    v_exp_f32 v70, v70
    v_cvt_pk_bf16_f32 v96, v64, v65
    v_exp_f32 v71, v71
    v_cvt_pk_bf16_f32 v97, v66, v67
    v_exp_f32 v72, v72
    v_exp_f32 v73, v73
    v_mfma_f32_32x32x8_bf16 v[80:95], v[122:123], v[28:29], v[80:95]
    ds_read_b32 v120, v15 offset:1792
    v_exp_f32 v74, v74
    v_cvt_pk_bf16_f32 v98, v68, v69
    v_exp_f32 v75, v75
    v_cvt_pk_bf16_f32 v99, v70, v71
    v_exp_f32 v76, v76
    v_exp_f32 v77, v77
    v_mfma_f32_32x32x16_bf16 v[48:63], v[128:131], v[108:111], v[48:63]
    ds_read_b128 v[136:139], v140 offset:16416
    v_mov_b32 v183, v215
    v_mov_b32 v184, v216
    v_mov_b32 v185, v217
    v_exp_f32 v78, v78
    v_exp_f32 v79, v79
    v_cvt_pk_bf16_f32 v100, v72, v73
    v_cvt_pk_bf16_f32 v101, v74, v75
    v_cvt_pk_bf16_f32 v102, v76, v77
    v_cvt_pk_bf16_f32 v103, v78, v79
    s_waitcnt lgkmcnt(0)
    v_mfma_f32_32x32x16_bf16 v[64:79], v[112:115], v[16:19], 0
    v_exp_f32 v80, v80
    v_exp_f32 v81, v81
    v_exp_f32 v82, v82
    v_exp_f32 v83, v83
    v_exp_f32 v84, v84
    v_exp_f32 v85, v85
    v_mfma_f32_32x32x16_bf16 v[32:47], v[132:135], v[96:99], v[32:47]
    v_mov_b32 v186, v218
    v_mov_b32 v187, v219
    v_mov_b32 v188, v220
    v_exp_f32 v86, v86
    v_cvt_pk_bf16_f32 v104, v80, v81
    v_exp_f32 v87, v87
    v_cvt_pk_bf16_f32 v105, v82, v83
    v_exp_f32 v88, v88
    v_exp_f32 v89, v89
    v_mfma_f32_32x32x8_bf16 v[64:79], v[120:121], v[20:21], v[64:79]
    v_exp_f32 v90, v90
    v_cvt_pk_bf16_f32 v106, v84, v85
    v_exp_f32 v91, v91
    v_cvt_pk_bf16_f32 v107, v86, v87
    v_exp_f32 v92, v92
    v_exp_f32 v93, v93
    v_mfma_f32_32x32x16_bf16 v[32:47], v[136:139], v[100:103], v[32:47]
    v_mov_b32 v189, v221
    v_mov_b32 v190, v222
    v_mov_b32 v191, v223
    v_exp_f32 v94, v94
    v_exp_f32 v95, v95
    v_cvt_pk_bf16_f32 v108, v88, v89
    v_cvt_pk_bf16_f32 v109, v90, v91
    v_cvt_pk_bf16_f32 v110, v92, v93
    v_cvt_pk_bf16_f32 v111, v94, v95
    v_mfma_f32_32x32x16_bf16 v[80:95], v[112:115], v[24:27], 0
    ds_read_b128 v[116:119], v14 offset:15360
    v_exp_f32 v64, v64
    v_exp_f32 v65, v65
    v_exp_f32 v66, v66
    v_exp_f32 v67, v67
    v_exp_f32 v68, v68
    v_exp_f32 v69, v69
    v_mfma_f32_32x32x16_bf16 v[48:63], v[132:135], v[104:107], v[48:63]
    ds_read_b128 v[124:127], v140 offset:17024
    v_mov_b32 v192, v224
    v_mov_b32 v193, v225
    v_mov_b32 v194, v226
    v_exp_f32 v70, v70
    v_cvt_pk_bf16_f32 v96, v64, v65
    v_exp_f32 v71, v71
    v_cvt_pk_bf16_f32 v97, v66, v67
    v_exp_f32 v72, v72
    v_exp_f32 v73, v73
    v_mfma_f32_32x32x8_bf16 v[80:95], v[120:121], v[28:29], v[80:95]
    ds_read_b32 v122, v15 offset:1920
    v_exp_f32 v74, v74
    v_cvt_pk_bf16_f32 v98, v68, v69
    v_exp_f32 v75, v75
    v_cvt_pk_bf16_f32 v99, v70, v71
    v_exp_f32 v76, v76
    v_exp_f32 v77, v77
    v_mfma_f32_32x32x16_bf16 v[48:63], v[136:139], v[108:111], v[48:63]
    ds_read_b128 v[128:131], v140 offset:17632
    v_mov_b32 v195, v227
    v_mov_b32 v196, v228
    v_mov_b32 v197, v229
    v_exp_f32 v78, v78
    v_exp_f32 v79, v79
    v_cvt_pk_bf16_f32 v100, v72, v73
    v_cvt_pk_bf16_f32 v101, v74, v75
    v_cvt_pk_bf16_f32 v102, v76, v77
    v_cvt_pk_bf16_f32 v103, v78, v79
    s_waitcnt lgkmcnt(0)
    v_mfma_f32_32x32x16_bf16 v[64:79], v[116:119], v[16:19], 0
    v_exp_f32 v80, v80
    v_exp_f32 v81, v81
    v_exp_f32 v82, v82
    v_exp_f32 v83, v83
    v_exp_f32 v84, v84
    v_exp_f32 v85, v85
    v_mfma_f32_32x32x16_bf16 v[32:47], v[124:127], v[96:99], v[32:47]
    v_mov_b32 v198, v230
    v_mov_b32 v199, v231
    v_mov_b32 v200, v232
    v_exp_f32 v86, v86
    v_cvt_pk_bf16_f32 v104, v80, v81
    v_exp_f32 v87, v87
    v_cvt_pk_bf16_f32 v105, v82, v83
    v_exp_f32 v88, v88
    v_exp_f32 v89, v89
    v_mfma_f32_32x32x8_bf16 v[64:79], v[122:123], v[20:21], v[64:79]
    v_exp_f32 v90, v90
    v_cvt_pk_bf16_f32 v106, v84, v85
    v_exp_f32 v91, v91
    v_cvt_pk_bf16_f32 v107, v86, v87
    v_exp_f32 v92, v92
    v_exp_f32 v93, v93
    v_mfma_f32_32x32x16_bf16 v[32:47], v[128:131], v[100:103], v[32:47]
    v_mov_b32 v201, v233
    v_mov_b32 v202, v234
    v_mov_b32 v203, v235
    v_exp_f32 v94, v94
    v_exp_f32 v95, v95
    v_cvt_pk_bf16_f32 v108, v88, v89
    v_cvt_pk_bf16_f32 v109, v90, v91
    v_cvt_pk_bf16_f32 v110, v92, v93
    v_cvt_pk_bf16_f32 v111, v94, v95
    s_waitcnt vmcnt(0)
    s_barrier
    v_mfma_f32_32x32x16_bf16 v[80:95], v[116:119], v[24:27], 0
    ds_read_b128 v[112:115], v14 offset:37888
    v_exp_f32 v64, v64
    v_exp_f32 v65, v65
    v_exp_f32 v66, v66
    v_exp_f32 v67, v67
    v_exp_f32 v68, v68
    v_exp_f32 v69, v69
    v_mfma_f32_32x32x16_bf16 v[48:63], v[124:127], v[104:107], v[48:63]
    ds_read_b128 v[132:135], v140 offset:18240
    v_mov_b32 v204, v236
    v_mov_b32 v205, v237
    v_mov_b32 v206, v238
    v_exp_f32 v70, v70
    v_cvt_pk_bf16_f32 v96, v64, v65
    v_exp_f32 v71, v71
    v_cvt_pk_bf16_f32 v97, v66, v67
    v_exp_f32 v72, v72
    v_exp_f32 v73, v73
    v_mfma_f32_32x32x8_bf16 v[80:95], v[122:123], v[28:29], v[80:95]
    ds_read_b32 v120, v15 offset:37888
    v_exp_f32 v74, v74
    v_cvt_pk_bf16_f32 v98, v68, v69
    v_exp_f32 v75, v75
    v_cvt_pk_bf16_f32 v99, v70, v71
    v_exp_f32 v76, v76
    v_exp_f32 v77, v77
    v_mfma_f32_32x32x16_bf16 v[48:63], v[128:131], v[108:111], v[48:63]
    ds_read_b128 v[136:139], v140 offset:18848
    v_mov_b32 v207, v239
    v_mov_b32 v208, v240
    v_mov_b32 v209, v241
    v_exp_f32 v78, v78
    v_exp_f32 v79, v79
    v_cvt_pk_bf16_f32 v100, v72, v73
    v_cvt_pk_bf16_f32 v101, v74, v75
    v_cvt_pk_bf16_f32 v102, v76, v77
    v_cvt_pk_bf16_f32 v103, v78, v79
    s_waitcnt lgkmcnt(0)
    v_mfma_f32_32x32x16_bf16 v[64:79], v[112:115], v[16:19], 0
    v_add_u32 v14, 37888, v14
    v_exp_f32 v80, v80
    v_exp_f32 v81, v81
    v_exp_f32 v82, v82
    v_exp_f32 v83, v83
    v_exp_f32 v84, v84
    v_exp_f32 v85, v85
    v_mfma_f32_32x32x16_bf16 v[32:47], v[132:135], v[96:99], v[32:47]
    v_add_u32 v15, 37888, v15
    v_mov_b32 v210, v242
    v_mov_b32 v211, v243
    v_exp_f32 v86, v86
    v_cvt_pk_bf16_f32 v104, v80, v81
    v_exp_f32 v87, v87
    v_cvt_pk_bf16_f32 v105, v82, v83
    v_exp_f32 v88, v88
    v_exp_f32 v89, v89
    v_mfma_f32_32x32x8_bf16 v[64:79], v[120:121], v[20:21], v[64:79]
    v_add_u32 v140, 37888, v140
    v_exp_f32 v90, v90
    v_cvt_pk_bf16_f32 v106, v84, v85
    v_exp_f32 v91, v91
    v_cvt_pk_bf16_f32 v107, v86, v87
    v_exp_f32 v92, v92
    v_exp_f32 v93, v93
    v_mfma_f32_32x32x16_bf16 v[32:47], v[136:139], v[100:103], v[32:47]
    s_add_u32 s44, s44, 1
    s_cmp_lt_u32 s44, 2
    s_mov_b32 s33, s52
    s_mov_b32 s34, s53
    s_mov_b32 s35, s54
    s_mov_b32 s36, s55
    v_mov_b32 v22, v23
    v_exp_f32 v94, v94
    v_exp_f32 v95, v95
    v_cvt_pk_bf16_f32 v108, v88, v89
    v_cvt_pk_bf16_f32 v109, v90, v91
    v_cvt_pk_bf16_f32 v110, v92, v93
    v_cvt_pk_bf16_f32 v111, v94, v95
    s_cbranch_scc1 ATT_LOOP
    s_mov_b32 s3, 0
WOP_40:
    v_cmp_ne_u32 vcc, s63, v178
    s_nop 4
    s_cbranch_vccz WOK_39
    buffer_load_dword v178, v179, s[28:31], 0 offen sc1
    s_waitcnt vmcnt(0)
    s_add_u32 s3, s3, 1
    s_cmp_lt_u32 s3, 0x200000
    s_cbranch_scc1 WOP_40
WOK_39:
    s_add_u32 s12, s86, 10113024
    s_addc_u32 s13, s87, 0
    s_mov_b32 s14, 663552
    s_mov_b32 s15, 0x20000
    s_lshr_b32 s36, s61, 1
    s_min_u32 s36, s36, 2
    s_lshl_b32 s36, s36, 2
    s_add_u32 s36, s36, s62
    s_mul_i32 s36, s36, 55296
    v_mfma_f32_32x32x16_bf16 v[80:95], v[112:115], v[24:27], 0
    ds_read_b128 v[116:119], v14 offset:1024
    v_exp_f32 v64, v64
    v_exp_f32 v65, v65
    v_exp_f32 v66, v66
    v_exp_f32 v67, v67
    v_exp_f32 v68, v68
    v_exp_f32 v69, v69
    v_mfma_f32_32x32x16_bf16 v[48:63], v[132:135], v[104:107], v[48:63]
    ds_read_b128 v[124:127], v140 offset:0
    buffer_load_dwordx4 a[0:3], v8, s[12:15], s36 offen offset:0 sc1
    v_exp_f32 v70, v70
    v_cvt_pk_bf16_f32 v96, v64, v65
    v_exp_f32 v71, v71
    v_cvt_pk_bf16_f32 v97, v66, v67
    v_exp_f32 v72, v72
    v_exp_f32 v73, v73
    v_mfma_f32_32x32x8_bf16 v[80:95], v[120:121], v[28:29], v[80:95]
    ds_read_b32 v122, v15 offset:128
    v_exp_f32 v74, v74
    v_cvt_pk_bf16_f32 v98, v68, v69
    v_exp_f32 v75, v75
    v_cvt_pk_bf16_f32 v99, v70, v71
    v_exp_f32 v76, v76
    v_exp_f32 v77, v77
    v_mfma_f32_32x32x16_bf16 v[48:63], v[136:139], v[108:111], v[48:63]
    ds_read_b128 v[128:131], v140 offset:608
    buffer_load_dwordx4 a[4:7], v8, s[12:15], s36 offen offset:1024 sc1
    v_exp_f32 v78, v78
    v_exp_f32 v79, v79
    v_cvt_pk_bf16_f32 v100, v72, v73
    v_cvt_pk_bf16_f32 v101, v74, v75
    v_cvt_pk_bf16_f32 v102, v76, v77
    v_cvt_pk_bf16_f32 v103, v78, v79
    s_waitcnt lgkmcnt(0)
    v_mfma_f32_32x32x16_bf16 v[64:79], v[116:119], v[16:19], 0
    v_exp_f32 v80, v80
    v_exp_f32 v81, v81
    v_exp_f32 v82, v82
    v_exp_f32 v83, v83
    v_exp_f32 v84, v84
    v_exp_f32 v85, v85
    v_mfma_f32_32x32x16_bf16 v[32:47], v[124:127], v[96:99], v[32:47]
    buffer_load_dwordx4 a[8:11], v8, s[12:15], s36 offen offset:2048 sc1
    v_exp_f32 v86, v86
    v_cvt_pk_bf16_f32 v104, v80, v81
    v_exp_f32 v87, v87
    v_cvt_pk_bf16_f32 v105, v82, v83
    v_exp_f32 v88, v88
    v_exp_f32 v89, v89
    v_mfma_f32_32x32x8_bf16 v[64:79], v[122:123], v[20:21], v[64:79]
    v_exp_f32 v90, v90
    v_cvt_pk_bf16_f32 v106, v84, v85
    v_exp_f32 v91, v91
    v_cvt_pk_bf16_f32 v107, v86, v87
    v_exp_f32 v92, v92
    v_exp_f32 v93, v93
    v_mfma_f32_32x32x16_bf16 v[32:47], v[128:131], v[100:103], v[32:47]
    buffer_load_dwordx4 a[12:15], v8, s[12:15], s36 offen offset:3072 sc1
    s_add_u32 s36, s36, 4096
    v_exp_f32 v94, v94
    v_exp_f32 v95, v95
    v_cvt_pk_bf16_f32 v108, v88, v89
    v_cvt_pk_bf16_f32 v109, v90, v91
    v_cvt_pk_bf16_f32 v110, v92, v93
    v_cvt_pk_bf16_f32 v111, v94, v95
    v_mfma_f32_32x32x16_bf16 v[80:95], v[116:119], v[24:27], 0
    ds_read_b128 v[112:115], v14 offset:2048
    v_exp_f32 v64, v64
    v_exp_f32 v65, v65
    v_exp_f32 v66, v66
    v_exp_f32 v67, v67
    v_exp_f32 v68, v68
    v_exp_f32 v69, v69
    v_mfma_f32_32x32x16_bf16 v[48:63], v[124:127], v[104:107], v[48:63]
    ds_read_b128 v[132:135], v140 offset:1216
    buffer_load_dwordx4 a[16:19], v8, s[12:15], s36 offen offset:0 sc1
    v_exp_f32 v70, v70
    v_cvt_pk_bf16_f32 v96, v64, v65
    v_exp_f32 v71, v71
    v_cvt_pk_bf16_f32 v97, v66, v67
    v_exp_f32 v72, v72
    v_exp_f32 v73, v73
    v_mfma_f32_32x32x8_bf16 v[80:95], v[122:123], v[28:29], v[80:95]
    ds_read_b32 v120, v15 offset:256
    v_exp_f32 v74, v74
    v_cvt_pk_bf16_f32 v98, v68, v69
    v_exp_f32 v75, v75
    v_cvt_pk_bf16_f32 v99, v70, v71
    v_exp_f32 v76, v76
    v_exp_f32 v77, v77
    v_mfma_f32_32x32x16_bf16 v[48:63], v[128:131], v[108:111], v[48:63]
    ds_read_b128 v[136:139], v140 offset:1824
    buffer_load_dwordx4 a[20:23], v8, s[12:15], s36 offen offset:1024 sc1
    v_exp_f32 v78, v78
    v_exp_f32 v79, v79
    v_cvt_pk_bf16_f32 v100, v72, v73
    v_cvt_pk_bf16_f32 v101, v74, v75
    v_cvt_pk_bf16_f32 v102, v76, v77
    v_cvt_pk_bf16_f32 v103, v78, v79
    s_waitcnt lgkmcnt(0)
    v_mfma_f32_32x32x16_bf16 v[64:79], v[112:115], v[16:19], 0
    v_exp_f32 v80, v80
    v_exp_f32 v81, v81
    v_exp_f32 v82, v82
    v_exp_f32 v83, v83
    v_exp_f32 v84, v84
    v_exp_f32 v85, v85
    v_mfma_f32_32x32x16_bf16 v[32:47], v[132:135], v[96:99], v[32:47]
    buffer_load_dwordx4 a[24:27], v8, s[12:15], s36 offen offset:2048 sc1
    v_exp_f32 v86, v86
    v_cvt_pk_bf16_f32 v104, v80, v81
    v_exp_f32 v87, v87
    v_cvt_pk_bf16_f32 v105, v82, v83
    v_exp_f32 v88, v88
    v_exp_f32 v89, v89
    v_mfma_f32_32x32x8_bf16 v[64:79], v[120:121], v[20:21], v[64:79]
    v_exp_f32 v90, v90
    v_cvt_pk_bf16_f32 v106, v84, v85
    v_exp_f32 v91, v91
    v_cvt_pk_bf16_f32 v107, v86, v87
    v_exp_f32 v92, v92
    v_exp_f32 v93, v93
    v_mfma_f32_32x32x16_bf16 v[32:47], v[136:139], v[100:103], v[32:47]
    buffer_load_dwordx4 a[28:31], v8, s[12:15], s36 offen offset:3072 sc1
    s_add_u32 s36, s36, 4096
    v_exp_f32 v94, v94
    v_exp_f32 v95, v95
    v_cvt_pk_bf16_f32 v108, v88, v89
    v_cvt_pk_bf16_f32 v109, v90, v91
    v_cvt_pk_bf16_f32 v110, v92, v93
    v_cvt_pk_bf16_f32 v111, v94, v95
    v_mfma_f32_32x32x16_bf16 v[80:95], v[112:115], v[24:27], 0
    ds_read_b128 v[116:119], v14 offset:3072
    v_exp_f32 v64, v64
    v_exp_f32 v65, v65
    v_exp_f32 v66, v66
    v_exp_f32 v67, v67
    v_exp_f32 v68, v68
    v_exp_f32 v69, v69
    v_mfma_f32_32x32x16_bf16 v[48:63], v[132:135], v[104:107], v[48:63]
    ds_read_b128 v[124:127], v140 offset:2432
    buffer_load_dwordx4 a[32:35], v8, s[12:15], s36 offen offset:0 sc1
    v_exp_f32 v70, v70
    v_cvt_pk_bf16_f32 v96, v64, v65
    v_exp_f32 v71, v71
    v_cvt_pk_bf16_f32 v97, v66, v67
    v_exp_f32 v72, v72
    v_exp_f32 v73, v73
    v_mfma_f32_32x32x8_bf16 v[80:95], v[120:121], v[28:29], v[80:95]
    ds_read_b32 v122, v15 offset:384
    v_exp_f32 v74, v74
    v_cvt_pk_bf16_f32 v98, v68, v69
    v_exp_f32 v75, v75
    v_cvt_pk_bf16_f32 v99, v70, v71
    v_exp_f32 v76, v76
    v_exp_f32 v77, v77
    v_mfma_f32_32x32x16_bf16 v[48:63], v[136:139], v[108:111], v[48:63]
    ds_read_b128 v[128:131], v140 offset:3040
    buffer_load_dwordx4 a[36:39], v8, s[12:15], s36 offen offset:1024 sc1
    v_exp_f32 v78, v78
    v_exp_f32 v79, v79
    v_cvt_pk_bf16_f32 v100, v72, v73
    v_cvt_pk_bf16_f32 v101, v74, v75
    v_cvt_pk_bf16_f32 v102, v76, v77
    v_cvt_pk_bf16_f32 v103, v78, v79
    s_waitcnt lgkmcnt(0)
    v_mfma_f32_32x32x16_bf16 v[64:79], v[116:119], v[16:19], 0
    v_exp_f32 v80, v80
    v_exp_f32 v81, v81
    v_exp_f32 v82, v82
    v_exp_f32 v83, v83
    v_exp_f32 v84, v84
    v_exp_f32 v85, v85
    v_mfma_f32_32x32x16_bf16 v[32:47], v[124:127], v[96:99], v[32:47]
    buffer_load_dwordx4 a[40:43], v8, s[12:15], s36 offen offset:2048 sc1
    v_exp_f32 v86, v86
    v_cvt_pk_bf16_f32 v104, v80, v81
    v_exp_f32 v87, v87
    v_cvt_pk_bf16_f32 v105, v82, v83
    v_exp_f32 v88, v88
    v_exp_f32 v89, v89
    v_mfma_f32_32x32x8_bf16 v[64:79], v[122:123], v[20:21], v[64:79]
    v_exp_f32 v90, v90
    v_cvt_pk_bf16_f32 v106, v84, v85
    v_exp_f32 v91, v91
    v_cvt_pk_bf16_f32 v107, v86, v87
    v_exp_f32 v92, v92
    v_exp_f32 v93, v93
    v_mfma_f32_32x32x16_bf16 v[32:47], v[128:131], v[100:103], v[32:47]
    buffer_load_dwordx4 a[44:47], v8, s[12:15], s36 offen offset:3072 sc1
    s_add_u32 s36, s36, 4096
    v_exp_f32 v94, v94
    v_exp_f32 v95, v95
    v_cvt_pk_bf16_f32 v108, v88, v89
    v_cvt_pk_bf16_f32 v109, v90, v91
    v_cvt_pk_bf16_f32 v110, v92, v93
    v_cvt_pk_bf16_f32 v111, v94, v95
    v_mfma_f32_32x32x16_bf16 v[80:95], v[116:119], v[24:27], 0
    ds_read_b128 v[112:115], v14 offset:4096
    v_exp_f32 v64, v64
    v_exp_f32 v65, v65
    v_exp_f32 v66, v66
    v_exp_f32 v67, v67
    v_exp_f32 v68, v68
    v_exp_f32 v69, v69
    v_mfma_f32_32x32x16_bf16 v[48:63], v[124:127], v[104:107], v[48:63]
    ds_read_b128 v[132:135], v140 offset:3648
    buffer_load_dwordx4 a[48:51], v8, s[12:15], s36 offen offset:0 sc1
    v_exp_f32 v70, v70
    v_cvt_pk_bf16_f32 v96, v64, v65
    v_exp_f32 v71, v71
    v_cvt_pk_bf16_f32 v97, v66, v67
    v_exp_f32 v72, v72
    v_exp_f32 v73, v73
    v_mfma_f32_32x32x8_bf16 v[80:95], v[122:123], v[28:29], v[80:95]
    ds_read_b32 v120, v15 offset:512
    v_exp_f32 v74, v74
    v_cvt_pk_bf16_f32 v98, v68, v69
    v_exp_f32 v75, v75
    v_cvt_pk_bf16_f32 v99, v70, v71
    v_exp_f32 v76, v76
    v_exp_f32 v77, v77
    v_mfma_f32_32x32x16_bf16 v[48:63], v[128:131], v[108:111], v[48:63]
    ds_read_b128 v[136:139], v140 offset:4256
    buffer_load_dwordx4 a[52:55], v8, s[12:15], s36 offen offset:1024 sc1
    v_exp_f32 v78, v78
    v_exp_f32 v79, v79
    v_cvt_pk_bf16_f32 v100, v72, v73
    v_cvt_pk_bf16_f32 v101, v74, v75
    v_cvt_pk_bf16_f32 v102, v76, v77
    v_cvt_pk_bf16_f32 v103, v78, v79
    s_waitcnt lgkmcnt(0)
    v_mfma_f32_32x32x16_bf16 v[64:79], v[112:115], v[16:19], 0
    v_exp_f32 v80, v80
    v_exp_f32 v81, v81
    v_exp_f32 v82, v82
    v_exp_f32 v83, v83
    v_exp_f32 v84, v84
    v_exp_f32 v85, v85
    v_mfma_f32_32x32x16_bf16 v[32:47], v[132:135], v[96:99], v[32:47]
    buffer_load_dwordx4 a[56:59], v8, s[12:15], s36 offen offset:2048 sc1
    v_exp_f32 v86, v86
    v_cvt_pk_bf16_f32 v104, v80, v81
    v_exp_f32 v87, v87
    v_cvt_pk_bf16_f32 v105, v82, v83
    v_exp_f32 v88, v88
    v_exp_f32 v89, v89
    v_mfma_f32_32x32x8_bf16 v[64:79], v[120:121], v[20:21], v[64:79]
    v_exp_f32 v90, v90
    v_cvt_pk_bf16_f32 v106, v84, v85
    v_exp_f32 v91, v91
    v_cvt_pk_bf16_f32 v107, v86, v87
    v_exp_f32 v92, v92
    v_exp_f32 v93, v93
    v_mfma_f32_32x32x16_bf16 v[32:47], v[136:139], v[100:103], v[32:47]
    buffer_load_dwordx4 a[60:63], v8, s[12:15], s36 offen offset:3072 sc1
    s_add_u32 s36, s36, 4096
    v_exp_f32 v94, v94
    v_exp_f32 v95, v95
    v_cvt_pk_bf16_f32 v108, v88, v89
    v_cvt_pk_bf16_f32 v109, v90, v91
    v_cvt_pk_bf16_f32 v110, v92, v93
    v_cvt_pk_bf16_f32 v111, v94, v95
    v_mfma_f32_32x32x16_bf16 v[80:95], v[112:115], v[24:27], 0
    ds_read_b128 v[116:119], v14 offset:5120
    v_exp_f32 v64, v64
    v_exp_f32 v65, v65
    v_exp_f32 v66, v66
    v_exp_f32 v67, v67
    v_exp_f32 v68, v68
    v_exp_f32 v69, v69
    v_mfma_f32_32x32x16_bf16 v[48:63], v[132:135], v[104:107], v[48:63]
    ds_read_b128 v[124:127], v140 offset:4864
    buffer_load_dwordx4 a[64:67], v8, s[12:15], s36 offen offset:0 sc1
    v_exp_f32 v70, v70
    v_cvt_pk_bf16_f32 v96, v64, v65
    v_exp_f32 v71, v71
    v_cvt_pk_bf16_f32 v97, v66, v67
    v_exp_f32 v72, v72
    v_exp_f32 v73, v73
    v_mfma_f32_32x32x8_bf16 v[80:95], v[120:121], v[28:29], v[80:95]
    ds_read_b32 v122, v15 offset:640
    v_exp_f32 v74, v74
    v_cvt_pk_bf16_f32 v98, v68, v69
    v_exp_f32 v75, v75
    v_cvt_pk_bf16_f32 v99, v70, v71
    v_exp_f32 v76, v76
    v_exp_f32 v77, v77
    v_mfma_f32_32x32x16_bf16 v[48:63], v[136:139], v[108:111], v[48:63]
    ds_read_b128 v[128:131], v140 offset:5472
    buffer_load_dwordx4 a[68:71], v8, s[12:15], s36 offen offset:1024 sc1
    v_exp_f32 v78, v78
    v_exp_f32 v79, v79
    v_cvt_pk_bf16_f32 v100, v72, v73
    v_cvt_pk_bf16_f32 v101, v74, v75
    v_cvt_pk_bf16_f32 v102, v76, v77
    v_cvt_pk_bf16_f32 v103, v78, v79
    s_waitcnt lgkmcnt(0)
    v_mfma_f32_32x32x16_bf16 v[64:79], v[116:119], v[16:19], 0
    v_exp_f32 v80, v80
    v_exp_f32 v81, v81
    v_exp_f32 v82, v82
    v_exp_f32 v83, v83
    v_exp_f32 v84, v84
    v_exp_f32 v85, v85
    v_mfma_f32_32x32x16_bf16 v[32:47], v[124:127], v[96:99], v[32:47]
    buffer_load_dwordx4 a[72:75], v8, s[12:15], s36 offen offset:2048 sc1
    v_exp_f32 v86, v86
    v_cvt_pk_bf16_f32 v104, v80, v81
    v_exp_f32 v87, v87
    v_cvt_pk_bf16_f32 v105, v82, v83
    v_exp_f32 v88, v88
    v_exp_f32 v89, v89
    v_mfma_f32_32x32x8_bf16 v[64:79], v[122:123], v[20:21], v[64:79]
    v_exp_f32 v90, v90
    v_cvt_pk_bf16_f32 v106, v84, v85
    v_exp_f32 v91, v91
    v_cvt_pk_bf16_f32 v107, v86, v87
    v_exp_f32 v92, v92
    v_exp_f32 v93, v93
    v_mfma_f32_32x32x16_bf16 v[32:47], v[128:131], v[100:103], v[32:47]
    buffer_load_dwordx4 a[76:79], v8, s[12:15], s36 offen offset:3072 sc1
    s_add_u32 s36, s36, 4096
    v_exp_f32 v94, v94
    v_exp_f32 v95, v95
    v_cvt_pk_bf16_f32 v108, v88, v89
    v_cvt_pk_bf16_f32 v109, v90, v91
    v_cvt_pk_bf16_f32 v110, v92, v93
    v_cvt_pk_bf16_f32 v111, v94, v95
    v_mfma_f32_32x32x16_bf16 v[80:95], v[116:119], v[24:27], 0
    ds_read_b128 v[112:115], v14 offset:6144
    v_exp_f32 v64, v64
    v_exp_f32 v65, v65
    v_exp_f32 v66, v66
    v_exp_f32 v67, v67
    v_exp_f32 v68, v68
    v_exp_f32 v69, v69
    v_mfma_f32_32x32x16_bf16 v[48:63], v[124:127], v[104:107], v[48:63]
    ds_read_b128 v[132:135], v140 offset:6080
    buffer_load_dwordx4 a[80:83], v8, s[12:15], s36 offen offset:0 sc1
    v_exp_f32 v70, v70
    v_cvt_pk_bf16_f32 v96, v64, v65
    v_exp_f32 v71, v71
    v_cvt_pk_bf16_f32 v97, v66, v67
    v_exp_f32 v72, v72
    v_exp_f32 v73, v73
    v_mfma_f32_32x32x8_bf16 v[80:95], v[122:123], v[28:29], v[80:95]
    ds_read_b32 v120, v15 offset:768
    v_exp_f32 v74, v74
    v_cvt_pk_bf16_f32 v98, v68, v69
    v_exp_f32 v75, v75
    v_cvt_pk_bf16_f32 v99, v70, v71
    v_exp_f32 v76, v76
    v_exp_f32 v77, v77
    v_mfma_f32_32x32x16_bf16 v[48:63], v[128:131], v[108:111], v[48:63]
    ds_read_b128 v[136:139], v140 offset:6688
    buffer_load_dwordx4 a[84:87], v8, s[12:15], s36 offen offset:1024 sc1
    v_exp_f32 v78, v78
    v_exp_f32 v79, v79
    v_cvt_pk_bf16_f32 v100, v72, v73
    v_cvt_pk_bf16_f32 v101, v74, v75
    v_cvt_pk_bf16_f32 v102, v76, v77
    v_cvt_pk_bf16_f32 v103, v78, v79
    s_waitcnt lgkmcnt(0)
    v_mfma_f32_32x32x16_bf16 v[64:79], v[112:115], v[16:19], 0
    v_exp_f32 v80, v80
    v_exp_f32 v81, v81
    v_exp_f32 v82, v82
    v_exp_f32 v83, v83
    v_exp_f32 v84, v84
    v_exp_f32 v85, v85
    v_mfma_f32_32x32x16_bf16 v[32:47], v[132:135], v[96:99], v[32:47]
    buffer_load_dwordx4 a[88:91], v8, s[12:15], s36 offen offset:2048 sc1
    v_exp_f32 v86, v86
    v_cvt_pk_bf16_f32 v104, v80, v81
    v_exp_f32 v87, v87
    v_cvt_pk_bf16_f32 v105, v82, v83
    v_exp_f32 v88, v88
    v_exp_f32 v89, v89
    v_mfma_f32_32x32x8_bf16 v[64:79], v[120:121], v[20:21], v[64:79]
    v_exp_f32 v90, v90
    v_cvt_pk_bf16_f32 v106, v84, v85
    v_exp_f32 v91, v91
    v_cvt_pk_bf16_f32 v107, v86, v87
    v_exp_f32 v92, v92
    v_exp_f32 v93, v93
    v_mfma_f32_32x32x16_bf16 v[32:47], v[136:139], v[100:103], v[32:47]
    buffer_load_dwordx4 a[92:95], v8, s[12:15], s36 offen offset:3072 sc1
    s_add_u32 s36, s36, 4096
    v_exp_f32 v94, v94
    v_exp_f32 v95, v95
    v_cvt_pk_bf16_f32 v108, v88, v89
    v_cvt_pk_bf16_f32 v109, v90, v91
    v_cvt_pk_bf16_f32 v110, v92, v93
    v_cvt_pk_bf16_f32 v111, v94, v95
    v_mfma_f32_32x32x16_bf16 v[80:95], v[112:115], v[24:27], 0
    ds_read_b128 v[116:119], v14 offset:7168
    v_exp_f32 v64, v64
    v_exp_f32 v65, v65
    v_exp_f32 v66, v66
    v_exp_f32 v67, v67
    v_exp_f32 v68, v68
    v_exp_f32 v69, v69
    v_mfma_f32_32x32x16_bf16 v[48:63], v[132:135], v[104:107], v[48:63]
    ds_read_b128 v[124:127], v140 offset:7296
    buffer_load_dwordx4 a[96:99], v8, s[12:15], s36 offen offset:0 sc1
    v_exp_f32 v70, v70
    v_cvt_pk_bf16_f32 v96, v64, v65
    v_exp_f32 v71, v71
    v_cvt_pk_bf16_f32 v97, v66, v67
    v_exp_f32 v72, v72
    v_exp_f32 v73, v73
    v_mfma_f32_32x32x8_bf16 v[80:95], v[120:121], v[28:29], v[80:95]
    ds_read_b32 v122, v15 offset:896
    v_exp_f32 v74, v74
    v_cvt_pk_bf16_f32 v98, v68, v69
    v_exp_f32 v75, v75
    v_cvt_pk_bf16_f32 v99, v70, v71
    v_exp_f32 v76, v76
    v_exp_f32 v77, v77
    v_mfma_f32_32x32x16_bf16 v[48:63], v[136:139], v[108:111], v[48:63]
    ds_read_b128 v[128:131], v140 offset:7904
    buffer_load_dwordx4 a[100:103], v8, s[12:15], s36 offen offset:1024 sc1
    v_exp_f32 v78, v78
    v_exp_f32 v79, v79
    v_cvt_pk_bf16_f32 v100, v72, v73
    v_cvt_pk_bf16_f32 v101, v74, v75
    v_cvt_pk_bf16_f32 v102, v76, v77
    v_cvt_pk_bf16_f32 v103, v78, v79
    s_waitcnt lgkmcnt(0)
    v_mfma_f32_32x32x16_bf16 v[64:79], v[116:119], v[16:19], 0
    v_exp_f32 v80, v80
    v_exp_f32 v81, v81
    v_exp_f32 v82, v82
    v_exp_f32 v83, v83
    v_exp_f32 v84, v84
    v_exp_f32 v85, v85
    v_mfma_f32_32x32x16_bf16 v[32:47], v[124:127], v[96:99], v[32:47]
    buffer_load_dwordx4 a[104:107], v8, s[12:15], s36 offen offset:2048 sc1
    v_exp_f32 v86, v86
    v_cvt_pk_bf16_f32 v104, v80, v81
    v_exp_f32 v87, v87
    v_cvt_pk_bf16_f32 v105, v82, v83
    v_exp_f32 v88, v88
    v_exp_f32 v89, v89
    v_mfma_f32_32x32x8_bf16 v[64:79], v[122:123], v[20:21], v[64:79]
    v_exp_f32 v90, v90
    v_cvt_pk_bf16_f32 v106, v84, v85
    v_exp_f32 v91, v91
    v_cvt_pk_bf16_f32 v107, v86, v87
    v_exp_f32 v92, v92
    v_exp_f32 v93, v93
    v_mfma_f32_32x32x16_bf16 v[32:47], v[128:131], v[100:103], v[32:47]
    buffer_load_dwordx4 a[108:111], v8, s[12:15], s36 offen offset:3072 sc1
    s_add_u32 s36, s36, 4096
    v_exp_f32 v94, v94
    v_exp_f32 v95, v95
    v_cvt_pk_bf16_f32 v108, v88, v89
    v_cvt_pk_bf16_f32 v109, v90, v91
    v_cvt_pk_bf16_f32 v110, v92, v93
    v_cvt_pk_bf16_f32 v111, v94, v95
    v_mfma_f32_32x32x16_bf16 v[80:95], v[116:119], v[24:27], 0
    ds_read_b128 v[112:115], v14 offset:8192
    v_exp_f32 v64, v64
    v_exp_f32 v65, v65
    v_exp_f32 v66, v66
    v_exp_f32 v67, v67
    v_exp_f32 v68, v68
    v_exp_f32 v69, v69
    v_mfma_f32_32x32x16_bf16 v[48:63], v[124:127], v[104:107], v[48:63]
    ds_read_b128 v[132:135], v140 offset:8512
    buffer_load_dwordx4 a[112:115], v8, s[12:15], s36 offen offset:0 sc1
    v_exp_f32 v70, v70
    v_cvt_pk_bf16_f32 v96, v64, v65
    v_exp_f32 v71, v71
    v_cvt_pk_bf16_f32 v97, v66, v67
    v_exp_f32 v72, v72
    v_exp_f32 v73, v73
    v_mfma_f32_32x32x8_bf16 v[80:95], v[122:123], v[28:29], v[80:95]
    ds_read_b32 v120, v15 offset:1024
    v_exp_f32 v74, v74
    v_cvt_pk_bf16_f32 v98, v68, v69
    v_exp_f32 v75, v75
    v_cvt_pk_bf16_f32 v99, v70, v71
    v_exp_f32 v76, v76
    v_exp_f32 v77, v77
    v_mfma_f32_32x32x16_bf16 v[48:63], v[128:131], v[108:111], v[48:63]
    ds_read_b128 v[136:139], v140 offset:9120
    buffer_load_dwordx4 a[116:119], v8, s[12:15], s36 offen offset:1024 sc1
    v_exp_f32 v78, v78
    v_exp_f32 v79, v79
    v_cvt_pk_bf16_f32 v100, v72, v73
    v_cvt_pk_bf16_f32 v101, v74, v75
    v_cvt_pk_bf16_f32 v102, v76, v77
    v_cvt_pk_bf16_f32 v103, v78, v79
    s_waitcnt lgkmcnt(0)
    v_mfma_f32_32x32x16_bf16 v[64:79], v[112:115], v[16:19], 0
    v_exp_f32 v80, v80
    v_exp_f32 v81, v81
    v_exp_f32 v82, v82
    v_exp_f32 v83, v83
    v_exp_f32 v84, v84
    v_exp_f32 v85, v85
    v_mfma_f32_32x32x16_bf16 v[32:47], v[132:135], v[96:99], v[32:47]
    buffer_load_dwordx4 a[120:123], v8, s[12:15], s36 offen offset:2048 sc1
    v_exp_f32 v86, v86
    v_cvt_pk_bf16_f32 v104, v80, v81
    v_exp_f32 v87, v87
    v_cvt_pk_bf16_f32 v105, v82, v83
    v_exp_f32 v88, v88
    v_exp_f32 v89, v89
    v_mfma_f32_32x32x8_bf16 v[64:79], v[120:121], v[20:21], v[64:79]
    v_exp_f32 v90, v90
    v_cvt_pk_bf16_f32 v106, v84, v85
    v_exp_f32 v91, v91
    v_cvt_pk_bf16_f32 v107, v86, v87
    v_exp_f32 v92, v92
    v_exp_f32 v93, v93
    v_mfma_f32_32x32x16_bf16 v[32:47], v[136:139], v[100:103], v[32:47]
    buffer_load_dwordx4 a[124:127], v8, s[12:15], s36 offen offset:3072 sc1
    s_add_u32 s36, s36, 4096
    v_exp_f32 v94, v94
    v_exp_f32 v95, v95
    v_cvt_pk_bf16_f32 v108, v88, v89
    v_cvt_pk_bf16_f32 v109, v90, v91
    v_cvt_pk_bf16_f32 v110, v92, v93
    v_cvt_pk_bf16_f32 v111, v94, v95
    v_mfma_f32_32x32x16_bf16 v[80:95], v[112:115], v[24:27], 0
    ds_read_b128 v[116:119], v14 offset:9216
    v_exp_f32 v64, v64
    v_exp_f32 v65, v65
    v_exp_f32 v66, v66
    v_exp_f32 v67, v67
    v_exp_f32 v68, v68
    v_exp_f32 v69, v69
    v_mfma_f32_32x32x16_bf16 v[48:63], v[132:135], v[104:107], v[48:63]
    ds_read_b128 v[124:127], v140 offset:9728
    buffer_load_dwordx4 a[128:131], v8, s[12:15], s36 offen offset:0 sc1
    v_exp_f32 v70, v70
    v_cvt_pk_bf16_f32 v96, v64, v65
    v_exp_f32 v71, v71
    v_cvt_pk_bf16_f32 v97, v66, v67
    v_exp_f32 v72, v72
    v_exp_f32 v73, v73
    v_mfma_f32_32x32x8_bf16 v[80:95], v[120:121], v[28:29], v[80:95]
    ds_read_b32 v122, v15 offset:1152
    v_exp_f32 v74, v74
    v_cvt_pk_bf16_f32 v98, v68, v69
    v_exp_f32 v75, v75
    v_cvt_pk_bf16_f32 v99, v70, v71
    v_exp_f32 v76, v76
    v_exp_f32 v77, v77
    v_mfma_f32_32x32x16_bf16 v[48:63], v[136:139], v[108:111], v[48:63]
    ds_read_b128 v[128:131], v140 offset:10336
    buffer_load_dwordx4 a[132:135], v8, s[12:15], s36 offen offset:1024 sc1
    v_exp_f32 v78, v78
    v_exp_f32 v79, v79
    v_cvt_pk_bf16_f32 v100, v72, v73
    v_cvt_pk_bf16_f32 v101, v74, v75
    v_cvt_pk_bf16_f32 v102, v76, v77
    v_cvt_pk_bf16_f32 v103, v78, v79
    s_waitcnt lgkmcnt(0)
    v_mfma_f32_32x32x16_bf16 v[64:79], v[116:119], v[16:19], 0
    v_exp_f32 v80, v80
    v_exp_f32 v81, v81
    v_exp_f32 v82, v82
    v_exp_f32 v83, v83
    v_exp_f32 v84, v84
    v_exp_f32 v85, v85
    v_mfma_f32_32x32x16_bf16 v[32:47], v[124:127], v[96:99], v[32:47]
    buffer_load_dwordx4 a[136:139], v8, s[12:15], s36 offen offset:2048 sc1
    v_exp_f32 v86, v86
    v_cvt_pk_bf16_f32 v104, v80, v81
    v_exp_f32 v87, v87
    v_cvt_pk_bf16_f32 v105, v82, v83
    v_exp_f32 v88, v88
    v_exp_f32 v89, v89
    v_mfma_f32_32x32x8_bf16 v[64:79], v[122:123], v[20:21], v[64:79]
    v_exp_f32 v90, v90
    v_cvt_pk_bf16_f32 v106, v84, v85
    v_exp_f32 v91, v91
    v_cvt_pk_bf16_f32 v107, v86, v87
    v_exp_f32 v92, v92
    v_exp_f32 v93, v93
    v_mfma_f32_32x32x16_bf16 v[32:47], v[128:131], v[100:103], v[32:47]
    buffer_load_dwordx4 a[140:143], v8, s[12:15], s36 offen offset:3072 sc1
    s_add_u32 s36, s36, 4096
    v_exp_f32 v94, v94
    v_exp_f32 v95, v95
    v_cvt_pk_bf16_f32 v108, v88, v89
    v_cvt_pk_bf16_f32 v109, v90, v91
    v_cvt_pk_bf16_f32 v110, v92, v93
    v_cvt_pk_bf16_f32 v111, v94, v95
    v_mfma_f32_32x32x16_bf16 v[80:95], v[116:119], v[24:27], 0
    ds_read_b128 v[112:115], v14 offset:10240
    v_exp_f32 v64, v64
    v_exp_f32 v65, v65
    v_exp_f32 v66, v66
    v_exp_f32 v67, v67
    v_exp_f32 v68, v68
    v_exp_f32 v69, v69
    v_mfma_f32_32x32x16_bf16 v[48:63], v[124:127], v[104:107], v[48:63]
    ds_read_b128 v[132:135], v140 offset:10944
    buffer_load_dwordx4 a[144:147], v8, s[12:15], s36 offen offset:0 sc1
    v_exp_f32 v70, v70
    v_cvt_pk_bf16_f32 v96, v64, v65
    v_exp_f32 v71, v71
    v_cvt_pk_bf16_f32 v97, v66, v67
    v_exp_f32 v72, v72
    v_exp_f32 v73, v73
    v_mfma_f32_32x32x8_bf16 v[80:95], v[122:123], v[28:29], v[80:95]
    ds_read_b32 v120, v15 offset:1280
    v_exp_f32 v74, v74
    v_cvt_pk_bf16_f32 v98, v68, v69
    v_exp_f32 v75, v75
    v_cvt_pk_bf16_f32 v99, v70, v71
    v_exp_f32 v76, v76
    v_exp_f32 v77, v77
    v_mfma_f32_32x32x16_bf16 v[48:63], v[128:131], v[108:111], v[48:63]
    ds_read_b128 v[136:139], v140 offset:11552
    buffer_load_dwordx4 a[148:151], v8, s[12:15], s36 offen offset:1024 sc1
    v_exp_f32 v78, v78
    v_exp_f32 v79, v79
    v_cvt_pk_bf16_f32 v100, v72, v73
    v_cvt_pk_bf16_f32 v101, v74, v75
    v_cvt_pk_bf16_f32 v102, v76, v77
    v_cvt_pk_bf16_f32 v103, v78, v79
    s_waitcnt lgkmcnt(0)
    v_mfma_f32_32x32x16_bf16 v[64:79], v[112:115], v[16:19], 0
    v_exp_f32 v80, v80
    v_exp_f32 v81, v81
    v_exp_f32 v82, v82
    v_exp_f32 v83, v83
    v_exp_f32 v84, v84
    v_exp_f32 v85, v85
    v_mfma_f32_32x32x16_bf16 v[32:47], v[132:135], v[96:99], v[32:47]
    buffer_load_dwordx4 a[152:155], v8, s[12:15], s36 offen offset:2048 sc1
    v_exp_f32 v86, v86
    v_cvt_pk_bf16_f32 v104, v80, v81
    v_exp_f32 v87, v87
    v_cvt_pk_bf16_f32 v105, v82, v83
    v_exp_f32 v88, v88
    v_exp_f32 v89, v89
    v_mfma_f32_32x32x8_bf16 v[64:79], v[120:121], v[20:21], v[64:79]
    v_exp_f32 v90, v90
    v_cvt_pk_bf16_f32 v106, v84, v85
    v_exp_f32 v91, v91
    v_cvt_pk_bf16_f32 v107, v86, v87
    v_exp_f32 v92, v92
    v_exp_f32 v93, v93
    v_mfma_f32_32x32x16_bf16 v[32:47], v[136:139], v[100:103], v[32:47]
    buffer_load_dwordx4 a[156:159], v8, s[12:15], s36 offen offset:3072 sc1
    s_add_u32 s36, s36, 4096
    v_exp_f32 v94, v94
    v_exp_f32 v95, v95
    v_cvt_pk_bf16_f32 v108, v88, v89
    v_cvt_pk_bf16_f32 v109, v90, v91
    v_cvt_pk_bf16_f32 v110, v92, v93
    v_cvt_pk_bf16_f32 v111, v94, v95
    v_mfma_f32_32x32x16_bf16 v[80:95], v[112:115], v[24:27], 0
    ds_read_b128 v[116:119], v14 offset:11264
    v_exp_f32 v64, v64
    v_exp_f32 v65, v65
    v_exp_f32 v66, v66
    v_exp_f32 v67, v67
    v_exp_f32 v68, v68
    v_exp_f32 v69, v69
    v_mfma_f32_32x32x16_bf16 v[48:63], v[132:135], v[104:107], v[48:63]
    ds_read_b128 v[124:127], v140 offset:12160
    buffer_load_dwordx4 a[160:163], v8, s[12:15], s36 offen offset:0 sc1
    v_exp_f32 v70, v70
    v_cvt_pk_bf16_f32 v96, v64, v65
    v_exp_f32 v71, v71
    v_cvt_pk_bf16_f32 v97, v66, v67
    v_exp_f32 v72, v72
    v_exp_f32 v73, v73
    v_mfma_f32_32x32x8_bf16 v[80:95], v[120:121], v[28:29], v[80:95]
    ds_read_b32 v122, v15 offset:1408
    v_exp_f32 v74, v74
    v_cvt_pk_bf16_f32 v98, v68, v69
    v_exp_f32 v75, v75
    v_cvt_pk_bf16_f32 v99, v70, v71
    v_exp_f32 v76, v76
    v_exp_f32 v77, v77
    v_mfma_f32_32x32x16_bf16 v[48:63], v[136:139], v[108:111], v[48:63]
    ds_read_b128 v[128:131], v140 offset:12768
    buffer_load_dwordx4 a[164:167], v8, s[12:15], s36 offen offset:1024 sc1
    v_exp_f32 v78, v78
    v_exp_f32 v79, v79
    v_cvt_pk_bf16_f32 v100, v72, v73
    v_cvt_pk_bf16_f32 v101, v74, v75
    v_cvt_pk_bf16_f32 v102, v76, v77
    v_cvt_pk_bf16_f32 v103, v78, v79
    s_waitcnt lgkmcnt(0)
    v_mfma_f32_32x32x16_bf16 v[64:79], v[116:119], v[16:19], 0
    v_exp_f32 v80, v80
    v_exp_f32 v81, v81
    v_exp_f32 v82, v82
    v_exp_f32 v83, v83
    v_exp_f32 v84, v84
    v_exp_f32 v85, v85
    v_mfma_f32_32x32x16_bf16 v[32:47], v[124:127], v[96:99], v[32:47]
    buffer_load_dwordx4 a[168:171], v8, s[12:15], s36 offen offset:2048 sc1
    v_exp_f32 v86, v86
    v_cvt_pk_bf16_f32 v104, v80, v81
    v_exp_f32 v87, v87
    v_cvt_pk_bf16_f32 v105, v82, v83
    v_exp_f32 v88, v88
    v_exp_f32 v89, v89
    v_mfma_f32_32x32x8_bf16 v[64:79], v[122:123], v[20:21], v[64:79]
    v_exp_f32 v90, v90
    v_cvt_pk_bf16_f32 v106, v84, v85
    v_exp_f32 v91, v91
    v_cvt_pk_bf16_f32 v107, v86, v87
    v_exp_f32 v92, v92
    v_exp_f32 v93, v93
    v_mfma_f32_32x32x16_bf16 v[32:47], v[128:131], v[100:103], v[32:47]
    buffer_load_dwordx4 a[172:175], v8, s[12:15], s36 offen offset:3072 sc1
    s_add_u32 s36, s36, 4096
    v_exp_f32 v94, v94
    v_exp_f32 v95, v95
    v_cvt_pk_bf16_f32 v108, v88, v89
    v_cvt_pk_bf16_f32 v109, v90, v91
    v_cvt_pk_bf16_f32 v110, v92, v93
    v_cvt_pk_bf16_f32 v111, v94, v95
    v_mfma_f32_32x32x16_bf16 v[80:95], v[116:119], v[24:27], 0
    ds_read_b128 v[112:115], v14 offset:12288
    v_exp_f32 v64, v64
    v_exp_f32 v65, v65
    v_exp_f32 v66, v66
    v_exp_f32 v67, v67
    v_exp_f32 v68, v68
    v_exp_f32 v69, v69
    v_mfma_f32_32x32x16_bf16 v[48:63], v[124:127], v[104:107], v[48:63]
    ds_read_b128 v[132:135], v140 offset:13376
    buffer_load_dwordx4 a[176:179], v8, s[12:15], s36 offen offset:0 sc1
    v_exp_f32 v70, v70
    v_cvt_pk_bf16_f32 v96, v64, v65
    v_exp_f32 v71, v71
    v_cvt_pk_bf16_f32 v97, v66, v67
    v_exp_f32 v72, v72
    v_exp_f32 v73, v73
    v_mfma_f32_32x32x8_bf16 v[80:95], v[122:123], v[28:29], v[80:95]
    ds_read_b32 v120, v15 offset:1536
    v_exp_f32 v74, v74
    v_cvt_pk_bf16_f32 v98, v68, v69
    v_exp_f32 v75, v75
    v_cvt_pk_bf16_f32 v99, v70, v71
    v_exp_f32 v76, v76
    v_exp_f32 v77, v77
    v_mfma_f32_32x32x16_bf16 v[48:63], v[128:131], v[108:111], v[48:63]
    ds_read_b128 v[136:139], v140 offset:13984
    buffer_load_dwordx4 a[180:183], v8, s[12:15], s36 offen offset:1024 sc1
    v_exp_f32 v78, v78
    v_exp_f32 v79, v79
    v_cvt_pk_bf16_f32 v100, v72, v73
    v_cvt_pk_bf16_f32 v101, v74, v75
    v_cvt_pk_bf16_f32 v102, v76, v77
    v_cvt_pk_bf16_f32 v103, v78, v79
    s_waitcnt lgkmcnt(0)
    v_mfma_f32_32x32x16_bf16 v[64:79], v[112:115], v[16:19], 0
    v_exp_f32 v80, v80
    v_exp_f32 v81, v81
    v_exp_f32 v82, v82
    v_exp_f32 v83, v83
    v_exp_f32 v84, v84
    v_exp_f32 v85, v85
    v_mfma_f32_32x32x16_bf16 v[32:47], v[132:135], v[96:99], v[32:47]
    buffer_load_dwordx4 a[184:187], v8, s[12:15], s36 offen offset:2048 sc1
    v_exp_f32 v86, v86
    v_cvt_pk_bf16_f32 v104, v80, v81
    v_exp_f32 v87, v87
    v_cvt_pk_bf16_f32 v105, v82, v83
    v_exp_f32 v88, v88
    v_exp_f32 v89, v89
    v_mfma_f32_32x32x8_bf16 v[64:79], v[120:121], v[20:21], v[64:79]
    v_exp_f32 v90, v90
    v_cvt_pk_bf16_f32 v106, v84, v85
    v_exp_f32 v91, v91
    v_cvt_pk_bf16_f32 v107, v86, v87
    v_exp_f32 v92, v92
    v_exp_f32 v93, v93
    v_mfma_f32_32x32x16_bf16 v[32:47], v[136:139], v[100:103], v[32:47]
    buffer_load_dwordx4 a[188:191], v8, s[12:15], s36 offen offset:3072 sc1
    s_add_u32 s36, s36, 4096
    v_exp_f32 v94, v94
    v_exp_f32 v95, v95
    v_cvt_pk_bf16_f32 v108, v88, v89
    v_cvt_pk_bf16_f32 v109, v90, v91
    v_cvt_pk_bf16_f32 v110, v92, v93
    v_cvt_pk_bf16_f32 v111, v94, v95
    v_mfma_f32_32x32x16_bf16 v[80:95], v[112:115], v[24:27], 0
    ds_read_b128 v[116:119], v14 offset:13312
    v_exp_f32 v64, v64
    v_exp_f32 v65, v65
    v_exp_f32 v66, v66
    v_exp_f32 v67, v67
    v_exp_f32 v68, v68
    v_exp_f32 v69, v69
    v_mfma_f32_32x32x16_bf16 v[48:63], v[132:135], v[104:107], v[48:63]
    ds_read_b128 v[124:127], v140 offset:14592
    buffer_load_dwordx4 a[192:195], v8, s[12:15], s36 offen offset:0 sc1
    v_exp_f32 v70, v70
    v_cvt_pk_bf16_f32 v96, v64, v65
    v_exp_f32 v71, v71
    v_cvt_pk_bf16_f32 v97, v66, v67
    v_exp_f32 v72, v72
    v_exp_f32 v73, v73
    v_mfma_f32_32x32x8_bf16 v[80:95], v[120:121], v[28:29], v[80:95]
    ds_read_b32 v122, v15 offset:1664
    v_exp_f32 v74, v74
    v_cvt_pk_bf16_f32 v98, v68, v69
    v_exp_f32 v75, v75
    v_cvt_pk_bf16_f32 v99, v70, v71
    v_exp_f32 v76, v76
    v_exp_f32 v77, v77
    v_mfma_f32_32x32x16_bf16 v[48:63], v[136:139], v[108:111], v[48:63]
    ds_read_b128 v[128:131], v140 offset:15200
    buffer_load_dwordx4 a[196:199], v8, s[12:15], s36 offen offset:1024 sc1
    v_exp_f32 v78, v78
    v_exp_f32 v79, v79
    v_cvt_pk_bf16_f32 v100, v72, v73
    v_cvt_pk_bf16_f32 v101, v74, v75
    v_cvt_pk_bf16_f32 v102, v76, v77
    v_cvt_pk_bf16_f32 v103, v78, v79
    s_waitcnt lgkmcnt(0)
    v_mfma_f32_32x32x16_bf16 v[64:79], v[116:119], v[16:19], 0
    v_exp_f32 v80, v80
    v_exp_f32 v81, v81
    v_exp_f32 v82, v82
    v_exp_f32 v83, v83
    v_exp_f32 v84, v84
    v_exp_f32 v85, v85
    v_mfma_f32_32x32x16_bf16 v[32:47], v[124:127], v[96:99], v[32:47]
    buffer_load_dwordx4 a[200:203], v8, s[12:15], s36 offen offset:2048 sc1
    v_exp_f32 v86, v86
    v_cvt_pk_bf16_f32 v104, v80, v81
    v_exp_f32 v87, v87
    v_cvt_pk_bf16_f32 v105, v82, v83
    v_exp_f32 v88, v88
    v_exp_f32 v89, v89
    v_mfma_f32_32x32x8_bf16 v[64:79], v[122:123], v[20:21], v[64:79]
    v_exp_f32 v90, v90
    v_cvt_pk_bf16_f32 v106, v84, v85
    v_exp_f32 v91, v91
    v_cvt_pk_bf16_f32 v107, v86, v87
    v_exp_f32 v92, v92
    v_exp_f32 v93, v93
    v_mfma_f32_32x32x16_bf16 v[32:47], v[128:131], v[100:103], v[32:47]
    buffer_load_dwordx4 a[204:207], v8, s[12:15], s36 offen offset:3072 sc1
    s_add_u32 s36, s36, 4096
    v_exp_f32 v94, v94
    v_exp_f32 v95, v95
    v_cvt_pk_bf16_f32 v108, v88, v89
    v_cvt_pk_bf16_f32 v109, v90, v91
    v_cvt_pk_bf16_f32 v110, v92, v93
    v_cvt_pk_bf16_f32 v111, v94, v95
    v_mfma_f32_32x32x16_bf16 v[80:95], v[116:119], v[24:27], 0
    ds_read_b128 v[112:115], v14 offset:14336
    v_exp_f32 v64, v64
    v_exp_f32 v65, v65
    v_exp_f32 v66, v66
    v_exp_f32 v67, v67
    v_exp_f32 v68, v68
    v_exp_f32 v69, v69
    v_mfma_f32_32x32x16_bf16 v[48:63], v[124:127], v[104:107], v[48:63]
    ds_read_b128 v[132:135], v140 offset:15808
    buffer_load_dwordx4 a[208:211], v8, s[12:15], s36 offen offset:0 sc1
    v_exp_f32 v70, v70
    v_cvt_pk_bf16_f32 v96, v64, v65
    v_exp_f32 v71, v71
    v_cvt_pk_bf16_f32 v97, v66, v67
    v_exp_f32 v72, v72
    v_exp_f32 v73, v73
    v_mfma_f32_32x32x8_bf16 v[80:95], v[122:123], v[28:29], v[80:95]
    ds_read_b32 v120, v15 offset:1792
    v_exp_f32 v74, v74
    v_cvt_pk_bf16_f32 v98, v68, v69
    v_exp_f32 v75, v75
    v_cvt_pk_bf16_f32 v99, v70, v71
    v_exp_f32 v76, v76
    v_exp_f32 v77, v77
    v_mfma_f32_32x32x16_bf16 v[48:63], v[128:131], v[108:111], v[48:63]
    ds_read_b128 v[136:139], v140 offset:16416
    buffer_load_dwordx4 a[212:215], v8, s[12:15], s36 offen offset:1024 sc1
    v_exp_f32 v78, v78
    v_exp_f32 v79, v79
    v_cvt_pk_bf16_f32 v100, v72, v73
    v_cvt_pk_bf16_f32 v101, v74, v75
    v_cvt_pk_bf16_f32 v102, v76, v77
    v_cvt_pk_bf16_f32 v103, v78, v79
    s_waitcnt lgkmcnt(0)
    v_mfma_f32_32x32x16_bf16 v[64:79], v[112:115], v[16:19], 0
    v_exp_f32 v80, v80
    v_exp_f32 v81, v81
    v_exp_f32 v82, v82
    v_exp_f32 v83, v83
    v_exp_f32 v84, v84
    v_exp_f32 v85, v85
    v_mfma_f32_32x32x16_bf16 v[32:47], v[132:135], v[96:99], v[32:47]
    v_exp_f32 v86, v86
    v_cvt_pk_bf16_f32 v104, v80, v81
    v_exp_f32 v87, v87
    v_cvt_pk_bf16_f32 v105, v82, v83
    v_exp_f32 v88, v88
    v_exp_f32 v89, v89
    v_mfma_f32_32x32x8_bf16 v[64:79], v[120:121], v[20:21], v[64:79]
    v_exp_f32 v90, v90
    v_cvt_pk_bf16_f32 v106, v84, v85
    v_exp_f32 v91, v91
    v_cvt_pk_bf16_f32 v107, v86, v87
    v_exp_f32 v92, v92
    v_exp_f32 v93, v93
    v_mfma_f32_32x32x16_bf16 v[32:47], v[136:139], v[100:103], v[32:47]
    v_exp_f32 v94, v94
    v_exp_f32 v95, v95
    v_cvt_pk_bf16_f32 v108, v88, v89
    v_cvt_pk_bf16_f32 v109, v90, v91
    v_cvt_pk_bf16_f32 v110, v92, v93
    v_cvt_pk_bf16_f32 v111, v94, v95
    v_mfma_f32_32x32x16_bf16 v[80:95], v[112:115], v[24:27], 0
    ds_read_b128 v[116:119], v14 offset:15360
    v_exp_f32 v64, v64
    v_exp_f32 v65, v65
    v_exp_f32 v66, v66
    v_exp_f32 v67, v67
    v_exp_f32 v68, v68
    v_exp_f32 v69, v69
    v_mfma_f32_32x32x16_bf16 v[48:63], v[132:135], v[104:107], v[48:63]
    ds_read_b128 v[124:127], v140 offset:17024
    v_exp_f32 v70, v70
    v_cvt_pk_bf16_f32 v96, v64, v65
    v_exp_f32 v71, v71
    v_cvt_pk_bf16_f32 v97, v66, v67
    v_exp_f32 v72, v72
    v_exp_f32 v73, v73
    v_mfma_f32_32x32x8_bf16 v[80:95], v[120:121], v[28:29], v[80:95]
    ds_read_b32 v122, v15 offset:1920
    v_exp_f32 v74, v74
    v_cvt_pk_bf16_f32 v98, v68, v69
    v_exp_f32 v75, v75
    v_cvt_pk_bf16_f32 v99, v70, v71
    v_exp_f32 v76, v76
    v_exp_f32 v77, v77
    v_mfma_f32_32x32x16_bf16 v[48:63], v[136:139], v[108:111], v[48:63]
    ds_read_b128 v[128:131], v140 offset:17632
    v_exp_f32 v78, v78
    v_exp_f32 v79, v79
    v_cvt_pk_bf16_f32 v100, v72, v73
    v_cvt_pk_bf16_f32 v101, v74, v75
    v_cvt_pk_bf16_f32 v102, v76, v77
    v_cvt_pk_bf16_f32 v103, v78, v79
    s_waitcnt lgkmcnt(0)
    v_mfma_f32_32x32x16_bf16 v[64:79], v[116:119], v[16:19], 0
    v_exp_f32 v80, v80
    v_exp_f32 v81, v81
    v_exp_f32 v82, v82
    v_exp_f32 v83, v83
    v_exp_f32 v84, v84
    v_exp_f32 v85, v85
    v_mfma_f32_32x32x16_bf16 v[32:47], v[124:127], v[96:99], v[32:47]
    v_exp_f32 v86, v86
    v_cvt_pk_bf16_f32 v104, v80, v81
    v_exp_f32 v87, v87
    v_cvt_pk_bf16_f32 v105, v82, v83
    v_exp_f32 v88, v88
    v_exp_f32 v89, v89
    v_mfma_f32_32x32x8_bf16 v[64:79], v[122:123], v[20:21], v[64:79]
    v_exp_f32 v90, v90
    v_cvt_pk_bf16_f32 v106, v84, v85
    v_exp_f32 v91, v91
    v_cvt_pk_bf16_f32 v107, v86, v87
    v_exp_f32 v92, v92
    v_exp_f32 v93, v93
    v_mfma_f32_32x32x16_bf16 v[32:47], v[128:131], v[100:103], v[32:47]
    v_exp_f32 v94, v94
    v_exp_f32 v95, v95
    v_cvt_pk_bf16_f32 v108, v88, v89
    v_cvt_pk_bf16_f32 v109, v90, v91
    v_cvt_pk_bf16_f32 v110, v92, v93
    v_cvt_pk_bf16_f32 v111, v94, v95
    v_mfma_f32_32x32x16_bf16 v[80:95], v[116:119], v[24:27], 0
    ds_read_b128 v[112:115], v14 offset:37888
    v_exp_f32 v64, v64
    v_exp_f32 v65, v65
    v_exp_f32 v66, v66
    v_exp_f32 v67, v67
    v_exp_f32 v68, v68
    v_exp_f32 v69, v69
    v_mfma_f32_32x32x16_bf16 v[48:63], v[124:127], v[104:107], v[48:63]
    ds_read_b128 v[132:135], v140 offset:18240
    v_exp_f32 v70, v70
    v_cvt_pk_bf16_f32 v96, v64, v65
    v_exp_f32 v71, v71
    v_cvt_pk_bf16_f32 v97, v66, v67
    v_exp_f32 v72, v72
    v_exp_f32 v73, v73
    v_mfma_f32_32x32x8_bf16 v[80:95], v[122:123], v[28:29], v[80:95]
    ds_read_b32 v120, v15 offset:37888
    v_exp_f32 v74, v74
    v_cvt_pk_bf16_f32 v98, v68, v69
    v_exp_f32 v75, v75
    v_cvt_pk_bf16_f32 v99, v70, v71
    v_exp_f32 v76, v76
    v_exp_f32 v77, v77
    v_mfma_f32_32x32x16_bf16 v[48:63], v[128:131], v[108:111], v[48:63]
    ds_read_b128 v[136:139], v140 offset:18848
    v_exp_f32 v78, v78
    v_exp_f32 v79, v79
    v_cvt_pk_bf16_f32 v100, v72, v73
    v_cvt_pk_bf16_f32 v101, v74, v75
    v_cvt_pk_bf16_f32 v102, v76, v77
    v_cvt_pk_bf16_f32 v103, v78, v79
    s_waitcnt lgkmcnt(0)
    v_mfma_f32_32x32x16_bf16 v[64:79], v[112:115], v[16:19], 0
    v_exp_f32 v80, v80
    v_exp_f32 v81, v81
    v_exp_f32 v82, v82
    v_exp_f32 v83, v83
    v_exp_f32 v84, v84
    v_exp_f32 v85, v85
    v_mfma_f32_32x32x16_bf16 v[32:47], v[132:135], v[96:99], v[32:47]
    v_exp_f32 v86, v86
    v_cvt_pk_bf16_f32 v104, v80, v81
    v_exp_f32 v87, v87
    v_cvt_pk_bf16_f32 v105, v82, v83
    v_exp_f32 v88, v88
    v_exp_f32 v89, v89
    v_mfma_f32_32x32x8_bf16 v[64:79], v[120:121], v[20:21], v[64:79]
    v_exp_f32 v90, v90
    v_cvt_pk_bf16_f32 v106, v84, v85
    v_exp_f32 v91, v91
    v_cvt_pk_bf16_f32 v107, v86, v87
    v_exp_f32 v92, v92
    v_exp_f32 v93, v93
    v_mfma_f32_32x32x16_bf16 v[32:47], v[136:139], v[100:103], v[32:47]
    v_exp_f32 v94, v94
    v_exp_f32 v95, v95
    v_cvt_pk_bf16_f32 v108, v88, v89
    v_cvt_pk_bf16_f32 v109, v90, v91
    v_cvt_pk_bf16_f32 v110, v92, v93
    v_cvt_pk_bf16_f32 v111, v94, v95
    s_nop 1
    v_mfma_f32_32x32x16_bf16 v[48:63], v[132:135], v[104:107], v[48:63]
    v_mfma_f32_32x32x16_bf16 v[48:63], v[136:139], v[108:111], v[48:63]
    s_add_u32 s16, s86, 2871296
    s_addc_u32 s17, s87, 0
    s_mov_b32 s18, 2359296
    s_mov_b32 s19, 0x20000
    s_mul_i32 s40, s60, 73728
    s_lshr_b32 s41, s32, 1
    s_lshl_b32 s41, s41, 10
    s_add_u32 s41, s41, s40
    s_and_b32 s42, s32, 1
    s_lshl_b32 s42, s42, 9
    s_add_u32 s41, s41, s42
    v_lshrrev_b32 v8, 4, v3
    v_mul_u32_u24 v8, 18432, v8
    v_and_b32 v9, 15, v3
    v_lshl_add_u32 v8, v9, 4, v8
    v_lshl_add_u32 v6, v4, 8, v8
    v_add_u32 v6, s41, v6
    s_lshr_b32 s41, s32, 4
    s_mul_i32 s41, s41, 18432
    s_add_u32 s41, s41, s40
    s_add_u32 s41, s41, 16384
    s_bfe_u32 s42, s32, 0x10003
    s_lshl_b32 s42, s42, 10
    s_add_u32 s41, s41, s42
    s_and_b32 s42, s32, 7
    s_lshl_b32 s42, s42, 7
    s_add_u32 s41, s41, s42
    v_lshl_add_u32 v7, v3, 2, s41
    v_mov_b32 v9, 0x7fffffff
    v_cmp_eq_u32 vcc, 0, v4
    s_nop 1
    v_cndmask_b32 v7, v9, v7, vcc
    s_mov_b32 s38, 36864
    v_mov_b32 v10, v42
    v_mov_b32 v11, v42
    s_nop 1
    v_permlane32_swap_b32 v10, v11
    v_rcp_f32 v10, v10
    s_nop 0
    v_mul_f32 v32, v10, v32
    v_mul_f32 v33, v10, v33
    v_mul_f32 v34, v10, v34
    v_mul_f32 v35, v10, v35
    v_mul_f32 v36, v10, v36
    v_mul_f32 v37, v10, v37
    v_mul_f32 v38, v10, v38
    v_mul_f32 v39, v10, v39
    v_mul_f32 v40, v10, v40
    v_mul_f32 v41, v10, v41
    v_cvt_pk_bf16_f32 v96, v32, v33
    v_cvt_pk_bf16_f32 v97, v34, v35
    v_cvt_pk_bf16_f32 v98, v36, v37
    v_cvt_pk_bf16_f32 v99, v38, v39
    v_cvt_pk_bf16_f32 v100, v40, v41
    v_permlane32_swap_b32 v96, v98
    v_permlane32_swap_b32 v97, v99
    buffer_store_dwordx4 v[96:99], v6, s[16:19], 0 offen sc1
    buffer_store_dword v100, v7, s[16:19], 0 offen sc1
    v_mov_b32 v10, v58
    v_mov_b32 v11, v58
    s_nop 1
    v_permlane32_swap_b32 v10, v11
    v_rcp_f32 v10, v10
    s_nop 0
    v_mul_f32 v48, v10, v48
    v_mul_f32 v49, v10, v49
    v_mul_f32 v50, v10, v50
    v_mul_f32 v51, v10, v51
    v_mul_f32 v52, v10, v52
    v_mul_f32 v53, v10, v53
    v_mul_f32 v54, v10, v54
    v_mul_f32 v55, v10, v55
    v_mul_f32 v56, v10, v56
    v_mul_f32 v57, v10, v57
    v_cvt_pk_bf16_f32 v104, v48, v49
    v_cvt_pk_bf16_f32 v105, v50, v51
    v_cvt_pk_bf16_f32 v106, v52, v53
    v_cvt_pk_bf16_f32 v107, v54, v55
    v_cvt_pk_bf16_f32 v108, v56, v57
    v_permlane32_swap_b32 v104, v106
    v_permlane32_swap_b32 v105, v107
    buffer_store_dwordx4 v[104:107], v6, s[16:19], s38 offen sc1
    buffer_store_dword v108, v7, s[16:19], s38 offen sc1
    s_lshl_b32 s6, s60, 3
    s_add_u32 s6, s6, s61
    s_lshl_b32 s6, s6, 6
    s_add_u32 s6, s6, 16384
    s_waitcnt vmcnt(0) lgkmcnt(0)
    s_barrier
    s_cmp_lg_u32 s62, 0
    s_cbranch_scc1 SIG_41
    s_mov_b32 s28, s86
    s_mov_b32 s29, s87
    s_mov_b32 s30, 327680
    s_mov_b32 s31, 0x20000
    v_mov_b32 v250, s6
    v_mov_b32 v251, s63
    s_mov_b64 exec, 1
    buffer_store_dword v251, v250, s[28:31], 0 offen sc1
    s_mov_b64 exec, -1
SIG_41:
    s_cmp_ge_u32 s61, 6
    s_cbranch_scc1 P3_SKIP
    s_mov_b32 s12, s64
    s_mov_b32 s13, s65
    s_mov_b32 s14, 2359296
    s_mov_b32 s15, 0x20000
    v_and_b32 v1, 63, v0
    v_and_b32 v3, 15, v1
    v_lshrrev_b32 v4, 4, v1
    s_and_b32 s35, s61, 1
    s_lshl_b32 s35, s35, 5
    s_lshl_b32 s36, s60, 6
    s_add_u32 s35, s35, s36
    s_lshr_b32 s36, s61, 1
    s_lshl_b32 s36, s36, 1
    s_lshr_b32 s37, s62, 1
    s_add_u32 s36, s36, s37
    v_add_u32 v5, s35, v3
    s_movk_i32 s37, 1152
    v_mul_u32_u24 v6, 48, v4
    s_mul_i32 s38, s36, 192
    v_add_u32 v6, s38, v6
    v_mad_u32_u24 v6, v5, s37, v6
    s_movk_i32 s38, 18432
    buffer_load_dwordx4 v[144:147], v6, s[12:15], 0 offen offset:0
    buffer_load_dwordx4 v[148:151], v6, s[12:15], 0 offen offset:16
    buffer_load_dwordx4 v[152:155], v6, s[12:15], 0 offen offset:32
    buffer_load_dwordx4 v[156:159], v6, s[12:15], s38 offen offset:0
    buffer_load_dwordx4 v[160:163], v6, s[12:15], s38 offen offset:16
    buffer_load_dwordx4 v[164:167], v6, s[12:15], s38 offen offset:32
    s_add_u32 s16, s86, 2854912
    s_addc_u32 s17, s87, 0
    s_mov_b32 s18, 16384
    s_mov_b32 s19, 0x20000
    v_lshlrev_b32 v7, 3, v5
    buffer_load_dwordx2 v[240:241], v7, s[16:19], 0 offen sc1
    buffer_load_dwordx2 v[242:243], v7, s[16:19], 0 offen offset:128 sc1
    s_add_u32 s20, s86, 9949184
    s_addc_u32 s21, s87, 0
    s_mov_b32 s22, 18432
    s_mov_b32 s23, 0x20000
    v_lshlrev_b32 v2, 4, v1
    s_movk_i32 s38, 0
    buffer_load_dwordx4 v[168:171], v2, s[20:23], s38 offen offset:0 sc1
    buffer_load_dwordx4 v[172:175], v2, s[20:23], s38 offen offset:1024 sc1
    buffer_load_dwordx4 v[176:179], v2, s[20:23], s38 offen offset:2048 sc1
    buffer_load_dwordx4 v[180:183], v2, s[20:23], s38 offen offset:3072 sc1
    s_movk_i32 s38, 4096
    buffer_load_dwordx4 v[184:187], v2, s[20:23], s38 offen offset:0 sc1
    buffer_load_dwordx4 v[188:191], v2, s[20:23], s38 offen offset:1024 sc1
    buffer_load_dwordx4 v[192:195], v2, s[20:23], s38 offen offset:2048 sc1
    buffer_load_dwordx4 v[196:199], v2, s[20:23], s38 offen offset:3072 sc1
    s_movk_i32 s38, 8192
    buffer_load_dwordx4 v[200:203], v2, s[20:23], s38 offen offset:0 sc1
    buffer_load_dwordx4 v[204:207], v2, s[20:23], s38 offen offset:1024 sc1
    buffer_load_dwordx4 v[208:211], v2, s[20:23], s38 offen offset:2048 sc1
    buffer_load_dwordx4 v[212:215], v2, s[20:23], s38 offen offset:3072 sc1
    s_movk_i32 s38, 12288
    buffer_load_dwordx4 v[216:219], v2, s[20:23], s38 offen offset:0 sc1
    buffer_load_dwordx4 v[220:223], v2, s[20:23], s38 offen offset:1024 sc1
    buffer_load_dwordx4 v[224:227], v2, s[20:23], s38 offen offset:2048 sc1
    buffer_load_dwordx4 v[228:231], v2, s[20:23], s38 offen offset:3072 sc1
    s_movk_i32 s38, 16384
    buffer_load_dwordx4 v[232:235], v2, s[20:23], s38 offen offset:0 sc1
    buffer_load_dwordx4 v[236:239], v2, s[20:23], s38 offen offset:1024 sc1
    v_and_b32 v12, 7, v0
    s_lshl_b32 s3, s60, 3
    v_add_u32 v12, s3, v12
    v_lshlrev_b32 v12, 6, v12
    v_add_u32 v12, 16384, v12
    s_cmp_lg_u32 s62, 0
    s_cbranch_scc1 POLE_43
    s_mov_b32 s28, s86
    s_mov_b32 s29, s87
    s_mov_b32 s30, 327680
    s_mov_b32 s31, 0x20000
    s_mov_b32 s3, 0
POL_42:
    buffer_load_dword v244, v12, s[28:31], 0 offen sc1
    s_waitcnt vmcnt(0)
    v_xor_b32 v244, s63, v244
    v_cmp_ne_u32 vcc, 0, v244
    s_add_u32 s3, s3, 1
    s_cmp_gt_u32 s3, 0x200000
    s_cbranch_scc1 POLE_43
    s_nop 1
    s_cbranch_vccnz POL_42
POLE_43:
    s_barrier
    s_add_u32 s8, s86, 2871296
    s_addc_u32 s9, s87, 0
    s_mov_b32 s10, 2359296
    s_mov_b32 s11, 0x20000
    s_mul_i32 s35, s60, 73728
    s_and_b32 s36, s61, 1
    s_mul_i32 s36, s36, 36864
    s_add_u32 s35, s35, s36
    s_and_b32 s37, s62, 1
    s_mul_i32 s37, s37, 18432
    s_lshr_b32 s38, s62, 1
    s_lshl_b32 s38, s38, 10
    s_add_u32 s37, s37, s38
    s_add_u32 s38, s35, s37
    s_mov_b32 m0, s37
    s_nop 0
    buffer_load_dwordx4 v2, s[8:11], s38 offen offset:0 sc1 lds
    buffer_load_dwordx4 v2, s[8:11], s38 offen offset:2048 sc1 lds
    s_add_u32 s37, s37, 4096
    s_add_u32 s38, s38, 4096
    s_mov_b32 m0, s37
    s_nop 0
    buffer_load_dwordx4 v2, s[8:11], s38 offen offset:0 sc1 lds
    buffer_load_dwordx4 v2, s[8:11], s38 offen offset:2048 sc1 lds
    s_add_u32 s37, s37, 4096
    s_add_u32 s38, s38, 4096
    s_mov_b32 m0, s37
    s_nop 0
    buffer_load_dwordx4 v2, s[8:11], s38 offen offset:0 sc1 lds
    buffer_load_dwordx4 v2, s[8:11], s38 offen offset:2048 sc1 lds
    s_add_u32 s37, s37, 4096
    s_add_u32 s38, s38, 4096
    s_mov_b32 m0, s37
    s_nop 0
    buffer_load_dwordx4 v2, s[8:11], s38 offen offset:0 sc1 lds
    buffer_load_dwordx4 v2, s[8:11], s38 offen offset:2048 sc1 lds
    s_add_u32 s37, s37, 4096
    s_add_u32 s38, s38, 4096
    s_mov_b32 m0, s37
    s_nop 0
    buffer_load_dwordx4 v2, s[8:11], s38 offen offset:0 sc1 lds
    s_mov_b32 s28, s86
    s_mov_b32 s29, s87
    s_mov_b32 s30, 327680
    s_mov_b32 s31, 0x20000
    v_add_u32 v96, 0, v1
    v_lshlrev_b32 v96, 6, v96
    v_add_u32 v96, 16384, v96
    buffer_load_dword v100, v96, s[28:31], 0 offen sc1
    v_add_u32 v97, 64, v1
    v_lshlrev_b32 v97, 6, v97
    v_add_u32 v97, 16384, v97
    buffer_load_dword v101, v97, s[28:31], 0 offen sc1
    v_add_u32 v98, 128, v1
    v_lshlrev_b32 v98, 6, v98
    v_add_u32 v98, 16384, v98
    buffer_load_dword v102, v98, s[28:31], 0 offen sc1
    v_add_u32 v99, 192, v1
    v_lshlrev_b32 v99, 6, v99
    v_add_u32 v99, 16384, v99
    buffer_load_dword v103, v99, s[28:31], 0 offen sc1
    s_add_u32 s24, s86, 7589888
    s_addc_u32 s25, s87, 0
    s_mov_b32 s26, 2359296
    s_mov_b32 s27, 0x20000
    s_add_u32 s16, s86, 9981952
    s_addc_u32 s17, s87, 0
    s_mov_b32 s18, 131072
    s_mov_b32 s19, 0x20000
    s_lshr_b32 s36, s61, 1
    s_lshl_b32 s36, s36, 1
    s_lshr_b32 s37, s62, 1
    s_add_u32 s36, s36, s37
    s_mul_i32 s36, s36, 6
    s_and_b32 s37, s62, 1
    s_mul_i32 s37, s37, 3
    s_add_u32 s36, s36, s37
    s_add_u32 s37, s36, 0
    s_lshr_b32 s38, s37, 1
    s_lshl_b32 s38, s38, 12
    s_and_b32 s37, s37, 1
    s_lshl_b32 s37, s37, 9
    s_add_u32 s56, s37, s38
    s_add_u32 s37, s36, 1
    s_lshr_b32 s38, s37, 1
    s_lshl_b32 s38, s38, 12
    s_and_b32 s37, s37, 1
    s_lshl_b32 s37, s37, 9
    s_add_u32 s57, s37, s38
    s_add_u32 s37, s36, 2
    s_lshr_b32 s38, s37, 1
    s_lshl_b32 s38, s38, 12
    s_and_b32 s37, s37, 1
    s_lshl_b32 s37, s37, 9
    s_add_u32 s58, s37, s38
    s_mul_i32 s36, s60, 73728
    s_and_b32 s37, s61, 1
    s_lshl_b32 s37, s37, 11
    s_add_u32 s36, s36, s37
    v_lshrrev_b32 v9, 1, v4
    v_lshlrev_b32 v9, 8, v9
    v_lshl_add_u32 v9, v3, 4, v9
    v_and_b32 v6, 1, v4
    v_lshl_add_u32 v9, v6, 10, v9
    v_add_u32 v9, s36, v9
    v_lshl_add_u32 v10, v4, 4, v3
    s_and_b32 s37, s61, 1
    s_lshl_b32 s37, s37, 5
    v_add_u32 v10, s37, v10
    v_lshlrev_b32 v10, 2, v10
    s_lshl_b32 s37, s60, 12
    v_add_u32 v10, s37, v10
    s_lshr_b32 s37, s61, 1
    s_lshl_b32 s37, s37, 2
    s_add_u32 s37, s37, s62
    s_movk_i32 s38, 3072
    s_cmp_eq_u32 s37, 0
    s_cselect_b32 s38, s38, 0x7f000000
    v_add_u32 v8, s38, v10
    s_lshl_b32 s37, s37, 8
    v_add_u32 v10, s37, v10
    v_mov_b32 v11, 0x7fffffff
    v_cmp_gt_u32 vcc, 2, v4
    s_nop 1
    v_cndmask_b32 v10, v11, v10, vcc
    v_cndmask_b32 v8, v11, v8, vcc
    v_lshrrev_b32 v13, 1, v4
    v_lshlrev_b32 v13, 10, v13
    v_and_b32 v14, 1, v4
    v_lshl_add_u32 v13, v14, 9, v13
    v_lshl_add_u32 v13, v3, 2, v13
    s_add_u32 s8, s86, 10776576
    s_addc_u32 s9, s87, 0
    s_mov_b32 s10, 15925248
    s_mov_b32 s11, 0x20000
    s_lshr_b32 s38, s2, 3
    s_and_b32 s37, s2, 7
    s_and_b32 s38, s38, 1
    s_lshl_b32 s39, s37, 1
    s_add_u32 s39, s39, s38
    s_lshl_b32 s39, s39, 2
    s_add_u32 s39, s39, s62
    s_mul_i32 s40, s39, 165888
    s_lshl_b32 s37, s37, 2
    s_add_u32 s37, s37, s62
    s_mul_i32 s37, s37, 165888
    s_add_u32 s37, s37, 10616832
    s_mul_i32 s39, s38, 82944
    s_add_u32 s54, s37, s39
    s_add_u32 s55, s37, 82944
    s_sub_u32 s55, s55, s39
    v_and_b32 v1, 63, v0
    v_lshlrev_b32 v2, 4, v1
    s_waitcnt vmcnt(10)
    s_barrier
    ds_read_b128 v[64:67], v2 offset:0
    ds_read_b128 v[68:71], v2 offset:18432
    ds_read_b128 v[72:75], v2 offset:1024
    ds_read_b128 v[76:79], v2 offset:19456
    s_waitcnt lgkmcnt(2)
    v_mfma_f32_16x16x32_bf16 v[32:35], a[0:3], v[64:67], 0
    ds_read_b128 v[80:83], v2 offset:2048
    v_mfma_f32_16x16x32_bf16 v[36:39], a[0:3], v[68:71], 0
    ds_read_b128 v[84:87], v2 offset:20480
    v_mfma_f32_16x16x32_bf16 v[40:43], a[4:7], v[64:67], 0
    v_mfma_f32_16x16x32_bf16 v[44:47], a[4:7], v[68:71], 0
    v_mfma_f32_16x16x32_bf16 v[48:51], a[8:11], v[64:67], 0
    v_mfma_f32_16x16x32_bf16 v[52:55], a[8:11], v[68:71], 0
    v_mfma_f32_16x16x32_bf16 v[56:59], v[168:171], v[64:67], 0
    v_mfma_f32_16x16x32_bf16 v[60:63], v[168:171], v[68:71], 0
    s_waitcnt lgkmcnt(2)
    v_mfma_f32_16x16x32_bf16 v[32:35], a[12:15], v[72:75], v[32:35]
    ds_read_b128 v[64:67], v2 offset:3072
    v_mfma_f32_16x16x32_bf16 v[36:39], a[12:15], v[76:79], v[36:39]
    ds_read_b128 v[68:71], v2 offset:21504
    v_mfma_f32_16x16x32_bf16 v[40:43], a[16:19], v[72:75], v[40:43]
    v_mfma_f32_16x16x32_bf16 v[44:47], a[16:19], v[76:79], v[44:47]
    v_mfma_f32_16x16x32_bf16 v[48:51], a[20:23], v[72:75], v[48:51]
    v_mfma_f32_16x16x32_bf16 v[52:55], a[20:23], v[76:79], v[52:55]
    v_mfma_f32_16x16x32_bf16 v[56:59], v[172:175], v[72:75], v[56:59]
    v_mfma_f32_16x16x32_bf16 v[60:63], v[172:175], v[76:79], v[60:63]
    s_waitcnt lgkmcnt(2)
    v_mfma_f32_16x16x32_bf16 v[32:35], a[24:27], v[80:83], v[32:35]
    ds_read_b128 v[72:75], v2 offset:4096
    v_mfma_f32_16x16x32_bf16 v[36:39], a[24:27], v[84:87], v[36:39]
    ds_read_b128 v[76:79], v2 offset:22528
    v_mfma_f32_16x16x32_bf16 v[40:43], a[28:31], v[80:83], v[40:43]
    v_mfma_f32_16x16x32_bf16 v[44:47], a[28:31], v[84:87], v[44:47]
    v_mfma_f32_16x16x32_bf16 v[48:51], a[32:35], v[80:83], v[48:51]
    v_mfma_f32_16x16x32_bf16 v[52:55], a[32:35], v[84:87], v[52:55]
    v_mfma_f32_16x16x32_bf16 v[56:59], v[176:179], v[80:83], v[56:59]
    v_mfma_f32_16x16x32_bf16 v[60:63], v[176:179], v[84:87], v[60:63]
    s_waitcnt lgkmcnt(2)
    v_mfma_f32_16x16x32_bf16 v[32:35], a[36:39], v[64:67], v[32:35]
    ds_read_b128 v[80:83], v2 offset:5120
    v_mfma_f32_16x16x32_bf16 v[36:39], a[36:39], v[68:71], v[36:39]
    ds_read_b128 v[84:87], v2 offset:23552
    v_mfma_f32_16x16x32_bf16 v[40:43], a[40:43], v[64:67], v[40:43]
    v_mfma_f32_16x16x32_bf16 v[44:47], a[40:43], v[68:71], v[44:47]
    v_mfma_f32_16x16x32_bf16 v[48:51], a[44:47], v[64:67], v[48:51]
    v_mfma_f32_16x16x32_bf16 v[52:55], a[44:47], v[68:71], v[52:55]
    v_mfma_f32_16x16x32_bf16 v[56:59], v[180:183], v[64:67], v[56:59]
    v_mfma_f32_16x16x32_bf16 v[60:63], v[180:183], v[68:71], v[60:63]
    s_waitcnt vmcnt(7)
    s_barrier
    s_waitcnt lgkmcnt(2)
    v_mfma_f32_16x16x32_bf16 v[32:35], a[48:51], v[72:75], v[32:35]
    ds_read_b128 v[64:67], v2 offset:6144
    v_mfma_f32_16x16x32_bf16 v[36:39], a[48:51], v[76:79], v[36:39]
    ds_read_b128 v[68:71], v2 offset:24576
    v_mfma_f32_16x16x32_bf16 v[40:43], a[52:55], v[72:75], v[40:43]
    v_mfma_f32_16x16x32_bf16 v[44:47], a[52:55], v[76:79], v[44:47]
    v_mfma_f32_16x16x32_bf16 v[48:51], a[56:59], v[72:75], v[48:51]
    v_mfma_f32_16x16x32_bf16 v[52:55], a[56:59], v[76:79], v[52:55]
    v_mfma_f32_16x16x32_bf16 v[56:59], v[184:187], v[72:75], v[56:59]
    v_mfma_f32_16x16x32_bf16 v[60:63], v[184:187], v[76:79], v[60:63]
    s_waitcnt lgkmcnt(2)
    v_mfma_f32_16x16x32_bf16 v[32:35], a[60:63], v[80:83], v[32:35]
    ds_read_b128 v[72:75], v2 offset:7168
    v_mfma_f32_16x16x32_bf16 v[36:39], a[60:63], v[84:87], v[36:39]
    ds_read_b128 v[76:79], v2 offset:25600
    v_mfma_f32_16x16x32_bf16 v[40:43], a[64:67], v[80:83], v[40:43]
    v_mfma_f32_16x16x32_bf16 v[44:47], a[64:67], v[84:87], v[44:47]
    v_mfma_f32_16x16x32_bf16 v[48:51], a[68:71], v[80:83], v[48:51]
    v_mfma_f32_16x16x32_bf16 v[52:55], a[68:71], v[84:87], v[52:55]
    v_mfma_f32_16x16x32_bf16 v[56:59], v[188:191], v[80:83], v[56:59]
    v_mfma_f32_16x16x32_bf16 v[60:63], v[188:191], v[84:87], v[60:63]
    s_waitcnt lgkmcnt(2)
    v_mfma_f32_16x16x32_bf16 v[32:35], a[72:75], v[64:67], v[32:35]
    ds_read_b128 v[80:83], v2 offset:8192
    v_mfma_f32_16x16x32_bf16 v[36:39], a[72:75], v[68:71], v[36:39]
    ds_read_b128 v[84:87], v2 offset:26624
    v_mfma_f32_16x16x32_bf16 v[40:43], a[76:79], v[64:67], v[40:43]
    v_mfma_f32_16x16x32_bf16 v[44:47], a[76:79], v[68:71], v[44:47]
    v_mfma_f32_16x16x32_bf16 v[48:51], a[80:83], v[64:67], v[48:51]
    v_mfma_f32_16x16x32_bf16 v[52:55], a[80:83], v[68:71], v[52:55]
    v_mfma_f32_16x16x32_bf16 v[56:59], v[192:195], v[64:67], v[56:59]
    v_mfma_f32_16x16x32_bf16 v[60:63], v[192:195], v[68:71], v[60:63]
    s_waitcnt lgkmcnt(2)
    v_mfma_f32_16x16x32_bf16 v[32:35], a[84:87], v[72:75], v[32:35]
    ds_read_b128 v[64:67], v2 offset:9216
    v_mfma_f32_16x16x32_bf16 v[36:39], a[84:87], v[76:79], v[36:39]
    ds_read_b128 v[68:71], v2 offset:27648
    v_mfma_f32_16x16x32_bf16 v[40:43], a[88:91], v[72:75], v[40:43]
    v_mfma_f32_16x16x32_bf16 v[44:47], a[88:91], v[76:79], v[44:47]
    v_mfma_f32_16x16x32_bf16 v[48:51], a[92:95], v[72:75], v[48:51]
    v_mfma_f32_16x16x32_bf16 v[52:55], a[92:95], v[76:79], v[52:55]
    v_mfma_f32_16x16x32_bf16 v[56:59], v[196:199], v[72:75], v[56:59]
    v_mfma_f32_16x16x32_bf16 v[60:63], v[196:199], v[76:79], v[60:63]
    s_waitcnt lgkmcnt(2)
    v_mfma_f32_16x16x32_bf16 v[32:35], a[96:99], v[80:83], v[32:35]
    ds_read_b128 v[72:75], v2 offset:10240
    v_mfma_f32_16x16x32_bf16 v[36:39], a[96:99], v[84:87], v[36:39]
    ds_read_b128 v[76:79], v2 offset:28672
    v_mfma_f32_16x16x32_bf16 v[40:43], a[100:103], v[80:83], v[40:43]
    v_mfma_f32_16x16x32_bf16 v[44:47], a[100:103], v[84:87], v[44:47]
    v_mfma_f32_16x16x32_bf16 v[48:51], a[104:107], v[80:83], v[48:51]
    v_mfma_f32_16x16x32_bf16 v[52:55], a[104:107], v[84:87], v[52:55]
    v_mfma_f32_16x16x32_bf16 v[56:59], v[200:203], v[80:83], v[56:59]
    v_mfma_f32_16x16x32_bf16 v[60:63], v[200:203], v[84:87], v[60:63]
    s_waitcnt lgkmcnt(2)
    v_mfma_f32_16x16x32_bf16 v[32:35], a[108:111], v[64:67], v[32:35]
    ds_read_b128 v[80:83], v2 offset:11264
    v_mfma_f32_16x16x32_bf16 v[36:39], a[108:111], v[68:71], v[36:39]
    ds_read_b128 v[84:87], v2 offset:29696
    v_mfma_f32_16x16x32_bf16 v[40:43], a[112:115], v[64:67], v[40:43]
    v_mfma_f32_16x16x32_bf16 v[44:47], a[112:115], v[68:71], v[44:47]
    v_mfma_f32_16x16x32_bf16 v[48:51], a[116:119], v[64:67], v[48:51]
    v_mfma_f32_16x16x32_bf16 v[52:55], a[116:119], v[68:71], v[52:55]
    v_mfma_f32_16x16x32_bf16 v[56:59], v[204:207], v[64:67], v[56:59]
    v_mfma_f32_16x16x32_bf16 v[60:63], v[204:207], v[68:71], v[60:63]
    s_waitcnt vmcnt(4)
    s_barrier
    s_waitcnt lgkmcnt(2)
    v_mfma_f32_16x16x32_bf16 v[32:35], a[120:123], v[72:75], v[32:35]
    ds_read_b128 v[64:67], v2 offset:12288
    v_mfma_f32_16x16x32_bf16 v[36:39], a[120:123], v[76:79], v[36:39]
    ds_read_b128 v[68:71], v2 offset:30720
    v_mfma_f32_16x16x32_bf16 v[40:43], a[124:127], v[72:75], v[40:43]
    v_mfma_f32_16x16x32_bf16 v[44:47], a[124:127], v[76:79], v[44:47]
    v_mfma_f32_16x16x32_bf16 v[48:51], a[128:131], v[72:75], v[48:51]
    v_mfma_f32_16x16x32_bf16 v[52:55], a[128:131], v[76:79], v[52:55]
    v_mfma_f32_16x16x32_bf16 v[56:59], v[208:211], v[72:75], v[56:59]
    v_mfma_f32_16x16x32_bf16 v[60:63], v[208:211], v[76:79], v[60:63]
    s_waitcnt lgkmcnt(2)
    v_mfma_f32_16x16x32_bf16 v[32:35], a[132:135], v[80:83], v[32:35]
    ds_read_b128 v[72:75], v2 offset:13312
    v_mfma_f32_16x16x32_bf16 v[36:39], a[132:135], v[84:87], v[36:39]
    ds_read_b128 v[76:79], v2 offset:31744
    v_mfma_f32_16x16x32_bf16 v[40:43], a[136:139], v[80:83], v[40:43]
    v_mfma_f32_16x16x32_bf16 v[44:47], a[136:139], v[84:87], v[44:47]
    v_mfma_f32_16x16x32_bf16 v[48:51], a[140:143], v[80:83], v[48:51]
    v_mfma_f32_16x16x32_bf16 v[52:55], a[140:143], v[84:87], v[52:55]
    v_mfma_f32_16x16x32_bf16 v[56:59], v[212:215], v[80:83], v[56:59]
    v_mfma_f32_16x16x32_bf16 v[60:63], v[212:215], v[84:87], v[60:63]
    s_waitcnt lgkmcnt(2)
    v_mfma_f32_16x16x32_bf16 v[32:35], a[144:147], v[64:67], v[32:35]
    ds_read_b128 v[80:83], v2 offset:14336
    v_mfma_f32_16x16x32_bf16 v[36:39], a[144:147], v[68:71], v[36:39]
    ds_read_b128 v[84:87], v2 offset:32768
    v_mfma_f32_16x16x32_bf16 v[40:43], a[148:151], v[64:67], v[40:43]
    v_mfma_f32_16x16x32_bf16 v[44:47], a[148:151], v[68:71], v[44:47]
    v_mfma_f32_16x16x32_bf16 v[48:51], a[152:155], v[64:67], v[48:51]
    v_mfma_f32_16x16x32_bf16 v[52:55], a[152:155], v[68:71], v[52:55]
    v_mfma_f32_16x16x32_bf16 v[56:59], v[216:219], v[64:67], v[56:59]
    v_mfma_f32_16x16x32_bf16 v[60:63], v[216:219], v[68:71], v[60:63]
    s_waitcnt lgkmcnt(2)
    v_mfma_f32_16x16x32_bf16 v[32:35], a[156:159], v[72:75], v[32:35]
    ds_read_b128 v[64:67], v2 offset:15360
    v_mfma_f32_16x16x32_bf16 v[36:39], a[156:159], v[76:79], v[36:39]
    ds_read_b128 v[68:71], v2 offset:33792
    v_mfma_f32_16x16x32_bf16 v[40:43], a[160:163], v[72:75], v[40:43]
    v_mfma_f32_16x16x32_bf16 v[44:47], a[160:163], v[76:79], v[44:47]
    v_mfma_f32_16x16x32_bf16 v[48:51], a[164:167], v[72:75], v[48:51]
    v_mfma_f32_16x16x32_bf16 v[52:55], a[164:167], v[76:79], v[52:55]
    v_mfma_f32_16x16x32_bf16 v[56:59], v[220:223], v[72:75], v[56:59]
    v_mfma_f32_16x16x32_bf16 v[60:63], v[220:223], v[76:79], v[60:63]
    s_waitcnt lgkmcnt(2)
    v_mfma_f32_16x16x32_bf16 v[32:35], a[168:171], v[80:83], v[32:35]
    ds_read_b32 v72, v13 offset:16384
    ds_read_b32 v73, v13 offset:16512
    v_mfma_f32_16x16x32_bf16 v[36:39], a[168:171], v[84:87], v[36:39]
    ds_read_b32 v74, v13 offset:16640
    ds_read_b32 v75, v13 offset:16768
    v_mfma_f32_16x16x32_bf16 v[40:43], a[172:175], v[80:83], v[40:43]
    ds_read_b32 v76, v13 offset:16448
    ds_read_b32 v77, v13 offset:16576
    v_mfma_f32_16x16x32_bf16 v[44:47], a[172:175], v[84:87], v[44:47]
    ds_read_b32 v78, v13 offset:16704
    ds_read_b32 v79, v13 offset:16832
    v_mfma_f32_16x16x32_bf16 v[48:51], a[176:179], v[80:83], v[48:51]
    v_mfma_f32_16x16x32_bf16 v[52:55], a[176:179], v[84:87], v[52:55]
    v_mfma_f32_16x16x32_bf16 v[56:59], v[224:227], v[80:83], v[56:59]
    v_mfma_f32_16x16x32_bf16 v[60:63], v[224:227], v[84:87], v[60:63]
    s_waitcnt lgkmcnt(8)
    v_mfma_f32_16x16x32_bf16 v[32:35], a[180:183], v[64:67], v[32:35]
    ds_read_b32 v80, v13 offset:34816
    ds_read_b32 v81, v13 offset:34944
    v_mfma_f32_16x16x32_bf16 v[36:39], a[180:183], v[68:71], v[36:39]
    ds_read_b32 v82, v13 offset:35072
    ds_read_b32 v83, v13 offset:35200
    v_mfma_f32_16x16x32_bf16 v[40:43], a[184:187], v[64:67], v[40:43]
    ds_read_b32 v84, v13 offset:34880
    ds_read_b32 v85, v13 offset:35008
    v_mfma_f32_16x16x32_bf16 v[44:47], a[184:187], v[68:71], v[44:47]
    s_waitcnt lgkmcnt(12)
    ds_read_b32 v86, v13 offset:35136
    ds_read_b32 v87, v13 offset:35264
    v_mfma_f32_16x16x32_bf16 v[48:51], a[188:191], v[64:67], v[48:51]
    v_mfma_f32_16x16x32_bf16 v[52:55], a[188:191], v[68:71], v[52:55]
    v_mfma_f32_16x16x32_bf16 v[56:59], v[228:231], v[64:67], v[56:59]
    v_mfma_f32_16x16x32_bf16 v[60:63], v[228:231], v[68:71], v[60:63]
    s_waitcnt lgkmcnt(8)
    v_mfma_f32_16x16x32_bf16 v[32:35], a[192:195], v[72:75], v[32:35]
    v_mfma_f32_16x16x32_bf16 v[36:39], a[192:195], v[76:79], v[36:39]
    v_mfma_f32_16x16x32_bf16 v[40:43], a[196:199], v[72:75], v[40:43]
    v_mfma_f32_16x16x32_bf16 v[44:47], a[196:199], v[76:79], v[44:47]
    v_mfma_f32_16x16x32_bf16 v[48:51], a[200:203], v[72:75], v[48:51]
    v_mfma_f32_16x16x32_bf16 v[52:55], a[200:203], v[76:79], v[52:55]
    v_mfma_f32_16x16x32_bf16 v[56:59], v[232:235], v[72:75], v[56:59]
    v_mfma_f32_16x16x32_bf16 v[60:63], v[232:235], v[76:79], v[60:63]
    s_waitcnt lgkmcnt(0)
    v_mfma_f32_16x16x32_bf16 v[32:35], a[204:207], v[80:83], v[32:35]
    v_mfma_f32_16x16x32_bf16 v[36:39], a[204:207], v[84:87], v[36:39]
    v_mfma_f32_16x16x32_bf16 v[40:43], a[208:211], v[80:83], v[40:43]
    v_mfma_f32_16x16x32_bf16 v[44:47], a[208:211], v[84:87], v[44:47]
    v_mfma_f32_16x16x32_bf16 v[48:51], a[212:215], v[80:83], v[48:51]
    v_mfma_f32_16x16x32_bf16 v[52:55], a[212:215], v[84:87], v[52:55]
    v_mfma_f32_16x16x32_bf16 v[56:59], v[236:239], v[80:83], v[56:59]
    v_mfma_f32_16x16x32_bf16 v[60:63], v[236:239], v[84:87], v[60:63]
    s_waitcnt vmcnt(0)
    s_and_b32 s36, s62, 1
    s_cmp_lg_u32 s36, 0
    s_cbranch_scc1 P3O_44
    v_lshlrev_b32 v88, 16, v144
    v_add_f32 v32, v32, v88
    v_lshlrev_b32 v89, 16, v147
    v_add_f32 v33, v33, v89
    v_lshlrev_b32 v88, 16, v150
    v_add_f32 v34, v34, v88
    v_lshlrev_b32 v89, 16, v153
    v_add_f32 v35, v35, v89
    v_and_b32 v88, 0xffff0000, v144
    v_add_f32 v40, v40, v88
    v_and_b32 v89, 0xffff0000, v147
    v_add_f32 v41, v41, v89
    v_and_b32 v88, 0xffff0000, v150
    v_add_f32 v42, v42, v88
    v_and_b32 v89, 0xffff0000, v153
    v_add_f32 v43, v43, v89
    v_lshlrev_b32 v88, 16, v145
    v_add_f32 v48, v48, v88
    v_lshlrev_b32 v89, 16, v148
    v_add_f32 v49, v49, v89
    v_lshlrev_b32 v88, 16, v151
    v_add_f32 v50, v50, v88
    v_lshlrev_b32 v89, 16, v154
    v_add_f32 v51, v51, v89
    v_lshlrev_b32 v88, 16, v156
    v_add_f32 v36, v36, v88
    v_lshlrev_b32 v89, 16, v159
    v_add_f32 v37, v37, v89
    v_lshlrev_b32 v88, 16, v162
    v_add_f32 v38, v38, v88
    v_lshlrev_b32 v89, 16, v165
    v_add_f32 v39, v39, v89
    v_and_b32 v88, 0xffff0000, v156
    v_add_f32 v44, v44, v88
    v_and_b32 v89, 0xffff0000, v159
    v_add_f32 v45, v45, v89
    v_and_b32 v88, 0xffff0000, v162
    v_add_f32 v46, v46, v88
    v_and_b32 v89, 0xffff0000, v165
    v_add_f32 v47, v47, v89
    v_lshlrev_b32 v88, 16, v157
    v_add_f32 v52, v52, v88
    v_lshlrev_b32 v89, 16, v160
    v_add_f32 v53, v53, v89
    v_lshlrev_b32 v88, 16, v163
    v_add_f32 v54, v54, v88
    v_lshlrev_b32 v89, 16, v166
    v_add_f32 v55, v55, v89
    s_branch P3E_45
P3O_44:
    v_and_b32 v88, 0xffff0000, v145
    v_add_f32 v32, v32, v88
    v_and_b32 v89, 0xffff0000, v148
    v_add_f32 v33, v33, v89
    v_and_b32 v88, 0xffff0000, v151
    v_add_f32 v34, v34, v88
    v_and_b32 v89, 0xffff0000, v154
    v_add_f32 v35, v35, v89
    v_lshlrev_b32 v88, 16, v146
    v_add_f32 v40, v40, v88
    v_lshlrev_b32 v89, 16, v149
    v_add_f32 v41, v41, v89
    v_lshlrev_b32 v88, 16, v152
    v_add_f32 v42, v42, v88
    v_lshlrev_b32 v89, 16, v155
    v_add_f32 v43, v43, v89
    v_and_b32 v88, 0xffff0000, v146
    v_add_f32 v48, v48, v88
    v_and_b32 v89, 0xffff0000, v149
    v_add_f32 v49, v49, v89
    v_and_b32 v88, 0xffff0000, v152
    v_add_f32 v50, v50, v88
    v_and_b32 v89, 0xffff0000, v155
    v_add_f32 v51, v51, v89
    v_and_b32 v88, 0xffff0000, v157
    v_add_f32 v36, v36, v88
    v_and_b32 v89, 0xffff0000, v160
    v_add_f32 v37, v37, v89
    v_and_b32 v88, 0xffff0000, v163
    v_add_f32 v38, v38, v88
    v_and_b32 v89, 0xffff0000, v166
    v_add_f32 v39, v39, v89
    v_lshlrev_b32 v88, 16, v158
    v_add_f32 v44, v44, v88
    v_lshlrev_b32 v89, 16, v161
    v_add_f32 v45, v45, v89
    v_lshlrev_b32 v88, 16, v164
    v_add_f32 v46, v46, v88
    v_lshlrev_b32 v89, 16, v167
    v_add_f32 v47, v47, v89
    v_and_b32 v88, 0xffff0000, v158
    v_add_f32 v52, v52, v88
    v_and_b32 v89, 0xffff0000, v161
    v_add_f32 v53, v53, v89
    v_and_b32 v88, 0xffff0000, v164
    v_add_f32 v54, v54, v88
    v_and_b32 v89, 0xffff0000, v167
    v_add_f32 v55, v55, v89
P3E_45:
    v_add_f32 v56, v56, v57
    v_add_f32 v58, v58, v59
    v_add_f32 v56, v56, v58
    v_add_f32 v60, v60, v61
    v_add_f32 v62, v62, v63
    v_add_f32 v60, v60, v62
    v_mov_b32 v88, v56
    s_nop 1
    v_permlane16_swap_b32 v56, v88
    v_add_f32 v56, v56, v88
    v_mov_b32 v89, v60
    s_nop 1
    v_permlane16_swap_b32 v60, v89
    v_add_f32 v60, v60, v89
    v_mov_b32 v88, v56
    s_nop 1
    v_permlane32_swap_b32 v56, v88
    v_add_f32 v56, v56, v88
    v_mov_b32 v89, v60
    s_nop 1
    v_permlane32_swap_b32 v60, v89
    v_add_f32 v60, v60, v89
    s_mov_b32 s36, 987991609
    v_fma_f32 v56, v56, s36, v240
    v_fma_f32 v60, v60, s36, v242
    v_mov_b32 v57, 0
    v_mov_b32 v61, 0
    v_sub_f32 v32, v32, v56
    v_sub_f32 v33, v33, v56
    v_sub_f32 v34, v34, v56
    v_sub_f32 v35, v35, v56
    v_sub_f32 v36, v36, v60
    v_sub_f32 v37, v37, v60
    v_sub_f32 v38, v38, v60
    v_sub_f32 v39, v39, v60
    v_fma_f32 v57, v32, v32, v57
    v_fma_f32 v57, v33, v33, v57
    v_fma_f32 v57, v34, v34, v57
    v_fma_f32 v57, v35, v35, v57
    v_fma_f32 v61, v36, v36, v61
    v_fma_f32 v61, v37, v37, v61
    v_fma_f32 v61, v38, v38, v61
    v_fma_f32 v61, v39, v39, v61
    v_cvt_pk_bf16_f32 v32, v32, v33
    v_cvt_pk_bf16_f32 v33, v34, v35
    v_cvt_pk_bf16_f32 v34, v36, v37
    v_cvt_pk_bf16_f32 v35, v38, v39
    s_nop 0
    v_permlane16_swap_b32 v32, v34
    v_permlane16_swap_b32 v33, v35
    buffer_store_dwordx4 v[32:35], v9, s[24:27], s56 offen sc1
    v_sub_f32 v40, v40, v56
    v_sub_f32 v41, v41, v56
    v_sub_f32 v42, v42, v56
    v_sub_f32 v43, v43, v56
    v_sub_f32 v44, v44, v60
    v_sub_f32 v45, v45, v60
    v_sub_f32 v46, v46, v60
    v_sub_f32 v47, v47, v60
    v_fma_f32 v57, v40, v40, v57
    v_fma_f32 v57, v41, v41, v57
    v_fma_f32 v57, v42, v42, v57
    v_fma_f32 v57, v43, v43, v57
    v_fma_f32 v61, v44, v44, v61
    v_fma_f32 v61, v45, v45, v61
    v_fma_f32 v61, v46, v46, v61
    v_fma_f32 v61, v47, v47, v61
    v_cvt_pk_bf16_f32 v40, v40, v41
    v_cvt_pk_bf16_f32 v41, v42, v43
    v_cvt_pk_bf16_f32 v42, v44, v45
    v_cvt_pk_bf16_f32 v43, v46, v47
    s_nop 0
    v_permlane16_swap_b32 v40, v42
    v_permlane16_swap_b32 v41, v43
    buffer_store_dwordx4 v[40:43], v9, s[24:27], s57 offen sc1
    v_sub_f32 v48, v48, v56
    v_sub_f32 v49, v49, v56
    v_sub_f32 v50, v50, v56
    v_sub_f32 v51, v51, v56
    v_sub_f32 v52, v52, v60
    v_sub_f32 v53, v53, v60
    v_sub_f32 v54, v54, v60
    v_sub_f32 v55, v55, v60
    v_fma_f32 v57, v48, v48, v57
    v_fma_f32 v57, v49, v49, v57
    v_fma_f32 v57, v50, v50, v57
    v_fma_f32 v57, v51, v51, v57
    v_fma_f32 v61, v52, v52, v61
    v_fma_f32 v61, v53, v53, v61
    v_fma_f32 v61, v54, v54, v61
    v_fma_f32 v61, v55, v55, v61
    v_cvt_pk_bf16_f32 v48, v48, v49
    v_cvt_pk_bf16_f32 v49, v50, v51
    v_cvt_pk_bf16_f32 v50, v52, v53
    v_cvt_pk_bf16_f32 v51, v54, v55
    s_nop 0
    v_permlane16_swap_b32 v48, v50
    v_permlane16_swap_b32 v49, v51
    buffer_store_dwordx4 v[48:51], v9, s[24:27], s58 offen sc1
    v_mov_b32 v88, v57
    s_nop 1
    v_permlane16_swap_b32 v57, v88
    v_add_f32 v57, v57, v88
    v_mov_b32 v89, v61
    s_nop 1
    v_permlane16_swap_b32 v61, v89
    v_add_f32 v61, v61, v89
    v_mov_b32 v88, v57
    s_nop 1
    v_permlane32_swap_b32 v57, v88
    v_add_f32 v57, v57, v88
    v_mov_b32 v89, v61
    s_nop 1
    v_permlane32_swap_b32 v61, v89
    v_add_f32 v61, v61, v89
    v_cmp_eq_u32 vcc, 1, v4
    s_nop 1
    v_cndmask_b32 v88, v57, v61, vcc
    v_cndmask_b32 v89, v56, v60, vcc
    buffer_store_dword v88, v10, s[16:19], 0 offen sc1
    buffer_store_dword v89, v8, s[16:19], 0 offen sc1
    s_mov_b32 s3, 0
PKC_46:
    v_xor_b32 v100, s63, v100
    v_xor_b32 v101, s63, v101
    v_xor_b32 v102, s63, v102
    v_xor_b32 v103, s63, v103
    v_or_b32 v100, v100, v101
    v_or_b32 v102, v102, v103
    v_or_b32 v100, v100, v102
    v_cmp_ne_u32 vcc, 0, v100
    s_nop 4
    s_cbranch_vccz PKD_47
    buffer_load_dword v100, v96, s[28:31], 0 offen sc1
    buffer_load_dword v101, v97, s[28:31], 0 offen sc1
    buffer_load_dword v102, v98, s[28:31], 0 offen sc1
    buffer_load_dword v103, v99, s[28:31], 0 offen sc1
    s_waitcnt vmcnt(0)
    s_add_u32 s3, s3, 1
    s_cmp_lt_u32 s3, 0x200000
    s_cbranch_scc1 PKC_46
PKD_47:
    buffer_load_dwordx4 a[0:3], v2, s[8:11], s40 offen offset:0 sc1
    buffer_load_dwordx4 a[4:7], v2, s[8:11], s40 offen offset:1024 sc1
    buffer_load_dwordx4 a[8:11], v2, s[8:11], s40 offen offset:2048 sc1
    buffer_load_dwordx4 a[12:15], v2, s[8:11], s40 offen offset:3072 sc1
    s_add_u32 s40, s40, 4096
    buffer_load_dwordx4 a[16:19], v2, s[8:11], s40 offen offset:0 sc1
    buffer_load_dwordx4 a[20:23], v2, s[8:11], s40 offen offset:1024 sc1
    buffer_load_dwordx4 a[24:27], v2, s[8:11], s40 offen offset:2048 sc1
    buffer_load_dwordx4 a[28:31], v2, s[8:11], s40 offen offset:3072 sc1
    s_add_u32 s40, s40, 4096
    s_lshl_b32 s6, s60, 3
    s_add_u32 s6, s6, s61
    s_lshl_b32 s6, s6, 6
    s_add_u32 s6, s6, 32768
    s_waitcnt vmcnt(8) lgkmcnt(0)
    s_barrier
    s_cmp_lg_u32 s62, 0
    s_cbranch_scc1 SIG_48
    s_mov_b32 s28, s86
    s_mov_b32 s29, s87
    s_mov_b32 s30, 327680
    s_mov_b32 s31, 0x20000
    v_mov_b32 v250, s6
    v_mov_b32 v251, s63
    s_mov_b64 exec, 1
    buffer_store_dword v251, v250, s[28:31], 0 offen sc1
    s_mov_b64 exec, -1
SIG_48:
    buffer_load_dwordx4 a[32:35], v2, s[8:11], s40 offen offset:0 sc1
    buffer_load_dwordx4 a[36:39], v2, s[8:11], s40 offen offset:1024 sc1
    buffer_load_dwordx4 a[40:43], v2, s[8:11], s40 offen offset:2048 sc1
    buffer_load_dwordx4 a[44:47], v2, s[8:11], s40 offen offset:3072 sc1
    s_add_u32 s40, s40, 4096
    buffer_load_dwordx4 a[48:51], v2, s[8:11], s40 offen offset:0 sc1
    buffer_load_dwordx4 a[52:55], v2, s[8:11], s40 offen offset:1024 sc1
    buffer_load_dwordx4 a[56:59], v2, s[8:11], s40 offen offset:2048 sc1
    buffer_load_dwordx4 a[60:63], v2, s[8:11], s40 offen offset:3072 sc1
    s_add_u32 s40, s40, 4096
    buffer_load_dwordx4 a[64:67], v2, s[8:11], s40 offen offset:0 sc1
    buffer_load_dwordx4 a[68:71], v2, s[8:11], s40 offen offset:1024 sc1
    buffer_load_dwordx4 a[72:75], v2, s[8:11], s40 offen offset:2048 sc1
    buffer_load_dwordx4 a[76:79], v2, s[8:11], s40 offen offset:3072 sc1
    s_add_u32 s40, s40, 4096
    buffer_load_dwordx4 a[80:83], v2, s[8:11], s40 offen offset:0 sc1
    buffer_load_dwordx4 a[84:87], v2, s[8:11], s40 offen offset:1024 sc1
    buffer_load_dwordx4 a[88:91], v2, s[8:11], s40 offen offset:2048 sc1
    buffer_load_dwordx4 a[92:95], v2, s[8:11], s40 offen offset:3072 sc1
    s_add_u32 s40, s40, 4096
    buffer_load_dwordx4 a[96:99], v2, s[8:11], s40 offen offset:0 sc1
    buffer_load_dwordx4 a[100:103], v2, s[8:11], s40 offen offset:1024 sc1
    buffer_load_dwordx4 a[104:107], v2, s[8:11], s40 offen offset:2048 sc1
    buffer_load_dwordx4 a[108:111], v2, s[8:11], s40 offen offset:3072 sc1
    s_add_u32 s40, s40, 4096
    buffer_load_dwordx4 a[112:115], v2, s[8:11], s40 offen offset:0 sc1
    buffer_load_dwordx4 a[116:119], v2, s[8:11], s40 offen offset:1024 sc1
    buffer_load_dwordx4 a[120:123], v2, s[8:11], s40 offen offset:2048 sc1
    buffer_load_dwordx4 a[124:127], v2, s[8:11], s40 offen offset:3072 sc1
    s_add_u32 s40, s40, 4096
    s_branch P3_DONE
P3_SKIP:
    v_and_b32 v12, 63, v0
    v_add_u32 v12, 0, v12
    v_lshlrev_b32 v12, 6, v12
    v_add_u32 v12, 16384, v12
    v_and_b32 v13, 63, v0
    v_add_u32 v13, 64, v13
    v_lshlrev_b32 v13, 6, v13
    v_add_u32 v13, 16384, v13
    v_and_b32 v14, 63, v0
    v_add_u32 v14, 128, v14
    v_lshlrev_b32 v14, 6, v14
    v_add_u32 v14, 16384, v14
    v_and_b32 v15, 63, v0
    v_add_u32 v15, 192, v15
    v_lshlrev_b32 v15, 6, v15
    v_add_u32 v15, 16384, v15
    s_lshl_b32 s34, s60, 1
    s_add_u32 s34, s34, s61
    s_sub_u32 s34, s34, 6
    s_lshl_b32 s34, s34, 2
    s_add_u32 s34, s34, s62
    s_cmp_ge_u32 s34, 112
    s_cbranch_scc1 PK3_49
    s_add_u32 s34, s34, 752
    s_add_u32 s24, s86, 10776576
    s_addc_u32 s25, s87, 0
    s_mov_b32 s26, 15925248
    s_mov_b32 s27, 0x20000
    s_mov_b32 s16, s80
    s_mov_b32 s17, s81
    s_mov_b32 s18, 5308416
    s_mov_b32 s19, 0x20000
    s_mul_hi_u32 s41, s34, 0x2aaaaaab
    s_mul_i32 s42, s41, 6
    s_sub_u32 s42, s34, s42
    s_mul_hi_u32 s43, s41, 0x1c71c71d
    s_mul_i32 s44, s43, 9
    s_sub_u32 s44, s41, s44
    s_and_b32 s41, s43, 1
    s_lshr_b32 s43, s43, 1
    s_and_b32 s45, s44, 1
    s_lshl_b32 s45, s45, 8
    s_lshr_b32 s46, s44, 1
    s_add_u32 s45, s45, s46
    s_cmp_lt_u32 s44, 8
    s_cselect_b32 s45, s45, 512
    s_mul_i32 s46, s43, 576
    s_add_u32 s45, s45, s46
    s_lshl_b32 s46, s41, 2
    s_add_u32 s45, s45, s46
    v_and_b32 v244, 63, v0
    v_and_b32 v245, 15, v244
    v_lshrrev_b32 v246, 4, v244
    s_cmp_lt_u32 s44, 8
    s_cselect_b32 s46, 4, 0
    v_lshlrev_b32 v247, s46, v246
    v_add_u32 v247, s45, v247
    v_mul_u32_u24 v247, 1152, v247
    v_mul_u32_u24 v248, 12, v245
    v_add_u32 v247, v247, v248
    s_mul_i32 s49, s42, 192
    v_add_u32 v31, s49, v247
    s_cmp_lt_u32 s44, 8
    s_mov_b32 s20, 0
    s_cmov_b32 s20, 0
    buffer_load_dwordx4 v[180:183], v31, s[16:19], s20 offen
    s_cmp_lt_u32 s44, 8
    s_mov_b32 s20, 9216
    s_cmov_b32 s20, 9216
    buffer_load_dwordx4 v[184:187], v31, s[16:19], s20 offen
    s_cmp_lt_u32 s44, 8
    s_mov_b32 s20, 18432
    s_cmov_b32 s20, 73728
    buffer_load_dwordx4 v[188:191], v31, s[16:19], s20 offen
    s_cmp_lt_u32 s44, 8
    s_mov_b32 s20, 27648
    s_cmov_b32 s20, 82944
    buffer_load_dwordx4 v[192:195], v31, s[16:19], s20 offen
    s_cmp_lt_u32 s44, 8
    s_mov_b32 s20, 36864
    s_cmov_b32 s20, 147456
    buffer_load_dwordx4 v[196:199], v31, s[16:19], s20 offen
    s_cmp_lt_u32 s44, 8
    s_mov_b32 s20, 46080
    s_cmov_b32 s20, 156672
    buffer_load_dwordx4 v[200:203], v31, s[16:19], s20 offen
    s_cmp_lt_u32 s44, 8
    s_mov_b32 s20, 55296
    s_cmov_b32 s20, 221184
    buffer_load_dwordx4 v[204:207], v31, s[16:19], s20 offen
    s_cmp_lt_u32 s44, 8
    s_mov_b32 s20, 64512
    s_cmov_b32 s20, 230400
    buffer_load_dwordx4 v[208:211], v31, s[16:19], s20 offen
    s_lshl_b32 s45, s43, 2
    s_and_b32 s46, s42, 1
    s_lshl_b32 s46, s46, 1
    s_add_u32 s45, s45, s46
    s_mul_i32 s45, s45, 165888
    s_mul_i32 s46, s41, 9
    s_add_u32 s46, s46, s44
    s_mul_i32 s46, s46, 9
    s_lshr_b32 s47, s42, 1
    s_mul_i32 s47, s47, 3
    s_add_u32 s46, s46, s47
    s_lshl_b32 s46, s46, 10
    s_add_u32 s45, s45, s46
    s_add_u32 s21, s45, 10616832
    s_add_u32 s22, s21, 165888
    v_and_b32 v244, 63, v0
    v_lshlrev_b32 v245, 4, v244
    s_waitcnt vmcnt(0)
    s_mov_b32 s50, 0x05040100
    s_mov_b32 s51, 0x07060302
    v_perm_b32 v64, v184, v180, s50
    v_perm_b32 v65, v192, v188, s50
    v_perm_b32 v66, v200, v196, s50
    v_perm_b32 v67, v208, v204, s50
    v_perm_b32 v68, v184, v180, s51
    v_perm_b32 v69, v192, v188, s51
    v_perm_b32 v70, v200, v196, s51
    v_perm_b32 v71, v208, v204, s51
    v_perm_b32 v72, v185, v181, s50
    v_perm_b32 v73, v193, v189, s50
    v_perm_b32 v74, v201, v197, s50
    v_perm_b32 v75, v209, v205, s50
    v_perm_b32 v76, v185, v181, s51
    v_perm_b32 v77, v193, v189, s51
    v_perm_b32 v78, v201, v197, s51
    v_perm_b32 v79, v209, v205, s51
    v_perm_b32 v80, v186, v182, s50
    v_perm_b32 v81, v194, v190, s50
    v_perm_b32 v82, v202, v198, s50
    v_perm_b32 v83, v210, v206, s50
    v_perm_b32 v84, v186, v182, s51
    v_perm_b32 v85, v194, v190, s51
    v_perm_b32 v86, v202, v198, s51
    v_perm_b32 v87, v210, v206, s51
    buffer_store_dwordx4 v[64:67], v245, s[24:27], s21 offen offset:0 sc1
    buffer_store_dwordx4 v[68:71], v245, s[24:27], s21 offen offset:1024 sc1
    buffer_store_dwordx4 v[72:75], v245, s[24:27], s21 offen offset:2048 sc1
    buffer_store_dwordx4 v[76:79], v245, s[24:27], s22 offen offset:0 sc1
    buffer_store_dwordx4 v[80:83], v245, s[24:27], s22 offen offset:1024 sc1
    buffer_store_dwordx4 v[84:87], v245, s[24:27], s22 offen offset:2048 sc1
PK3_49:
    s_lshl_b32 s6, s60, 3
    s_add_u32 s6, s6, s61
    s_lshl_b32 s6, s6, 6
    s_add_u32 s6, s6, 65536
    s_waitcnt vmcnt(0) lgkmcnt(0)
    s_barrier
    s_cmp_lg_u32 s62, 0
    s_cbranch_scc1 SIG_50
    s_mov_b32 s28, s86
    s_mov_b32 s29, s87
    s_mov_b32 s30, 327680
    s_mov_b32 s31, 0x20000
    v_mov_b32 v250, s6
    v_mov_b32 v251, s63
    s_mov_b64 exec, 1
    buffer_store_dword v251, v250, s[28:31], 0 offen sc1
    s_mov_b64 exec, -1
SIG_50:
    s_cmp_lg_u32 s62, 0
    s_cbranch_scc1 POLE_52
    s_mov_b32 s28, s86
    s_mov_b32 s29, s87
    s_mov_b32 s30, 327680
    s_mov_b32 s31, 0x20000
    s_mov_b32 s3, 0
POL_51:
    buffer_load_dword v244, v12, s[28:31], 0 offen sc1
    buffer_load_dword v245, v13, s[28:31], 0 offen sc1
    buffer_load_dword v246, v14, s[28:31], 0 offen sc1
    buffer_load_dword v247, v15, s[28:31], 0 offen sc1
    s_waitcnt vmcnt(0)
    v_xor_b32 v244, s63, v244
    v_xor_b32 v245, s63, v245
    v_or_b32 v244, v244, v245
    v_xor_b32 v246, s63, v246
    v_or_b32 v244, v244, v246
    v_xor_b32 v247, s63, v247
    v_or_b32 v244, v244, v247
    v_cmp_ne_u32 vcc, 0, v244
    s_add_u32 s3, s3, 1
    s_cmp_gt_u32 s3, 0x200000
    s_cbranch_scc1 POLE_52
    s_nop 1
    s_cbranch_vccnz POL_51
POLE_52:
    s_barrier
    s_add_u32 s8, s86, 10776576
    s_addc_u32 s9, s87, 0
    s_mov_b32 s10, 15925248
    s_mov_b32 s11, 0x20000
    s_lshr_b32 s38, s2, 3
    s_and_b32 s37, s2, 7
    s_and_b32 s38, s38, 1
    s_lshl_b32 s39, s37, 1
    s_add_u32 s39, s39, s38
    s_lshl_b32 s39, s39, 2
    s_add_u32 s39, s39, s62
    s_mul_i32 s40, s39, 165888
    s_lshl_b32 s37, s37, 2
    s_add_u32 s37, s37, s62
    s_mul_i32 s37, s37, 165888
    s_add_u32 s37, s37, 10616832
    s_mul_i32 s39, s38, 82944
    s_add_u32 s54, s37, s39
    s_add_u32 s55, s37, 82944
    s_sub_u32 s55, s55, s39
    v_and_b32 v1, 63, v0
    v_lshlrev_b32 v2, 4, v1
    buffer_load_dwordx4 a[0:3], v2, s[8:11], s40 offen offset:0 sc1
    buffer_load_dwordx4 a[4:7], v2, s[8:11], s40 offen offset:1024 sc1
    buffer_load_dwordx4 a[8:11], v2, s[8:11], s40 offen offset:2048 sc1
    buffer_load_dwordx4 a[12:15], v2, s[8:11], s40 offen offset:3072 sc1
    s_add_u32 s40, s40, 4096
    buffer_load_dwordx4 a[16:19], v2, s[8:11], s40 offen offset:0 sc1
    buffer_load_dwordx4 a[20:23], v2, s[8:11], s40 offen offset:1024 sc1
    buffer_load_dwordx4 a[24:27], v2, s[8:11], s40 offen offset:2048 sc1
    buffer_load_dwordx4 a[28:31], v2, s[8:11], s40 offen offset:3072 sc1
    s_add_u32 s40, s40, 4096
    buffer_load_dwordx4 a[32:35], v2, s[8:11], s40 offen offset:0 sc1
    buffer_load_dwordx4 a[36:39], v2, s[8:11], s40 offen offset:1024 sc1
    buffer_load_dwordx4 a[40:43], v2, s[8:11], s40 offen offset:2048 sc1
    buffer_load_dwordx4 a[44:47], v2, s[8:11], s40 offen offset:3072 sc1
    s_add_u32 s40, s40, 4096
    buffer_load_dwordx4 a[48:51], v2, s[8:11], s40 offen offset:0 sc1
    buffer_load_dwordx4 a[52:55], v2, s[8:11], s40 offen offset:1024 sc1
    buffer_load_dwordx4 a[56:59], v2, s[8:11], s40 offen offset:2048 sc1
    buffer_load_dwordx4 a[60:63], v2, s[8:11], s40 offen offset:3072 sc1
    s_add_u32 s40, s40, 4096
    buffer_load_dwordx4 a[64:67], v2, s[8:11], s40 offen offset:0 sc1
    buffer_load_dwordx4 a[68:71], v2, s[8:11], s40 offen offset:1024 sc1
    buffer_load_dwordx4 a[72:75], v2, s[8:11], s40 offen offset:2048 sc1
    buffer_load_dwordx4 a[76:79], v2, s[8:11], s40 offen offset:3072 sc1
    s_add_u32 s40, s40, 4096
    buffer_load_dwordx4 a[80:83], v2, s[8:11], s40 offen offset:0 sc1
    buffer_load_dwordx4 a[84:87], v2, s[8:11], s40 offen offset:1024 sc1
    buffer_load_dwordx4 a[88:91], v2, s[8:11], s40 offen offset:2048 sc1
    buffer_load_dwordx4 a[92:95], v2, s[8:11], s40 offen offset:3072 sc1
    s_add_u32 s40, s40, 4096
    buffer_load_dwordx4 a[96:99], v2, s[8:11], s40 offen offset:0 sc1
    buffer_load_dwordx4 a[100:103], v2, s[8:11], s40 offen offset:1024 sc1
    buffer_load_dwordx4 a[104:107], v2, s[8:11], s40 offen offset:2048 sc1
    buffer_load_dwordx4 a[108:111], v2, s[8:11], s40 offen offset:3072 sc1
    s_add_u32 s40, s40, 4096
    buffer_load_dwordx4 a[112:115], v2, s[8:11], s40 offen offset:0 sc1
    buffer_load_dwordx4 a[116:119], v2, s[8:11], s40 offen offset:1024 sc1
    buffer_load_dwordx4 a[120:123], v2, s[8:11], s40 offen offset:2048 sc1
    buffer_load_dwordx4 a[124:127], v2, s[8:11], s40 offen offset:3072 sc1
    s_add_u32 s40, s40, 4096
P3_DONE:
    s_lshr_b32 s60, s2, 3
    s_and_b32 s61, s2, 7
    v_and_b32 v11, 7, v0
    v_min_u32 v11, 5, v11
    v_bfe_u32 v12, v0, 3, 1
    v_lshl_add_u32 v11, v12, 3, v11
    s_and_b32 s3, s60, 30
    s_lshl_b32 s3, s3, 3
    v_add_u32 v11, s3, v11
    v_lshlrev_b32 v11, 6, v11
    v_add_u32 v11, 32768, v11
    v_and_b32 v16, 63, v0
    v_lshrrev_b32 v17, 1, v16
    v_lshlrev_b32 v17, 3, v17
    v_and_b32 v16, 1, v16
    v_add_u32 v16, v16, v17
    v_add_u32 v16, 6, v16
    v_lshlrev_b32 v16, 6, v16
    v_add_u32 v16, 65536, v16
    s_cmp_lg_u32 s62, 0
    s_cbranch_scc1 POLE_54
    s_mov_b32 s28, s86
    s_mov_b32 s29, s87
    s_mov_b32 s30, 327680
    s_mov_b32 s31, 0x20000
    s_mov_b32 s3, 0
POL_53:
    buffer_load_dword v244, v11, s[28:31], 0 offen sc1
    buffer_load_dword v245, v16, s[28:31], 0 offen sc1
    s_waitcnt vmcnt(0)
    v_xor_b32 v244, s63, v244
    v_xor_b32 v245, s63, v245
    v_or_b32 v244, v244, v245
    v_cmp_ne_u32 vcc, 0, v244
    s_add_u32 s3, s3, 1
    s_cmp_gt_u32 s3, 0x200000
    s_cbranch_scc1 POLE_54
    s_nop 1
    s_cbranch_vccnz POL_53
POLE_54:
    s_barrier
    s_mov_b32 s28, s86
    s_mov_b32 s29, s87
    s_mov_b32 s30, 327680
    s_mov_b32 s31, 0x20000
    s_or_b32 s3, s2, s62
    s_cmp_lg_u32 s3, 0
    s_cbranch_scc1 BMP_55
    s_sub_u32 s4, s63, 0x7f4a7c15
    s_mul_i32 s4, s4, 0xe8b2f51
    s_add_u32 s4, s4, 1
    v_mov_b32 v250, 0
    v_mov_b32 v251, s4
    s_mov_b64 exec, 1
    buffer_store_dword v251, v250, s[28:31], 0 offen sc1
    s_mov_b64 exec, -1
BMP_55:
    s_add_u32 s12, s86, 7589888
    s_addc_u32 s13, s87, 0
    s_mov_b32 s14, 2359296
    s_mov_b32 s15, 0x20000
    s_and_b32 s36, s62, 1
    s_lshr_b32 s34, s62, 1
    s_lshl_b32 s35, s34, 13
    s_lshl_b32 s37, s36, 12
    s_add_u32 s35, s35, s37
    s_xor_b32 s33, s60, s36
    s_mul_i32 s33, s33, 73728
    s_lshl_b32 s34, s34, 12
    s_add_u32 s33, s33, s34
    s_mov_b32 m0, s35
    s_nop 0
    buffer_load_dwordx4 v2, s[12:15], s33 offen offset:0 sc1 lds
    buffer_load_dwordx4 v2, s[12:15], s33 offen offset:1024 sc1 lds
    buffer_load_dwordx4 v2, s[12:15], s33 offen offset:2048 sc1 lds
    buffer_load_dwordx4 v2, s[12:15], s33 offen offset:3072 sc1 lds
    s_add_u32 s35, s35, 16384
    s_add_u32 s33, s33, 8192
    s_mov_b32 m0, s35
    s_nop 0
    buffer_load_dwordx4 v2, s[12:15], s33 offen offset:0 sc1 lds
    buffer_load_dwordx4 v2, s[12:15], s33 offen offset:1024 sc1 lds
    buffer_load_dwordx4 v2, s[12:15], s33 offen offset:2048 sc1 lds
    buffer_load_dwordx4 v2, s[12:15], s33 offen offset:3072 sc1 lds
    s_add_u32 s35, s35, 16384
    s_add_u32 s33, s33, 8192
    s_add_u32 s16, s86, 26701824
    s_addc_u32 s17, s87, 0
    s_mov_b32 s18, 18874368
    s_mov_b32 s19, 0x20000
    s_add_u32 s20, s86, 45576192
    s_addc_u32 s21, s87, 0
    s_mov_b32 s22, 9437184
    s_mov_b32 s23, 0x20000
    s_mov_b32 s28, s86
    s_mov_b32 s29, s87
    s_mov_b32 s30, 327680
    s_mov_b32 s31, 0x20000
    v_add_u32 v3, 65536, v2
    v_add_u32 v4, 131072, v2
    s_lshl_b32 s38, s62, 13
    v_add_u32 v5, s38, v2
    s_lshl_b32 s39, s62, 8
    s_add_u32 s39, s39, 32768
    v_lshrrev_b32 v12, 4, v1
    v_lshlrev_b32 v12, 10, v12
    v_and_b32 v13, 15, v1
    v_lshl_add_u32 v12, v13, 4, v12
    v_add_u32 v6, s39, v12
    s_xor_b32 s41, s60, 1
    s_lshl_b32 s41, s41, 3
    s_add_u32 s41, s41, s61
    s_mul_i32 s42, s41, 36864
    v_add_u32 v7, s42, v5
    v_add_u32 v8, s42, v6
    s_lshl_b32 s41, s41, 6
    s_add_u32 s41, s41, 81920
    v_mov_b32 v10, s41
    s_lshl_b32 s6, s60, 3
    s_add_u32 s6, s6, s61
    s_lshl_b32 s6, s6, 6
    s_add_u32 s6, s6, 81920
    v_mov_b32 v12, s6
    v_mov_b32 v13, s63
    s_mul_i32 s41, s61, 2359296
    s_mul_i32 s42, s60, 73728
    s_add_u32 s41, s41, s42
    s_mul_i32 s42, s62, 6144
    s_add_u32 s41, s41, s42
    v_add_u32 v9, s41, v2
    s_movk_i32 s44, 4096
    s_lshl_b32 s48, s60, 3
    s_add_u32 s48, s48, s61
    s_lshl_b32 s48, s48, 2
    s_add_u32 s48, s48, s62
    s_lshl_b32 s48, s48, 6
    s_add_u32 s48, s48, 98304
    s_lshl_b32 s46, s60, 3
    s_add_u32 s46, s46, s61
    s_mul_i32 s46, s46, 36864
    s_lshl_b32 s47, s62, 10
    s_add_u32 s46, s46, s47
    s_add_u32 s47, s47, 36864
    buffer_load_dwordx4 a[128:131], v2, s[8:11], s40 offen offset:0 sc1
    buffer_load_dwordx4 a[132:135], v2, s[8:11], s40 offen offset:1024 sc1
    buffer_load_dwordx4 a[136:139], v2, s[8:11], s40 offen offset:2048 sc1
    buffer_load_dwordx4 a[140:143], v2, s[8:11], s40 offen offset:3072 sc1
    s_add_u32 s40, s40, 4096
    buffer_load_dwordx4 a[144:147], v2, s[8:11], s40 offen offset:0 sc1
    buffer_load_dwordx4 a[148:151], v2, s[8:11], s40 offen offset:1024 sc1
    buffer_load_dwordx4 a[152:155], v2, s[8:11], s40 offen offset:2048 sc1
    buffer_load_dwordx4 a[156:159], v2, s[8:11], s40 offen offset:3072 sc1
    s_add_u32 s40, s40, 4096
    s_mov_b32 m0, s35
    s_nop 0
    buffer_load_dwordx4 v2, s[12:15], s33 offen offset:0 sc1 lds
    buffer_load_dwordx4 v2, s[12:15], s33 offen offset:1024 sc1 lds
    buffer_load_dwordx4 v2, s[12:15], s33 offen offset:2048 sc1 lds
    buffer_load_dwordx4 v2, s[12:15], s33 offen offset:3072 sc1 lds
    s_add_u32 s35, s35, 16384
    s_add_u32 s33, s33, 8192
    s_mov_b32 m0, s35
    s_nop 0
    buffer_load_dwordx4 v2, s[12:15], s33 offen offset:0 sc1 lds
    buffer_load_dwordx4 v2, s[12:15], s33 offen offset:1024 sc1 lds
    buffer_load_dwordx4 v2, s[12:15], s33 offen offset:2048 sc1 lds
    buffer_load_dwordx4 v2, s[12:15], s33 offen offset:3072 sc1 lds
    s_add_u32 s35, s35, 16384
    s_add_u32 s33, s33, 8192
    s_waitcnt vmcnt(20)
    s_barrier
    ds_read_b128 v[16:19], v2 offset:0
    ds_read_b128 v[20:23], v2 offset:1024
    ds_read_b128 v[24:27], v2 offset:2048
    s_waitcnt vmcnt(51) lgkmcnt(2)
    v_mfma_f32_16x16x32_bf16 a[192:195], a[0:3], v[16:19], 0
    ds_read_b128 v[28:31], v2 offset:3072
    s_mov_b32 m0, s35
    v_mfma_f32_16x16x32_bf16 a[196:199], a[4:7], v[16:19], 0
    v_mfma_f32_16x16x32_bf16 a[200:203], a[8:11], v[16:19], 0
    buffer_load_dwordx4 v2, s[12:15], s33 offen offset:0 sc1 lds
    v_mfma_f32_16x16x32_bf16 a[204:207], a[12:15], v[16:19], 0
    buffer_load_dwordx4 v2, s[12:15], s33 offen offset:1024 sc1 lds
    v_mfma_f32_16x16x32_bf16 v[112:115], a[16:19], v[16:19], 0
    s_waitcnt lgkmcnt(2)
    v_mfma_f32_16x16x32_bf16 a[208:211], a[0:3], v[20:23], 0
    ds_read_b128 v[16:19], v2 offset:4096
    v_mfma_f32_16x16x32_bf16 a[212:215], a[4:7], v[20:23], 0
    v_mfma_f32_16x16x32_bf16 a[216:219], a[8:11], v[20:23], 0
    buffer_load_dwordx4 v2, s[12:15], s33 offen offset:2048 sc1 lds
    v_mfma_f32_16x16x32_bf16 a[220:223], a[12:15], v[20:23], 0
    buffer_load_dwordx4 v2, s[12:15], s33 offen offset:3072 sc1 lds
    v_mfma_f32_16x16x32_bf16 v[116:119], a[16:19], v[20:23], 0
    s_add_u32 s35, s35, 16384
    s_waitcnt lgkmcnt(2)
    v_mfma_f32_16x16x32_bf16 a[224:227], a[0:3], v[24:27], 0
    ds_read_b128 v[20:23], v2 offset:5120
    s_add_u32 s33, s33, 8192
    v_mfma_f32_16x16x32_bf16 a[228:231], a[4:7], v[24:27], 0
    s_mov_b32 m0, s35
    v_mfma_f32_16x16x32_bf16 a[232:235], a[8:11], v[24:27], 0
    buffer_load_dwordx4 v2, s[12:15], s33 offen offset:0 sc1 lds
    v_mfma_f32_16x16x32_bf16 a[236:239], a[12:15], v[24:27], 0
    buffer_load_dwordx4 v2, s[12:15], s33 offen offset:1024 sc1 lds
    v_mfma_f32_16x16x32_bf16 v[120:123], a[16:19], v[24:27], 0
    s_waitcnt lgkmcnt(2)
    v_mfma_f32_16x16x32_bf16 a[240:243], a[0:3], v[28:31], 0
    ds_read_b128 v[24:27], v2 offset:6144
    v_mfma_f32_16x16x32_bf16 a[244:247], a[4:7], v[28:31], 0
    v_mfma_f32_16x16x32_bf16 a[248:251], a[8:11], v[28:31], 0
    v_mfma_f32_16x16x32_bf16 a[252:255], a[12:15], v[28:31], 0
    v_mfma_f32_16x16x32_bf16 v[124:127], a[16:19], v[28:31], 0
    s_waitcnt lgkmcnt(2)
    v_mfma_f32_16x16x32_bf16 v[32:35], a[0:3], v[16:19], 0
    ds_read_b128 v[28:31], v2 offset:7168
    v_mfma_f32_16x16x32_bf16 v[36:39], a[4:7], v[16:19], 0
    v_mfma_f32_16x16x32_bf16 v[40:43], a[8:11], v[16:19], 0
    v_mfma_f32_16x16x32_bf16 v[44:47], a[12:15], v[16:19], 0
    v_mfma_f32_16x16x32_bf16 v[48:51], a[16:19], v[16:19], 0
    s_waitcnt lgkmcnt(2)
    v_mfma_f32_16x16x32_bf16 v[52:55], a[0:3], v[20:23], 0
    ds_read_b128 v[16:19], v2 offset:8192
    v_mfma_f32_16x16x32_bf16 v[56:59], a[4:7], v[20:23], 0
    v_mfma_f32_16x16x32_bf16 v[60:63], a[8:11], v[20:23], 0
    v_mfma_f32_16x16x32_bf16 v[64:67], a[12:15], v[20:23], 0
    v_mfma_f32_16x16x32_bf16 v[68:71], a[16:19], v[20:23], 0
    s_waitcnt lgkmcnt(2)
    v_mfma_f32_16x16x32_bf16 v[72:75], a[0:3], v[24:27], 0
    ds_read_b128 v[20:23], v2 offset:9216
    v_mfma_f32_16x16x32_bf16 v[76:79], a[4:7], v[24:27], 0
    v_mfma_f32_16x16x32_bf16 v[80:83], a[8:11], v[24:27], 0
    v_mfma_f32_16x16x32_bf16 v[84:87], a[12:15], v[24:27], 0
    v_mfma_f32_16x16x32_bf16 v[88:91], a[16:19], v[24:27], 0
    s_waitcnt lgkmcnt(2)
    v_mfma_f32_16x16x32_bf16 v[92:95], a[0:3], v[28:31], 0
    ds_read_b128 v[24:27], v2 offset:10240
    v_mfma_f32_16x16x32_bf16 v[96:99], a[4:7], v[28:31], 0
    v_mfma_f32_16x16x32_bf16 v[100:103], a[8:11], v[28:31], 0
    v_mfma_f32_16x16x32_bf16 v[104:107], a[12:15], v[28:31], 0
    v_mfma_f32_16x16x32_bf16 v[108:111], a[16:19], v[28:31], 0
    s_waitcnt vmcnt(22)
    s_barrier
    s_waitcnt vmcnt(52) lgkmcnt(2)
    v_mfma_f32_16x16x32_bf16 a[192:195], a[20:23], v[16:19], a[192:195]
    ds_read_b128 v[28:31], v2 offset:11264
    v_mfma_f32_16x16x32_bf16 a[196:199], a[24:27], v[16:19], a[196:199]
    v_mfma_f32_16x16x32_bf16 a[200:203], a[28:31], v[16:19], a[200:203]
    buffer_load_dwordx4 v2, s[12:15], s33 offen offset:2048 sc1 lds
    v_mfma_f32_16x16x32_bf16 a[204:207], a[32:35], v[16:19], a[204:207]
    buffer_load_dwordx4 v2, s[12:15], s33 offen offset:3072 sc1 lds
    v_mfma_f32_16x16x32_bf16 v[112:115], a[36:39], v[16:19], v[112:115]
    s_add_u32 s35, s35, 16384
    s_waitcnt lgkmcnt(2)
    v_mfma_f32_16x16x32_bf16 a[208:211], a[20:23], v[20:23], a[208:211]
    ds_read_b128 v[16:19], v2 offset:12288
    s_add_u32 s33, s33, 8192
    v_mfma_f32_16x16x32_bf16 a[212:215], a[24:27], v[20:23], a[212:215]
    s_mov_b32 m0, s35
    v_mfma_f32_16x16x32_bf16 a[216:219], a[28:31], v[20:23], a[216:219]
    buffer_load_dwordx4 v2, s[12:15], s33 offen offset:0 sc1 lds
    v_mfma_f32_16x16x32_bf16 a[220:223], a[32:35], v[20:23], a[220:223]
    buffer_load_dwordx4 v2, s[12:15], s33 offen offset:1024 sc1 lds
    v_mfma_f32_16x16x32_bf16 v[116:119], a[36:39], v[20:23], v[116:119]
    s_waitcnt lgkmcnt(2)
    v_mfma_f32_16x16x32_bf16 a[224:227], a[20:23], v[24:27], a[224:227]
    ds_read_b128 v[20:23], v2 offset:13312
    v_mfma_f32_16x16x32_bf16 a[228:231], a[24:27], v[24:27], a[228:231]
    v_mfma_f32_16x16x32_bf16 a[232:235], a[28:31], v[24:27], a[232:235]
    buffer_load_dwordx4 v2, s[12:15], s33 offen offset:2048 sc1 lds
    v_mfma_f32_16x16x32_bf16 a[236:239], a[32:35], v[24:27], a[236:239]
    buffer_load_dwordx4 v2, s[12:15], s33 offen offset:3072 sc1 lds
    v_mfma_f32_16x16x32_bf16 v[120:123], a[36:39], v[24:27], v[120:123]
    s_add_u32 s35, s35, 16384
    s_waitcnt lgkmcnt(2)
    v_mfma_f32_16x16x32_bf16 a[240:243], a[20:23], v[28:31], a[240:243]
    ds_read_b128 v[24:27], v2 offset:14336
    s_add_u32 s33, s33, 8192
    v_mfma_f32_16x16x32_bf16 a[244:247], a[24:27], v[28:31], a[244:247]
    s_mov_b32 m0, s35
    v_mfma_f32_16x16x32_bf16 a[248:251], a[28:31], v[28:31], a[248:251]
    v_mfma_f32_16x16x32_bf16 a[252:255], a[32:35], v[28:31], a[252:255]
    v_mfma_f32_16x16x32_bf16 v[124:127], a[36:39], v[28:31], v[124:127]
    s_waitcnt lgkmcnt(2)
    v_mfma_f32_16x16x32_bf16 v[32:35], a[20:23], v[16:19], v[32:35]
    ds_read_b128 v[28:31], v2 offset:15360
    v_mfma_f32_16x16x32_bf16 v[36:39], a[24:27], v[16:19], v[36:39]
    v_mfma_f32_16x16x32_bf16 v[40:43], a[28:31], v[16:19], v[40:43]
    v_mfma_f32_16x16x32_bf16 v[44:47], a[32:35], v[16:19], v[44:47]
    v_mfma_f32_16x16x32_bf16 v[48:51], a[36:39], v[16:19], v[48:51]
    s_waitcnt lgkmcnt(2)
    v_mfma_f32_16x16x32_bf16 v[52:55], a[20:23], v[20:23], v[52:55]
    ds_read_b128 v[16:19], v2 offset:16384
    v_mfma_f32_16x16x32_bf16 v[56:59], a[24:27], v[20:23], v[56:59]
    v_mfma_f32_16x16x32_bf16 v[60:63], a[28:31], v[20:23], v[60:63]
    v_mfma_f32_16x16x32_bf16 v[64:67], a[32:35], v[20:23], v[64:67]
    v_mfma_f32_16x16x32_bf16 v[68:71], a[36:39], v[20:23], v[68:71]
    s_waitcnt lgkmcnt(2)
    v_mfma_f32_16x16x32_bf16 v[72:75], a[20:23], v[24:27], v[72:75]
    ds_read_b128 v[20:23], v2 offset:17408
    v_mfma_f32_16x16x32_bf16 v[76:79], a[24:27], v[24:27], v[76:79]
    v_mfma_f32_16x16x32_bf16 v[80:83], a[28:31], v[24:27], v[80:83]
    v_mfma_f32_16x16x32_bf16 v[84:87], a[32:35], v[24:27], v[84:87]
    v_mfma_f32_16x16x32_bf16 v[88:91], a[36:39], v[24:27], v[88:91]
    s_waitcnt lgkmcnt(2)
    v_mfma_f32_16x16x32_bf16 v[92:95], a[20:23], v[28:31], v[92:95]
    ds_read_b128 v[24:27], v2 offset:18432
    v_mfma_f32_16x16x32_bf16 v[96:99], a[24:27], v[28:31], v[96:99]
    v_mfma_f32_16x16x32_bf16 v[100:103], a[28:31], v[28:31], v[100:103]
    v_mfma_f32_16x16x32_bf16 v[104:107], a[32:35], v[28:31], v[104:107]
    v_mfma_f32_16x16x32_bf16 v[108:111], a[36:39], v[28:31], v[108:111]
    s_waitcnt vmcnt(53) lgkmcnt(2)
    v_mfma_f32_16x16x32_bf16 a[192:195], a[40:43], v[16:19], a[192:195]
    ds_read_b128 v[28:31], v2 offset:19456
    v_mfma_f32_16x16x32_bf16 a[196:199], a[44:47], v[16:19], a[196:199]
    v_mfma_f32_16x16x32_bf16 a[200:203], a[48:51], v[16:19], a[200:203]
    buffer_load_dwordx4 v2, s[12:15], s33 offen offset:0 sc1 lds
    v_mfma_f32_16x16x32_bf16 a[204:207], a[52:55], v[16:19], a[204:207]
    buffer_load_dwordx4 v2, s[12:15], s33 offen offset:1024 sc1 lds
    v_mfma_f32_16x16x32_bf16 v[112:115], a[56:59], v[16:19], v[112:115]
    s_waitcnt lgkmcnt(2)
    v_mfma_f32_16x16x32_bf16 a[208:211], a[40:43], v[20:23], a[208:211]
    ds_read_b128 v[16:19], v2 offset:20480
    v_mfma_f32_16x16x32_bf16 a[212:215], a[44:47], v[20:23], a[212:215]
    v_mfma_f32_16x16x32_bf16 a[216:219], a[48:51], v[20:23], a[216:219]
    buffer_load_dwordx4 v2, s[12:15], s33 offen offset:2048 sc1 lds
    v_mfma_f32_16x16x32_bf16 a[220:223], a[52:55], v[20:23], a[220:223]
    buffer_load_dwordx4 v2, s[12:15], s33 offen offset:3072 sc1 lds
    v_mfma_f32_16x16x32_bf16 v[116:119], a[56:59], v[20:23], v[116:119]
    s_add_u32 s35, s35, 16384
    s_waitcnt lgkmcnt(2)
    v_mfma_f32_16x16x32_bf16 a[224:227], a[40:43], v[24:27], a[224:227]
    ds_read_b128 v[20:23], v2 offset:21504
    s_add_u32 s33, s33, 8192
    v_mfma_f32_16x16x32_bf16 a[228:231], a[44:47], v[24:27], a[228:231]
    s_mov_b32 m0, s35
    v_mfma_f32_16x16x32_bf16 a[232:235], a[48:51], v[24:27], a[232:235]
    buffer_load_dwordx4 v2, s[12:15], s33 offen offset:0 sc1 lds
    v_mfma_f32_16x16x32_bf16 a[236:239], a[52:55], v[24:27], a[236:239]
    buffer_load_dwordx4 v2, s[12:15], s33 offen offset:1024 sc1 lds
    v_mfma_f32_16x16x32_bf16 v[120:123], a[56:59], v[24:27], v[120:123]
    s_waitcnt lgkmcnt(2)
    v_mfma_f32_16x16x32_bf16 a[240:243], a[40:43], v[28:31], a[240:243]
    ds_read_b128 v[24:27], v2 offset:22528
    v_mfma_f32_16x16x32_bf16 a[244:247], a[44:47], v[28:31], a[244:247]
    v_mfma_f32_16x16x32_bf16 a[248:251], a[48:51], v[28:31], a[248:251]
    v_mfma_f32_16x16x32_bf16 a[252:255], a[52:55], v[28:31], a[252:255]
    v_mfma_f32_16x16x32_bf16 v[124:127], a[56:59], v[28:31], v[124:127]
    s_waitcnt lgkmcnt(2)
    v_mfma_f32_16x16x32_bf16 v[32:35], a[40:43], v[16:19], v[32:35]
    ds_read_b128 v[28:31], v2 offset:23552
    v_mfma_f32_16x16x32_bf16 v[36:39], a[44:47], v[16:19], v[36:39]
    v_mfma_f32_16x16x32_bf16 v[40:43], a[48:51], v[16:19], v[40:43]
    v_mfma_f32_16x16x32_bf16 v[44:47], a[52:55], v[16:19], v[44:47]
    v_mfma_f32_16x16x32_bf16 v[48:51], a[56:59], v[16:19], v[48:51]
    s_waitcnt lgkmcnt(2)
    v_mfma_f32_16x16x32_bf16 v[52:55], a[40:43], v[20:23], v[52:55]
    ds_read_b128 v[16:19], v2 offset:24576
    v_mfma_f32_16x16x32_bf16 v[56:59], a[44:47], v[20:23], v[56:59]
    v_mfma_f32_16x16x32_bf16 v[60:63], a[48:51], v[20:23], v[60:63]
    v_mfma_f32_16x16x32_bf16 v[64:67], a[52:55], v[20:23], v[64:67]
    v_mfma_f32_16x16x32_bf16 v[68:71], a[56:59], v[20:23], v[68:71]
    s_waitcnt lgkmcnt(2)
    v_mfma_f32_16x16x32_bf16 v[72:75], a[40:43], v[24:27], v[72:75]
    ds_read_b128 v[20:23], v2 offset:25600
    v_mfma_f32_16x16x32_bf16 v[76:79], a[44:47], v[24:27], v[76:79]
    v_mfma_f32_16x16x32_bf16 v[80:83], a[48:51], v[24:27], v[80:83]
    v_mfma_f32_16x16x32_bf16 v[84:87], a[52:55], v[24:27], v[84:87]
    v_mfma_f32_16x16x32_bf16 v[88:91], a[56:59], v[24:27], v[88:91]
    s_waitcnt lgkmcnt(2)
    v_mfma_f32_16x16x32_bf16 v[92:95], a[40:43], v[28:31], v[92:95]
    ds_read_b128 v[24:27], v2 offset:26624
    v_mfma_f32_16x16x32_bf16 v[96:99], a[44:47], v[28:31], v[96:99]
    v_mfma_f32_16x16x32_bf16 v[100:103], a[48:51], v[28:31], v[100:103]
    v_mfma_f32_16x16x32_bf16 v[104:107], a[52:55], v[28:31], v[104:107]
    v_mfma_f32_16x16x32_bf16 v[108:111], a[56:59], v[28:31], v[108:111]
    s_waitcnt vmcnt(18)
    s_barrier
    s_waitcnt vmcnt(54) lgkmcnt(2)
    v_mfma_f32_16x16x32_bf16 a[192:195], a[60:63], v[16:19], a[192:195]
    ds_read_b128 v[28:31], v2 offset:27648
    v_mfma_f32_16x16x32_bf16 a[196:199], a[64:67], v[16:19], a[196:199]
    v_mfma_f32_16x16x32_bf16 a[200:203], a[68:71], v[16:19], a[200:203]
    buffer_load_dwordx4 v2, s[12:15], s33 offen offset:2048 sc1 lds
    v_mfma_f32_16x16x32_bf16 a[204:207], a[72:75], v[16:19], a[204:207]
    buffer_load_dwordx4 v2, s[12:15], s33 offen offset:3072 sc1 lds
    v_mfma_f32_16x16x32_bf16 v[112:115], a[76:79], v[16:19], v[112:115]
    s_add_u32 s35, s35, 16384
    s_waitcnt lgkmcnt(2)
    v_mfma_f32_16x16x32_bf16 a[208:211], a[60:63], v[20:23], a[208:211]
    ds_read_b128 v[16:19], v2 offset:28672
    s_add_u32 s33, s33, 8192
    v_mfma_f32_16x16x32_bf16 a[212:215], a[64:67], v[20:23], a[212:215]
    v_mfma_f32_16x16x32_bf16 a[216:219], a[68:71], v[20:23], a[216:219]
    v_mfma_f32_16x16x32_bf16 a[220:223], a[72:75], v[20:23], a[220:223]
    v_mfma_f32_16x16x32_bf16 v[116:119], a[76:79], v[20:23], v[116:119]
    s_waitcnt lgkmcnt(2)
    v_mfma_f32_16x16x32_bf16 a[224:227], a[60:63], v[24:27], a[224:227]
    ds_read_b128 v[20:23], v2 offset:29696
    v_mfma_f32_16x16x32_bf16 a[228:231], a[64:67], v[24:27], a[228:231]
    v_mfma_f32_16x16x32_bf16 a[232:235], a[68:71], v[24:27], a[232:235]
    v_mfma_f32_16x16x32_bf16 a[236:239], a[72:75], v[24:27], a[236:239]
    v_mfma_f32_16x16x32_bf16 v[120:123], a[76:79], v[24:27], v[120:123]
    s_waitcnt lgkmcnt(2)
    v_mfma_f32_16x16x32_bf16 a[240:243], a[60:63], v[28:31], a[240:243]
    ds_read_b128 v[24:27], v2 offset:30720
    v_mfma_f32_16x16x32_bf16 a[244:247], a[64:67], v[28:31], a[244:247]
    v_mfma_f32_16x16x32_bf16 a[248:251], a[68:71], v[28:31], a[248:251]
    v_mfma_f32_16x16x32_bf16 a[252:255], a[72:75], v[28:31], a[252:255]
    v_mfma_f32_16x16x32_bf16 v[124:127], a[76:79], v[28:31], v[124:127]
    s_waitcnt lgkmcnt(2)
    v_mfma_f32_16x16x32_bf16 v[32:35], a[60:63], v[16:19], v[32:35]
    ds_read_b128 v[28:31], v2 offset:31744
    v_mfma_f32_16x16x32_bf16 v[36:39], a[64:67], v[16:19], v[36:39]
    v_mfma_f32_16x16x32_bf16 v[40:43], a[68:71], v[16:19], v[40:43]
    v_mfma_f32_16x16x32_bf16 v[44:47], a[72:75], v[16:19], v[44:47]
    v_mfma_f32_16x16x32_bf16 v[48:51], a[76:79], v[16:19], v[48:51]
    s_waitcnt lgkmcnt(2)
    v_mfma_f32_16x16x32_bf16 v[52:55], a[60:63], v[20:23], v[52:55]
    ds_read_b128 v[16:19], v2 offset:32768
    v_mfma_f32_16x16x32_bf16 v[56:59], a[64:67], v[20:23], v[56:59]
    v_mfma_f32_16x16x32_bf16 v[60:63], a[68:71], v[20:23], v[60:63]
    v_mfma_f32_16x16x32_bf16 v[64:67], a[72:75], v[20:23], v[64:67]
    v_mfma_f32_16x16x32_bf16 v[68:71], a[76:79], v[20:23], v[68:71]
    s_waitcnt lgkmcnt(2)
    v_mfma_f32_16x16x32_bf16 v[72:75], a[60:63], v[24:27], v[72:75]
    ds_read_b128 v[20:23], v2 offset:33792
    v_mfma_f32_16x16x32_bf16 v[76:79], a[64:67], v[24:27], v[76:79]
    v_mfma_f32_16x16x32_bf16 v[80:83], a[68:71], v[24:27], v[80:83]
    v_mfma_f32_16x16x32_bf16 v[84:87], a[72:75], v[24:27], v[84:87]
    v_mfma_f32_16x16x32_bf16 v[88:91], a[76:79], v[24:27], v[88:91]
    s_waitcnt lgkmcnt(2)
    v_mfma_f32_16x16x32_bf16 v[92:95], a[60:63], v[28:31], v[92:95]
    ds_read_b128 v[24:27], v2 offset:34816
    v_mfma_f32_16x16x32_bf16 v[96:99], a[64:67], v[28:31], v[96:99]
    v_mfma_f32_16x16x32_bf16 v[100:103], a[68:71], v[28:31], v[100:103]
    v_mfma_f32_16x16x32_bf16 v[104:107], a[72:75], v[28:31], v[104:107]
    v_mfma_f32_16x16x32_bf16 v[108:111], a[76:79], v[28:31], v[108:111]
    s_waitcnt vmcnt(51) lgkmcnt(2)
    v_mfma_f32_16x16x32_bf16 a[192:195], a[80:83], v[16:19], a[192:195]
    ds_read_b128 v[28:31], v2 offset:35840
    v_mfma_f32_16x16x32_bf16 a[196:199], a[84:87], v[16:19], a[196:199]
    v_mfma_f32_16x16x32_bf16 a[200:203], a[88:91], v[16:19], a[200:203]
    v_mfma_f32_16x16x32_bf16 a[204:207], a[92:95], v[16:19], a[204:207]
    v_mfma_f32_16x16x32_bf16 v[112:115], a[96:99], v[16:19], v[112:115]
    s_waitcnt lgkmcnt(2)
    v_mfma_f32_16x16x32_bf16 a[208:211], a[80:83], v[20:23], a[208:211]
    ds_read_b128 v[16:19], v2 offset:36864
    v_mfma_f32_16x16x32_bf16 a[212:215], a[84:87], v[20:23], a[212:215]
    v_mfma_f32_16x16x32_bf16 a[216:219], a[88:91], v[20:23], a[216:219]
    v_mfma_f32_16x16x32_bf16 a[220:223], a[92:95], v[20:23], a[220:223]
    v_mfma_f32_16x16x32_bf16 v[116:119], a[96:99], v[20:23], v[116:119]
    s_waitcnt lgkmcnt(2)
    v_mfma_f32_16x16x32_bf16 a[224:227], a[80:83], v[24:27], a[224:227]
    ds_read_b128 v[20:23], v2 offset:37888
    v_mfma_f32_16x16x32_bf16 a[228:231], a[84:87], v[24:27], a[228:231]
    v_mfma_f32_16x16x32_bf16 a[232:235], a[88:91], v[24:27], a[232:235]
    v_mfma_f32_16x16x32_bf16 a[236:239], a[92:95], v[24:27], a[236:239]
    v_mfma_f32_16x16x32_bf16 v[120:123], a[96:99], v[24:27], v[120:123]
    s_waitcnt lgkmcnt(2)
    v_mfma_f32_16x16x32_bf16 a[240:243], a[80:83], v[28:31], a[240:243]
    ds_read_b128 v[24:27], v2 offset:38912
    v_mfma_f32_16x16x32_bf16 a[244:247], a[84:87], v[28:31], a[244:247]
    v_mfma_f32_16x16x32_bf16 a[248:251], a[88:91], v[28:31], a[248:251]
    v_mfma_f32_16x16x32_bf16 a[252:255], a[92:95], v[28:31], a[252:255]
    v_mfma_f32_16x16x32_bf16 v[124:127], a[96:99], v[28:31], v[124:127]
    s_waitcnt lgkmcnt(2)
    v_mfma_f32_16x16x32_bf16 v[32:35], a[80:83], v[16:19], v[32:35]
    ds_read_b128 v[28:31], v2 offset:39936
    v_mfma_f32_16x16x32_bf16 v[36:39], a[84:87], v[16:19], v[36:39]
    v_mfma_f32_16x16x32_bf16 v[40:43], a[88:91], v[16:19], v[40:43]
    v_mfma_f32_16x16x32_bf16 v[44:47], a[92:95], v[16:19], v[44:47]
    v_mfma_f32_16x16x32_bf16 v[48:51], a[96:99], v[16:19], v[48:51]
    s_waitcnt lgkmcnt(2)
    v_mfma_f32_16x16x32_bf16 v[52:55], a[80:83], v[20:23], v[52:55]
    ds_read_b128 v[16:19], v2 offset:40960
    v_mfma_f32_16x16x32_bf16 v[56:59], a[84:87], v[20:23], v[56:59]
    v_mfma_f32_16x16x32_bf16 v[60:63], a[88:91], v[20:23], v[60:63]
    v_mfma_f32_16x16x32_bf16 v[64:67], a[92:95], v[20:23], v[64:67]
    v_mfma_f32_16x16x32_bf16 v[68:71], a[96:99], v[20:23], v[68:71]
    s_waitcnt lgkmcnt(2)
    v_mfma_f32_16x16x32_bf16 v[72:75], a[80:83], v[24:27], v[72:75]
    ds_read_b128 v[20:23], v2 offset:41984
    v_mfma_f32_16x16x32_bf16 v[76:79], a[84:87], v[24:27], v[76:79]
    v_mfma_f32_16x16x32_bf16 v[80:83], a[88:91], v[24:27], v[80:83]
    v_mfma_f32_16x16x32_bf16 v[84:87], a[92:95], v[24:27], v[84:87]
    v_mfma_f32_16x16x32_bf16 v[88:91], a[96:99], v[24:27], v[88:91]
    s_waitcnt lgkmcnt(2)
    v_mfma_f32_16x16x32_bf16 v[92:95], a[80:83], v[28:31], v[92:95]
    ds_read_b128 v[24:27], v2 offset:43008
    v_mfma_f32_16x16x32_bf16 v[96:99], a[84:87], v[28:31], v[96:99]
    v_mfma_f32_16x16x32_bf16 v[100:103], a[88:91], v[28:31], v[100:103]
    v_mfma_f32_16x16x32_bf16 v[104:107], a[92:95], v[28:31], v[104:107]
    v_mfma_f32_16x16x32_bf16 v[108:111], a[96:99], v[28:31], v[108:111]
    s_waitcnt vmcnt(46) lgkmcnt(2)
    v_mfma_f32_16x16x32_bf16 a[192:195], a[100:103], v[16:19], a[192:195]
    ds_read_b128 v[28:31], v2 offset:44032
    v_mfma_f32_16x16x32_bf16 a[196:199], a[104:107], v[16:19], a[196:199]
    v_mfma_f32_16x16x32_bf16 a[200:203], a[108:111], v[16:19], a[200:203]
    buffer_load_dwordx4 a[160:163], v2, s[8:11], s40 offen offset:0 sc1
    v_mfma_f32_16x16x32_bf16 a[204:207], a[112:115], v[16:19], a[204:207]
    v_mfma_f32_16x16x32_bf16 v[112:115], a[116:119], v[16:19], v[112:115]
    s_waitcnt lgkmcnt(2)
    v_mfma_f32_16x16x32_bf16 a[208:211], a[100:103], v[20:23], a[208:211]
    ds_read_b128 v[16:19], v2 offset:45056
    v_mfma_f32_16x16x32_bf16 a[212:215], a[104:107], v[20:23], a[212:215]
    v_mfma_f32_16x16x32_bf16 a[216:219], a[108:111], v[20:23], a[216:219]
    buffer_load_dwordx4 a[164:167], v2, s[8:11], s40 offen offset:1024 sc1
    v_mfma_f32_16x16x32_bf16 a[220:223], a[112:115], v[20:23], a[220:223]
    v_mfma_f32_16x16x32_bf16 v[116:119], a[116:119], v[20:23], v[116:119]
    s_waitcnt lgkmcnt(2)
    v_mfma_f32_16x16x32_bf16 a[224:227], a[100:103], v[24:27], a[224:227]
    ds_read_b128 v[20:23], v2 offset:46080
    v_mfma_f32_16x16x32_bf16 a[228:231], a[104:107], v[24:27], a[228:231]
    v_mfma_f32_16x16x32_bf16 a[232:235], a[108:111], v[24:27], a[232:235]
    buffer_load_dwordx4 a[168:171], v2, s[8:11], s40 offen offset:2048 sc1
    v_mfma_f32_16x16x32_bf16 a[236:239], a[112:115], v[24:27], a[236:239]
    v_mfma_f32_16x16x32_bf16 v[120:123], a[116:119], v[24:27], v[120:123]
    s_waitcnt lgkmcnt(2)
    v_mfma_f32_16x16x32_bf16 a[240:243], a[100:103], v[28:31], a[240:243]
    ds_read_b128 v[24:27], v2 offset:47104
    v_mfma_f32_16x16x32_bf16 a[244:247], a[104:107], v[28:31], a[244:247]
    v_mfma_f32_16x16x32_bf16 a[248:251], a[108:111], v[28:31], a[248:251]
    buffer_load_dwordx4 a[172:175], v2, s[8:11], s40 offen offset:3072 sc1
    v_mfma_f32_16x16x32_bf16 a[252:255], a[112:115], v[28:31], a[252:255]
    s_add_u32 s40, s40, 4096
    v_mfma_f32_16x16x32_bf16 v[124:127], a[116:119], v[28:31], v[124:127]
    s_waitcnt lgkmcnt(2)
    v_mfma_f32_16x16x32_bf16 v[32:35], a[100:103], v[16:19], v[32:35]
    ds_read_b128 v[28:31], v2 offset:48128
    v_mfma_f32_16x16x32_bf16 v[36:39], a[104:107], v[16:19], v[36:39]
    v_mfma_f32_16x16x32_bf16 v[40:43], a[108:111], v[16:19], v[40:43]
    buffer_load_dwordx4 a[176:179], v2, s[8:11], s40 offen offset:0 sc1
    v_mfma_f32_16x16x32_bf16 v[44:47], a[112:115], v[16:19], v[44:47]
    v_mfma_f32_16x16x32_bf16 v[48:51], a[116:119], v[16:19], v[48:51]
    s_waitcnt lgkmcnt(2)
    v_mfma_f32_16x16x32_bf16 v[52:55], a[100:103], v[20:23], v[52:55]
    ds_read_b128 v[16:19], v2 offset:49152
    v_mfma_f32_16x16x32_bf16 v[56:59], a[104:107], v[20:23], v[56:59]
    v_mfma_f32_16x16x32_bf16 v[60:63], a[108:111], v[20:23], v[60:63]
    buffer_load_dwordx4 a[180:183], v2, s[8:11], s40 offen offset:1024 sc1
    v_mfma_f32_16x16x32_bf16 v[64:67], a[112:115], v[20:23], v[64:67]
    v_mfma_f32_16x16x32_bf16 v[68:71], a[116:119], v[20:23], v[68:71]
    s_waitcnt lgkmcnt(2)
    v_mfma_f32_16x16x32_bf16 v[72:75], a[100:103], v[24:27], v[72:75]
    ds_read_b128 v[20:23], v2 offset:50176
    v_mfma_f32_16x16x32_bf16 v[76:79], a[104:107], v[24:27], v[76:79]
    v_mfma_f32_16x16x32_bf16 v[80:83], a[108:111], v[24:27], v[80:83]
    buffer_load_dwordx4 a[184:187], v2, s[8:11], s40 offen offset:2048 sc1
    v_mfma_f32_16x16x32_bf16 v[84:87], a[112:115], v[24:27], v[84:87]
    v_mfma_f32_16x16x32_bf16 v[88:91], a[116:119], v[24:27], v[88:91]
    s_waitcnt lgkmcnt(2)
    v_mfma_f32_16x16x32_bf16 v[92:95], a[100:103], v[28:31], v[92:95]
    ds_read_b128 v[24:27], v2 offset:51200
    v_mfma_f32_16x16x32_bf16 v[96:99], a[104:107], v[28:31], v[96:99]
    v_mfma_f32_16x16x32_bf16 v[100:103], a[108:111], v[28:31], v[100:103]
    buffer_load_dwordx4 a[188:191], v2, s[8:11], s40 offen offset:3072 sc1
    v_mfma_f32_16x16x32_bf16 v[104:107], a[112:115], v[28:31], v[104:107]
    s_add_u32 s40, s40, 4096
    v_mfma_f32_16x16x32_bf16 v[108:111], a[116:119], v[28:31], v[108:111]
    s_waitcnt vmcnt(41) lgkmcnt(2)
    v_mfma_f32_16x16x32_bf16 a[192:195], a[120:123], v[16:19], a[192:195]
    ds_read_b128 v[28:31], v2 offset:52224
    v_mfma_f32_16x16x32_bf16 a[196:199], a[124:127], v[16:19], a[196:199]
    v_mfma_f32_16x16x32_bf16 a[200:203], a[128:131], v[16:19], a[200:203]
    buffer_load_dwordx4 a[0:3], v2, s[8:11], s40 offen offset:0 sc1
    v_mfma_f32_16x16x32_bf16 a[204:207], a[132:135], v[16:19], a[204:207]
    v_mfma_f32_16x16x32_bf16 v[112:115], a[136:139], v[16:19], v[112:115]
    s_waitcnt lgkmcnt(2)
    v_mfma_f32_16x16x32_bf16 a[208:211], a[120:123], v[20:23], a[208:211]
    ds_read_b128 v[16:19], v2 offset:53248
    v_mfma_f32_16x16x32_bf16 a[212:215], a[124:127], v[20:23], a[212:215]
    v_mfma_f32_16x16x32_bf16 a[216:219], a[128:131], v[20:23], a[216:219]
    buffer_load_dwordx4 a[4:7], v2, s[8:11], s40 offen offset:1024 sc1
    v_mfma_f32_16x16x32_bf16 a[220:223], a[132:135], v[20:23], a[220:223]
    v_mfma_f32_16x16x32_bf16 v[116:119], a[136:139], v[20:23], v[116:119]
    s_waitcnt lgkmcnt(2)
    v_mfma_f32_16x16x32_bf16 a[224:227], a[120:123], v[24:27], a[224:227]
    ds_read_b128 v[20:23], v2 offset:54272
    v_mfma_f32_16x16x32_bf16 a[228:231], a[124:127], v[24:27], a[228:231]
    v_mfma_f32_16x16x32_bf16 a[232:235], a[128:131], v[24:27], a[232:235]
    buffer_load_dwordx4 a[8:11], v2, s[8:11], s40 offen offset:2048 sc1
    v_mfma_f32_16x16x32_bf16 a[236:239], a[132:135], v[24:27], a[236:239]
    v_mfma_f32_16x16x32_bf16 v[120:123], a[136:139], v[24:27], v[120:123]
    s_waitcnt lgkmcnt(2)
    v_mfma_f32_16x16x32_bf16 a[240:243], a[120:123], v[28:31], a[240:243]
    ds_read_b128 v[24:27], v2 offset:55296
    v_mfma_f32_16x16x32_bf16 a[244:247], a[124:127], v[28:31], a[244:247]
    v_mfma_f32_16x16x32_bf16 a[248:251], a[128:131], v[28:31], a[248:251]
    buffer_load_dwordx4 a[12:15], v2, s[8:11], s40 offen offset:3072 sc1
    v_mfma_f32_16x16x32_bf16 a[252:255], a[132:135], v[28:31], a[252:255]
    s_add_u32 s40, s40, 4096
    v_mfma_f32_16x16x32_bf16 v[124:127], a[136:139], v[28:31], v[124:127]
    s_waitcnt lgkmcnt(2)
    v_mfma_f32_16x16x32_bf16 v[32:35], a[120:123], v[16:19], v[32:35]
    ds_read_b128 v[28:31], v2 offset:56320
    v_mfma_f32_16x16x32_bf16 v[36:39], a[124:127], v[16:19], v[36:39]
    v_mfma_f32_16x16x32_bf16 v[40:43], a[128:131], v[16:19], v[40:43]
    buffer_load_dwordx4 a[16:19], v2, s[8:11], s40 offen offset:0 sc1
    v_mfma_f32_16x16x32_bf16 v[44:47], a[132:135], v[16:19], v[44:47]
    v_mfma_f32_16x16x32_bf16 v[48:51], a[136:139], v[16:19], v[48:51]
    s_waitcnt lgkmcnt(2)
    v_mfma_f32_16x16x32_bf16 v[52:55], a[120:123], v[20:23], v[52:55]
    ds_read_b128 v[16:19], v2 offset:57344
    v_mfma_f32_16x16x32_bf16 v[56:59], a[124:127], v[20:23], v[56:59]
    v_mfma_f32_16x16x32_bf16 v[60:63], a[128:131], v[20:23], v[60:63]
    buffer_load_dwordx4 a[20:23], v2, s[8:11], s40 offen offset:1024 sc1
    v_mfma_f32_16x16x32_bf16 v[64:67], a[132:135], v[20:23], v[64:67]
    v_mfma_f32_16x16x32_bf16 v[68:71], a[136:139], v[20:23], v[68:71]
    s_waitcnt lgkmcnt(2)
    v_mfma_f32_16x16x32_bf16 v[72:75], a[120:123], v[24:27], v[72:75]
    ds_read_b128 v[20:23], v2 offset:58368
    v_mfma_f32_16x16x32_bf16 v[76:79], a[124:127], v[24:27], v[76:79]
    v_mfma_f32_16x16x32_bf16 v[80:83], a[128:131], v[24:27], v[80:83]
    buffer_load_dwordx4 a[24:27], v2, s[8:11], s40 offen offset:2048 sc1
    v_mfma_f32_16x16x32_bf16 v[84:87], a[132:135], v[24:27], v[84:87]
    v_mfma_f32_16x16x32_bf16 v[88:91], a[136:139], v[24:27], v[88:91]
    s_waitcnt lgkmcnt(2)
    v_mfma_f32_16x16x32_bf16 v[92:95], a[120:123], v[28:31], v[92:95]
    ds_read_b128 v[24:27], v2 offset:59392
    v_mfma_f32_16x16x32_bf16 v[96:99], a[124:127], v[28:31], v[96:99]
    v_mfma_f32_16x16x32_bf16 v[100:103], a[128:131], v[28:31], v[100:103]
    buffer_load_dwordx4 a[28:31], v2, s[8:11], s40 offen offset:3072 sc1
    v_mfma_f32_16x16x32_bf16 v[104:107], a[132:135], v[28:31], v[104:107]
    s_add_u32 s40, s40, 4096
    v_mfma_f32_16x16x32_bf16 v[108:111], a[136:139], v[28:31], v[108:111]
    s_waitcnt vmcnt(16)
    s_barrier
    s_waitcnt vmcnt(44) lgkmcnt(2)
    v_mfma_f32_16x16x32_bf16 a[192:195], a[140:143], v[16:19], a[192:195]
    ds_read_b128 v[28:31], v2 offset:60416
    v_mfma_f32_16x16x32_bf16 a[196:199], a[144:147], v[16:19], a[196:199]
    v_mfma_f32_16x16x32_bf16 a[200:203], a[148:151], v[16:19], a[200:203]
    buffer_load_dwordx4 a[32:35], v2, s[8:11], s40 offen offset:0 sc1
    v_mfma_f32_16x16x32_bf16 a[204:207], a[152:155], v[16:19], a[204:207]
    v_mfma_f32_16x16x32_bf16 v[112:115], a[156:159], v[16:19], v[112:115]
    s_waitcnt lgkmcnt(2)
    v_mfma_f32_16x16x32_bf16 a[208:211], a[140:143], v[20:23], a[208:211]
    ds_read_b128 v[16:19], v2 offset:61440
    v_mfma_f32_16x16x32_bf16 a[212:215], a[144:147], v[20:23], a[212:215]
    v_mfma_f32_16x16x32_bf16 a[216:219], a[148:151], v[20:23], a[216:219]
    buffer_load_dwordx4 a[36:39], v2, s[8:11], s40 offen offset:1024 sc1
    v_mfma_f32_16x16x32_bf16 a[220:223], a[152:155], v[20:23], a[220:223]
    v_mfma_f32_16x16x32_bf16 v[116:119], a[156:159], v[20:23], v[116:119]
    s_waitcnt lgkmcnt(2)
    v_mfma_f32_16x16x32_bf16 a[224:227], a[140:143], v[24:27], a[224:227]
    ds_read_b128 v[20:23], v2 offset:62464
    v_mfma_f32_16x16x32_bf16 a[228:231], a[144:147], v[24:27], a[228:231]
    v_mfma_f32_16x16x32_bf16 a[232:235], a[148:151], v[24:27], a[232:235]
    buffer_load_dwordx4 a[40:43], v2, s[8:11], s40 offen offset:2048 sc1
    v_mfma_f32_16x16x32_bf16 a[236:239], a[152:155], v[24:27], a[236:239]
    v_mfma_f32_16x16x32_bf16 v[120:123], a[156:159], v[24:27], v[120:123]
    s_waitcnt lgkmcnt(2)
    v_mfma_f32_16x16x32_bf16 a[240:243], a[140:143], v[28:31], a[240:243]
    ds_read_b128 v[24:27], v2 offset:63488
    v_mfma_f32_16x16x32_bf16 a[244:247], a[144:147], v[28:31], a[244:247]
    v_mfma_f32_16x16x32_bf16 a[248:251], a[148:151], v[28:31], a[248:251]
    buffer_load_dwordx4 a[44:47], v2, s[8:11], s40 offen offset:3072 sc1
    v_mfma_f32_16x16x32_bf16 a[252:255], a[152:155], v[28:31], a[252:255]
    s_add_u32 s40, s40, 4096
    v_mfma_f32_16x16x32_bf16 v[124:127], a[156:159], v[28:31], v[124:127]
    s_waitcnt lgkmcnt(2)
    v_mfma_f32_16x16x32_bf16 v[32:35], a[140:143], v[16:19], v[32:35]
    ds_read_b128 v[28:31], v2 offset:64512
    v_mfma_f32_16x16x32_bf16 v[36:39], a[144:147], v[16:19], v[36:39]
    v_mfma_f32_16x16x32_bf16 v[40:43], a[148:151], v[16:19], v[40:43]
    buffer_load_dwordx4 a[48:51], v2, s[8:11], s40 offen offset:0 sc1
    v_mfma_f32_16x16x32_bf16 v[44:47], a[152:155], v[16:19], v[44:47]
    v_mfma_f32_16x16x32_bf16 v[48:51], a[156:159], v[16:19], v[48:51]
    s_waitcnt lgkmcnt(2)
    v_mfma_f32_16x16x32_bf16 v[52:55], a[140:143], v[20:23], v[52:55]
    ds_read_b128 v[16:19], v3 offset:0
    v_mfma_f32_16x16x32_bf16 v[56:59], a[144:147], v[20:23], v[56:59]
    v_mfma_f32_16x16x32_bf16 v[60:63], a[148:151], v[20:23], v[60:63]
    buffer_load_dwordx4 a[52:55], v2, s[8:11], s40 offen offset:1024 sc1
    v_mfma_f32_16x16x32_bf16 v[64:67], a[152:155], v[20:23], v[64:67]
    v_mfma_f32_16x16x32_bf16 v[68:71], a[156:159], v[20:23], v[68:71]
    s_waitcnt lgkmcnt(2)
    v_mfma_f32_16x16x32_bf16 v[72:75], a[140:143], v[24:27], v[72:75]
    ds_read_b128 v[20:23], v3 offset:1024
    v_mfma_f32_16x16x32_bf16 v[76:79], a[144:147], v[24:27], v[76:79]
    v_mfma_f32_16x16x32_bf16 v[80:83], a[148:151], v[24:27], v[80:83]
    buffer_load_dwordx4 a[56:59], v2, s[8:11], s40 offen offset:2048 sc1
    v_mfma_f32_16x16x32_bf16 v[84:87], a[152:155], v[24:27], v[84:87]
    v_mfma_f32_16x16x32_bf16 v[88:91], a[156:159], v[24:27], v[88:91]
    s_waitcnt lgkmcnt(2)
    v_mfma_f32_16x16x32_bf16 v[92:95], a[140:143], v[28:31], v[92:95]
    ds_read_b128 v[24:27], v3 offset:2048
    v_mfma_f32_16x16x32_bf16 v[96:99], a[144:147], v[28:31], v[96:99]
    v_mfma_f32_16x16x32_bf16 v[100:103], a[148:151], v[28:31], v[100:103]
    buffer_load_dwordx4 a[60:63], v2, s[8:11], s40 offen offset:3072 sc1
    v_mfma_f32_16x16x32_bf16 v[104:107], a[152:155], v[28:31], v[104:107]
    s_add_u32 s40, s40, 4096
    v_mfma_f32_16x16x32_bf16 v[108:111], a[156:159], v[28:31], v[108:111]
    s_waitcnt vmcnt(19) lgkmcnt(2)
    v_mfma_f32_16x16x32_bf16 a[192:195], a[160:163], v[16:19], a[192:195]
    ds_read_b128 v[28:31], v3 offset:3072
    v_mfma_f32_16x16x32_bf16 a[196:199], a[164:167], v[16:19], a[196:199]
    v_mfma_f32_16x16x32_bf16 a[200:203], a[168:171], v[16:19], a[200:203]
    buffer_load_dwordx4 a[64:67], v2, s[8:11], s40 offen offset:0 sc1
    v_mfma_f32_16x16x32_bf16 a[204:207], a[172:175], v[16:19], a[204:207]
    v_mfma_f32_16x16x32_bf16 v[112:115], a[176:179], v[16:19], v[112:115]
    s_waitcnt lgkmcnt(2)
    v_mfma_f32_16x16x32_bf16 a[208:211], a[160:163], v[20:23], a[208:211]
    ds_read_b128 v[16:19], v3 offset:4096
    v_mfma_f32_16x16x32_bf16 a[212:215], a[164:167], v[20:23], a[212:215]
    v_mfma_f32_16x16x32_bf16 a[216:219], a[168:171], v[20:23], a[216:219]
    buffer_load_dwordx4 a[68:71], v2, s[8:11], s40 offen offset:1024 sc1
    v_mfma_f32_16x16x32_bf16 a[220:223], a[172:175], v[20:23], a[220:223]
    v_mfma_f32_16x16x32_bf16 v[116:119], a[176:179], v[20:23], v[116:119]
    s_waitcnt lgkmcnt(2)
    v_mfma_f32_16x16x32_bf16 a[224:227], a[160:163], v[24:27], a[224:227]
    ds_read_b128 v[20:23], v3 offset:5120
    v_mfma_f32_16x16x32_bf16 a[228:231], a[164:167], v[24:27], a[228:231]
    v_mfma_f32_16x16x32_bf16 a[232:235], a[168:171], v[24:27], a[232:235]
    buffer_load_dwordx4 a[72:75], v2, s[8:11], s40 offen offset:2048 sc1
    v_mfma_f32_16x16x32_bf16 a[236:239], a[172:175], v[24:27], a[236:239]
    v_mfma_f32_16x16x32_bf16 v[120:123], a[176:179], v[24:27], v[120:123]
    s_waitcnt lgkmcnt(2)
    v_mfma_f32_16x16x32_bf16 a[240:243], a[160:163], v[28:31], a[240:243]
    ds_read_b128 v[24:27], v3 offset:6144
    v_mfma_f32_16x16x32_bf16 a[244:247], a[164:167], v[28:31], a[244:247]
    v_mfma_f32_16x16x32_bf16 a[248:251], a[168:171], v[28:31], a[248:251]
    buffer_load_dwordx4 a[76:79], v2, s[8:11], s40 offen offset:3072 sc1
    v_mfma_f32_16x16x32_bf16 a[252:255], a[172:175], v[28:31], a[252:255]
    s_add_u32 s40, s40, 4096
    v_mfma_f32_16x16x32_bf16 v[124:127], a[176:179], v[28:31], v[124:127]
    s_waitcnt lgkmcnt(2)
    v_mfma_f32_16x16x32_bf16 v[32:35], a[160:163], v[16:19], v[32:35]
    ds_read_b128 v[28:31], v3 offset:7168
    v_mfma_f32_16x16x32_bf16 v[36:39], a[164:167], v[16:19], v[36:39]
    v_mfma_f32_16x16x32_bf16 v[40:43], a[168:171], v[16:19], v[40:43]
    buffer_load_dwordx4 a[80:83], v2, s[8:11], s40 offen offset:0 sc1
    v_mfma_f32_16x16x32_bf16 v[44:47], a[172:175], v[16:19], v[44:47]
    v_mfma_f32_16x16x32_bf16 v[48:51], a[176:179], v[16:19], v[48:51]
    s_waitcnt lgkmcnt(2)
    v_mfma_f32_16x16x32_bf16 v[52:55], a[160:163], v[20:23], v[52:55]
    ds_read_b128 v[16:19], v3 offset:8192
    v_mfma_f32_16x16x32_bf16 v[56:59], a[164:167], v[20:23], v[56:59]
    v_mfma_f32_16x16x32_bf16 v[60:63], a[168:171], v[20:23], v[60:63]
    buffer_load_dwordx4 a[84:87], v2, s[8:11], s40 offen offset:1024 sc1
    v_mfma_f32_16x16x32_bf16 v[64:67], a[172:175], v[20:23], v[64:67]
    v_mfma_f32_16x16x32_bf16 v[68:71], a[176:179], v[20:23], v[68:71]
    s_waitcnt lgkmcnt(2)
    v_mfma_f32_16x16x32_bf16 v[72:75], a[160:163], v[24:27], v[72:75]
    ds_read_b128 v[20:23], v3 offset:9216
    v_mfma_f32_16x16x32_bf16 v[76:79], a[164:167], v[24:27], v[76:79]
    v_mfma_f32_16x16x32_bf16 v[80:83], a[168:171], v[24:27], v[80:83]
    buffer_load_dwordx4 a[88:91], v2, s[8:11], s40 offen offset:2048 sc1
    v_mfma_f32_16x16x32_bf16 v[84:87], a[172:175], v[24:27], v[84:87]
    v_mfma_f32_16x16x32_bf16 v[88:91], a[176:179], v[24:27], v[88:91]
    s_waitcnt lgkmcnt(2)
    v_mfma_f32_16x16x32_bf16 v[92:95], a[160:163], v[28:31], v[92:95]
    ds_read_b128 v[24:27], v3 offset:10240
    v_mfma_f32_16x16x32_bf16 v[96:99], a[164:167], v[28:31], v[96:99]
    v_mfma_f32_16x16x32_bf16 v[100:103], a[168:171], v[28:31], v[100:103]
    buffer_load_dwordx4 a[92:95], v2, s[8:11], s40 offen offset:3072 sc1
    v_mfma_f32_16x16x32_bf16 v[104:107], a[172:175], v[28:31], v[104:107]
    s_add_u32 s40, s40, 4096
    v_mfma_f32_16x16x32_bf16 v[108:111], a[176:179], v[28:31], v[108:111]
    s_waitcnt vmcnt(22) lgkmcnt(2)
    v_mfma_f32_16x16x32_bf16 a[192:195], a[180:183], v[16:19], a[192:195]
    ds_read_b128 v[28:31], v3 offset:11264
    v_mfma_f32_16x16x32_bf16 a[196:199], a[184:187], v[16:19], a[196:199]
    v_mfma_f32_16x16x32_bf16 a[200:203], a[188:191], v[16:19], a[200:203]
    buffer_load_dwordx4 a[96:99], v2, s[8:11], s40 offen offset:0 sc1
    v_mfma_f32_16x16x32_bf16 a[204:207], a[0:3], v[16:19], a[204:207]
    v_mfma_f32_16x16x32_bf16 v[112:115], a[4:7], v[16:19], v[112:115]
    s_waitcnt lgkmcnt(2)
    v_mfma_f32_16x16x32_bf16 a[208:211], a[180:183], v[20:23], a[208:211]
    ds_read_b128 v[16:19], v3 offset:12288
    v_mfma_f32_16x16x32_bf16 a[212:215], a[184:187], v[20:23], a[212:215]
    v_mfma_f32_16x16x32_bf16 a[216:219], a[188:191], v[20:23], a[216:219]
    buffer_load_dwordx4 a[100:103], v2, s[8:11], s40 offen offset:1024 sc1
    v_mfma_f32_16x16x32_bf16 a[220:223], a[0:3], v[20:23], a[220:223]
    v_mfma_f32_16x16x32_bf16 v[116:119], a[4:7], v[20:23], v[116:119]
    s_waitcnt lgkmcnt(2)
    v_mfma_f32_16x16x32_bf16 a[224:227], a[180:183], v[24:27], a[224:227]
    ds_read_b128 v[20:23], v3 offset:13312
    v_mfma_f32_16x16x32_bf16 a[228:231], a[184:187], v[24:27], a[228:231]
    v_mfma_f32_16x16x32_bf16 a[232:235], a[188:191], v[24:27], a[232:235]
    buffer_load_dwordx4 a[104:107], v2, s[8:11], s40 offen offset:2048 sc1
    v_mfma_f32_16x16x32_bf16 a[236:239], a[0:3], v[24:27], a[236:239]
    v_mfma_f32_16x16x32_bf16 v[120:123], a[4:7], v[24:27], v[120:123]
    s_waitcnt lgkmcnt(2)
    v_mfma_f32_16x16x32_bf16 a[240:243], a[180:183], v[28:31], a[240:243]
    ds_read_b128 v[24:27], v3 offset:14336
    v_mfma_f32_16x16x32_bf16 a[244:247], a[184:187], v[28:31], a[244:247]
    v_mfma_f32_16x16x32_bf16 a[248:251], a[188:191], v[28:31], a[248:251]
    buffer_load_dwordx4 a[108:111], v2, s[8:11], s40 offen offset:3072 sc1
    v_mfma_f32_16x16x32_bf16 a[252:255], a[0:3], v[28:31], a[252:255]
    s_add_u32 s40, s40, 4096
    v_mfma_f32_16x16x32_bf16 v[124:127], a[4:7], v[28:31], v[124:127]
    s_waitcnt lgkmcnt(2)
    v_mfma_f32_16x16x32_bf16 v[32:35], a[180:183], v[16:19], v[32:35]
    ds_read_b128 v[28:31], v3 offset:15360
    v_mfma_f32_16x16x32_bf16 v[36:39], a[184:187], v[16:19], v[36:39]
    v_mfma_f32_16x16x32_bf16 v[40:43], a[188:191], v[16:19], v[40:43]
    buffer_load_dwordx4 a[112:115], v2, s[8:11], s40 offen offset:0 sc1
    v_mfma_f32_16x16x32_bf16 v[44:47], a[0:3], v[16:19], v[44:47]
    v_mfma_f32_16x16x32_bf16 v[48:51], a[4:7], v[16:19], v[48:51]
    s_waitcnt lgkmcnt(2)
    v_mfma_f32_16x16x32_bf16 v[52:55], a[180:183], v[20:23], v[52:55]
    ds_read_b128 v[16:19], v3 offset:16384
    v_mfma_f32_16x16x32_bf16 v[56:59], a[184:187], v[20:23], v[56:59]
    v_mfma_f32_16x16x32_bf16 v[60:63], a[188:191], v[20:23], v[60:63]
    buffer_load_dwordx4 a[116:119], v2, s[8:11], s40 offen offset:1024 sc1
    v_mfma_f32_16x16x32_bf16 v[64:67], a[0:3], v[20:23], v[64:67]
    v_mfma_f32_16x16x32_bf16 v[68:71], a[4:7], v[20:23], v[68:71]
    s_waitcnt lgkmcnt(2)
    v_mfma_f32_16x16x32_bf16 v[72:75], a[180:183], v[24:27], v[72:75]
    ds_read_b128 v[20:23], v3 offset:17408
    v_mfma_f32_16x16x32_bf16 v[76:79], a[184:187], v[24:27], v[76:79]
    v_mfma_f32_16x16x32_bf16 v[80:83], a[188:191], v[24:27], v[80:83]
    buffer_load_dwordx4 a[120:123], v2, s[8:11], s40 offen offset:2048 sc1
    v_mfma_f32_16x16x32_bf16 v[84:87], a[0:3], v[24:27], v[84:87]
    v_mfma_f32_16x16x32_bf16 v[88:91], a[4:7], v[24:27], v[88:91]
    s_waitcnt lgkmcnt(2)
    v_mfma_f32_16x16x32_bf16 v[92:95], a[180:183], v[28:31], v[92:95]
    ds_read_b128 v[24:27], v3 offset:18432
    v_mfma_f32_16x16x32_bf16 v[96:99], a[184:187], v[28:31], v[96:99]
    v_mfma_f32_16x16x32_bf16 v[100:103], a[188:191], v[28:31], v[100:103]
    buffer_load_dwordx4 a[124:127], v2, s[8:11], s40 offen offset:3072 sc1
    v_mfma_f32_16x16x32_bf16 v[104:107], a[0:3], v[28:31], v[104:107]
    s_add_u32 s40, s40, 4096
    v_mfma_f32_16x16x32_bf16 v[108:111], a[4:7], v[28:31], v[108:111]
    s_waitcnt vmcnt(25) lgkmcnt(2)
    v_mfma_f32_16x16x32_bf16 a[192:195], a[8:11], v[16:19], a[192:195]
    ds_read_b128 v[28:31], v3 offset:19456
    v_mfma_f32_16x16x32_bf16 a[196:199], a[12:15], v[16:19], a[196:199]
    v_mfma_f32_16x16x32_bf16 a[200:203], a[16:19], v[16:19], a[200:203]
    buffer_load_dwordx4 a[128:131], v2, s[8:11], s40 offen offset:0 sc1
    v_mfma_f32_16x16x32_bf16 a[204:207], a[20:23], v[16:19], a[204:207]
    v_mfma_f32_16x16x32_bf16 v[112:115], a[24:27], v[16:19], v[112:115]
    s_waitcnt lgkmcnt(2)
    v_mfma_f32_16x16x32_bf16 a[208:211], a[8:11], v[20:23], a[208:211]
    ds_read_b128 v[16:19], v3 offset:20480
    v_mfma_f32_16x16x32_bf16 a[212:215], a[12:15], v[20:23], a[212:215]
    v_mfma_f32_16x16x32_bf16 a[216:219], a[16:19], v[20:23], a[216:219]
    buffer_load_dwordx4 a[132:135], v2, s[8:11], s40 offen offset:1024 sc1
    v_mfma_f32_16x16x32_bf16 a[220:223], a[20:23], v[20:23], a[220:223]
    v_mfma_f32_16x16x32_bf16 v[116:119], a[24:27], v[20:23], v[116:119]
    s_waitcnt lgkmcnt(2)
    v_mfma_f32_16x16x32_bf16 a[224:227], a[8:11], v[24:27], a[224:227]
    ds_read_b128 v[20:23], v3 offset:21504
    v_mfma_f32_16x16x32_bf16 a[228:231], a[12:15], v[24:27], a[228:231]
    v_mfma_f32_16x16x32_bf16 a[232:235], a[16:19], v[24:27], a[232:235]
    buffer_load_dwordx4 a[136:139], v2, s[8:11], s40 offen offset:2048 sc1
    v_mfma_f32_16x16x32_bf16 a[236:239], a[20:23], v[24:27], a[236:239]
    v_mfma_f32_16x16x32_bf16 v[120:123], a[24:27], v[24:27], v[120:123]
    s_waitcnt lgkmcnt(2)
    v_mfma_f32_16x16x32_bf16 a[240:243], a[8:11], v[28:31], a[240:243]
    ds_read_b128 v[24:27], v3 offset:22528
    v_mfma_f32_16x16x32_bf16 a[244:247], a[12:15], v[28:31], a[244:247]
    v_mfma_f32_16x16x32_bf16 a[248:251], a[16:19], v[28:31], a[248:251]
    buffer_load_dwordx4 a[140:143], v2, s[8:11], s40 offen offset:3072 sc1
    v_mfma_f32_16x16x32_bf16 a[252:255], a[20:23], v[28:31], a[252:255]
    s_add_u32 s40, s40, 4096
    v_mfma_f32_16x16x32_bf16 v[124:127], a[24:27], v[28:31], v[124:127]
    s_waitcnt lgkmcnt(2)
    v_mfma_f32_16x16x32_bf16 v[32:35], a[8:11], v[16:19], v[32:35]
    ds_read_b128 v[28:31], v3 offset:23552
    v_mfma_f32_16x16x32_bf16 v[36:39], a[12:15], v[16:19], v[36:39]
    v_mfma_f32_16x16x32_bf16 v[40:43], a[16:19], v[16:19], v[40:43]
    buffer_load_dwordx4 a[144:147], v2, s[8:11], s40 offen offset:0 sc1
    v_mfma_f32_16x16x32_bf16 v[44:47], a[20:23], v[16:19], v[44:47]
    v_mfma_f32_16x16x32_bf16 v[48:51], a[24:27], v[16:19], v[48:51]
    s_waitcnt lgkmcnt(2)
    v_mfma_f32_16x16x32_bf16 v[52:55], a[8:11], v[20:23], v[52:55]
    ds_read_b128 v[16:19], v3 offset:24576
    v_mfma_f32_16x16x32_bf16 v[56:59], a[12:15], v[20:23], v[56:59]
    v_mfma_f32_16x16x32_bf16 v[60:63], a[16:19], v[20:23], v[60:63]
    buffer_load_dwordx4 a[148:151], v2, s[8:11], s40 offen offset:1024 sc1
    v_mfma_f32_16x16x32_bf16 v[64:67], a[20:23], v[20:23], v[64:67]
    v_mfma_f32_16x16x32_bf16 v[68:71], a[24:27], v[20:23], v[68:71]
    s_waitcnt lgkmcnt(2)
    v_mfma_f32_16x16x32_bf16 v[72:75], a[8:11], v[24:27], v[72:75]
    ds_read_b128 v[20:23], v3 offset:25600
    v_mfma_f32_16x16x32_bf16 v[76:79], a[12:15], v[24:27], v[76:79]
    v_mfma_f32_16x16x32_bf16 v[80:83], a[16:19], v[24:27], v[80:83]
    buffer_load_dwordx4 a[152:155], v2, s[8:11], s40 offen offset:2048 sc1
    v_mfma_f32_16x16x32_bf16 v[84:87], a[20:23], v[24:27], v[84:87]
    v_mfma_f32_16x16x32_bf16 v[88:91], a[24:27], v[24:27], v[88:91]
    s_waitcnt lgkmcnt(2)
    v_mfma_f32_16x16x32_bf16 v[92:95], a[8:11], v[28:31], v[92:95]
    ds_read_b128 v[24:27], v3 offset:26624
    v_mfma_f32_16x16x32_bf16 v[96:99], a[12:15], v[28:31], v[96:99]
    v_mfma_f32_16x16x32_bf16 v[100:103], a[16:19], v[28:31], v[100:103]
    buffer_load_dwordx4 a[156:159], v2, s[8:11], s40 offen offset:3072 sc1
    v_mfma_f32_16x16x32_bf16 v[104:107], a[20:23], v[28:31], v[104:107]
    s_add_u32 s40, s40, 4096
    v_mfma_f32_16x16x32_bf16 v[108:111], a[24:27], v[28:31], v[108:111]
    s_waitcnt vmcnt(28) lgkmcnt(2)
    v_mfma_f32_16x16x32_bf16 a[192:195], a[28:31], v[16:19], a[192:195]
    ds_read_b128 v[28:31], v3 offset:27648
    v_mfma_f32_16x16x32_bf16 a[196:199], a[32:35], v[16:19], a[196:199]
    v_mfma_f32_16x16x32_bf16 a[200:203], a[36:39], v[16:19], a[200:203]
    buffer_load_dwordx4 a[160:163], v2, s[8:11], s40 offen offset:0 sc1
    v_mfma_f32_16x16x32_bf16 a[204:207], a[40:43], v[16:19], a[204:207]
    v_mfma_f32_16x16x32_bf16 v[112:115], a[44:47], v[16:19], v[112:115]
    s_waitcnt lgkmcnt(2)
    v_mfma_f32_16x16x32_bf16 a[208:211], a[28:31], v[20:23], a[208:211]
    ds_read_b128 v[16:19], v3 offset:28672
    v_mfma_f32_16x16x32_bf16 a[212:215], a[32:35], v[20:23], a[212:215]
    v_mfma_f32_16x16x32_bf16 a[216:219], a[36:39], v[20:23], a[216:219]
    buffer_load_dwordx4 a[164:167], v2, s[8:11], s40 offen offset:1024 sc1
    v_mfma_f32_16x16x32_bf16 a[220:223], a[40:43], v[20:23], a[220:223]
    v_mfma_f32_16x16x32_bf16 v[116:119], a[44:47], v[20:23], v[116:119]
    s_waitcnt lgkmcnt(2)
    v_mfma_f32_16x16x32_bf16 a[224:227], a[28:31], v[24:27], a[224:227]
    ds_read_b128 v[20:23], v3 offset:29696
    v_mfma_f32_16x16x32_bf16 a[228:231], a[32:35], v[24:27], a[228:231]
    v_mfma_f32_16x16x32_bf16 a[232:235], a[36:39], v[24:27], a[232:235]
    buffer_load_dwordx4 a[168:171], v2, s[8:11], s40 offen offset:2048 sc1
    v_mfma_f32_16x16x32_bf16 a[236:239], a[40:43], v[24:27], a[236:239]
    v_mfma_f32_16x16x32_bf16 v[120:123], a[44:47], v[24:27], v[120:123]
    s_waitcnt lgkmcnt(2)
    v_mfma_f32_16x16x32_bf16 a[240:243], a[28:31], v[28:31], a[240:243]
    ds_read_b128 v[24:27], v3 offset:30720
    v_mfma_f32_16x16x32_bf16 a[244:247], a[32:35], v[28:31], a[244:247]
    v_mfma_f32_16x16x32_bf16 a[248:251], a[36:39], v[28:31], a[248:251]
    buffer_load_dwordx4 a[172:175], v2, s[8:11], s40 offen offset:3072 sc1
    v_mfma_f32_16x16x32_bf16 a[252:255], a[40:43], v[28:31], a[252:255]
    s_add_u32 s40, s40, 4096
    v_mfma_f32_16x16x32_bf16 v[124:127], a[44:47], v[28:31], v[124:127]
    s_waitcnt lgkmcnt(2)
    v_mfma_f32_16x16x32_bf16 v[32:35], a[28:31], v[16:19], v[32:35]
    ds_read_b128 v[28:31], v3 offset:31744
    v_mfma_f32_16x16x32_bf16 v[36:39], a[32:35], v[16:19], v[36:39]
    v_mfma_f32_16x16x32_bf16 v[40:43], a[36:39], v[16:19], v[40:43]
    buffer_load_dwordx4 a[176:179], v2, s[8:11], s40 offen offset:0 sc1
    v_mfma_f32_16x16x32_bf16 v[44:47], a[40:43], v[16:19], v[44:47]
    v_mfma_f32_16x16x32_bf16 v[48:51], a[44:47], v[16:19], v[48:51]
    s_waitcnt lgkmcnt(2)
    v_mfma_f32_16x16x32_bf16 v[52:55], a[28:31], v[20:23], v[52:55]
    ds_read_b128 v[16:19], v3 offset:32768
    v_mfma_f32_16x16x32_bf16 v[56:59], a[32:35], v[20:23], v[56:59]
    v_mfma_f32_16x16x32_bf16 v[60:63], a[36:39], v[20:23], v[60:63]
    buffer_load_dwordx4 a[180:183], v2, s[8:11], s40 offen offset:1024 sc1
    v_mfma_f32_16x16x32_bf16 v[64:67], a[40:43], v[20:23], v[64:67]
    v_mfma_f32_16x16x32_bf16 v[68:71], a[44:47], v[20:23], v[68:71]
    s_waitcnt lgkmcnt(2)
    v_mfma_f32_16x16x32_bf16 v[72:75], a[28:31], v[24:27], v[72:75]
    ds_read_b128 v[20:23], v3 offset:33792
    v_mfma_f32_16x16x32_bf16 v[76:79], a[32:35], v[24:27], v[76:79]
    v_mfma_f32_16x16x32_bf16 v[80:83], a[36:39], v[24:27], v[80:83]
    buffer_load_dwordx4 a[184:187], v2, s[8:11], s40 offen offset:2048 sc1
    v_mfma_f32_16x16x32_bf16 v[84:87], a[40:43], v[24:27], v[84:87]
    v_mfma_f32_16x16x32_bf16 v[88:91], a[44:47], v[24:27], v[88:91]
    s_waitcnt lgkmcnt(2)
    v_mfma_f32_16x16x32_bf16 v[92:95], a[28:31], v[28:31], v[92:95]
    ds_read_b128 v[24:27], v3 offset:34816
    v_mfma_f32_16x16x32_bf16 v[96:99], a[32:35], v[28:31], v[96:99]
    v_mfma_f32_16x16x32_bf16 v[100:103], a[36:39], v[28:31], v[100:103]
    buffer_load_dwordx4 a[188:191], v2, s[8:11], s40 offen offset:3072 sc1
    v_mfma_f32_16x16x32_bf16 v[104:107], a[40:43], v[28:31], v[104:107]
    s_add_u32 s40, s40, 4096
    v_mfma_f32_16x16x32_bf16 v[108:111], a[44:47], v[28:31], v[108:111]
    s_waitcnt vmcnt(31) lgkmcnt(2)
    v_mfma_f32_16x16x32_bf16 a[192:195], a[48:51], v[16:19], a[192:195]
    ds_read_b128 v[28:31], v3 offset:35840
    v_mfma_f32_16x16x32_bf16 a[196:199], a[52:55], v[16:19], a[196:199]
    v_mfma_f32_16x16x32_bf16 a[200:203], a[56:59], v[16:19], a[200:203]
    buffer_load_dwordx4 a[0:3], v2, s[8:11], s40 offen offset:0 sc1
    v_mfma_f32_16x16x32_bf16 a[204:207], a[60:63], v[16:19], a[204:207]
    v_mfma_f32_16x16x32_bf16 v[112:115], a[64:67], v[16:19], v[112:115]
    s_waitcnt lgkmcnt(2)
    v_mfma_f32_16x16x32_bf16 a[208:211], a[48:51], v[20:23], a[208:211]
    ds_read_b128 v[16:19], v3 offset:36864
    v_mfma_f32_16x16x32_bf16 a[212:215], a[52:55], v[20:23], a[212:215]
    v_mfma_f32_16x16x32_bf16 a[216:219], a[56:59], v[20:23], a[216:219]
    buffer_load_dwordx4 a[4:7], v2, s[8:11], s40 offen offset:1024 sc1
    v_mfma_f32_16x16x32_bf16 a[220:223], a[60:63], v[20:23], a[220:223]
    v_mfma_f32_16x16x32_bf16 v[116:119], a[64:67], v[20:23], v[116:119]
    s_waitcnt lgkmcnt(2)
    v_mfma_f32_16x16x32_bf16 a[224:227], a[48:51], v[24:27], a[224:227]
    ds_read_b128 v[20:23], v3 offset:37888
    v_mfma_f32_16x16x32_bf16 a[228:231], a[52:55], v[24:27], a[228:231]
    v_mfma_f32_16x16x32_bf16 a[232:235], a[56:59], v[24:27], a[232:235]
    buffer_load_dwordx4 a[8:11], v2, s[8:11], s40 offen offset:2048 sc1
    v_mfma_f32_16x16x32_bf16 a[236:239], a[60:63], v[24:27], a[236:239]
    v_mfma_f32_16x16x32_bf16 v[120:123], a[64:67], v[24:27], v[120:123]
    s_waitcnt lgkmcnt(2)
    v_mfma_f32_16x16x32_bf16 a[240:243], a[48:51], v[28:31], a[240:243]
    ds_read_b128 v[24:27], v3 offset:38912
    v_mfma_f32_16x16x32_bf16 a[244:247], a[52:55], v[28:31], a[244:247]
    v_mfma_f32_16x16x32_bf16 a[248:251], a[56:59], v[28:31], a[248:251]
    buffer_load_dwordx4 a[12:15], v2, s[8:11], s40 offen offset:3072 sc1
    v_mfma_f32_16x16x32_bf16 a[252:255], a[60:63], v[28:31], a[252:255]
    s_add_u32 s40, s40, 4096
    v_mfma_f32_16x16x32_bf16 v[124:127], a[64:67], v[28:31], v[124:127]
    s_waitcnt lgkmcnt(2)
    v_mfma_f32_16x16x32_bf16 v[32:35], a[48:51], v[16:19], v[32:35]
    ds_read_b128 v[28:31], v3 offset:39936
    v_mfma_f32_16x16x32_bf16 v[36:39], a[52:55], v[16:19], v[36:39]
    v_mfma_f32_16x16x32_bf16 v[40:43], a[56:59], v[16:19], v[40:43]
    buffer_load_dwordx4 a[16:19], v2, s[8:11], s40 offen offset:0 sc1
    v_mfma_f32_16x16x32_bf16 v[44:47], a[60:63], v[16:19], v[44:47]
    v_mfma_f32_16x16x32_bf16 v[48:51], a[64:67], v[16:19], v[48:51]
    s_waitcnt lgkmcnt(2)
    v_mfma_f32_16x16x32_bf16 v[52:55], a[48:51], v[20:23], v[52:55]
    ds_read_b128 v[16:19], v3 offset:40960
    v_mfma_f32_16x16x32_bf16 v[56:59], a[52:55], v[20:23], v[56:59]
    v_mfma_f32_16x16x32_bf16 v[60:63], a[56:59], v[20:23], v[60:63]
    buffer_load_dwordx4 a[20:23], v2, s[8:11], s40 offen offset:1024 sc1
    v_mfma_f32_16x16x32_bf16 v[64:67], a[60:63], v[20:23], v[64:67]
    v_mfma_f32_16x16x32_bf16 v[68:71], a[64:67], v[20:23], v[68:71]
    s_waitcnt lgkmcnt(2)
    v_mfma_f32_16x16x32_bf16 v[72:75], a[48:51], v[24:27], v[72:75]
    ds_read_b128 v[20:23], v3 offset:41984
    v_mfma_f32_16x16x32_bf16 v[76:79], a[52:55], v[24:27], v[76:79]
    v_mfma_f32_16x16x32_bf16 v[80:83], a[56:59], v[24:27], v[80:83]
    buffer_load_dwordx4 a[24:27], v2, s[8:11], s40 offen offset:2048 sc1
    v_mfma_f32_16x16x32_bf16 v[84:87], a[60:63], v[24:27], v[84:87]
    v_mfma_f32_16x16x32_bf16 v[88:91], a[64:67], v[24:27], v[88:91]
    s_waitcnt lgkmcnt(2)
    v_mfma_f32_16x16x32_bf16 v[92:95], a[48:51], v[28:31], v[92:95]
    ds_read_b128 v[24:27], v3 offset:43008
    v_mfma_f32_16x16x32_bf16 v[96:99], a[52:55], v[28:31], v[96:99]
    v_mfma_f32_16x16x32_bf16 v[100:103], a[56:59], v[28:31], v[100:103]
    buffer_load_dwordx4 a[28:31], v2, s[8:11], s40 offen offset:3072 sc1
    v_mfma_f32_16x16x32_bf16 v[104:107], a[60:63], v[28:31], v[104:107]
    s_add_u32 s40, s40, 4096
    v_mfma_f32_16x16x32_bf16 v[108:111], a[64:67], v[28:31], v[108:111]
    s_waitcnt vmcnt(34) lgkmcnt(2)
    v_mfma_f32_16x16x32_bf16 a[192:195], a[68:71], v[16:19], a[192:195]
    ds_read_b128 v[28:31], v3 offset:44032
    v_mfma_f32_16x16x32_bf16 a[196:199], a[72:75], v[16:19], a[196:199]
    v_mfma_f32_16x16x32_bf16 a[200:203], a[76:79], v[16:19], a[200:203]
    buffer_load_dwordx4 a[32:35], v2, s[8:11], s40 offen offset:0 sc1
    v_mfma_f32_16x16x32_bf16 a[204:207], a[80:83], v[16:19], a[204:207]
    v_mfma_f32_16x16x32_bf16 v[112:115], a[84:87], v[16:19], v[112:115]
    s_waitcnt lgkmcnt(2)
    v_mfma_f32_16x16x32_bf16 a[208:211], a[68:71], v[20:23], a[208:211]
    ds_read_b128 v[16:19], v3 offset:45056
    v_mfma_f32_16x16x32_bf16 a[212:215], a[72:75], v[20:23], a[212:215]
    v_mfma_f32_16x16x32_bf16 a[216:219], a[76:79], v[20:23], a[216:219]
    buffer_load_dwordx4 a[36:39], v2, s[8:11], s40 offen offset:1024 sc1
    v_mfma_f32_16x16x32_bf16 a[220:223], a[80:83], v[20:23], a[220:223]
    v_mfma_f32_16x16x32_bf16 v[116:119], a[84:87], v[20:23], v[116:119]
    s_waitcnt lgkmcnt(2)
    v_mfma_f32_16x16x32_bf16 a[224:227], a[68:71], v[24:27], a[224:227]
    ds_read_b128 v[20:23], v3 offset:46080
    v_mfma_f32_16x16x32_bf16 a[228:231], a[72:75], v[24:27], a[228:231]
    v_mfma_f32_16x16x32_bf16 a[232:235], a[76:79], v[24:27], a[232:235]
    buffer_load_dwordx4 a[40:43], v2, s[8:11], s40 offen offset:2048 sc1
    v_mfma_f32_16x16x32_bf16 a[236:239], a[80:83], v[24:27], a[236:239]
    v_mfma_f32_16x16x32_bf16 v[120:123], a[84:87], v[24:27], v[120:123]
    s_waitcnt lgkmcnt(2)
    v_mfma_f32_16x16x32_bf16 a[240:243], a[68:71], v[28:31], a[240:243]
    ds_read_b128 v[24:27], v3 offset:47104
    v_mfma_f32_16x16x32_bf16 a[244:247], a[72:75], v[28:31], a[244:247]
    v_mfma_f32_16x16x32_bf16 a[248:251], a[76:79], v[28:31], a[248:251]
    buffer_load_dwordx4 a[44:47], v2, s[8:11], s40 offen offset:3072 sc1
    v_mfma_f32_16x16x32_bf16 a[252:255], a[80:83], v[28:31], a[252:255]
    s_add_u32 s40, s40, 4096
    v_mfma_f32_16x16x32_bf16 v[124:127], a[84:87], v[28:31], v[124:127]
    s_waitcnt lgkmcnt(2)
    v_mfma_f32_16x16x32_bf16 v[32:35], a[68:71], v[16:19], v[32:35]
    ds_read_b128 v[28:31], v3 offset:48128
    v_mfma_f32_16x16x32_bf16 v[36:39], a[72:75], v[16:19], v[36:39]
    v_mfma_f32_16x16x32_bf16 v[40:43], a[76:79], v[16:19], v[40:43]
    buffer_load_dwordx4 a[48:51], v2, s[8:11], s40 offen offset:0 sc1
    v_mfma_f32_16x16x32_bf16 v[44:47], a[80:83], v[16:19], v[44:47]
    v_mfma_f32_16x16x32_bf16 v[48:51], a[84:87], v[16:19], v[48:51]
    s_waitcnt lgkmcnt(2)
    v_mfma_f32_16x16x32_bf16 v[52:55], a[68:71], v[20:23], v[52:55]
    ds_read_b128 v[16:19], v3 offset:49152
    v_mfma_f32_16x16x32_bf16 v[56:59], a[72:75], v[20:23], v[56:59]
    v_mfma_f32_16x16x32_bf16 v[60:63], a[76:79], v[20:23], v[60:63]
    buffer_load_dwordx4 a[52:55], v2, s[8:11], s40 offen offset:1024 sc1
    v_mfma_f32_16x16x32_bf16 v[64:67], a[80:83], v[20:23], v[64:67]
    v_mfma_f32_16x16x32_bf16 v[68:71], a[84:87], v[20:23], v[68:71]
    s_waitcnt lgkmcnt(2)
    v_mfma_f32_16x16x32_bf16 v[72:75], a[68:71], v[24:27], v[72:75]
    ds_read_b128 v[20:23], v3 offset:50176
    v_mfma_f32_16x16x32_bf16 v[76:79], a[72:75], v[24:27], v[76:79]
    v_mfma_f32_16x16x32_bf16 v[80:83], a[76:79], v[24:27], v[80:83]
    buffer_load_dwordx4 a[56:59], v2, s[8:11], s40 offen offset:2048 sc1
    v_mfma_f32_16x16x32_bf16 v[84:87], a[80:83], v[24:27], v[84:87]
    v_mfma_f32_16x16x32_bf16 v[88:91], a[84:87], v[24:27], v[88:91]
    s_waitcnt lgkmcnt(2)
    v_mfma_f32_16x16x32_bf16 v[92:95], a[68:71], v[28:31], v[92:95]
    ds_read_b128 v[24:27], v3 offset:51200
    v_mfma_f32_16x16x32_bf16 v[96:99], a[72:75], v[28:31], v[96:99]
    v_mfma_f32_16x16x32_bf16 v[100:103], a[76:79], v[28:31], v[100:103]
    buffer_load_dwordx4 a[60:63], v2, s[8:11], s40 offen offset:3072 sc1
    v_mfma_f32_16x16x32_bf16 v[104:107], a[80:83], v[28:31], v[104:107]
    s_add_u32 s40, s40, 4096
    v_mfma_f32_16x16x32_bf16 v[108:111], a[84:87], v[28:31], v[108:111]
    s_waitcnt vmcnt(37) lgkmcnt(2)
    v_mfma_f32_16x16x32_bf16 a[192:195], a[88:91], v[16:19], a[192:195]
    ds_read_b128 v[28:31], v3 offset:52224
    v_mfma_f32_16x16x32_bf16 a[196:199], a[92:95], v[16:19], a[196:199]
    v_mfma_f32_16x16x32_bf16 a[200:203], a[96:99], v[16:19], a[200:203]
    buffer_load_dwordx4 a[64:67], v2, s[8:11], s40 offen offset:0 sc1
    v_mfma_f32_16x16x32_bf16 a[204:207], a[100:103], v[16:19], a[204:207]
    v_mfma_f32_16x16x32_bf16 v[112:115], a[104:107], v[16:19], v[112:115]
    s_waitcnt lgkmcnt(2)
    v_mfma_f32_16x16x32_bf16 a[208:211], a[88:91], v[20:23], a[208:211]
    ds_read_b128 v[16:19], v3 offset:53248
    v_mfma_f32_16x16x32_bf16 a[212:215], a[92:95], v[20:23], a[212:215]
    v_mfma_f32_16x16x32_bf16 a[216:219], a[96:99], v[20:23], a[216:219]
    buffer_load_dwordx4 a[68:71], v2, s[8:11], s40 offen offset:1024 sc1
    v_mfma_f32_16x16x32_bf16 a[220:223], a[100:103], v[20:23], a[220:223]
    v_mfma_f32_16x16x32_bf16 v[116:119], a[104:107], v[20:23], v[116:119]
    s_waitcnt lgkmcnt(2)
    v_mfma_f32_16x16x32_bf16 a[224:227], a[88:91], v[24:27], a[224:227]
    ds_read_b128 v[20:23], v3 offset:54272
    v_mfma_f32_16x16x32_bf16 a[228:231], a[92:95], v[24:27], a[228:231]
    v_mfma_f32_16x16x32_bf16 a[232:235], a[96:99], v[24:27], a[232:235]
    buffer_load_dwordx4 a[72:75], v2, s[8:11], s40 offen offset:2048 sc1
    v_mfma_f32_16x16x32_bf16 a[236:239], a[100:103], v[24:27], a[236:239]
    v_mfma_f32_16x16x32_bf16 v[120:123], a[104:107], v[24:27], v[120:123]
    s_waitcnt lgkmcnt(2)
    v_mfma_f32_16x16x32_bf16 a[240:243], a[88:91], v[28:31], a[240:243]
    ds_read_b128 v[24:27], v3 offset:55296
    v_mfma_f32_16x16x32_bf16 a[244:247], a[92:95], v[28:31], a[244:247]
    v_mfma_f32_16x16x32_bf16 a[248:251], a[96:99], v[28:31], a[248:251]
    buffer_load_dwordx4 a[76:79], v2, s[8:11], s40 offen offset:3072 sc1
    v_mfma_f32_16x16x32_bf16 a[252:255], a[100:103], v[28:31], a[252:255]
    s_add_u32 s40, s40, 4096
    v_mfma_f32_16x16x32_bf16 v[124:127], a[104:107], v[28:31], v[124:127]
    s_waitcnt lgkmcnt(2)
    v_mfma_f32_16x16x32_bf16 v[32:35], a[88:91], v[16:19], v[32:35]
    ds_read_b128 v[28:31], v3 offset:56320
    v_mfma_f32_16x16x32_bf16 v[36:39], a[92:95], v[16:19], v[36:39]
    v_mfma_f32_16x16x32_bf16 v[40:43], a[96:99], v[16:19], v[40:43]
    buffer_load_dwordx4 a[80:83], v2, s[8:11], s40 offen offset:0 sc1
    v_mfma_f32_16x16x32_bf16 v[44:47], a[100:103], v[16:19], v[44:47]
    v_mfma_f32_16x16x32_bf16 v[48:51], a[104:107], v[16:19], v[48:51]
    s_waitcnt lgkmcnt(2)
    v_mfma_f32_16x16x32_bf16 v[52:55], a[88:91], v[20:23], v[52:55]
    ds_read_b128 v[16:19], v3 offset:57344
    v_mfma_f32_16x16x32_bf16 v[56:59], a[92:95], v[20:23], v[56:59]
    v_mfma_f32_16x16x32_bf16 v[60:63], a[96:99], v[20:23], v[60:63]
    buffer_load_dwordx4 a[84:87], v2, s[8:11], s40 offen offset:1024 sc1
    v_mfma_f32_16x16x32_bf16 v[64:67], a[100:103], v[20:23], v[64:67]
    v_mfma_f32_16x16x32_bf16 v[68:71], a[104:107], v[20:23], v[68:71]
    s_waitcnt lgkmcnt(2)
    v_mfma_f32_16x16x32_bf16 v[72:75], a[88:91], v[24:27], v[72:75]
    ds_read_b128 v[20:23], v3 offset:58368
    v_mfma_f32_16x16x32_bf16 v[76:79], a[92:95], v[24:27], v[76:79]
    v_mfma_f32_16x16x32_bf16 v[80:83], a[96:99], v[24:27], v[80:83]
    v_mfma_f32_16x16x32_bf16 v[84:87], a[100:103], v[24:27], v[84:87]
    v_mfma_f32_16x16x32_bf16 v[88:91], a[104:107], v[24:27], v[88:91]
    s_waitcnt lgkmcnt(2)
    v_mfma_f32_16x16x32_bf16 v[92:95], a[88:91], v[28:31], v[92:95]
    ds_read_b128 v[24:27], v3 offset:59392
    v_mfma_f32_16x16x32_bf16 v[96:99], a[92:95], v[28:31], v[96:99]
    v_mfma_f32_16x16x32_bf16 v[100:103], a[96:99], v[28:31], v[100:103]
    v_mfma_f32_16x16x32_bf16 v[104:107], a[100:103], v[28:31], v[104:107]
    v_mfma_f32_16x16x32_bf16 v[108:111], a[104:107], v[28:31], v[108:111]
    s_waitcnt vmcnt(38) lgkmcnt(2)
    v_mfma_f32_16x16x32_bf16 a[192:195], a[108:111], v[16:19], a[192:195]
    ds_read_b128 v[28:31], v3 offset:60416
    v_mfma_f32_16x16x32_bf16 a[196:199], a[112:115], v[16:19], a[196:199]
    v_mfma_f32_16x16x32_bf16 a[200:203], a[116:119], v[16:19], a[200:203]
    buffer_load_dwordx4 a[88:91], v2, s[8:11], s40 offen offset:2048 sc1
    v_mfma_f32_16x16x32_bf16 a[204:207], a[120:123], v[16:19], a[204:207]
    v_mfma_f32_16x16x32_bf16 v[112:115], a[124:127], v[16:19], v[112:115]
    s_waitcnt lgkmcnt(2)
    v_mfma_f32_16x16x32_bf16 a[208:211], a[108:111], v[20:23], a[208:211]
    ds_read_b128 v[16:19], v3 offset:61440
    v_mfma_f32_16x16x32_bf16 a[212:215], a[112:115], v[20:23], a[212:215]
    v_mfma_f32_16x16x32_bf16 a[216:219], a[116:119], v[20:23], a[216:219]
    buffer_load_dwordx4 a[92:95], v2, s[8:11], s40 offen offset:3072 sc1
    v_mfma_f32_16x16x32_bf16 a[220:223], a[120:123], v[20:23], a[220:223]
    s_add_u32 s40, s40, 4096
    v_mfma_f32_16x16x32_bf16 v[116:119], a[124:127], v[20:23], v[116:119]
    s_waitcnt lgkmcnt(2)
    v_mfma_f32_16x16x32_bf16 a[224:227], a[108:111], v[24:27], a[224:227]
    ds_read_b128 v[20:23], v3 offset:62464
    v_mfma_f32_16x16x32_bf16 a[228:231], a[112:115], v[24:27], a[228:231]
    v_mfma_f32_16x16x32_bf16 a[232:235], a[116:119], v[24:27], a[232:235]
    buffer_load_dwordx4 a[96:99], v2, s[8:11], s40 offen offset:0 sc1
    v_mfma_f32_16x16x32_bf16 a[236:239], a[120:123], v[24:27], a[236:239]
    v_mfma_f32_16x16x32_bf16 v[120:123], a[124:127], v[24:27], v[120:123]
    s_waitcnt lgkmcnt(2)
    v_mfma_f32_16x16x32_bf16 a[240:243], a[108:111], v[28:31], a[240:243]
    ds_read_b128 v[24:27], v3 offset:63488
    v_mfma_f32_16x16x32_bf16 a[244:247], a[112:115], v[28:31], a[244:247]
    v_mfma_f32_16x16x32_bf16 a[248:251], a[116:119], v[28:31], a[248:251]
    buffer_load_dwordx4 a[100:103], v2, s[8:11], s40 offen offset:1024 sc1
    v_mfma_f32_16x16x32_bf16 a[252:255], a[120:123], v[28:31], a[252:255]
    v_mfma_f32_16x16x32_bf16 v[124:127], a[124:127], v[28:31], v[124:127]
    s_waitcnt lgkmcnt(2)
    v_mfma_f32_16x16x32_bf16 v[32:35], a[108:111], v[16:19], v[32:35]
    ds_read_b128 v[28:31], v3 offset:64512
    v_mfma_f32_16x16x32_bf16 v[36:39], a[112:115], v[16:19], v[36:39]
    v_mfma_f32_16x16x32_bf16 v[40:43], a[116:119], v[16:19], v[40:43]
    buffer_load_dwordx4 a[104:107], v2, s[8:11], s40 offen offset:2048 sc1
    v_mfma_f32_16x16x32_bf16 v[44:47], a[120:123], v[16:19], v[44:47]
    v_mfma_f32_16x16x32_bf16 v[48:51], a[124:127], v[16:19], v[48:51]
    s_waitcnt lgkmcnt(2)
    v_mfma_f32_16x16x32_bf16 v[52:55], a[108:111], v[20:23], v[52:55]
    ds_read_b128 v[16:19], v4 offset:0
    v_mfma_f32_16x16x32_bf16 v[56:59], a[112:115], v[20:23], v[56:59]
    v_mfma_f32_16x16x32_bf16 v[60:63], a[116:119], v[20:23], v[60:63]
    v_mfma_f32_16x16x32_bf16 v[64:67], a[120:123], v[20:23], v[64:67]
    v_mfma_f32_16x16x32_bf16 v[68:71], a[124:127], v[20:23], v[68:71]
    s_waitcnt lgkmcnt(2)
    v_mfma_f32_16x16x32_bf16 v[72:75], a[108:111], v[24:27], v[72:75]
    ds_read_b128 v[20:23], v4 offset:1024
    v_mfma_f32_16x16x32_bf16 v[76:79], a[112:115], v[24:27], v[76:79]
    v_mfma_f32_16x16x32_bf16 v[80:83], a[116:119], v[24:27], v[80:83]
    v_mfma_f32_16x16x32_bf16 v[84:87], a[120:123], v[24:27], v[84:87]
    v_mfma_f32_16x16x32_bf16 v[88:91], a[124:127], v[24:27], v[88:91]
    s_waitcnt lgkmcnt(2)
    v_mfma_f32_16x16x32_bf16 v[92:95], a[108:111], v[28:31], v[92:95]
    ds_read_b128 v[24:27], v4 offset:2048
    v_mfma_f32_16x16x32_bf16 v[96:99], a[112:115], v[28:31], v[96:99]
    v_mfma_f32_16x16x32_bf16 v[100:103], a[116:119], v[28:31], v[100:103]
    v_mfma_f32_16x16x32_bf16 v[104:107], a[120:123], v[28:31], v[104:107]
    v_mfma_f32_16x16x32_bf16 v[108:111], a[124:127], v[28:31], v[108:111]
    s_waitcnt vmcnt(38) lgkmcnt(2)
    v_mfma_f32_16x16x32_bf16 a[192:195], a[128:131], v[16:19], a[192:195]
    ds_read_b128 v[28:31], v4 offset:3072
    v_mfma_f32_16x16x32_bf16 a[196:199], a[132:135], v[16:19], a[196:199]
    v_mfma_f32_16x16x32_bf16 a[200:203], a[136:139], v[16:19], a[200:203]
    buffer_load_dwordx4 a[108:111], v2, s[8:11], s40 offen offset:3072 sc1
    v_mfma_f32_16x16x32_bf16 a[204:207], a[140:143], v[16:19], a[204:207]
    s_add_u32 s40, s40, 4096
    v_mfma_f32_16x16x32_bf16 v[112:115], a[144:147], v[16:19], v[112:115]
    s_waitcnt lgkmcnt(2)
    v_mfma_f32_16x16x32_bf16 a[208:211], a[128:131], v[20:23], a[208:211]
    ds_read_b128 v[16:19], v4 offset:4096
    v_mfma_f32_16x16x32_bf16 a[212:215], a[132:135], v[20:23], a[212:215]
    v_mfma_f32_16x16x32_bf16 a[216:219], a[136:139], v[20:23], a[216:219]
    buffer_load_dwordx4 a[112:115], v2, s[8:11], s40 offen offset:0 sc1
    v_mfma_f32_16x16x32_bf16 a[220:223], a[140:143], v[20:23], a[220:223]
    v_mfma_f32_16x16x32_bf16 v[116:119], a[144:147], v[20:23], v[116:119]
    s_waitcnt lgkmcnt(2)
    v_mfma_f32_16x16x32_bf16 a[224:227], a[128:131], v[24:27], a[224:227]
    ds_read_b128 v[20:23], v4 offset:5120
    v_mfma_f32_16x16x32_bf16 a[228:231], a[132:135], v[24:27], a[228:231]
    v_mfma_f32_16x16x32_bf16 a[232:235], a[136:139], v[24:27], a[232:235]
    buffer_load_dwordx4 a[116:119], v2, s[8:11], s40 offen offset:1024 sc1
    v_mfma_f32_16x16x32_bf16 a[236:239], a[140:143], v[24:27], a[236:239]
    v_mfma_f32_16x16x32_bf16 v[120:123], a[144:147], v[24:27], v[120:123]
    s_waitcnt lgkmcnt(2)
    v_mfma_f32_16x16x32_bf16 a[240:243], a[128:131], v[28:31], a[240:243]
    ds_read_b128 v[24:27], v4 offset:6144
    v_mfma_f32_16x16x32_bf16 a[244:247], a[132:135], v[28:31], a[244:247]
    v_mfma_f32_16x16x32_bf16 a[248:251], a[136:139], v[28:31], a[248:251]
    buffer_load_dwordx4 a[120:123], v2, s[8:11], s40 offen offset:2048 sc1
    v_mfma_f32_16x16x32_bf16 a[252:255], a[140:143], v[28:31], a[252:255]
    v_mfma_f32_16x16x32_bf16 v[124:127], a[144:147], v[28:31], v[124:127]
    s_waitcnt lgkmcnt(2)
    v_mfma_f32_16x16x32_bf16 v[32:35], a[128:131], v[16:19], v[32:35]
    ds_read_b128 v[28:31], v4 offset:7168
    v_mfma_f32_16x16x32_bf16 v[36:39], a[132:135], v[16:19], v[36:39]
    v_mfma_f32_16x16x32_bf16 v[40:43], a[136:139], v[16:19], v[40:43]
    buffer_load_dwordx4 a[124:127], v2, s[8:11], s40 offen offset:3072 sc1
    v_mfma_f32_16x16x32_bf16 v[44:47], a[140:143], v[16:19], v[44:47]
    s_add_u32 s40, s40, 4096
    v_mfma_f32_16x16x32_bf16 v[48:51], a[144:147], v[16:19], v[48:51]
    s_waitcnt lgkmcnt(2)
    v_mfma_f32_16x16x32_bf16 v[52:55], a[128:131], v[20:23], v[52:55]
    ds_read_b128 v[16:19], v4 offset:8192
    v_mfma_f32_16x16x32_bf16 v[56:59], a[132:135], v[20:23], v[56:59]
    v_mfma_f32_16x16x32_bf16 v[60:63], a[136:139], v[20:23], v[60:63]
    v_mfma_f32_16x16x32_bf16 v[64:67], a[140:143], v[20:23], v[64:67]
    v_mfma_f32_16x16x32_bf16 v[68:71], a[144:147], v[20:23], v[68:71]
    s_waitcnt lgkmcnt(2)
    v_mfma_f32_16x16x32_bf16 v[72:75], a[128:131], v[24:27], v[72:75]
    ds_read_b128 v[20:23], v4 offset:9216
    v_mfma_f32_16x16x32_bf16 v[76:79], a[132:135], v[24:27], v[76:79]
    v_mfma_f32_16x16x32_bf16 v[80:83], a[136:139], v[24:27], v[80:83]
    v_mfma_f32_16x16x32_bf16 v[84:87], a[140:143], v[24:27], v[84:87]
    v_mfma_f32_16x16x32_bf16 v[88:91], a[144:147], v[24:27], v[88:91]
    s_waitcnt lgkmcnt(2)
    v_mfma_f32_16x16x32_bf16 v[92:95], a[128:131], v[28:31], v[92:95]
    ds_read_b128 v[24:27], v4 offset:10240
    v_mfma_f32_16x16x32_bf16 v[96:99], a[132:135], v[28:31], v[96:99]
    v_mfma_f32_16x16x32_bf16 v[100:103], a[136:139], v[28:31], v[100:103]
    v_mfma_f32_16x16x32_bf16 v[104:107], a[140:143], v[28:31], v[104:107]
    v_mfma_f32_16x16x32_bf16 v[108:111], a[144:147], v[28:31], v[108:111]
    s_waitcnt vmcnt(38) lgkmcnt(2)
    v_mfma_f32_16x16x32_bf16 a[192:195], a[148:151], v[16:19], a[192:195]
    ds_read_b128 v[28:31], v4 offset:11264
    v_mfma_f32_16x16x32_bf16 a[196:199], a[152:155], v[16:19], a[196:199]
    v_mfma_f32_16x16x32_bf16 a[200:203], a[156:159], v[16:19], a[200:203]
    buffer_load_dwordx4 a[128:131], v2, s[8:11], s40 offen offset:0 sc1
    v_mfma_f32_16x16x32_bf16 a[204:207], a[160:163], v[16:19], a[204:207]
    v_mfma_f32_16x16x32_bf16 v[112:115], a[164:167], v[16:19], v[112:115]
    s_waitcnt lgkmcnt(2)
    v_mfma_f32_16x16x32_bf16 a[208:211], a[148:151], v[20:23], a[208:211]
    ds_read_b128 v[16:19], v4 offset:12288
    v_mfma_f32_16x16x32_bf16 a[212:215], a[152:155], v[20:23], a[212:215]
    v_mfma_f32_16x16x32_bf16 a[216:219], a[156:159], v[20:23], a[216:219]
    buffer_load_dwordx4 a[132:135], v2, s[8:11], s40 offen offset:1024 sc1
    v_mfma_f32_16x16x32_bf16 a[220:223], a[160:163], v[20:23], a[220:223]
    v_mfma_f32_16x16x32_bf16 v[116:119], a[164:167], v[20:23], v[116:119]
    s_waitcnt lgkmcnt(2)
    v_mfma_f32_16x16x32_bf16 a[224:227], a[148:151], v[24:27], a[224:227]
    ds_read_b128 v[20:23], v4 offset:13312
    v_mfma_f32_16x16x32_bf16 a[228:231], a[152:155], v[24:27], a[228:231]
    v_mfma_f32_16x16x32_bf16 a[232:235], a[156:159], v[24:27], a[232:235]
    buffer_load_dwordx4 a[136:139], v2, s[8:11], s40 offen offset:2048 sc1
    v_mfma_f32_16x16x32_bf16 a[236:239], a[160:163], v[24:27], a[236:239]
    v_mfma_f32_16x16x32_bf16 v[120:123], a[164:167], v[24:27], v[120:123]
    s_waitcnt lgkmcnt(2)
    v_mfma_f32_16x16x32_bf16 a[240:243], a[148:151], v[28:31], a[240:243]
    ds_read_b128 v[24:27], v4 offset:14336
    v_mfma_f32_16x16x32_bf16 a[244:247], a[152:155], v[28:31], a[244:247]
    v_mfma_f32_16x16x32_bf16 a[248:251], a[156:159], v[28:31], a[248:251]
    buffer_load_dwordx4 a[140:143], v2, s[8:11], s40 offen offset:3072 sc1
    v_mfma_f32_16x16x32_bf16 a[252:255], a[160:163], v[28:31], a[252:255]
    s_add_u32 s40, s40, 4096
    v_mfma_f32_16x16x32_bf16 v[124:127], a[164:167], v[28:31], v[124:127]
    s_waitcnt lgkmcnt(2)
    v_mfma_f32_16x16x32_bf16 v[32:35], a[148:151], v[16:19], v[32:35]
    ds_read_b128 v[28:31], v4 offset:15360
    v_mfma_f32_16x16x32_bf16 v[36:39], a[152:155], v[16:19], v[36:39]
    v_mfma_f32_16x16x32_bf16 v[40:43], a[156:159], v[16:19], v[40:43]
    buffer_load_dwordx4 a[144:147], v2, s[8:11], s40 offen offset:0 sc1
    v_mfma_f32_16x16x32_bf16 v[44:47], a[160:163], v[16:19], v[44:47]
    v_mfma_f32_16x16x32_bf16 v[48:51], a[164:167], v[16:19], v[48:51]
    s_waitcnt lgkmcnt(2)
    v_mfma_f32_16x16x32_bf16 v[52:55], a[148:151], v[20:23], v[52:55]
    ds_read_b128 v[16:19], v2 offset:4096
    v_mfma_f32_16x16x32_bf16 v[56:59], a[152:155], v[20:23], v[56:59]
    v_mfma_f32_16x16x32_bf16 v[60:63], a[156:159], v[20:23], v[60:63]
    v_mfma_f32_16x16x32_bf16 v[64:67], a[160:163], v[20:23], v[64:67]
    v_mfma_f32_16x16x32_bf16 v[68:71], a[164:167], v[20:23], v[68:71]
    s_waitcnt lgkmcnt(2)
    v_mfma_f32_16x16x32_bf16 v[72:75], a[148:151], v[24:27], v[72:75]
    ds_read_b128 v[20:23], v2 offset:5120
    v_mfma_f32_16x16x32_bf16 v[76:79], a[152:155], v[24:27], v[76:79]
    v_mfma_f32_16x16x32_bf16 v[80:83], a[156:159], v[24:27], v[80:83]
    v_mfma_f32_16x16x32_bf16 v[84:87], a[160:163], v[24:27], v[84:87]
    v_mfma_f32_16x16x32_bf16 v[88:91], a[164:167], v[24:27], v[88:91]
    s_waitcnt lgkmcnt(2)
    v_mfma_f32_16x16x32_bf16 v[92:95], a[148:151], v[28:31], v[92:95]
    ds_read_b128 v[24:27], v2 offset:6144
    v_mfma_f32_16x16x32_bf16 v[96:99], a[152:155], v[28:31], v[96:99]
    v_mfma_f32_16x16x32_bf16 v[100:103], a[156:159], v[28:31], v[100:103]
    v_mfma_f32_16x16x32_bf16 v[104:107], a[160:163], v[28:31], v[104:107]
    v_mfma_f32_16x16x32_bf16 v[108:111], a[164:167], v[28:31], v[108:111]
    s_waitcnt vmcnt(39) lgkmcnt(2)
    v_mfma_f32_16x16x32_bf16 v[192:195], a[168:171], v[16:19], 0
    ds_read_b128 v[28:31], v2 offset:7168
    v_mul_f32 v48, v48, v50
    v_mfma_f32_16x16x32_bf16 v[196:199], a[172:175], v[16:19], 0
    v_mul_f32 v49, v49, v51
    v_mfma_f32_16x16x32_bf16 v[200:203], a[176:179], v[16:19], 0
    buffer_load_dwordx4 a[148:151], v2, s[8:11], s40 offen offset:1024 sc1
    v_mfma_f32_16x16x32_bf16 v[204:207], a[180:183], v[16:19], 0
    s_waitcnt lgkmcnt(2)
    v_mfma_f32_16x16x32_bf16 v[208:211], a[168:171], v[20:23], 0
    ds_read_b128 v[16:19], v2 offset:0
    v_cvt_pk_bf16_f32 v48, v48, v49
    v_mfma_f32_16x16x32_bf16 v[212:215], a[172:175], v[20:23], 0
    v_mul_f32 v68, v68, v70
    v_mfma_f32_16x16x32_bf16 v[216:219], a[176:179], v[20:23], 0
    buffer_load_dwordx4 a[152:155], v2, s[8:11], s40 offen offset:2048 sc1
    v_mfma_f32_16x16x32_bf16 v[220:223], a[180:183], v[20:23], 0
    s_waitcnt lgkmcnt(2)
    v_mfma_f32_16x16x32_bf16 v[224:227], a[168:171], v[24:27], 0
    ds_read_b128 v[20:23], v2 offset:1024
    v_mul_f32 v69, v69, v71
    v_mfma_f32_16x16x32_bf16 v[228:231], a[172:175], v[24:27], 0
    v_cvt_pk_bf16_f32 v49, v68, v69
    v_mfma_f32_16x16x32_bf16 v[232:235], a[176:179], v[24:27], 0
    buffer_load_dwordx4 a[156:159], v2, s[8:11], s40 offen offset:3072 sc1
    v_mfma_f32_16x16x32_bf16 v[236:239], a[180:183], v[24:27], 0
    s_add_u32 s40, s40, 4096
    s_waitcnt lgkmcnt(2)
    v_mfma_f32_16x16x32_bf16 v[240:243], a[168:171], v[28:31], 0
    ds_read_b128 v[24:27], v2 offset:2048
    v_mul_f32 v88, v88, v90
    v_mfma_f32_16x16x32_bf16 v[244:247], a[172:175], v[28:31], 0
    v_mul_f32 v89, v89, v91
    v_mfma_f32_16x16x32_bf16 v[248:251], a[176:179], v[28:31], 0
    buffer_load_dwordx4 a[160:163], v2, s[8:11], s40 offen offset:0 sc1
    v_mfma_f32_16x16x32_bf16 v[252:255], a[180:183], v[28:31], 0
    s_waitcnt lgkmcnt(2)
    v_mfma_f32_16x16x32_bf16 v[128:131], a[168:171], v[16:19], 0
    ds_read_b128 v[28:31], v2 offset:3072
    v_cvt_pk_bf16_f32 v50, v88, v89
    v_mfma_f32_16x16x32_bf16 v[132:135], a[172:175], v[16:19], 0
    v_mul_f32 v108, v108, v110
    v_mfma_f32_16x16x32_bf16 v[136:139], a[176:179], v[16:19], 0
    buffer_load_dwordx4 a[164:167], v2, s[8:11], s40 offen offset:1024 sc1
    v_mfma_f32_16x16x32_bf16 v[140:143], a[180:183], v[16:19], 0
    s_waitcnt lgkmcnt(2)
    v_mfma_f32_16x16x32_bf16 v[144:147], a[168:171], v[20:23], 0
    ds_read_b128 v[16:19], v2 offset:12288
    v_mul_f32 v109, v109, v111
    v_mfma_f32_16x16x32_bf16 v[148:151], a[172:175], v[20:23], 0
    v_cvt_pk_bf16_f32 v51, v108, v109
    v_mfma_f32_16x16x32_bf16 v[152:155], a[176:179], v[20:23], 0
    v_mfma_f32_16x16x32_bf16 v[156:159], a[180:183], v[20:23], 0
    s_waitcnt lgkmcnt(2)
    v_mfma_f32_16x16x32_bf16 v[160:163], a[168:171], v[24:27], 0
    ds_read_b128 v[20:23], v2 offset:13312
    v_permlane32_swap_b32 v48, v50
    v_mfma_f32_16x16x32_bf16 v[164:167], a[172:175], v[24:27], 0
    v_permlane32_swap_b32 v49, v51
    v_mfma_f32_16x16x32_bf16 v[168:171], a[176:179], v[24:27], 0
    v_mfma_f32_16x16x32_bf16 v[172:175], a[180:183], v[24:27], 0
    s_waitcnt lgkmcnt(2)
    v_mfma_f32_16x16x32_bf16 v[176:179], a[168:171], v[28:31], 0
    ds_read_b128 v[24:27], v2 offset:14336
    v_permlane16_swap_b32 v48, v49
    v_mfma_f32_16x16x32_bf16 v[180:183], a[172:175], v[28:31], 0
    v_permlane16_swap_b32 v50, v51
    v_mfma_f32_16x16x32_bf16 v[184:187], a[176:179], v[28:31], 0
    v_mfma_f32_16x16x32_bf16 v[188:191], a[180:183], v[28:31], 0
    s_waitcnt vmcnt(40) lgkmcnt(2)
    v_mfma_f32_16x16x32_bf16 v[192:195], a[184:187], v[16:19], v[192:195]
    ds_read_b128 v[28:31], v2 offset:15360
    v_mfma_f32_16x16x32_bf16 v[196:199], a[188:191], v[16:19], v[196:199]
    buffer_store_dwordx4 v[48:51], v8, s[20:23], 0 offen sc1
    v_mfma_f32_16x16x32_bf16 v[200:203], a[0:3], v[16:19], v[200:203]
    buffer_load_dwordx4 a[168:171], v2, s[8:11], s40 offen offset:2048 sc1
    v_mfma_f32_16x16x32_bf16 v[204:207], a[4:7], v[16:19], v[204:207]
    v_mul_f32 v32, v32, v34
    s_waitcnt lgkmcnt(2)
    v_mfma_f32_16x16x32_bf16 v[208:211], a[184:187], v[20:23], v[208:211]
    ds_read_b128 v[16:19], v2 offset:8192
    v_mul_f32 v33, v33, v35
    v_mfma_f32_16x16x32_bf16 v[212:215], a[188:191], v[20:23], v[212:215]
    v_cvt_pk_bf16_f32 v32, v32, v33
    v_mfma_f32_16x16x32_bf16 v[216:219], a[0:3], v[20:23], v[216:219]
    buffer_load_dwordx4 a[172:175], v2, s[8:11], s40 offen offset:3072 sc1
    v_mfma_f32_16x16x32_bf16 v[220:223], a[4:7], v[20:23], v[220:223]
    s_add_u32 s40, s40, 4096
    s_waitcnt lgkmcnt(2)
    v_mfma_f32_16x16x32_bf16 v[224:227], a[184:187], v[24:27], v[224:227]
    ds_read_b128 v[20:23], v2 offset:9216
    v_mul_f32 v36, v36, v38
    v_mfma_f32_16x16x32_bf16 v[228:231], a[188:191], v[24:27], v[228:231]
    v_mul_f32 v37, v37, v39
    v_mfma_f32_16x16x32_bf16 v[232:235], a[0:3], v[24:27], v[232:235]
    buffer_load_dwordx4 a[176:179], v2, s[8:11], s40 offen offset:0 sc1
    v_mfma_f32_16x16x32_bf16 v[236:239], a[4:7], v[24:27], v[236:239]
    s_waitcnt lgkmcnt(2)
    v_mfma_f32_16x16x32_bf16 v[240:243], a[184:187], v[28:31], v[240:243]
    ds_read_b128 v[24:27], v2 offset:10240
    v_cvt_pk_bf16_f32 v33, v36, v37
    v_mfma_f32_16x16x32_bf16 v[244:247], a[188:191], v[28:31], v[244:247]
    v_mul_f32 v40, v40, v42
    v_mfma_f32_16x16x32_bf16 v[248:251], a[0:3], v[28:31], v[248:251]
    buffer_load_dwordx4 a[180:183], v2, s[8:11], s40 offen offset:1024 sc1
    v_mfma_f32_16x16x32_bf16 v[252:255], a[4:7], v[28:31], v[252:255]
    s_waitcnt lgkmcnt(2)
    v_mfma_f32_16x16x32_bf16 v[128:131], a[184:187], v[16:19], v[128:131]
    ds_read_b128 v[28:31], v2 offset:11264
    v_mul_f32 v41, v41, v43
    v_mfma_f32_16x16x32_bf16 v[132:135], a[188:191], v[16:19], v[132:135]
    v_cvt_pk_bf16_f32 v34, v40, v41
    v_mfma_f32_16x16x32_bf16 v[136:139], a[0:3], v[16:19], v[136:139]
    v_mfma_f32_16x16x32_bf16 v[140:143], a[4:7], v[16:19], v[140:143]
    s_waitcnt lgkmcnt(2)
    v_mfma_f32_16x16x32_bf16 v[144:147], a[184:187], v[20:23], v[144:147]
    ds_read_b128 v[16:19], v2 offset:20480
    v_mul_f32 v44, v44, v46
    v_mfma_f32_16x16x32_bf16 v[148:151], a[188:191], v[20:23], v[148:151]
    v_mul_f32 v45, v45, v47
    v_mfma_f32_16x16x32_bf16 v[152:155], a[0:3], v[20:23], v[152:155]
    v_mfma_f32_16x16x32_bf16 v[156:159], a[4:7], v[20:23], v[156:159]
    s_waitcnt lgkmcnt(2)
    v_mfma_f32_16x16x32_bf16 v[160:163], a[184:187], v[24:27], v[160:163]
    ds_read_b128 v[20:23], v2 offset:21504
    v_cvt_pk_bf16_f32 v35, v44, v45
    v_mfma_f32_16x16x32_bf16 v[164:167], a[188:191], v[24:27], v[164:167]
    buffer_store_dwordx4 v[32:35], v7, s[20:23], 0 offen offset:0 sc1
    v_mfma_f32_16x16x32_bf16 v[168:171], a[0:3], v[24:27], v[168:171]
    v_mfma_f32_16x16x32_bf16 v[172:175], a[4:7], v[24:27], v[172:175]
    s_waitcnt lgkmcnt(2)
    v_mfma_f32_16x16x32_bf16 v[176:179], a[184:187], v[28:31], v[176:179]
    ds_read_b128 v[24:27], v2 offset:22528
    v_mul_f32 v52, v52, v54
    v_mfma_f32_16x16x32_bf16 v[180:183], a[188:191], v[28:31], v[180:183]
    v_mul_f32 v53, v53, v55
    v_mfma_f32_16x16x32_bf16 v[184:187], a[0:3], v[28:31], v[184:187]
    v_mfma_f32_16x16x32_bf16 v[188:191], a[4:7], v[28:31], v[188:191]
    s_waitcnt vmcnt(42) lgkmcnt(2)
    v_mfma_f32_16x16x32_bf16 v[192:195], a[8:11], v[16:19], v[192:195]
    ds_read_b128 v[28:31], v2 offset:23552
    v_cvt_pk_bf16_f32 v52, v52, v53
    v_mfma_f32_16x16x32_bf16 v[196:199], a[12:15], v[16:19], v[196:199]
    v_mul_f32 v56, v56, v58
    v_mfma_f32_16x16x32_bf16 v[200:203], a[16:19], v[16:19], v[200:203]
    buffer_load_dwordx4 a[184:187], v2, s[8:11], s40 offen offset:2048 sc1
    v_mfma_f32_16x16x32_bf16 v[204:207], a[20:23], v[16:19], v[204:207]
    s_waitcnt lgkmcnt(2)
    v_mfma_f32_16x16x32_bf16 v[208:211], a[8:11], v[20:23], v[208:211]
    ds_read_b128 v[16:19], v2 offset:16384
    v_mul_f32 v57, v57, v59
    v_mfma_f32_16x16x32_bf16 v[212:215], a[12:15], v[20:23], v[212:215]
    v_cvt_pk_bf16_f32 v53, v56, v57
    v_mfma_f32_16x16x32_bf16 v[216:219], a[16:19], v[20:23], v[216:219]
    buffer_load_dwordx4 a[188:191], v2, s[8:11], s40 offen offset:3072 sc1
    v_mfma_f32_16x16x32_bf16 v[220:223], a[20:23], v[20:23], v[220:223]
    s_add_u32 s40, s40, 4096
    s_waitcnt lgkmcnt(2)
    v_mfma_f32_16x16x32_bf16 v[224:227], a[8:11], v[24:27], v[224:227]
    ds_read_b128 v[20:23], v2 offset:17408
    v_mul_f32 v60, v60, v62
    v_mfma_f32_16x16x32_bf16 v[228:231], a[12:15], v[24:27], v[228:231]
    v_mul_f32 v61, v61, v63
    v_mfma_f32_16x16x32_bf16 v[232:235], a[16:19], v[24:27], v[232:235]
    buffer_load_dwordx4 a[0:3], v2, s[8:11], s40 offen offset:0 sc1
    v_mfma_f32_16x16x32_bf16 v[236:239], a[20:23], v[24:27], v[236:239]
    s_waitcnt lgkmcnt(2)
    v_mfma_f32_16x16x32_bf16 v[240:243], a[8:11], v[28:31], v[240:243]
    ds_read_b128 v[24:27], v2 offset:18432
    v_cvt_pk_bf16_f32 v54, v60, v61
    v_mfma_f32_16x16x32_bf16 v[244:247], a[12:15], v[28:31], v[244:247]
    v_mul_f32 v64, v64, v66
    v_mfma_f32_16x16x32_bf16 v[248:251], a[16:19], v[28:31], v[248:251]
    buffer_load_dwordx4 a[4:7], v2, s[8:11], s40 offen offset:1024 sc1
    v_mfma_f32_16x16x32_bf16 v[252:255], a[20:23], v[28:31], v[252:255]
    s_waitcnt lgkmcnt(2)
    v_mfma_f32_16x16x32_bf16 v[128:131], a[8:11], v[16:19], v[128:131]
    ds_read_b128 v[28:31], v2 offset:19456
    v_mul_f32 v65, v65, v67
    v_mfma_f32_16x16x32_bf16 v[132:135], a[12:15], v[16:19], v[132:135]
    v_cvt_pk_bf16_f32 v55, v64, v65
    v_mfma_f32_16x16x32_bf16 v[136:139], a[16:19], v[16:19], v[136:139]
    v_mfma_f32_16x16x32_bf16 v[140:143], a[20:23], v[16:19], v[140:143]
    s_waitcnt lgkmcnt(2)
    v_mfma_f32_16x16x32_bf16 v[144:147], a[8:11], v[20:23], v[144:147]
    ds_read_b128 v[16:19], v2 offset:28672
    v_mfma_f32_16x16x32_bf16 v[148:151], a[12:15], v[20:23], v[148:151]
    buffer_store_dwordx4 v[52:55], v7, s[20:23], 0 offen offset:1024 sc1
    v_mfma_f32_16x16x32_bf16 v[152:155], a[16:19], v[20:23], v[152:155]
    v_mul_f32 v72, v72, v74
    v_mfma_f32_16x16x32_bf16 v[156:159], a[20:23], v[20:23], v[156:159]
    s_waitcnt lgkmcnt(2)
    v_mfma_f32_16x16x32_bf16 v[160:163], a[8:11], v[24:27], v[160:163]
    ds_read_b128 v[20:23], v2 offset:29696
    v_mul_f32 v73, v73, v75
    v_mfma_f32_16x16x32_bf16 v[164:167], a[12:15], v[24:27], v[164:167]
    v_cvt_pk_bf16_f32 v72, v72, v73
    v_mfma_f32_16x16x32_bf16 v[168:171], a[16:19], v[24:27], v[168:171]
    v_mfma_f32_16x16x32_bf16 v[172:175], a[20:23], v[24:27], v[172:175]
    s_waitcnt lgkmcnt(2)
    v_mfma_f32_16x16x32_bf16 v[176:179], a[8:11], v[28:31], v[176:179]
    ds_read_b128 v[24:27], v2 offset:30720
    v_mul_f32 v76, v76, v78
    v_mfma_f32_16x16x32_bf16 v[180:183], a[12:15], v[28:31], v[180:183]
    v_mul_f32 v77, v77, v79
    v_mfma_f32_16x16x32_bf16 v[184:187], a[16:19], v[28:31], v[184:187]
    v_mfma_f32_16x16x32_bf16 v[188:191], a[20:23], v[28:31], v[188:191]
    s_waitcnt vmcnt(43) lgkmcnt(2)
    v_mfma_f32_16x16x32_bf16 v[192:195], a[24:27], v[16:19], v[192:195]
    ds_read_b128 v[28:31], v2 offset:31744
    v_cvt_pk_bf16_f32 v73, v76, v77
    v_mfma_f32_16x16x32_bf16 v[196:199], a[28:31], v[16:19], v[196:199]
    v_mul_f32 v80, v80, v82
    v_mfma_f32_16x16x32_bf16 v[200:203], a[32:35], v[16:19], v[200:203]
    buffer_load_dwordx4 a[8:11], v2, s[8:11], s40 offen offset:2048 sc1
    v_mfma_f32_16x16x32_bf16 v[204:207], a[36:39], v[16:19], v[204:207]
    s_waitcnt lgkmcnt(2)
    v_mfma_f32_16x16x32_bf16 v[208:211], a[24:27], v[20:23], v[208:211]
    ds_read_b128 v[16:19], v2 offset:24576
    v_mul_f32 v81, v81, v83
    v_mfma_f32_16x16x32_bf16 v[212:215], a[28:31], v[20:23], v[212:215]
    v_cvt_pk_bf16_f32 v74, v80, v81
    v_mfma_f32_16x16x32_bf16 v[216:219], a[32:35], v[20:23], v[216:219]
    buffer_load_dwordx4 a[12:15], v2, s[8:11], s40 offen offset:3072 sc1
    v_mfma_f32_16x16x32_bf16 v[220:223], a[36:39], v[20:23], v[220:223]
    s_add_u32 s40, s40, 4096
    s_waitcnt lgkmcnt(2)
    v_mfma_f32_16x16x32_bf16 v[224:227], a[24:27], v[24:27], v[224:227]
    ds_read_b128 v[20:23], v2 offset:25600
    v_mul_f32 v84, v84, v86
    v_mfma_f32_16x16x32_bf16 v[228:231], a[28:31], v[24:27], v[228:231]
    v_mul_f32 v85, v85, v87
    v_mfma_f32_16x16x32_bf16 v[232:235], a[32:35], v[24:27], v[232:235]
    buffer_load_dwordx4 a[16:19], v2, s[8:11], s40 offen offset:0 sc1
    v_mfma_f32_16x16x32_bf16 v[236:239], a[36:39], v[24:27], v[236:239]
    s_waitcnt lgkmcnt(2)
    v_mfma_f32_16x16x32_bf16 v[240:243], a[24:27], v[28:31], v[240:243]
    ds_read_b128 v[24:27], v2 offset:26624
    v_cvt_pk_bf16_f32 v75, v84, v85
    v_mfma_f32_16x16x32_bf16 v[244:247], a[28:31], v[28:31], v[244:247]
    buffer_store_dwordx4 v[72:75], v7, s[20:23], 0 offen offset:2048 sc1
    v_mfma_f32_16x16x32_bf16 v[248:251], a[32:35], v[28:31], v[248:251]
    buffer_load_dwordx4 a[20:23], v2, s[8:11], s40 offen offset:1024 sc1
    v_mfma_f32_16x16x32_bf16 v[252:255], a[36:39], v[28:31], v[252:255]
    s_waitcnt lgkmcnt(2)
    v_mfma_f32_16x16x32_bf16 v[128:131], a[24:27], v[16:19], v[128:131]
    ds_read_b128 v[28:31], v2 offset:27648
    v_mul_f32 v92, v92, v94
    v_mfma_f32_16x16x32_bf16 v[132:135], a[28:31], v[16:19], v[132:135]
    v_mul_f32 v93, v93, v95
    v_mfma_f32_16x16x32_bf16 v[136:139], a[32:35], v[16:19], v[136:139]
    v_mfma_f32_16x16x32_bf16 v[140:143], a[36:39], v[16:19], v[140:143]
    s_waitcnt lgkmcnt(2)
    v_mfma_f32_16x16x32_bf16 v[144:147], a[24:27], v[20:23], v[144:147]
    ds_read_b128 v[16:19], v2 offset:36864
    v_cvt_pk_bf16_f32 v92, v92, v93
    v_mfma_f32_16x16x32_bf16 v[148:151], a[28:31], v[20:23], v[148:151]
    v_mul_f32 v96, v96, v98
    v_mfma_f32_16x16x32_bf16 v[152:155], a[32:35], v[20:23], v[152:155]
    v_mfma_f32_16x16x32_bf16 v[156:159], a[36:39], v[20:23], v[156:159]
    s_waitcnt lgkmcnt(2)
    v_mfma_f32_16x16x32_bf16 v[160:163], a[24:27], v[24:27], v[160:163]
    ds_read_b128 v[20:23], v2 offset:37888
    v_mul_f32 v97, v97, v99
    v_mfma_f32_16x16x32_bf16 v[164:167], a[28:31], v[24:27], v[164:167]
    v_cvt_pk_bf16_f32 v93, v96, v97
    v_mfma_f32_16x16x32_bf16 v[168:171], a[32:35], v[24:27], v[168:171]
    v_mfma_f32_16x16x32_bf16 v[172:175], a[36:39], v[24:27], v[172:175]
    s_waitcnt lgkmcnt(2)
    v_mfma_f32_16x16x32_bf16 v[176:179], a[24:27], v[28:31], v[176:179]
    ds_read_b128 v[24:27], v2 offset:38912
    v_mul_f32 v100, v100, v102
    v_mfma_f32_16x16x32_bf16 v[180:183], a[28:31], v[28:31], v[180:183]
    v_mul_f32 v101, v101, v103
    v_mfma_f32_16x16x32_bf16 v[184:187], a[32:35], v[28:31], v[184:187]
    v_mfma_f32_16x16x32_bf16 v[188:191], a[36:39], v[28:31], v[188:191]
    s_waitcnt vmcnt(44) lgkmcnt(2)
    v_mfma_f32_16x16x32_bf16 v[192:195], a[40:43], v[16:19], v[192:195]
    ds_read_b128 v[28:31], v2 offset:39936
    v_cvt_pk_bf16_f32 v94, v100, v101
    v_mfma_f32_16x16x32_bf16 v[196:199], a[44:47], v[16:19], v[196:199]
    v_mul_f32 v104, v104, v106
    v_mfma_f32_16x16x32_bf16 v[200:203], a[48:51], v[16:19], v[200:203]
    buffer_load_dwordx4 a[24:27], v2, s[8:11], s40 offen offset:2048 sc1
    v_mfma_f32_16x16x32_bf16 v[204:207], a[52:55], v[16:19], v[204:207]
    s_waitcnt lgkmcnt(2)
    v_mfma_f32_16x16x32_bf16 v[208:211], a[40:43], v[20:23], v[208:211]
    ds_read_b128 v[16:19], v2 offset:32768
    v_mul_f32 v105, v105, v107
    v_mfma_f32_16x16x32_bf16 v[212:215], a[44:47], v[20:23], v[212:215]
    v_cvt_pk_bf16_f32 v95, v104, v105
    v_mfma_f32_16x16x32_bf16 v[216:219], a[48:51], v[20:23], v[216:219]
    buffer_load_dwordx4 a[28:31], v2, s[8:11], s40 offen offset:3072 sc1
    v_mfma_f32_16x16x32_bf16 v[220:223], a[52:55], v[20:23], v[220:223]
    s_add_u32 s40, s40, 4096
    s_waitcnt lgkmcnt(2)
    v_mfma_f32_16x16x32_bf16 v[224:227], a[40:43], v[24:27], v[224:227]
    ds_read_b128 v[20:23], v2 offset:33792
    v_mfma_f32_16x16x32_bf16 v[228:231], a[44:47], v[24:27], v[228:231]
    buffer_store_dwordx4 v[92:95], v7, s[20:23], 0 offen offset:3072 sc1
    v_mfma_f32_16x16x32_bf16 v[232:235], a[48:51], v[24:27], v[232:235]
    buffer_load_dwordx4 a[32:35], v2, s[8:11], s40 offen offset:0 sc1
    v_mfma_f32_16x16x32_bf16 v[236:239], a[52:55], v[24:27], v[236:239]
    v_mul_f32 v112, v112, v114
    s_waitcnt lgkmcnt(2)
    v_mfma_f32_16x16x32_bf16 v[240:243], a[40:43], v[28:31], v[240:243]
    ds_read_b128 v[24:27], v2 offset:34816
    v_mul_f32 v113, v113, v115
    v_mfma_f32_16x16x32_bf16 v[244:247], a[44:47], v[28:31], v[244:247]
    v_cvt_pk_bf16_f32 v112, v112, v113
    v_mfma_f32_16x16x32_bf16 v[248:251], a[48:51], v[28:31], v[248:251]
    buffer_load_dwordx4 a[36:39], v2, s[8:11], s40 offen offset:1024 sc1
    v_mfma_f32_16x16x32_bf16 v[252:255], a[52:55], v[28:31], v[252:255]
    s_waitcnt lgkmcnt(2)
    v_mfma_f32_16x16x32_bf16 v[128:131], a[40:43], v[16:19], v[128:131]
    ds_read_b128 v[28:31], v2 offset:35840
    v_mul_f32 v116, v116, v118
    v_mfma_f32_16x16x32_bf16 v[132:135], a[44:47], v[16:19], v[132:135]
    v_mul_f32 v117, v117, v119
    v_mfma_f32_16x16x32_bf16 v[136:139], a[48:51], v[16:19], v[136:139]
    v_mfma_f32_16x16x32_bf16 v[140:143], a[52:55], v[16:19], v[140:143]
    s_waitcnt lgkmcnt(2)
    v_mfma_f32_16x16x32_bf16 v[144:147], a[40:43], v[20:23], v[144:147]
    ds_read_b128 v[16:19], v2 offset:45056
    v_cvt_pk_bf16_f32 v113, v116, v117
    v_mfma_f32_16x16x32_bf16 v[148:151], a[44:47], v[20:23], v[148:151]
    v_mul_f32 v120, v120, v122
    v_mfma_f32_16x16x32_bf16 v[152:155], a[48:51], v[20:23], v[152:155]
    v_mfma_f32_16x16x32_bf16 v[156:159], a[52:55], v[20:23], v[156:159]
    s_waitcnt lgkmcnt(2)
    v_mfma_f32_16x16x32_bf16 v[160:163], a[40:43], v[24:27], v[160:163]
    ds_read_b128 v[20:23], v2 offset:46080
    v_mul_f32 v121, v121, v123
    v_mfma_f32_16x16x32_bf16 v[164:167], a[44:47], v[24:27], v[164:167]
    v_cvt_pk_bf16_f32 v114, v120, v121
    v_mfma_f32_16x16x32_bf16 v[168:171], a[48:51], v[24:27], v[168:171]
    v_mfma_f32_16x16x32_bf16 v[172:175], a[52:55], v[24:27], v[172:175]
    s_waitcnt lgkmcnt(2)
    v_mfma_f32_16x16x32_bf16 v[176:179], a[40:43], v[28:31], v[176:179]
    ds_read_b128 v[24:27], v2 offset:47104
    v_mul_f32 v124, v124, v126
    v_mfma_f32_16x16x32_bf16 v[180:183], a[44:47], v[28:31], v[180:183]
    v_mul_f32 v125, v125, v127
    v_mfma_f32_16x16x32_bf16 v[184:187], a[48:51], v[28:31], v[184:187]
    v_mfma_f32_16x16x32_bf16 v[188:191], a[52:55], v[28:31], v[188:191]
    s_barrier
    s_waitcnt vmcnt(45) lgkmcnt(2)
    v_mfma_f32_16x16x32_bf16 v[192:195], a[56:59], v[16:19], v[192:195]
    ds_read_b128 v[28:31], v2 offset:48128
    v_cvt_pk_bf16_f32 v115, v124, v125
    v_mfma_f32_16x16x32_bf16 v[196:199], a[60:63], v[16:19], v[196:199]
    v_permlane32_swap_b32 v112, v114
    v_mfma_f32_16x16x32_bf16 v[200:203], a[64:67], v[16:19], v[200:203]
    buffer_load_dwordx4 a[40:43], v2, s[8:11], s40 offen offset:2048 sc1
    v_mfma_f32_16x16x32_bf16 v[204:207], a[68:71], v[16:19], v[204:207]
    s_waitcnt lgkmcnt(2)
    v_mfma_f32_16x16x32_bf16 v[208:211], a[56:59], v[20:23], v[208:211]
    ds_read_b128 v[16:19], v2 offset:40960
    v_permlane32_swap_b32 v113, v115
    v_mfma_f32_16x16x32_bf16 v[212:215], a[60:63], v[20:23], v[212:215]
    s_nop 0
    v_permlane16_swap_b32 v112, v113
    v_mfma_f32_16x16x32_bf16 v[216:219], a[64:67], v[20:23], v[216:219]
    buffer_load_dwordx4 a[44:47], v2, s[8:11], s40 offen offset:3072 sc1
    v_mfma_f32_16x16x32_bf16 v[220:223], a[68:71], v[20:23], v[220:223]
    s_add_u32 s40, s40, 4096
    s_waitcnt lgkmcnt(2)
    v_mfma_f32_16x16x32_bf16 v[224:227], a[56:59], v[24:27], v[224:227]
    ds_read_b128 v[20:23], v2 offset:41984
    v_permlane16_swap_b32 v114, v115
    v_mfma_f32_16x16x32_bf16 v[228:231], a[60:63], v[24:27], v[228:231]
    v_accvgpr_read_b32 v116, a192
    v_mfma_f32_16x16x32_bf16 v[232:235], a[64:67], v[24:27], v[232:235]
    buffer_load_dwordx4 a[48:51], v2, s[8:11], s40 offen offset:0 sc1
    v_mfma_f32_16x16x32_bf16 v[236:239], a[68:71], v[24:27], v[236:239]
    s_waitcnt lgkmcnt(2)
    v_mfma_f32_16x16x32_bf16 v[240:243], a[56:59], v[28:31], v[240:243]
    ds_read_b128 v[24:27], v2 offset:43008
    v_accvgpr_read_b32 v117, a193
    v_mfma_f32_16x16x32_bf16 v[244:247], a[60:63], v[28:31], v[244:247]
    v_accvgpr_read_b32 v118, a194
    v_mfma_f32_16x16x32_bf16 v[248:251], a[64:67], v[28:31], v[248:251]
    buffer_load_dwordx4 a[52:55], v2, s[8:11], s40 offen offset:1024 sc1
    v_mfma_f32_16x16x32_bf16 v[252:255], a[68:71], v[28:31], v[252:255]
    s_waitcnt lgkmcnt(2)
    v_mfma_f32_16x16x32_bf16 v[128:131], a[56:59], v[16:19], v[128:131]
    ds_read_b128 v[28:31], v2 offset:44032
    v_accvgpr_read_b32 v119, a195
    v_mfma_f32_16x16x32_bf16 v[132:135], a[60:63], v[16:19], v[132:135]
    v_mul_f32 v116, v116, v118
    v_mfma_f32_16x16x32_bf16 v[136:139], a[64:67], v[16:19], v[136:139]
    buffer_load_dwordx4 v[48:51], v2, s[8:11], s40 offen offset:2048 sc1
    v_mfma_f32_16x16x32_bf16 v[140:143], a[68:71], v[16:19], v[140:143]
    s_waitcnt lgkmcnt(2)
    v_mfma_f32_16x16x32_bf16 v[144:147], a[56:59], v[20:23], v[144:147]
    ds_read_b128 v[16:19], v2 offset:53248
    v_mul_f32 v117, v117, v119
    v_mfma_f32_16x16x32_bf16 v[148:151], a[60:63], v[20:23], v[148:151]
    v_cvt_pk_bf16_f32 v36, v116, v117
    v_mfma_f32_16x16x32_bf16 v[152:155], a[64:67], v[20:23], v[152:155]
    buffer_load_dwordx4 v[52:55], v2, s[8:11], s40 offen offset:3072 sc1
    v_mfma_f32_16x16x32_bf16 v[156:159], a[68:71], v[20:23], v[156:159]
    s_add_u32 s40, s40, 4096
    s_waitcnt lgkmcnt(2)
    v_mfma_f32_16x16x32_bf16 v[160:163], a[56:59], v[24:27], v[160:163]
    ds_read_b128 v[20:23], v2 offset:54272
    v_accvgpr_read_b32 v116, a196
    v_mfma_f32_16x16x32_bf16 v[164:167], a[60:63], v[24:27], v[164:167]
    v_accvgpr_read_b32 v117, a197
    v_mfma_f32_16x16x32_bf16 v[168:171], a[64:67], v[24:27], v[168:171]
    buffer_load_dwordx4 v[56:59], v2, s[8:11], s40 offen offset:0 sc1
    v_mfma_f32_16x16x32_bf16 v[172:175], a[68:71], v[24:27], v[172:175]
    s_waitcnt lgkmcnt(2)
    v_mfma_f32_16x16x32_bf16 v[176:179], a[56:59], v[28:31], v[176:179]
    ds_read_b128 v[24:27], v2 offset:55296
    v_accvgpr_read_b32 v118, a198
    v_mfma_f32_16x16x32_bf16 v[180:183], a[60:63], v[28:31], v[180:183]
    v_accvgpr_read_b32 v119, a199
    v_mfma_f32_16x16x32_bf16 v[184:187], a[64:67], v[28:31], v[184:187]
    buffer_load_dwordx4 v[60:63], v2, s[8:11], s40 offen offset:1024 sc1
    v_mfma_f32_16x16x32_bf16 v[188:191], a[68:71], v[28:31], v[188:191]
    s_mov_b32 s40, s54
    s_waitcnt vmcnt(49) lgkmcnt(2)
    v_mfma_f32_16x16x32_bf16 v[192:195], a[72:75], v[16:19], v[192:195]
    ds_read_b128 v[28:31], v2 offset:56320
    v_mul_f32 v116, v116, v118
    v_mfma_f32_16x16x32_bf16 v[196:199], a[76:79], v[16:19], v[196:199]
    v_mul_f32 v117, v117, v119
    v_mfma_f32_16x16x32_bf16 v[200:203], a[80:83], v[16:19], v[200:203]
    buffer_load_dwordx4 v[64:67], v2, s[8:11], s40 offen offset:0 sc1
    v_mfma_f32_16x16x32_bf16 v[204:207], a[84:87], v[16:19], v[204:207]
    s_waitcnt lgkmcnt(2)
    v_mfma_f32_16x16x32_bf16 v[208:211], a[72:75], v[20:23], v[208:211]
    ds_read_b128 v[16:19], v2 offset:49152
    v_cvt_pk_bf16_f32 v37, v116, v117
    v_mfma_f32_16x16x32_bf16 v[212:215], a[76:79], v[20:23], v[212:215]
    v_accvgpr_read_b32 v116, a200
    v_mfma_f32_16x16x32_bf16 v[216:219], a[80:83], v[20:23], v[216:219]
    buffer_load_dwordx4 v[68:71], v2, s[8:11], s40 offen offset:1024 sc1
    v_mfma_f32_16x16x32_bf16 v[220:223], a[84:87], v[20:23], v[220:223]
    s_waitcnt lgkmcnt(2)
    v_mfma_f32_16x16x32_bf16 v[224:227], a[72:75], v[24:27], v[224:227]
    ds_read_b128 v[20:23], v2 offset:50176
    v_accvgpr_read_b32 v117, a201
    v_mfma_f32_16x16x32_bf16 v[228:231], a[76:79], v[24:27], v[228:231]
    v_accvgpr_read_b32 v118, a202
    v_mfma_f32_16x16x32_bf16 v[232:235], a[80:83], v[24:27], v[232:235]
    buffer_load_dwordx4 v[72:75], v2, s[8:11], s40 offen offset:2048 sc1
    v_mfma_f32_16x16x32_bf16 v[236:239], a[84:87], v[24:27], v[236:239]
    s_waitcnt lgkmcnt(2)
    v_mfma_f32_16x16x32_bf16 v[240:243], a[72:75], v[28:31], v[240:243]
    ds_read_b128 v[24:27], v2 offset:51200
    v_accvgpr_read_b32 v119, a203
    v_mfma_f32_16x16x32_bf16 v[244:247], a[76:79], v[28:31], v[244:247]
    v_mul_f32 v116, v116, v118
    v_mfma_f32_16x16x32_bf16 v[248:251], a[80:83], v[28:31], v[248:251]
    buffer_load_dwordx4 v[76:79], v2, s[8:11], s40 offen offset:3072 sc1
    v_mfma_f32_16x16x32_bf16 v[252:255], a[84:87], v[28:31], v[252:255]
    s_add_u32 s40, s40, 4096
    s_waitcnt lgkmcnt(2)
    v_mfma_f32_16x16x32_bf16 v[128:131], a[72:75], v[16:19], v[128:131]
    ds_read_b128 v[28:31], v2 offset:52224
    v_mul_f32 v117, v117, v119
    v_mfma_f32_16x16x32_bf16 v[132:135], a[76:79], v[16:19], v[132:135]
    v_cvt_pk_bf16_f32 v38, v116, v117
    v_mfma_f32_16x16x32_bf16 v[136:139], a[80:83], v[16:19], v[136:139]
    buffer_load_dwordx4 v[80:83], v2, s[8:11], s40 offen offset:0 sc1
    v_mfma_f32_16x16x32_bf16 v[140:143], a[84:87], v[16:19], v[140:143]
    s_waitcnt lgkmcnt(2)
    v_mfma_f32_16x16x32_bf16 v[144:147], a[72:75], v[20:23], v[144:147]
    ds_read_b128 v[16:19], v2 offset:61440
    v_accvgpr_read_b32 v116, a204
    v_mfma_f32_16x16x32_bf16 v[148:151], a[76:79], v[20:23], v[148:151]
    v_accvgpr_read_b32 v117, a205
    v_mfma_f32_16x16x32_bf16 v[152:155], a[80:83], v[20:23], v[152:155]
    buffer_load_dwordx4 v[84:87], v2, s[8:11], s40 offen offset:1024 sc1
    v_mfma_f32_16x16x32_bf16 v[156:159], a[84:87], v[20:23], v[156:159]
    s_waitcnt lgkmcnt(2)
    v_mfma_f32_16x16x32_bf16 v[160:163], a[72:75], v[24:27], v[160:163]
    ds_read_b128 v[20:23], v2 offset:62464
    v_accvgpr_read_b32 v118, a206
    v_mfma_f32_16x16x32_bf16 v[164:167], a[76:79], v[24:27], v[164:167]
    v_accvgpr_read_b32 v119, a207
    v_mfma_f32_16x16x32_bf16 v[168:171], a[80:83], v[24:27], v[168:171]
    buffer_load_dwordx4 v[88:91], v2, s[8:11], s40 offen offset:2048 sc1
    v_mfma_f32_16x16x32_bf16 v[172:175], a[84:87], v[24:27], v[172:175]
    s_waitcnt lgkmcnt(2)
    v_mfma_f32_16x16x32_bf16 v[176:179], a[72:75], v[28:31], v[176:179]
    ds_read_b128 v[24:27], v2 offset:63488
    v_mul_f32 v116, v116, v118
    v_mfma_f32_16x16x32_bf16 v[180:183], a[76:79], v[28:31], v[180:183]
    v_mul_f32 v117, v117, v119
    v_mfma_f32_16x16x32_bf16 v[184:187], a[80:83], v[28:31], v[184:187]
    buffer_load_dwordx4 v[92:95], v2, s[8:11], s40 offen offset:3072 sc1
    v_mfma_f32_16x16x32_bf16 v[188:191], a[84:87], v[28:31], v[188:191]
    s_add_u32 s40, s40, 4096
    s_waitcnt vmcnt(53) lgkmcnt(2)
    v_mfma_f32_16x16x32_bf16 v[192:195], a[88:91], v[16:19], v[192:195]
    ds_read_b128 v[28:31], v2 offset:64512
    v_cvt_pk_bf16_f32 v39, v116, v117
    v_mfma_f32_16x16x32_bf16 v[196:199], a[92:95], v[16:19], v[196:199]
    ds_write_b128 v5, v[36:39] offset:0
    v_mfma_f32_16x16x32_bf16 v[200:203], a[96:99], v[16:19], v[200:203]
    buffer_load_dwordx4 v[96:99], v2, s[8:11], s40 offen offset:0 sc1
    v_mfma_f32_16x16x32_bf16 v[204:207], a[100:103], v[16:19], v[204:207]
    s_waitcnt lgkmcnt(3)
    v_mfma_f32_16x16x32_bf16 v[208:211], a[88:91], v[20:23], v[208:211]
    ds_read_b128 v[16:19], v2 offset:57344
    v_accvgpr_read_b32 v116, a208
    v_mfma_f32_16x16x32_bf16 v[212:215], a[92:95], v[20:23], v[212:215]
    v_accvgpr_read_b32 v117, a209
    v_mfma_f32_16x16x32_bf16 v[216:219], a[96:99], v[20:23], v[216:219]
    buffer_load_dwordx4 v[100:103], v2, s[8:11], s40 offen offset:1024 sc1
    v_mfma_f32_16x16x32_bf16 v[220:223], a[100:103], v[20:23], v[220:223]
    s_waitcnt lgkmcnt(3)
    v_mfma_f32_16x16x32_bf16 v[224:227], a[88:91], v[24:27], v[224:227]
    ds_read_b128 v[20:23], v2 offset:58368
    v_accvgpr_read_b32 v118, a210
    v_mfma_f32_16x16x32_bf16 v[228:231], a[92:95], v[24:27], v[228:231]
    v_accvgpr_read_b32 v119, a211
    v_mfma_f32_16x16x32_bf16 v[232:235], a[96:99], v[24:27], v[232:235]
    buffer_load_dwordx4 v[104:107], v2, s[8:11], s40 offen offset:2048 sc1
    v_mfma_f32_16x16x32_bf16 v[236:239], a[100:103], v[24:27], v[236:239]
    s_waitcnt lgkmcnt(3)
    v_mfma_f32_16x16x32_bf16 v[240:243], a[88:91], v[28:31], v[240:243]
    ds_read_b128 v[24:27], v2 offset:59392
    v_mul_f32 v116, v116, v118
    v_mfma_f32_16x16x32_bf16 v[244:247], a[92:95], v[28:31], v[244:247]
    v_mul_f32 v117, v117, v119
    v_mfma_f32_16x16x32_bf16 v[248:251], a[96:99], v[28:31], v[248:251]
    buffer_load_dwordx4 v[108:111], v2, s[8:11], s40 offen offset:3072 sc1
    v_mfma_f32_16x16x32_bf16 v[252:255], a[100:103], v[28:31], v[252:255]
    s_add_u32 s40, s40, 4096
    s_waitcnt lgkmcnt(2)
    v_mfma_f32_16x16x32_bf16 v[128:131], a[88:91], v[16:19], v[128:131]
    ds_read_b128 v[28:31], v2 offset:60416
    v_cvt_pk_bf16_f32 v40, v116, v117
    v_mfma_f32_16x16x32_bf16 v[132:135], a[92:95], v[16:19], v[132:135]
    v_accvgpr_read_b32 v116, a212
    v_mfma_f32_16x16x32_bf16 v[136:139], a[96:99], v[16:19], v[136:139]
    buffer_load_dwordx4 a[56:59], v2, s[8:11], s40 offen offset:0 sc1
    v_mfma_f32_16x16x32_bf16 v[140:143], a[100:103], v[16:19], v[140:143]
    s_waitcnt lgkmcnt(2)
    v_mfma_f32_16x16x32_bf16 v[144:147], a[88:91], v[20:23], v[144:147]
    ds_read_b128 v[16:19], v3 offset:4096
    v_accvgpr_read_b32 v117, a213
    v_mfma_f32_16x16x32_bf16 v[148:151], a[92:95], v[20:23], v[148:151]
    v_accvgpr_read_b32 v118, a214
    v_mfma_f32_16x16x32_bf16 v[152:155], a[96:99], v[20:23], v[152:155]
    buffer_load_dwordx4 a[60:63], v2, s[8:11], s40 offen offset:1024 sc1
    v_mfma_f32_16x16x32_bf16 v[156:159], a[100:103], v[20:23], v[156:159]
    s_waitcnt lgkmcnt(2)
    v_mfma_f32_16x16x32_bf16 v[160:163], a[88:91], v[24:27], v[160:163]
    ds_read_b128 v[20:23], v3 offset:5120
    v_accvgpr_read_b32 v119, a215
    v_mfma_f32_16x16x32_bf16 v[164:167], a[92:95], v[24:27], v[164:167]
    v_mul_f32 v116, v116, v118
    v_mfma_f32_16x16x32_bf16 v[168:171], a[96:99], v[24:27], v[168:171]
    buffer_load_dwordx4 a[64:67], v2, s[8:11], s40 offen offset:2048 sc1
    v_mfma_f32_16x16x32_bf16 v[172:175], a[100:103], v[24:27], v[172:175]
    s_waitcnt lgkmcnt(2)
    v_mfma_f32_16x16x32_bf16 v[176:179], a[88:91], v[28:31], v[176:179]
    ds_read_b128 v[24:27], v3 offset:6144
    v_mul_f32 v117, v117, v119
    v_mfma_f32_16x16x32_bf16 v[180:183], a[92:95], v[28:31], v[180:183]
    v_cvt_pk_bf16_f32 v41, v116, v117
    v_mfma_f32_16x16x32_bf16 v[184:187], a[96:99], v[28:31], v[184:187]
    buffer_load_dwordx4 a[68:71], v2, s[8:11], s40 offen offset:3072 sc1
    v_mfma_f32_16x16x32_bf16 v[188:191], a[100:103], v[28:31], v[188:191]
    s_add_u32 s40, s40, 4096
    s_waitcnt vmcnt(57) lgkmcnt(2)
    v_mfma_f32_16x16x32_bf16 v[192:195], a[104:107], v[16:19], v[192:195]
    ds_read_b128 v[28:31], v3 offset:7168
    v_accvgpr_read_b32 v116, a216
    v_mfma_f32_16x16x32_bf16 v[196:199], a[108:111], v[16:19], v[196:199]
    v_accvgpr_read_b32 v117, a217
    v_mfma_f32_16x16x32_bf16 v[200:203], a[112:115], v[16:19], v[200:203]
    buffer_load_dwordx4 a[72:75], v2, s[8:11], s40 offen offset:0 sc1
    v_mfma_f32_16x16x32_bf16 v[204:207], a[116:119], v[16:19], v[204:207]
    s_waitcnt lgkmcnt(2)
    v_mfma_f32_16x16x32_bf16 v[208:211], a[104:107], v[20:23], v[208:211]
    ds_read_b128 v[16:19], v3 offset:0
    v_accvgpr_read_b32 v118, a218
    v_mfma_f32_16x16x32_bf16 v[212:215], a[108:111], v[20:23], v[212:215]
    v_accvgpr_read_b32 v119, a219
    v_mfma_f32_16x16x32_bf16 v[216:219], a[112:115], v[20:23], v[216:219]
    buffer_load_dwordx4 a[76:79], v2, s[8:11], s40 offen offset:1024 sc1
    v_mfma_f32_16x16x32_bf16 v[220:223], a[116:119], v[20:23], v[220:223]
    s_waitcnt lgkmcnt(2)
    v_mfma_f32_16x16x32_bf16 v[224:227], a[104:107], v[24:27], v[224:227]
    ds_read_b128 v[20:23], v3 offset:1024
    v_mul_f32 v116, v116, v118
    v_mfma_f32_16x16x32_bf16 v[228:231], a[108:111], v[24:27], v[228:231]
    v_mul_f32 v117, v117, v119
    v_mfma_f32_16x16x32_bf16 v[232:235], a[112:115], v[24:27], v[232:235]
    buffer_load_dwordx4 a[80:83], v2, s[8:11], s40 offen offset:2048 sc1
    v_mfma_f32_16x16x32_bf16 v[236:239], a[116:119], v[24:27], v[236:239]
    s_waitcnt lgkmcnt(2)
    v_mfma_f32_16x16x32_bf16 v[240:243], a[104:107], v[28:31], v[240:243]
    ds_read_b128 v[24:27], v3 offset:2048
    v_cvt_pk_bf16_f32 v42, v116, v117
    v_mfma_f32_16x16x32_bf16 v[244:247], a[108:111], v[28:31], v[244:247]
    v_accvgpr_read_b32 v116, a220
    v_mfma_f32_16x16x32_bf16 v[248:251], a[112:115], v[28:31], v[248:251]
    buffer_load_dwordx4 a[84:87], v2, s[8:11], s40 offen offset:3072 sc1
    v_mfma_f32_16x16x32_bf16 v[252:255], a[116:119], v[28:31], v[252:255]
    s_add_u32 s40, s40, 4096
    s_waitcnt lgkmcnt(2)
    v_mfma_f32_16x16x32_bf16 v[128:131], a[104:107], v[16:19], v[128:131]
    ds_read_b128 v[28:31], v3 offset:3072
    v_accvgpr_read_b32 v117, a221
    v_mfma_f32_16x16x32_bf16 v[132:135], a[108:111], v[16:19], v[132:135]
    v_accvgpr_read_b32 v118, a222
    v_mfma_f32_16x16x32_bf16 v[136:139], a[112:115], v[16:19], v[136:139]
    buffer_load_dwordx4 a[88:91], v2, s[8:11], s40 offen offset:0 sc1
    v_mfma_f32_16x16x32_bf16 v[140:143], a[116:119], v[16:19], v[140:143]
    s_waitcnt lgkmcnt(2)
    v_mfma_f32_16x16x32_bf16 v[144:147], a[104:107], v[20:23], v[144:147]
    ds_read_b128 v[16:19], v3 offset:12288
    v_accvgpr_read_b32 v119, a223
    v_mfma_f32_16x16x32_bf16 v[148:151], a[108:111], v[20:23], v[148:151]
    v_mul_f32 v116, v116, v118
    v_mfma_f32_16x16x32_bf16 v[152:155], a[112:115], v[20:23], v[152:155]
    s_waitcnt vmcnt(60)
    buffer_load_dwordx4 a[92:95], v2, s[8:11], s40 offen offset:1024 sc1
    v_mfma_f32_16x16x32_bf16 v[156:159], a[116:119], v[20:23], v[156:159]
    s_waitcnt lgkmcnt(2)
    v_mfma_f32_16x16x32_bf16 v[160:163], a[104:107], v[24:27], v[160:163]
    ds_read_b128 v[20:23], v3 offset:13312
    v_mul_f32 v117, v117, v119
    v_mfma_f32_16x16x32_bf16 v[164:167], a[108:111], v[24:27], v[164:167]
    v_cvt_pk_bf16_f32 v43, v116, v117
    v_mfma_f32_16x16x32_bf16 v[168:171], a[112:115], v[24:27], v[168:171]
    buffer_load_dwordx4 a[96:99], v2, s[8:11], s40 offen offset:2048 sc1
    v_mfma_f32_16x16x32_bf16 v[172:175], a[116:119], v[24:27], v[172:175]
    s_waitcnt lgkmcnt(2)
    v_mfma_f32_16x16x32_bf16 v[176:179], a[104:107], v[28:31], v[176:179]
    ds_read_b128 v[24:27], v3 offset:14336
    ds_write_b128 v5, v[40:43] offset:1024
    v_mfma_f32_16x16x32_bf16 v[180:183], a[108:111], v[28:31], v[180:183]
    v_accvgpr_read_b32 v116, a224
    v_mfma_f32_16x16x32_bf16 v[184:187], a[112:115], v[28:31], v[184:187]
    s_waitcnt vmcnt(60)
    buffer_load_dwordx4 a[100:103], v2, s[8:11], s40 offen offset:3072 sc1
    v_mfma_f32_16x16x32_bf16 v[188:191], a[116:119], v[28:31], v[188:191]
    s_add_u32 s40, s40, 4096
    s_waitcnt vmcnt(61) lgkmcnt(3)
    v_mfma_f32_16x16x32_bf16 v[192:195], a[120:123], v[16:19], v[192:195]
    ds_read_b128 v[28:31], v3 offset:15360
    v_accvgpr_read_b32 v117, a225
    v_mfma_f32_16x16x32_bf16 v[196:199], a[124:127], v[16:19], v[196:199]
    v_accvgpr_read_b32 v118, a226
    v_mfma_f32_16x16x32_bf16 v[200:203], a[128:131], v[16:19], v[200:203]
    buffer_load_dwordx4 a[104:107], v2, s[8:11], s40 offen offset:0 sc1
    v_mfma_f32_16x16x32_bf16 v[204:207], a[132:135], v[16:19], v[204:207]
    s_waitcnt lgkmcnt(3)
    v_mfma_f32_16x16x32_bf16 v[208:211], a[120:123], v[20:23], v[208:211]
    ds_read_b128 v[16:19], v3 offset:8192
    v_accvgpr_read_b32 v119, a227
    v_mfma_f32_16x16x32_bf16 v[212:215], a[124:127], v[20:23], v[212:215]
    v_mul_f32 v116, v116, v118
    v_mfma_f32_16x16x32_bf16 v[216:219], a[128:131], v[20:23], v[216:219]
    s_waitcnt vmcnt(60)
    buffer_load_dwordx4 a[108:111], v2, s[8:11], s40 offen offset:1024 sc1
    v_mfma_f32_16x16x32_bf16 v[220:223], a[132:135], v[20:23], v[220:223]
    s_waitcnt lgkmcnt(3)
    v_mfma_f32_16x16x32_bf16 v[224:227], a[120:123], v[24:27], v[224:227]
    ds_read_b128 v[20:23], v3 offset:9216
    v_mul_f32 v117, v117, v119
    v_mfma_f32_16x16x32_bf16 v[228:231], a[124:127], v[24:27], v[228:231]
    v_cvt_pk_bf16_f32 v44, v116, v117
    v_mfma_f32_16x16x32_bf16 v[232:235], a[128:131], v[24:27], v[232:235]
    buffer_load_dwordx4 a[112:115], v2, s[8:11], s40 offen offset:2048 sc1
    v_mfma_f32_16x16x32_bf16 v[236:239], a[132:135], v[24:27], v[236:239]
    s_waitcnt lgkmcnt(2)
    v_mfma_f32_16x16x32_bf16 v[240:243], a[120:123], v[28:31], v[240:243]
    ds_read_b128 v[24:27], v3 offset:10240
    v_accvgpr_read_b32 v116, a228
    v_mfma_f32_16x16x32_bf16 v[244:247], a[124:127], v[28:31], v[244:247]
    v_accvgpr_read_b32 v117, a229
    v_mfma_f32_16x16x32_bf16 v[248:251], a[128:131], v[28:31], v[248:251]
    s_waitcnt vmcnt(60)
    buffer_load_dwordx4 a[116:119], v2, s[8:11], s40 offen offset:3072 sc1
    v_mfma_f32_16x16x32_bf16 v[252:255], a[132:135], v[28:31], v[252:255]
    s_add_u32 s40, s40, 4096
    s_waitcnt lgkmcnt(2)
    v_mfma_f32_16x16x32_bf16 v[128:131], a[120:123], v[16:19], v[128:131]
    ds_read_b128 v[28:31], v3 offset:11264
    v_accvgpr_read_b32 v118, a230
    v_mfma_f32_16x16x32_bf16 v[132:135], a[124:127], v[16:19], v[132:135]
    v_accvgpr_read_b32 v119, a231
    v_mfma_f32_16x16x32_bf16 v[136:139], a[128:131], v[16:19], v[136:139]
    v_mfma_f32_16x16x32_bf16 v[140:143], a[132:135], v[16:19], v[140:143]
    s_waitcnt lgkmcnt(2)
    v_mfma_f32_16x16x32_bf16 v[144:147], a[120:123], v[20:23], v[144:147]
    ds_read_b128 v[16:19], v3 offset:20480
    v_mul_f32 v116, v116, v118
    v_mfma_f32_16x16x32_bf16 v[148:151], a[124:127], v[20:23], v[148:151]
    v_mul_f32 v117, v117, v119
    v_mfma_f32_16x16x32_bf16 v[152:155], a[128:131], v[20:23], v[152:155]
    v_mfma_f32_16x16x32_bf16 v[156:159], a[132:135], v[20:23], v[156:159]
    s_waitcnt lgkmcnt(2)
    v_mfma_f32_16x16x32_bf16 v[160:163], a[120:123], v[24:27], v[160:163]
    ds_read_b128 v[20:23], v3 offset:21504
    v_cvt_pk_bf16_f32 v45, v116, v117
    v_mfma_f32_16x16x32_bf16 v[164:167], a[124:127], v[24:27], v[164:167]
    v_accvgpr_read_b32 v116, a232
    v_mfma_f32_16x16x32_bf16 v[168:171], a[128:131], v[24:27], v[168:171]
    v_mfma_f32_16x16x32_bf16 v[172:175], a[132:135], v[24:27], v[172:175]
    s_waitcnt lgkmcnt(2)
    v_mfma_f32_16x16x32_bf16 v[176:179], a[120:123], v[28:31], v[176:179]
    ds_read_b128 v[24:27], v3 offset:22528
    v_accvgpr_read_b32 v117, a233
    v_mfma_f32_16x16x32_bf16 v[180:183], a[124:127], v[28:31], v[180:183]
    v_accvgpr_read_b32 v118, a234
    v_mfma_f32_16x16x32_bf16 v[184:187], a[128:131], v[28:31], v[184:187]
    v_mfma_f32_16x16x32_bf16 v[188:191], a[132:135], v[28:31], v[188:191]
    s_waitcnt vmcnt(61) lgkmcnt(2)
    v_mfma_f32_16x16x32_bf16 v[192:195], a[136:139], v[16:19], v[192:195]
    ds_read_b128 v[28:31], v3 offset:23552
    v_accvgpr_read_b32 v119, a235
    v_mfma_f32_16x16x32_bf16 v[196:199], a[140:143], v[16:19], v[196:199]
    v_mul_f32 v116, v116, v118
    v_mfma_f32_16x16x32_bf16 v[200:203], a[144:147], v[16:19], v[200:203]
    buffer_load_dwordx4 a[120:123], v2, s[8:11], s40 offen offset:0 sc1
    v_mfma_f32_16x16x32_bf16 v[204:207], a[148:151], v[16:19], v[204:207]
    s_waitcnt lgkmcnt(2)
    v_mfma_f32_16x16x32_bf16 v[208:211], a[136:139], v[20:23], v[208:211]
    ds_read_b128 v[16:19], v3 offset:16384
    v_mul_f32 v117, v117, v119
    v_mfma_f32_16x16x32_bf16 v[212:215], a[140:143], v[20:23], v[212:215]
    v_cvt_pk_bf16_f32 v46, v116, v117
    v_mfma_f32_16x16x32_bf16 v[216:219], a[144:147], v[20:23], v[216:219]
    s_waitcnt vmcnt(60)
    buffer_load_dwordx4 a[124:127], v2, s[8:11], s40 offen offset:1024 sc1
    v_mfma_f32_16x16x32_bf16 v[220:223], a[148:151], v[20:23], v[220:223]
    s_waitcnt lgkmcnt(2)
    v_mfma_f32_16x16x32_bf16 v[224:227], a[136:139], v[24:27], v[224:227]
    ds_read_b128 v[20:23], v3 offset:17408
    v_accvgpr_read_b32 v116, a236
    v_mfma_f32_16x16x32_bf16 v[228:231], a[140:143], v[24:27], v[228:231]
    v_accvgpr_read_b32 v117, a237
    v_mfma_f32_16x16x32_bf16 v[232:235], a[144:147], v[24:27], v[232:235]
    buffer_load_dwordx4 a[128:131], v2, s[8:11], s40 offen offset:2048 sc1
    v_mfma_f32_16x16x32_bf16 v[236:239], a[148:151], v[24:27], v[236:239]
    s_waitcnt lgkmcnt(2)
    v_mfma_f32_16x16x32_bf16 v[240:243], a[136:139], v[28:31], v[240:243]
    ds_read_b128 v[24:27], v3 offset:18432
    v_accvgpr_read_b32 v118, a238
    v_mfma_f32_16x16x32_bf16 v[244:247], a[140:143], v[28:31], v[244:247]
    v_accvgpr_read_b32 v119, a239
    v_mfma_f32_16x16x32_bf16 v[248:251], a[144:147], v[28:31], v[248:251]
    s_waitcnt vmcnt(60)
    buffer_load_dwordx4 a[132:135], v2, s[8:11], s40 offen offset:3072 sc1
    v_mfma_f32_16x16x32_bf16 v[252:255], a[148:151], v[28:31], v[252:255]
    s_add_u32 s40, s40, 4096
    s_waitcnt lgkmcnt(2)
    v_mfma_f32_16x16x32_bf16 v[128:131], a[136:139], v[16:19], v[128:131]
    ds_read_b128 v[28:31], v3 offset:19456
    v_mul_f32 v116, v116, v118
    v_mfma_f32_16x16x32_bf16 v[132:135], a[140:143], v[16:19], v[132:135]
    v_mul_f32 v117, v117, v119
    v_mfma_f32_16x16x32_bf16 v[136:139], a[144:147], v[16:19], v[136:139]
    v_mfma_f32_16x16x32_bf16 v[140:143], a[148:151], v[16:19], v[140:143]
    s_waitcnt lgkmcnt(2)
    v_mfma_f32_16x16x32_bf16 v[144:147], a[136:139], v[20:23], v[144:147]
    ds_read_b128 v[16:19], v3 offset:28672
    v_cvt_pk_bf16_f32 v47, v116, v117
    v_mfma_f32_16x16x32_bf16 v[148:151], a[140:143], v[20:23], v[148:151]
    ds_write_b128 v5, v[44:47] offset:2048
    v_mfma_f32_16x16x32_bf16 v[152:155], a[144:147], v[20:23], v[152:155]
    v_mfma_f32_16x16x32_bf16 v[156:159], a[148:151], v[20:23], v[156:159]
    s_waitcnt lgkmcnt(3)
    v_mfma_f32_16x16x32_bf16 v[160:163], a[136:139], v[24:27], v[160:163]
    ds_read_b128 v[20:23], v3 offset:29696
    v_accvgpr_read_b32 v116, a240
    v_mfma_f32_16x16x32_bf16 v[164:167], a[140:143], v[24:27], v[164:167]
    v_accvgpr_read_b32 v117, a241
    v_mfma_f32_16x16x32_bf16 v[168:171], a[144:147], v[24:27], v[168:171]
    v_mfma_f32_16x16x32_bf16 v[172:175], a[148:151], v[24:27], v[172:175]
    s_waitcnt lgkmcnt(3)
    v_mfma_f32_16x16x32_bf16 v[176:179], a[136:139], v[28:31], v[176:179]
    ds_read_b128 v[24:27], v3 offset:30720
    v_accvgpr_read_b32 v118, a242
    v_mfma_f32_16x16x32_bf16 v[180:183], a[140:143], v[28:31], v[180:183]
    v_accvgpr_read_b32 v119, a243
    v_mfma_f32_16x16x32_bf16 v[184:187], a[144:147], v[28:31], v[184:187]
    v_mfma_f32_16x16x32_bf16 v[188:191], a[148:151], v[28:31], v[188:191]
    s_waitcnt vmcnt(61) lgkmcnt(3)
    v_mfma_f32_16x16x32_bf16 v[192:195], a[152:155], v[16:19], v[192:195]
    ds_read_b128 v[28:31], v3 offset:31744
    v_mul_f32 v116, v116, v118
    v_mfma_f32_16x16x32_bf16 v[196:199], a[156:159], v[16:19], v[196:199]
    v_mul_f32 v117, v117, v119
    v_mfma_f32_16x16x32_bf16 v[200:203], a[160:163], v[16:19], v[200:203]
    buffer_load_dwordx4 a[136:139], v2, s[8:11], s40 offen offset:0 sc1
    v_mfma_f32_16x16x32_bf16 v[204:207], a[164:167], v[16:19], v[204:207]
    s_waitcnt lgkmcnt(2)
    v_mfma_f32_16x16x32_bf16 v[208:211], a[152:155], v[20:23], v[208:211]
    ds_read_b128 v[16:19], v3 offset:24576
    v_cvt_pk_bf16_f32 v32, v116, v117
    v_mfma_f32_16x16x32_bf16 v[212:215], a[156:159], v[20:23], v[212:215]
    v_accvgpr_read_b32 v116, a244
    v_mfma_f32_16x16x32_bf16 v[216:219], a[160:163], v[20:23], v[216:219]
    s_waitcnt vmcnt(60)
    buffer_load_dwordx4 a[140:143], v2, s[8:11], s40 offen offset:1024 sc1
    v_mfma_f32_16x16x32_bf16 v[220:223], a[164:167], v[20:23], v[220:223]
    s_waitcnt lgkmcnt(2)
    v_mfma_f32_16x16x32_bf16 v[224:227], a[152:155], v[24:27], v[224:227]
    ds_read_b128 v[20:23], v3 offset:25600
    v_accvgpr_read_b32 v117, a245
    v_mfma_f32_16x16x32_bf16 v[228:231], a[156:159], v[24:27], v[228:231]
    v_accvgpr_read_b32 v118, a246
    v_mfma_f32_16x16x32_bf16 v[232:235], a[160:163], v[24:27], v[232:235]
    buffer_load_dwordx4 a[144:147], v2, s[8:11], s40 offen offset:2048 sc1
    v_mfma_f32_16x16x32_bf16 v[236:239], a[164:167], v[24:27], v[236:239]
    s_waitcnt lgkmcnt(2)
    v_mfma_f32_16x16x32_bf16 v[240:243], a[152:155], v[28:31], v[240:243]
    ds_read_b128 v[24:27], v3 offset:26624
    v_accvgpr_read_b32 v119, a247
    v_mfma_f32_16x16x32_bf16 v[244:247], a[156:159], v[28:31], v[244:247]
    v_mul_f32 v116, v116, v118
    v_mfma_f32_16x16x32_bf16 v[248:251], a[160:163], v[28:31], v[248:251]
    s_waitcnt vmcnt(60)
    buffer_load_dwordx4 a[148:151], v2, s[8:11], s40 offen offset:3072 sc1
    v_mfma_f32_16x16x32_bf16 v[252:255], a[164:167], v[28:31], v[252:255]
    s_add_u32 s40, s40, 4096
    s_waitcnt lgkmcnt(2)
    v_mfma_f32_16x16x32_bf16 v[128:131], a[152:155], v[16:19], v[128:131]
    ds_read_b128 v[28:31], v3 offset:27648
    v_mul_f32 v117, v117, v119
    v_mfma_f32_16x16x32_bf16 v[132:135], a[156:159], v[16:19], v[132:135]
    v_cvt_pk_bf16_f32 v33, v116, v117
    v_mfma_f32_16x16x32_bf16 v[136:139], a[160:163], v[16:19], v[136:139]
    v_mfma_f32_16x16x32_bf16 v[140:143], a[164:167], v[16:19], v[140:143]
    s_waitcnt lgkmcnt(2)
    v_mfma_f32_16x16x32_bf16 v[144:147], a[152:155], v[20:23], v[144:147]
    ds_read_b128 v[16:19], v3 offset:36864
    v_accvgpr_read_b32 v116, a248
    v_mfma_f32_16x16x32_bf16 v[148:151], a[156:159], v[20:23], v[148:151]
    v_accvgpr_read_b32 v117, a249
    v_mfma_f32_16x16x32_bf16 v[152:155], a[160:163], v[20:23], v[152:155]
    v_mfma_f32_16x16x32_bf16 v[156:159], a[164:167], v[20:23], v[156:159]
    s_waitcnt lgkmcnt(2)
    v_mfma_f32_16x16x32_bf16 v[160:163], a[152:155], v[24:27], v[160:163]
    ds_read_b128 v[20:23], v3 offset:37888
    v_accvgpr_read_b32 v118, a250
    v_mfma_f32_16x16x32_bf16 v[164:167], a[156:159], v[24:27], v[164:167]
    v_accvgpr_read_b32 v119, a251
    v_mfma_f32_16x16x32_bf16 v[168:171], a[160:163], v[24:27], v[168:171]
    v_mfma_f32_16x16x32_bf16 v[172:175], a[164:167], v[24:27], v[172:175]
    s_waitcnt lgkmcnt(2)
    v_mfma_f32_16x16x32_bf16 v[176:179], a[152:155], v[28:31], v[176:179]
    ds_read_b128 v[24:27], v3 offset:38912
    v_mul_f32 v116, v116, v118
    v_mfma_f32_16x16x32_bf16 v[180:183], a[156:159], v[28:31], v[180:183]
    v_mul_f32 v117, v117, v119
    v_mfma_f32_16x16x32_bf16 v[184:187], a[160:163], v[28:31], v[184:187]
    v_mfma_f32_16x16x32_bf16 v[188:191], a[164:167], v[28:31], v[188:191]
    s_waitcnt vmcnt(60) lgkmcnt(2)
    v_mfma_f32_16x16x32_bf16 v[192:195], a[168:171], v[16:19], v[192:195]
    ds_read_b128 v[28:31], v3 offset:39936
    v_cvt_pk_bf16_f32 v34, v116, v117
    v_mfma_f32_16x16x32_bf16 v[196:199], a[172:175], v[16:19], v[196:199]
    v_accvgpr_read_b32 v116, a252
    v_mfma_f32_16x16x32_bf16 v[200:203], a[176:179], v[16:19], v[200:203]
    buffer_load_dwordx4 a[152:155], v2, s[8:11], s40 offen offset:0 sc1
    v_mfma_f32_16x16x32_bf16 v[204:207], a[180:183], v[16:19], v[204:207]
    s_waitcnt lgkmcnt(2)
    v_mfma_f32_16x16x32_bf16 v[208:211], a[168:171], v[20:23], v[208:211]
    ds_read_b128 v[16:19], v3 offset:32768
    v_accvgpr_read_b32 v117, a253
    v_mfma_f32_16x16x32_bf16 v[212:215], a[172:175], v[20:23], v[212:215]
    v_accvgpr_read_b32 v118, a254
    v_mfma_f32_16x16x32_bf16 v[216:219], a[176:179], v[20:23], v[216:219]
    buffer_load_dwordx4 a[156:159], v2, s[8:11], s40 offen offset:1024 sc1
    v_mfma_f32_16x16x32_bf16 v[220:223], a[180:183], v[20:23], v[220:223]
    s_waitcnt lgkmcnt(2)
    v_mfma_f32_16x16x32_bf16 v[224:227], a[168:171], v[24:27], v[224:227]
    ds_read_b128 v[20:23], v3 offset:33792
    v_accvgpr_read_b32 v119, a255
    v_mfma_f32_16x16x32_bf16 v[228:231], a[172:175], v[24:27], v[228:231]
    v_mul_f32 v116, v116, v118
    v_mfma_f32_16x16x32_bf16 v[232:235], a[176:179], v[24:27], v[232:235]
    s_waitcnt vmcnt(60)
    buffer_load_dwordx4 a[160:163], v2, s[8:11], s40 offen offset:2048 sc1
    v_mfma_f32_16x16x32_bf16 v[236:239], a[180:183], v[24:27], v[236:239]
    s_waitcnt lgkmcnt(2)
    v_mfma_f32_16x16x32_bf16 v[240:243], a[168:171], v[28:31], v[240:243]
    ds_read_b128 v[24:27], v3 offset:34816
    v_mul_f32 v117, v117, v119
    v_mfma_f32_16x16x32_bf16 v[244:247], a[172:175], v[28:31], v[244:247]
    v_cvt_pk_bf16_f32 v35, v116, v117
    v_mfma_f32_16x16x32_bf16 v[248:251], a[176:179], v[28:31], v[248:251]
    buffer_load_dwordx4 a[164:167], v2, s[8:11], s40 offen offset:3072 sc1
    v_mfma_f32_16x16x32_bf16 v[252:255], a[180:183], v[28:31], v[252:255]
    s_add_u32 s40, s40, 4096
    s_waitcnt lgkmcnt(2)
    v_mfma_f32_16x16x32_bf16 v[128:131], a[168:171], v[16:19], v[128:131]
    ds_read_b128 v[28:31], v3 offset:35840
    ds_write_b128 v5, v[32:35] offset:3072
    v_mfma_f32_16x16x32_bf16 v[132:135], a[172:175], v[16:19], v[132:135]
    ds_write_b128 v6, v[112:115]
    v_mfma_f32_16x16x32_bf16 v[136:139], a[176:179], v[16:19], v[136:139]
    s_waitcnt vmcnt(60)
    buffer_load_dwordx4 a[192:195], v2, s[8:11], s40 offen offset:0 sc1
    v_mfma_f32_16x16x32_bf16 v[140:143], a[180:183], v[16:19], v[140:143]
    s_waitcnt lgkmcnt(4)
    v_mfma_f32_16x16x32_bf16 v[144:147], a[168:171], v[20:23], v[144:147]
    ds_read_b128 v[16:19], v3 offset:45056
    v_mfma_f32_16x16x32_bf16 v[148:151], a[172:175], v[20:23], v[148:151]
    v_mfma_f32_16x16x32_bf16 v[152:155], a[176:179], v[20:23], v[152:155]
    buffer_load_dwordx4 a[196:199], v2, s[8:11], s40 offen offset:1024 sc1
    v_mfma_f32_16x16x32_bf16 v[156:159], a[180:183], v[20:23], v[156:159]
    s_waitcnt lgkmcnt(4)
    v_mfma_f32_16x16x32_bf16 v[160:163], a[168:171], v[24:27], v[160:163]
    ds_read_b128 v[20:23], v3 offset:46080
    v_mfma_f32_16x16x32_bf16 v[164:167], a[172:175], v[24:27], v[164:167]
    v_mfma_f32_16x16x32_bf16 v[168:171], a[176:179], v[24:27], v[168:171]
    s_waitcnt vmcnt(60)
    buffer_load_dwordx4 a[200:203], v2, s[8:11], s40 offen offset:2048 sc1
    v_mfma_f32_16x16x32_bf16 v[172:175], a[180:183], v[24:27], v[172:175]
    s_waitcnt lgkmcnt(4)
    v_mfma_f32_16x16x32_bf16 v[176:179], a[168:171], v[28:31], v[176:179]
    ds_read_b128 v[24:27], v3 offset:47104
    v_mfma_f32_16x16x32_bf16 v[180:183], a[172:175], v[28:31], v[180:183]
    v_mfma_f32_16x16x32_bf16 v[184:187], a[176:179], v[28:31], v[184:187]
    buffer_load_dwordx4 a[204:207], v2, s[8:11], s40 offen offset:3072 sc1
    v_mfma_f32_16x16x32_bf16 v[188:191], a[180:183], v[28:31], v[188:191]
    s_add_u32 s40, s40, 4096
    s_waitcnt vmcnt(63) lgkmcnt(2)
    v_mfma_f32_16x16x32_bf16 v[192:195], a[184:187], v[16:19], v[192:195]
    ds_read_b128 v[28:31], v3 offset:48128
    v_mfma_f32_16x16x32_bf16 v[196:199], a[188:191], v[16:19], v[196:199]
    v_mfma_f32_16x16x32_bf16 v[200:203], a[0:3], v[16:19], v[200:203]
    s_waitcnt vmcnt(60)
    buffer_load_dwordx4 a[208:211], v2, s[8:11], s40 offen offset:0 sc1
    v_mfma_f32_16x16x32_bf16 v[204:207], a[4:7], v[16:19], v[204:207]
    s_waitcnt lgkmcnt(2)
    v_mfma_f32_16x16x32_bf16 v[208:211], a[184:187], v[20:23], v[208:211]
    ds_read_b128 v[16:19], v3 offset:40960
    v_mfma_f32_16x16x32_bf16 v[212:215], a[188:191], v[20:23], v[212:215]
    v_mfma_f32_16x16x32_bf16 v[216:219], a[0:3], v[20:23], v[216:219]
    buffer_load_dwordx4 a[212:215], v2, s[8:11], s40 offen offset:1024 sc1
    v_mfma_f32_16x16x32_bf16 v[220:223], a[4:7], v[20:23], v[220:223]
    s_waitcnt lgkmcnt(2)
    v_mfma_f32_16x16x32_bf16 v[224:227], a[184:187], v[24:27], v[224:227]
    ds_read_b128 v[20:23], v3 offset:41984
    v_mfma_f32_16x16x32_bf16 v[228:231], a[188:191], v[24:27], v[228:231]
    v_mfma_f32_16x16x32_bf16 v[232:235], a[0:3], v[24:27], v[232:235]
    s_waitcnt vmcnt(60)
    buffer_load_dwordx4 a[216:219], v2, s[8:11], s40 offen offset:2048 sc1
    v_mfma_f32_16x16x32_bf16 v[236:239], a[4:7], v[24:27], v[236:239]
    s_waitcnt lgkmcnt(2)
    v_mfma_f32_16x16x32_bf16 v[240:243], a[184:187], v[28:31], v[240:243]
    ds_read_b128 v[24:27], v3 offset:43008
    v_mfma_f32_16x16x32_bf16 v[244:247], a[188:191], v[28:31], v[244:247]
    v_mfma_f32_16x16x32_bf16 v[248:251], a[0:3], v[28:31], v[248:251]
    buffer_load_dwordx4 a[220:223], v2, s[8:11], s40 offen offset:3072 sc1
    v_mfma_f32_16x16x32_bf16 v[252:255], a[4:7], v[28:31], v[252:255]
    s_add_u32 s40, s40, 4096
    s_waitcnt lgkmcnt(2)
    v_mfma_f32_16x16x32_bf16 v[128:131], a[184:187], v[16:19], v[128:131]
    ds_read_b128 v[28:31], v3 offset:44032
    v_mfma_f32_16x16x32_bf16 v[132:135], a[188:191], v[16:19], v[132:135]
    v_mfma_f32_16x16x32_bf16 v[136:139], a[0:3], v[16:19], v[136:139]
    s_waitcnt vmcnt(60)
    buffer_load_dwordx4 a[224:227], v2, s[8:11], s40 offen offset:0 sc1
    v_mfma_f32_16x16x32_bf16 v[140:143], a[4:7], v[16:19], v[140:143]
    s_waitcnt lgkmcnt(2)
    v_mfma_f32_16x16x32_bf16 v[144:147], a[184:187], v[20:23], v[144:147]
    ds_read_b128 v[16:19], v3 offset:53248
    v_mfma_f32_16x16x32_bf16 v[148:151], a[188:191], v[20:23], v[148:151]
    v_mfma_f32_16x16x32_bf16 v[152:155], a[0:3], v[20:23], v[152:155]
    buffer_load_dwordx4 a[228:231], v2, s[8:11], s40 offen offset:1024 sc1
    v_mfma_f32_16x16x32_bf16 v[156:159], a[4:7], v[20:23], v[156:159]
    s_waitcnt lgkmcnt(2)
    v_mfma_f32_16x16x32_bf16 v[160:163], a[184:187], v[24:27], v[160:163]
    ds_read_b128 v[20:23], v3 offset:54272
    v_mfma_f32_16x16x32_bf16 v[164:167], a[188:191], v[24:27], v[164:167]
    v_mfma_f32_16x16x32_bf16 v[168:171], a[0:3], v[24:27], v[168:171]
    s_waitcnt vmcnt(60)
    buffer_load_dwordx4 a[232:235], v2, s[8:11], s40 offen offset:2048 sc1
    v_mfma_f32_16x16x32_bf16 v[172:175], a[4:7], v[24:27], v[172:175]
    s_waitcnt lgkmcnt(2)
    v_mfma_f32_16x16x32_bf16 v[176:179], a[184:187], v[28:31], v[176:179]
    ds_read_b128 v[24:27], v3 offset:55296
    v_mfma_f32_16x16x32_bf16 v[180:183], a[188:191], v[28:31], v[180:183]
    v_mfma_f32_16x16x32_bf16 v[184:187], a[0:3], v[28:31], v[184:187]
    buffer_load_dwordx4 a[236:239], v2, s[8:11], s40 offen offset:3072 sc1
    v_mfma_f32_16x16x32_bf16 v[188:191], a[4:7], v[28:31], v[188:191]
    s_add_u32 s40, s40, 4096
    s_waitcnt vmcnt(63) lgkmcnt(2)
    v_mfma_f32_16x16x32_bf16 v[192:195], a[8:11], v[16:19], v[192:195]
    ds_read_b128 v[28:31], v3 offset:56320
    v_mfma_f32_16x16x32_bf16 v[196:199], a[12:15], v[16:19], v[196:199]
    v_mfma_f32_16x16x32_bf16 v[200:203], a[16:19], v[16:19], v[200:203]
    s_waitcnt vmcnt(60)
    buffer_load_dwordx4 a[240:243], v2, s[8:11], s40 offen offset:0 sc1
    v_mfma_f32_16x16x32_bf16 v[204:207], a[20:23], v[16:19], v[204:207]
    s_waitcnt lgkmcnt(2)
    v_mfma_f32_16x16x32_bf16 v[208:211], a[8:11], v[20:23], v[208:211]
    ds_read_b128 v[16:19], v3 offset:49152
    v_mfma_f32_16x16x32_bf16 v[212:215], a[12:15], v[20:23], v[212:215]
    v_mfma_f32_16x16x32_bf16 v[216:219], a[16:19], v[20:23], v[216:219]
    buffer_load_dwordx4 a[244:247], v2, s[8:11], s40 offen offset:1024 sc1
    v_mfma_f32_16x16x32_bf16 v[220:223], a[20:23], v[20:23], v[220:223]
    s_waitcnt lgkmcnt(2)
    v_mfma_f32_16x16x32_bf16 v[224:227], a[8:11], v[24:27], v[224:227]
    ds_read_b128 v[20:23], v3 offset:50176
    v_mfma_f32_16x16x32_bf16 v[228:231], a[12:15], v[24:27], v[228:231]
    v_mfma_f32_16x16x32_bf16 v[232:235], a[16:19], v[24:27], v[232:235]
    s_waitcnt vmcnt(60)
    buffer_load_dwordx4 a[248:251], v2, s[8:11], s40 offen offset:2048 sc1
    v_mfma_f32_16x16x32_bf16 v[236:239], a[20:23], v[24:27], v[236:239]
    s_waitcnt lgkmcnt(2)
    v_mfma_f32_16x16x32_bf16 v[240:243], a[8:11], v[28:31], v[240:243]
    ds_read_b128 v[24:27], v3 offset:51200
    v_mfma_f32_16x16x32_bf16 v[244:247], a[12:15], v[28:31], v[244:247]
    v_mfma_f32_16x16x32_bf16 v[248:251], a[16:19], v[28:31], v[248:251]
    buffer_load_dwordx4 a[252:255], v2, s[8:11], s40 offen offset:3072 sc1
    v_mfma_f32_16x16x32_bf16 v[252:255], a[20:23], v[28:31], v[252:255]
    s_add_u32 s40, s40, 4096
    s_waitcnt lgkmcnt(2)
    v_mfma_f32_16x16x32_bf16 v[128:131], a[8:11], v[16:19], v[128:131]
    ds_read_b128 v[28:31], v3 offset:52224
    v_mfma_f32_16x16x32_bf16 v[132:135], a[12:15], v[16:19], v[132:135]
    v_mfma_f32_16x16x32_bf16 v[136:139], a[16:19], v[16:19], v[136:139]
    s_waitcnt vmcnt(60)
    buffer_load_dwordx4 a[168:171], v2, s[8:11], s40 offen offset:0 sc1
    v_mfma_f32_16x16x32_bf16 v[140:143], a[20:23], v[16:19], v[140:143]
    s_waitcnt lgkmcnt(2)
    v_mfma_f32_16x16x32_bf16 v[144:147], a[8:11], v[20:23], v[144:147]
    ds_read_b128 v[16:19], v3 offset:61440
    v_mfma_f32_16x16x32_bf16 v[148:151], a[12:15], v[20:23], v[148:151]
    v_mfma_f32_16x16x32_bf16 v[152:155], a[16:19], v[20:23], v[152:155]
    buffer_load_dwordx4 a[172:175], v2, s[8:11], s40 offen offset:1024 sc1
    v_mfma_f32_16x16x32_bf16 v[156:159], a[20:23], v[20:23], v[156:159]
    s_waitcnt lgkmcnt(2)
    v_mfma_f32_16x16x32_bf16 v[160:163], a[8:11], v[24:27], v[160:163]
    ds_read_b128 v[20:23], v3 offset:62464
    v_mfma_f32_16x16x32_bf16 v[164:167], a[12:15], v[24:27], v[164:167]
    v_mfma_f32_16x16x32_bf16 v[168:171], a[16:19], v[24:27], v[168:171]
    s_waitcnt vmcnt(60)
    buffer_load_dwordx4 a[176:179], v2, s[8:11], s40 offen offset:2048 sc1
    v_mfma_f32_16x16x32_bf16 v[172:175], a[20:23], v[24:27], v[172:175]
    s_waitcnt lgkmcnt(2)
    v_mfma_f32_16x16x32_bf16 v[176:179], a[8:11], v[28:31], v[176:179]
    ds_read_b128 v[24:27], v3 offset:63488
    v_mfma_f32_16x16x32_bf16 v[180:183], a[12:15], v[28:31], v[180:183]
    v_mfma_f32_16x16x32_bf16 v[184:187], a[16:19], v[28:31], v[184:187]
    buffer_load_dwordx4 a[180:183], v2, s[8:11], s40 offen offset:3072 sc1
    v_mfma_f32_16x16x32_bf16 v[188:191], a[20:23], v[28:31], v[188:191]
    s_add_u32 s40, s40, 4096
    s_waitcnt vmcnt(60) lgkmcnt(2)
    v_mfma_f32_16x16x32_bf16 v[192:195], a[24:27], v[16:19], v[192:195]
    ds_read_b128 v[28:31], v3 offset:64512
    v_mfma_f32_16x16x32_bf16 v[196:199], a[28:31], v[16:19], v[196:199]
    v_mfma_f32_16x16x32_bf16 v[200:203], a[32:35], v[16:19], v[200:203]
    buffer_load_dwordx4 a[184:187], v2, s[8:11], s40 offen offset:0 sc1
    v_mfma_f32_16x16x32_bf16 v[204:207], a[36:39], v[16:19], v[204:207]
    s_waitcnt lgkmcnt(2)
    v_mfma_f32_16x16x32_bf16 v[208:211], a[24:27], v[20:23], v[208:211]
    ds_read_b128 v[16:19], v4 offset:4096
    v_mfma_f32_16x16x32_bf16 v[212:215], a[28:31], v[20:23], v[212:215]
    v_mfma_f32_16x16x32_bf16 v[216:219], a[32:35], v[20:23], v[216:219]
    buffer_load_dwordx4 a[188:191], v2, s[8:11], s40 offen offset:1024 sc1
    v_mfma_f32_16x16x32_bf16 v[220:223], a[36:39], v[20:23], v[220:223]
    s_waitcnt lgkmcnt(2)
    v_mfma_f32_16x16x32_bf16 v[224:227], a[24:27], v[24:27], v[224:227]
    ds_read_b128 v[20:23], v4 offset:5120
    v_mfma_f32_16x16x32_bf16 v[228:231], a[28:31], v[24:27], v[228:231]
    v_mfma_f32_16x16x32_bf16 v[232:235], a[32:35], v[24:27], v[232:235]
    s_waitcnt vmcnt(60)
    buffer_load_dwordx4 a[0:3], v2, s[8:11], s40 offen offset:2048 sc1
    v_mfma_f32_16x16x32_bf16 v[236:239], a[36:39], v[24:27], v[236:239]
    s_waitcnt lgkmcnt(2)
    v_mfma_f32_16x16x32_bf16 v[240:243], a[24:27], v[28:31], v[240:243]
    ds_read_b128 v[24:27], v4 offset:6144
    v_mfma_f32_16x16x32_bf16 v[244:247], a[28:31], v[28:31], v[244:247]
    v_mfma_f32_16x16x32_bf16 v[248:251], a[32:35], v[28:31], v[248:251]
    buffer_load_dwordx4 a[4:7], v2, s[8:11], s40 offen offset:3072 sc1
    v_mfma_f32_16x16x32_bf16 v[252:255], a[36:39], v[28:31], v[252:255]
    s_add_u32 s40, s40, 4096
    s_waitcnt lgkmcnt(2)
    v_mfma_f32_16x16x32_bf16 v[192:195], a[40:43], v[16:19], v[192:195]
    ds_read_b128 v[28:31], v4 offset:7168
    v_mfma_f32_16x16x32_bf16 v[196:199], a[44:47], v[16:19], v[196:199]
    v_mfma_f32_16x16x32_bf16 v[200:203], a[48:51], v[16:19], v[200:203]
    s_waitcnt vmcnt(60)
    buffer_load_dwordx4 a[8:11], v2, s[8:11], s40 offen offset:0 sc1
    v_mfma_f32_16x16x32_bf16 v[204:207], a[52:55], v[16:19], v[204:207]
    s_waitcnt lgkmcnt(2)
    v_mfma_f32_16x16x32_bf16 v[208:211], a[40:43], v[20:23], v[208:211]
    ds_read_b128 v[16:19], v4 offset:12288
    v_mfma_f32_16x16x32_bf16 v[212:215], a[44:47], v[20:23], v[212:215]
    v_mfma_f32_16x16x32_bf16 v[216:219], a[48:51], v[20:23], v[216:219]
    buffer_load_dwordx4 a[12:15], v2, s[8:11], s40 offen offset:1024 sc1
    v_mfma_f32_16x16x32_bf16 v[220:223], a[52:55], v[20:23], v[220:223]
    s_waitcnt lgkmcnt(2)
    v_mfma_f32_16x16x32_bf16 v[224:227], a[40:43], v[24:27], v[224:227]
    ds_read_b128 v[20:23], v4 offset:13312
    v_mfma_f32_16x16x32_bf16 v[228:231], a[44:47], v[24:27], v[228:231]
    v_mfma_f32_16x16x32_bf16 v[232:235], a[48:51], v[24:27], v[232:235]
    s_waitcnt vmcnt(60)
    buffer_load_dwordx4 a[16:19], v2, s[8:11], s40 offen offset:2048 sc1
    v_mfma_f32_16x16x32_bf16 v[236:239], a[52:55], v[24:27], v[236:239]
    s_waitcnt lgkmcnt(2)
    v_mfma_f32_16x16x32_bf16 v[240:243], a[40:43], v[28:31], v[240:243]
    ds_read_b128 v[24:27], v4 offset:14336
    v_mfma_f32_16x16x32_bf16 v[244:247], a[44:47], v[28:31], v[244:247]
    v_mfma_f32_16x16x32_bf16 v[248:251], a[48:51], v[28:31], v[248:251]
    buffer_load_dwordx4 a[20:23], v2, s[8:11], s40 offen offset:3072 sc1
    v_mfma_f32_16x16x32_bf16 v[252:255], a[52:55], v[28:31], v[252:255]
    s_add_u32 s40, s40, 4096
    s_waitcnt lgkmcnt(2)
    v_mfma_f32_16x16x32_bf16 v[192:195], v[48:51], v[16:19], v[192:195]
    ds_read_b128 v[28:31], v4 offset:15360
    v_mfma_f32_16x16x32_bf16 v[196:199], v[52:55], v[16:19], v[196:199]
    v_mfma_f32_16x16x32_bf16 v[200:203], v[56:59], v[16:19], v[200:203]
    v_mfma_f32_16x16x32_bf16 v[204:207], v[60:63], v[16:19], v[204:207]
    s_waitcnt lgkmcnt(2)
    v_mfma_f32_16x16x32_bf16 v[208:211], v[48:51], v[20:23], v[208:211]
    ds_read_b128 v[16:19], v3 offset:57344
    v_mfma_f32_16x16x32_bf16 v[212:215], v[52:55], v[20:23], v[212:215]
    v_mfma_f32_16x16x32_bf16 v[216:219], v[56:59], v[20:23], v[216:219]
    v_mfma_f32_16x16x32_bf16 v[220:223], v[60:63], v[20:23], v[220:223]
    s_waitcnt lgkmcnt(2)
    v_mfma_f32_16x16x32_bf16 v[224:227], v[48:51], v[24:27], v[224:227]
    ds_read_b128 v[20:23], v3 offset:58368
    v_mul_f32 v192, v192, v194
    v_mfma_f32_16x16x32_bf16 v[228:231], v[52:55], v[24:27], v[228:231]
    v_mul_f32 v193, v193, v195
    v_cvt_pk_bf16_f32 v192, v192, v193
    v_mfma_f32_16x16x32_bf16 v[232:235], v[56:59], v[24:27], v[232:235]
    v_mul_f32 v196, v196, v198
    v_mul_f32 v197, v197, v199
    v_mfma_f32_16x16x32_bf16 v[236:239], v[60:63], v[24:27], v[236:239]
    v_cvt_pk_bf16_f32 v193, v196, v197
    s_waitcnt lgkmcnt(2)
    v_mfma_f32_16x16x32_bf16 v[240:243], v[48:51], v[28:31], v[240:243]
    ds_read_b128 v[24:27], v4 offset:0
    v_mul_f32 v200, v200, v202
    v_mfma_f32_16x16x32_bf16 v[244:247], v[52:55], v[28:31], v[244:247]
    v_mul_f32 v201, v201, v203
    v_cvt_pk_bf16_f32 v194, v200, v201
    v_mfma_f32_16x16x32_bf16 v[248:251], v[56:59], v[28:31], v[248:251]
    v_mul_f32 v204, v204, v206
    v_mul_f32 v205, v205, v207
    v_mfma_f32_16x16x32_bf16 v[252:255], v[60:63], v[28:31], v[252:255]
    v_cvt_pk_bf16_f32 v195, v204, v205
    s_waitcnt lgkmcnt(2)
    v_mfma_f32_16x16x32_bf16 v[128:131], a[24:27], v[16:19], v[128:131]
    ds_read_b128 v[28:31], v4 offset:1024
    v_mfma_f32_16x16x32_bf16 v[132:135], a[28:31], v[16:19], v[132:135]
    s_waitcnt vmcnt(60)
    buffer_store_dwordx4 v[192:195], v7, s[20:23], s44 offen offset:0 sc1
    v_mfma_f32_16x16x32_bf16 v[136:139], a[32:35], v[16:19], v[136:139]
    v_mul_f32 v208, v208, v210
    v_mul_f32 v209, v209, v211
    v_mfma_f32_16x16x32_bf16 v[140:143], a[36:39], v[16:19], v[140:143]
    v_cvt_pk_bf16_f32 v208, v208, v209
    s_waitcnt lgkmcnt(2)
    v_mfma_f32_16x16x32_bf16 v[144:147], a[24:27], v[20:23], v[144:147]
    ds_read_b128 v[16:19], v4 offset:8192
    v_mul_f32 v212, v212, v214
    v_mfma_f32_16x16x32_bf16 v[148:151], a[28:31], v[20:23], v[148:151]
    v_mul_f32 v213, v213, v215
    v_cvt_pk_bf16_f32 v209, v212, v213
    v_mfma_f32_16x16x32_bf16 v[152:155], a[32:35], v[20:23], v[152:155]
    v_mul_f32 v216, v216, v218
    v_mul_f32 v217, v217, v219
    v_mfma_f32_16x16x32_bf16 v[156:159], a[36:39], v[20:23], v[156:159]
    v_cvt_pk_bf16_f32 v210, v216, v217
    s_waitcnt lgkmcnt(2)
    v_mfma_f32_16x16x32_bf16 v[128:131], a[40:43], v[24:27], v[128:131]
    ds_read_b128 v[20:23], v4 offset:9216
    v_mul_f32 v220, v220, v222
    v_mfma_f32_16x16x32_bf16 v[132:135], a[44:47], v[24:27], v[132:135]
    v_mul_f32 v221, v221, v223
    v_cvt_pk_bf16_f32 v211, v220, v221
    v_mfma_f32_16x16x32_bf16 v[136:139], a[48:51], v[24:27], v[136:139]
    buffer_store_dwordx4 v[208:211], v7, s[20:23], s44 offen offset:1024 sc1
    v_mfma_f32_16x16x32_bf16 v[140:143], a[52:55], v[24:27], v[140:143]
    v_mul_f32 v224, v224, v226
    s_waitcnt lgkmcnt(2)
    v_mfma_f32_16x16x32_bf16 v[144:147], a[40:43], v[28:31], v[144:147]
    ds_read_b128 v[24:27], v3 offset:59392
    v_mul_f32 v225, v225, v227
    v_mfma_f32_16x16x32_bf16 v[148:151], a[44:47], v[28:31], v[148:151]
    v_cvt_pk_bf16_f32 v224, v224, v225
    v_mul_f32 v228, v228, v230
    v_mfma_f32_16x16x32_bf16 v[152:155], a[48:51], v[28:31], v[152:155]
    v_mul_f32 v229, v229, v231
    v_cvt_pk_bf16_f32 v225, v228, v229
    v_mfma_f32_16x16x32_bf16 v[156:159], a[52:55], v[28:31], v[156:159]
    v_mul_f32 v232, v232, v234
    s_waitcnt lgkmcnt(2)
    v_mfma_f32_16x16x32_bf16 v[128:131], v[48:51], v[16:19], v[128:131]
    ds_read_b128 v[28:31], v3 offset:60416
    v_mul_f32 v233, v233, v235
    v_mfma_f32_16x16x32_bf16 v[132:135], v[52:55], v[16:19], v[132:135]
    v_cvt_pk_bf16_f32 v226, v232, v233
    v_mul_f32 v236, v236, v238
    v_mfma_f32_16x16x32_bf16 v[136:139], v[56:59], v[16:19], v[136:139]
    v_mul_f32 v237, v237, v239
    v_cvt_pk_bf16_f32 v227, v236, v237
    v_mfma_f32_16x16x32_bf16 v[140:143], v[60:63], v[16:19], v[140:143]
    s_waitcnt lgkmcnt(2)
    v_mfma_f32_16x16x32_bf16 v[144:147], v[48:51], v[20:23], v[144:147]
    ds_read_b128 v[16:19], v4 offset:2048
    v_mfma_f32_16x16x32_bf16 v[148:151], v[52:55], v[20:23], v[148:151]
    s_waitcnt vmcnt(60)
    buffer_store_dwordx4 v[224:227], v7, s[20:23], s44 offen offset:2048 sc1
    v_mfma_f32_16x16x32_bf16 v[152:155], v[56:59], v[20:23], v[152:155]
    v_mul_f32 v240, v240, v242
    v_mul_f32 v241, v241, v243
    v_mfma_f32_16x16x32_bf16 v[156:159], v[60:63], v[20:23], v[156:159]
    v_cvt_pk_bf16_f32 v240, v240, v241
    s_waitcnt lgkmcnt(2)
    v_mfma_f32_16x16x32_bf16 v[160:163], a[24:27], v[24:27], v[160:163]
    ds_read_b128 v[20:23], v4 offset:3072
    v_mul_f32 v244, v244, v246
    v_mfma_f32_16x16x32_bf16 v[164:167], a[28:31], v[24:27], v[164:167]
    v_mul_f32 v245, v245, v247
    v_cvt_pk_bf16_f32 v241, v244, v245
    v_mfma_f32_16x16x32_bf16 v[168:171], a[32:35], v[24:27], v[168:171]
    v_mul_f32 v248, v248, v250
    v_mul_f32 v249, v249, v251
    v_mfma_f32_16x16x32_bf16 v[172:175], a[36:39], v[24:27], v[172:175]
    v_cvt_pk_bf16_f32 v242, v248, v249
    s_waitcnt lgkmcnt(2)
    v_mfma_f32_16x16x32_bf16 v[176:179], a[24:27], v[28:31], v[176:179]
    ds_read_b128 v[24:27], v4 offset:10240
    v_mul_f32 v252, v252, v254
    v_mfma_f32_16x16x32_bf16 v[180:183], a[28:31], v[28:31], v[180:183]
    v_mul_f32 v253, v253, v255
    v_cvt_pk_bf16_f32 v243, v252, v253
    v_mfma_f32_16x16x32_bf16 v[184:187], a[32:35], v[28:31], v[184:187]
    buffer_store_dwordx4 v[240:243], v7, s[20:23], s44 offen offset:3072 sc1
    v_mfma_f32_16x16x32_bf16 v[188:191], a[36:39], v[28:31], v[188:191]
    v_mul_f32 v128, v128, v130
    s_waitcnt lgkmcnt(2)
    v_mfma_f32_16x16x32_bf16 v[160:163], a[40:43], v[16:19], v[160:163]
    ds_read_b128 v[28:31], v4 offset:11264
    v_mul_f32 v129, v129, v131
    v_mfma_f32_16x16x32_bf16 v[164:167], a[44:47], v[16:19], v[164:167]
    v_cvt_pk_bf16_f32 v128, v128, v129
    v_mul_f32 v132, v132, v134
    v_mfma_f32_16x16x32_bf16 v[168:171], a[48:51], v[16:19], v[168:171]
    v_mul_f32 v133, v133, v135
    v_cvt_pk_bf16_f32 v129, v132, v133
    v_mfma_f32_16x16x32_bf16 v[172:175], a[52:55], v[16:19], v[172:175]
    v_mul_f32 v136, v136, v138
    s_waitcnt lgkmcnt(2)
    v_mfma_f32_16x16x32_bf16 v[176:179], a[40:43], v[20:23], v[176:179]
    v_mul_f32 v137, v137, v139
    v_cvt_pk_bf16_f32 v130, v136, v137
    v_mfma_f32_16x16x32_bf16 v[180:183], a[44:47], v[20:23], v[180:183]
    v_mul_f32 v140, v140, v142
    v_mul_f32 v141, v141, v143
    v_mfma_f32_16x16x32_bf16 v[184:187], a[48:51], v[20:23], v[184:187]
    v_cvt_pk_bf16_f32 v131, v140, v141
    ds_write_b128 v5, v[128:131] offset:4096
    v_mfma_f32_16x16x32_bf16 v[188:191], a[52:55], v[20:23], v[188:191]
    v_mul_f32 v144, v144, v146
    s_waitcnt lgkmcnt(2)
    v_mfma_f32_16x16x32_bf16 v[160:163], v[48:51], v[24:27], v[160:163]
    v_mul_f32 v145, v145, v147
    v_cvt_pk_bf16_f32 v144, v144, v145
    v_mfma_f32_16x16x32_bf16 v[164:167], v[52:55], v[24:27], v[164:167]
    v_mul_f32 v148, v148, v150
    v_mul_f32 v149, v149, v151
    v_mfma_f32_16x16x32_bf16 v[168:171], v[56:59], v[24:27], v[168:171]
    v_cvt_pk_bf16_f32 v145, v148, v149
    v_mul_f32 v152, v152, v154
    v_mfma_f32_16x16x32_bf16 v[172:175], v[60:63], v[24:27], v[172:175]
    v_mul_f32 v153, v153, v155
    s_waitcnt lgkmcnt(1)
    v_mfma_f32_16x16x32_bf16 v[176:179], v[48:51], v[28:31], v[176:179]
    v_cvt_pk_bf16_f32 v146, v152, v153
    v_mul_f32 v156, v156, v158
    v_mfma_f32_16x16x32_bf16 v[180:183], v[52:55], v[28:31], v[180:183]
    v_mul_f32 v157, v157, v159
    v_cvt_pk_bf16_f32 v147, v156, v157
    v_mfma_f32_16x16x32_bf16 v[184:187], v[56:59], v[28:31], v[184:187]
    ds_write_b128 v5, v[144:147] offset:5120
    v_mfma_f32_16x16x32_bf16 v[188:191], v[60:63], v[28:31], v[188:191]
    v_mul_f32 v160, v160, v162
    v_mul_f32 v161, v161, v163
    v_cvt_pk_bf16_f32 v160, v160, v161
    v_mul_f32 v164, v164, v166
    v_mul_f32 v165, v165, v167
    v_cvt_pk_bf16_f32 v161, v164, v165
    v_mul_f32 v168, v168, v170
    v_mul_f32 v169, v169, v171
    v_cvt_pk_bf16_f32 v162, v168, v169
    v_mul_f32 v172, v172, v174
    v_mul_f32 v173, v173, v175
    v_cvt_pk_bf16_f32 v163, v172, v173
    ds_write_b128 v5, v[160:163] offset:6144
    v_mul_f32 v176, v176, v178
    v_mul_f32 v177, v177, v179
    v_cvt_pk_bf16_f32 v176, v176, v177
    v_mul_f32 v180, v180, v182
    v_mul_f32 v181, v181, v183
    v_cvt_pk_bf16_f32 v177, v180, v181
    v_mul_f32 v184, v184, v186
    v_mul_f32 v185, v185, v187
    v_cvt_pk_bf16_f32 v178, v184, v185
    v_mul_f32 v188, v188, v190
    v_mul_f32 v189, v189, v191
    v_cvt_pk_bf16_f32 v179, v188, v189
    ds_write_b128 v5, v[176:179] offset:7168
    s_waitcnt lgkmcnt(0)
    s_barrier
    ds_read_b128 v[16:19], v2 offset:0
    ds_read_b128 v[20:23], v2 offset:1024
    ds_read_b128 v[24:27], v2 offset:2048
    ds_read_b128 v[28:31], v2 offset:3072
    s_waitcnt vmcnt(63) lgkmcnt(0)
    v_mfma_f32_16x16x32_bf16 v[112:115], v[64:67], v[16:19], 0
    ds_read_b128 v[32:35], v2 offset:4096
    v_mfma_f32_16x16x32_bf16 v[116:119], v[64:67], v[20:23], 0
    v_mfma_f32_16x16x32_bf16 v[120:123], v[64:67], v[24:27], 0
    s_waitcnt vmcnt(60)
    buffer_load_dwordx4 a[24:27], v2, s[8:11], s40 offen offset:0 sc1
    v_mfma_f32_16x16x32_bf16 v[124:127], v[64:67], v[28:31], 0
    v_mfma_f32_16x16x32_bf16 v[128:131], v[68:71], v[16:19], 0
    ds_read_b128 v[36:39], v2 offset:5120
    v_mfma_f32_16x16x32_bf16 v[132:135], v[68:71], v[20:23], 0
    v_mfma_f32_16x16x32_bf16 v[136:139], v[68:71], v[24:27], 0
    buffer_load_dwordx4 a[28:31], v2, s[8:11], s40 offen offset:1024 sc1
    v_mfma_f32_16x16x32_bf16 v[140:143], v[68:71], v[28:31], 0
    v_mfma_f32_16x16x32_bf16 v[144:147], v[72:75], v[16:19], 0
    ds_read_b128 v[40:43], v2 offset:6144
    v_mfma_f32_16x16x32_bf16 v[148:151], v[72:75], v[20:23], 0
    v_mfma_f32_16x16x32_bf16 v[152:155], v[72:75], v[24:27], 0
    s_waitcnt vmcnt(60)
    buffer_load_dwordx4 a[32:35], v2, s[8:11], s40 offen offset:2048 sc1
    v_mfma_f32_16x16x32_bf16 v[156:159], v[72:75], v[28:31], 0
    s_waitcnt vmcnt(63)
    v_mfma_f32_16x16x32_bf16 v[160:163], v[76:79], v[16:19], 0
    ds_read_b128 v[44:47], v2 offset:7168
    v_mfma_f32_16x16x32_bf16 v[164:167], v[76:79], v[20:23], 0
    v_mfma_f32_16x16x32_bf16 v[168:171], v[76:79], v[24:27], 0
    buffer_load_dwordx4 a[36:39], v2, s[8:11], s40 offen offset:3072 sc1
    v_mfma_f32_16x16x32_bf16 v[172:175], v[76:79], v[28:31], 0
    s_add_u32 s40, s40, 4096
    v_mfma_f32_16x16x32_bf16 v[176:179], v[80:83], v[16:19], 0
    v_mfma_f32_16x16x32_bf16 v[180:183], v[80:83], v[20:23], 0
    v_mfma_f32_16x16x32_bf16 v[184:187], v[80:83], v[24:27], 0
    s_waitcnt vmcnt(60)
    buffer_load_dwordx4 a[40:43], v2, s[8:11], s40 offen offset:0 sc1
    v_mfma_f32_16x16x32_bf16 v[188:191], v[80:83], v[28:31], 0
    v_mfma_f32_16x16x32_bf16 v[192:195], v[84:87], v[16:19], 0
    v_mfma_f32_16x16x32_bf16 v[196:199], v[84:87], v[20:23], 0
    v_mfma_f32_16x16x32_bf16 v[200:203], v[84:87], v[24:27], 0
    buffer_load_dwordx4 a[44:47], v2, s[8:11], s40 offen offset:1024 sc1
    v_mfma_f32_16x16x32_bf16 v[204:207], v[84:87], v[28:31], 0
    s_waitcnt vmcnt(63)
    v_mfma_f32_16x16x32_bf16 v[208:211], v[88:91], v[16:19], 0
    v_mfma_f32_16x16x32_bf16 v[212:215], v[88:91], v[20:23], 0
    v_mfma_f32_16x16x32_bf16 v[216:219], v[88:91], v[24:27], 0
    s_waitcnt vmcnt(60)
    buffer_load_dwordx4 a[48:51], v2, s[8:11], s40 offen offset:2048 sc1
    v_mfma_f32_16x16x32_bf16 v[220:223], v[88:91], v[28:31], 0
    v_mfma_f32_16x16x32_bf16 v[224:227], v[92:95], v[16:19], 0
    v_mfma_f32_16x16x32_bf16 v[228:231], v[92:95], v[20:23], 0
    v_mfma_f32_16x16x32_bf16 v[232:235], v[92:95], v[24:27], 0
    buffer_load_dwordx4 a[52:55], v2, s[8:11], s40 offen offset:3072 sc1
    v_mfma_f32_16x16x32_bf16 v[236:239], v[92:95], v[28:31], 0
    s_add_u32 s40, s40, 4096
    v_mfma_f32_16x16x32_bf16 v[240:243], v[96:99], v[16:19], 0
    v_mfma_f32_16x16x32_bf16 v[244:247], v[96:99], v[20:23], 0
    v_mfma_f32_16x16x32_bf16 v[248:251], v[96:99], v[24:27], 0
    s_waitcnt vmcnt(60)
    buffer_load_dwordx4 v[48:51], v2, s[8:11], s40 offen offset:0 sc1
    v_mfma_f32_16x16x32_bf16 v[252:255], v[96:99], v[28:31], 0
    s_waitcnt vmcnt(9)
    s_barrier
    s_mov_b64 exec, 1
    buffer_store_dword v13, v12, s[28:31], 0 offen sc1
    s_mov_b64 exec, -1
    v_mov_b32 v12, s48
    s_waitcnt vmcnt(63) lgkmcnt(0)
    v_mfma_f32_16x16x32_bf16 v[112:115], v[100:103], v[32:35], v[112:115]
    ds_read_b128 v[16:19], v2 offset:8192
    v_mfma_f32_16x16x32_bf16 v[116:119], v[100:103], v[36:39], v[116:119]
    v_mfma_f32_16x16x32_bf16 v[120:123], v[100:103], v[40:43], v[120:123]
    buffer_load_dwordx4 v[52:55], v2, s[8:11], s40 offen offset:1024 sc1
    v_mfma_f32_16x16x32_bf16 v[124:127], v[100:103], v[44:47], v[124:127]
    v_mfma_f32_16x16x32_bf16 v[128:131], v[104:107], v[32:35], v[128:131]
    ds_read_b128 v[20:23], v2 offset:9216
    v_mfma_f32_16x16x32_bf16 v[132:135], v[104:107], v[36:39], v[132:135]
    v_mfma_f32_16x16x32_bf16 v[136:139], v[104:107], v[40:43], v[136:139]
    buffer_load_dwordx4 v[56:59], v2, s[8:11], s40 offen offset:2048 sc1
    v_mfma_f32_16x16x32_bf16 v[140:143], v[104:107], v[44:47], v[140:143]
    v_mfma_f32_16x16x32_bf16 v[144:147], v[108:111], v[32:35], v[144:147]
    ds_read_b128 v[24:27], v2 offset:10240
    v_mfma_f32_16x16x32_bf16 v[148:151], v[108:111], v[36:39], v[148:151]
    v_mfma_f32_16x16x32_bf16 v[152:155], v[108:111], v[40:43], v[152:155]
    buffer_load_dwordx4 v[60:63], v2, s[8:11], s40 offen offset:3072 sc1
    v_mfma_f32_16x16x32_bf16 v[156:159], v[108:111], v[44:47], v[156:159]
    s_add_u32 s40, s40, 4096
    s_waitcnt vmcnt(63)
    v_mfma_f32_16x16x32_bf16 v[160:163], a[56:59], v[32:35], v[160:163]
    ds_read_b128 v[28:31], v2 offset:11264
    v_mfma_f32_16x16x32_bf16 v[164:167], a[56:59], v[36:39], v[164:167]
    v_mfma_f32_16x16x32_bf16 v[168:171], a[56:59], v[40:43], v[168:171]
    buffer_load_dwordx4 v[64:67], v2, s[8:11], s40 offen offset:0 sc1
    v_mfma_f32_16x16x32_bf16 v[172:175], a[56:59], v[44:47], v[172:175]
    s_mov_b32 s40, s55
    v_mfma_f32_16x16x32_bf16 v[176:179], a[60:63], v[32:35], v[176:179]
    v_mfma_f32_16x16x32_bf16 v[180:183], a[60:63], v[36:39], v[180:183]
    v_mfma_f32_16x16x32_bf16 v[184:187], a[60:63], v[40:43], v[184:187]
    buffer_load_dwordx4 v[68:71], v2, s[8:11], s40 offen offset:0 sc1
    v_mfma_f32_16x16x32_bf16 v[188:191], a[60:63], v[44:47], v[188:191]
    v_mfma_f32_16x16x32_bf16 v[192:195], a[64:67], v[32:35], v[192:195]
    v_mfma_f32_16x16x32_bf16 v[196:199], a[64:67], v[36:39], v[196:199]
    v_mfma_f32_16x16x32_bf16 v[200:203], a[64:67], v[40:43], v[200:203]
    buffer_load_dwordx4 v[72:75], v2, s[8:11], s40 offen offset:1024 sc1
    v_mfma_f32_16x16x32_bf16 v[204:207], a[64:67], v[44:47], v[204:207]
    s_waitcnt vmcnt(63)
    v_mfma_f32_16x16x32_bf16 v[208:211], a[68:71], v[32:35], v[208:211]
    v_mfma_f32_16x16x32_bf16 v[212:215], a[68:71], v[36:39], v[212:215]
    v_mfma_f32_16x16x32_bf16 v[216:219], a[68:71], v[40:43], v[216:219]
    buffer_load_dwordx4 v[76:79], v2, s[8:11], s40 offen offset:2048 sc1
    v_mfma_f32_16x16x32_bf16 v[220:223], a[68:71], v[44:47], v[220:223]
    s_add_u32 s40, s40, 9216
    v_mfma_f32_16x16x32_bf16 v[224:227], a[72:75], v[32:35], v[224:227]
    v_mfma_f32_16x16x32_bf16 v[228:231], a[72:75], v[36:39], v[228:231]
    v_mfma_f32_16x16x32_bf16 v[232:235], a[72:75], v[40:43], v[232:235]
    buffer_load_dwordx4 v[80:83], v2, s[8:11], s40 offen offset:0 sc1
    v_mfma_f32_16x16x32_bf16 v[236:239], a[72:75], v[44:47], v[236:239]
    v_mfma_f32_16x16x32_bf16 v[240:243], a[76:79], v[32:35], v[240:243]
    v_mfma_f32_16x16x32_bf16 v[244:247], a[76:79], v[36:39], v[244:247]
    v_mfma_f32_16x16x32_bf16 v[248:251], a[76:79], v[40:43], v[248:251]
    buffer_load_dwordx4 v[84:87], v2, s[8:11], s40 offen offset:1024 sc1
    v_mfma_f32_16x16x32_bf16 v[252:255], a[76:79], v[44:47], v[252:255]
    s_waitcnt vmcnt(63) lgkmcnt(0)
    v_mfma_f32_16x16x32_bf16 v[112:115], a[80:83], v[16:19], v[112:115]
    ds_read_b128 v[32:35], v2 offset:12288
    v_mfma_f32_16x16x32_bf16 v[116:119], a[80:83], v[20:23], v[116:119]
    v_mfma_f32_16x16x32_bf16 v[120:123], a[80:83], v[24:27], v[120:123]
    buffer_load_dwordx4 v[88:91], v2, s[8:11], s40 offen offset:2048 sc1
    v_mfma_f32_16x16x32_bf16 v[124:127], a[80:83], v[28:31], v[124:127]
    s_add_u32 s40, s40, 9216
    v_mfma_f32_16x16x32_bf16 v[128:131], a[84:87], v[16:19], v[128:131]
    ds_read_b128 v[36:39], v2 offset:13312
    v_mfma_f32_16x16x32_bf16 v[132:135], a[84:87], v[20:23], v[132:135]
    v_mfma_f32_16x16x32_bf16 v[136:139], a[84:87], v[24:27], v[136:139]
    buffer_load_dwordx4 v[92:95], v2, s[8:11], s40 offen offset:0 sc1
    v_mfma_f32_16x16x32_bf16 v[140:143], a[84:87], v[28:31], v[140:143]
    v_mfma_f32_16x16x32_bf16 v[144:147], a[88:91], v[16:19], v[144:147]
    ds_read_b128 v[40:43], v2 offset:14336
    v_mfma_f32_16x16x32_bf16 v[148:151], a[88:91], v[20:23], v[148:151]
    v_mfma_f32_16x16x32_bf16 v[152:155], a[88:91], v[24:27], v[152:155]
    buffer_load_dwordx4 v[96:99], v2, s[8:11], s40 offen offset:1024 sc1
    v_mfma_f32_16x16x32_bf16 v[156:159], a[88:91], v[28:31], v[156:159]
    s_waitcnt vmcnt(63)
    v_mfma_f32_16x16x32_bf16 v[160:163], a[92:95], v[16:19], v[160:163]
    ds_read_b128 v[44:47], v2 offset:15360
    v_mfma_f32_16x16x32_bf16 v[164:167], a[92:95], v[20:23], v[164:167]
    v_mfma_f32_16x16x32_bf16 v[168:171], a[92:95], v[24:27], v[168:171]
    buffer_load_dwordx4 v[100:103], v2, s[8:11], s40 offen offset:2048 sc1
    v_mfma_f32_16x16x32_bf16 v[172:175], a[92:95], v[28:31], v[172:175]
    s_add_u32 s40, s40, 9216
    v_mfma_f32_16x16x32_bf16 v[176:179], a[96:99], v[16:19], v[176:179]
    v_mfma_f32_16x16x32_bf16 v[180:183], a[96:99], v[20:23], v[180:183]
    v_mfma_f32_16x16x32_bf16 v[184:187], a[96:99], v[24:27], v[184:187]
    buffer_load_dwordx4 v[104:107], v2, s[8:11], s40 offen offset:0 sc1
    v_mfma_f32_16x16x32_bf16 v[188:191], a[96:99], v[28:31], v[188:191]
    v_mfma_f32_16x16x32_bf16 v[192:195], a[100:103], v[16:19], v[192:195]
    v_mfma_f32_16x16x32_bf16 v[196:199], a[100:103], v[20:23], v[196:199]
    v_mfma_f32_16x16x32_bf16 v[200:203], a[100:103], v[24:27], v[200:203]
    buffer_load_dwordx4 v[108:111], v2, s[8:11], s40 offen offset:1024 sc1
    v_mfma_f32_16x16x32_bf16 v[204:207], a[100:103], v[28:31], v[204:207]
    s_waitcnt vmcnt(63)
    v_mfma_f32_16x16x32_bf16 v[208:211], a[104:107], v[16:19], v[208:211]
    v_mfma_f32_16x16x32_bf16 v[212:215], a[104:107], v[20:23], v[212:215]
    v_mfma_f32_16x16x32_bf16 v[216:219], a[104:107], v[24:27], v[216:219]
    buffer_load_dwordx4 a[56:59], v2, s[8:11], s40 offen offset:2048 sc1
    v_mfma_f32_16x16x32_bf16 v[220:223], a[104:107], v[28:31], v[220:223]
    s_add_u32 s40, s40, 9216
    v_mfma_f32_16x16x32_bf16 v[224:227], a[108:111], v[16:19], v[224:227]
    v_mfma_f32_16x16x32_bf16 v[228:231], a[108:111], v[20:23], v[228:231]
    v_mfma_f32_16x16x32_bf16 v[232:235], a[108:111], v[24:27], v[232:235]
    buffer_load_dwordx4 a[60:63], v2, s[8:11], s40 offen offset:0 sc1
    v_mfma_f32_16x16x32_bf16 v[236:239], a[108:111], v[28:31], v[236:239]
    v_mfma_f32_16x16x32_bf16 v[240:243], a[112:115], v[16:19], v[240:243]
    v_mfma_f32_16x16x32_bf16 v[244:247], a[112:115], v[20:23], v[244:247]
    v_mfma_f32_16x16x32_bf16 v[248:251], a[112:115], v[24:27], v[248:251]
    buffer_load_dwordx4 a[64:67], v2, s[8:11], s40 offen offset:1024 sc1
    v_mfma_f32_16x16x32_bf16 v[252:255], a[112:115], v[28:31], v[252:255]
    s_waitcnt vmcnt(63) lgkmcnt(0)
    v_mfma_f32_16x16x32_bf16 v[112:115], a[116:119], v[32:35], v[112:115]
    ds_read_b128 v[16:19], v2 offset:16384
    v_mfma_f32_16x16x32_bf16 v[116:119], a[116:119], v[36:39], v[116:119]
    v_mfma_f32_16x16x32_bf16 v[120:123], a[116:119], v[40:43], v[120:123]
    buffer_load_dwordx4 a[68:71], v2, s[8:11], s40 offen offset:2048 sc1
    v_mfma_f32_16x16x32_bf16 v[124:127], a[116:119], v[44:47], v[124:127]
    s_add_u32 s40, s40, 9216
    v_mfma_f32_16x16x32_bf16 v[128:131], a[120:123], v[32:35], v[128:131]
    ds_read_b128 v[20:23], v2 offset:17408
    v_mfma_f32_16x16x32_bf16 v[132:135], a[120:123], v[36:39], v[132:135]
    v_mfma_f32_16x16x32_bf16 v[136:139], a[120:123], v[40:43], v[136:139]
    buffer_load_dwordx4 a[72:75], v2, s[8:11], s40 offen offset:0 sc1
    v_mfma_f32_16x16x32_bf16 v[140:143], a[120:123], v[44:47], v[140:143]
    v_mfma_f32_16x16x32_bf16 v[144:147], a[124:127], v[32:35], v[144:147]
    ds_read_b128 v[24:27], v2 offset:18432
    v_mfma_f32_16x16x32_bf16 v[148:151], a[124:127], v[36:39], v[148:151]
    v_mfma_f32_16x16x32_bf16 v[152:155], a[124:127], v[40:43], v[152:155]
    buffer_load_dwordx4 a[76:79], v2, s[8:11], s40 offen offset:1024 sc1
    v_mfma_f32_16x16x32_bf16 v[156:159], a[124:127], v[44:47], v[156:159]
    s_waitcnt vmcnt(63)
    v_mfma_f32_16x16x32_bf16 v[160:163], a[128:131], v[32:35], v[160:163]
    ds_read_b128 v[28:31], v2 offset:19456
    v_mfma_f32_16x16x32_bf16 v[164:167], a[128:131], v[36:39], v[164:167]
    v_mfma_f32_16x16x32_bf16 v[168:171], a[128:131], v[40:43], v[168:171]
    buffer_load_dwordx4 a[80:83], v2, s[8:11], s40 offen offset:2048 sc1
    v_mfma_f32_16x16x32_bf16 v[172:175], a[128:131], v[44:47], v[172:175]
    s_add_u32 s40, s40, 9216
    v_mfma_f32_16x16x32_bf16 v[176:179], a[132:135], v[32:35], v[176:179]
    v_mfma_f32_16x16x32_bf16 v[180:183], a[132:135], v[36:39], v[180:183]
    v_mfma_f32_16x16x32_bf16 v[184:187], a[132:135], v[40:43], v[184:187]
    buffer_load_dwordx4 a[84:87], v2, s[8:11], s40 offen offset:0 sc1
    v_mfma_f32_16x16x32_bf16 v[188:191], a[132:135], v[44:47], v[188:191]
    v_mfma_f32_16x16x32_bf16 v[192:195], a[136:139], v[32:35], v[192:195]
    v_mfma_f32_16x16x32_bf16 v[196:199], a[136:139], v[36:39], v[196:199]
    v_mfma_f32_16x16x32_bf16 v[200:203], a[136:139], v[40:43], v[200:203]
    buffer_load_dwordx4 a[88:91], v2, s[8:11], s40 offen offset:1024 sc1
    v_mfma_f32_16x16x32_bf16 v[204:207], a[136:139], v[44:47], v[204:207]
    s_waitcnt vmcnt(63)
    v_mfma_f32_16x16x32_bf16 v[208:211], a[140:143], v[32:35], v[208:211]
    v_mfma_f32_16x16x32_bf16 v[212:215], a[140:143], v[36:39], v[212:215]
    v_mfma_f32_16x16x32_bf16 v[216:219], a[140:143], v[40:43], v[216:219]
    buffer_load_dwordx4 a[92:95], v2, s[8:11], s40 offen offset:2048 sc1
    v_mfma_f32_16x16x32_bf16 v[220:223], a[140:143], v[44:47], v[220:223]
    s_add_u32 s40, s40, 9216
    v_mfma_f32_16x16x32_bf16 v[224:227], a[144:147], v[32:35], v[224:227]
    v_mfma_f32_16x16x32_bf16 v[228:231], a[144:147], v[36:39], v[228:231]
    v_mfma_f32_16x16x32_bf16 v[232:235], a[144:147], v[40:43], v[232:235]
    buffer_load_dwordx4 a[96:99], v2, s[8:11], s40 offen offset:0 sc1
    v_mfma_f32_16x16x32_bf16 v[236:239], a[144:147], v[44:47], v[236:239]
    v_mfma_f32_16x16x32_bf16 v[240:243], a[148:151], v[32:35], v[240:243]
    v_mfma_f32_16x16x32_bf16 v[244:247], a[148:151], v[36:39], v[244:247]
    v_mfma_f32_16x16x32_bf16 v[248:251], a[148:151], v[40:43], v[248:251]
    buffer_load_dwordx4 a[100:103], v2, s[8:11], s40 offen offset:1024 sc1
    v_mfma_f32_16x16x32_bf16 v[252:255], a[148:151], v[44:47], v[252:255]
    s_waitcnt vmcnt(63) lgkmcnt(0)
    v_mfma_f32_16x16x32_bf16 v[112:115], a[152:155], v[16:19], v[112:115]
    ds_read_b128 v[32:35], v2 offset:20480
    v_mfma_f32_16x16x32_bf16 v[116:119], a[152:155], v[20:23], v[116:119]
    v_mfma_f32_16x16x32_bf16 v[120:123], a[152:155], v[24:27], v[120:123]
    buffer_load_dwordx4 a[104:107], v2, s[8:11], s40 offen offset:2048 sc1
    v_mfma_f32_16x16x32_bf16 v[124:127], a[152:155], v[28:31], v[124:127]
    s_add_u32 s40, s40, 9216
    v_mfma_f32_16x16x32_bf16 v[128:131], a[156:159], v[16:19], v[128:131]
    ds_read_b128 v[36:39], v2 offset:21504
    v_mfma_f32_16x16x32_bf16 v[132:135], a[156:159], v[20:23], v[132:135]
    v_mfma_f32_16x16x32_bf16 v[136:139], a[156:159], v[24:27], v[136:139]
    buffer_load_dwordx4 a[108:111], v2, s[8:11], s40 offen offset:0 sc1
    v_mfma_f32_16x16x32_bf16 v[140:143], a[156:159], v[28:31], v[140:143]
    v_mfma_f32_16x16x32_bf16 v[144:147], a[160:163], v[16:19], v[144:147]
    ds_read_b128 v[40:43], v2 offset:22528
    v_mfma_f32_16x16x32_bf16 v[148:151], a[160:163], v[20:23], v[148:151]
    v_mfma_f32_16x16x32_bf16 v[152:155], a[160:163], v[24:27], v[152:155]
    buffer_load_dwordx4 a[112:115], v2, s[8:11], s40 offen offset:1024 sc1
    v_mfma_f32_16x16x32_bf16 v[156:159], a[160:163], v[28:31], v[156:159]
    s_waitcnt vmcnt(63)
    v_mfma_f32_16x16x32_bf16 v[160:163], a[164:167], v[16:19], v[160:163]
    ds_read_b128 v[44:47], v2 offset:23552
    v_mfma_f32_16x16x32_bf16 v[164:167], a[164:167], v[20:23], v[164:167]
    v_mfma_f32_16x16x32_bf16 v[168:171], a[164:167], v[24:27], v[168:171]
    buffer_load_dwordx4 a[116:119], v2, s[8:11], s40 offen offset:2048 sc1
    v_mfma_f32_16x16x32_bf16 v[172:175], a[164:167], v[28:31], v[172:175]
    s_add_u32 s40, s40, 4294896640
    v_mfma_f32_16x16x32_bf16 v[176:179], a[192:195], v[16:19], v[176:179]
    v_mfma_f32_16x16x32_bf16 v[180:183], a[192:195], v[20:23], v[180:183]
    v_mfma_f32_16x16x32_bf16 v[184:187], a[192:195], v[24:27], v[184:187]
    buffer_load_dwordx4 a[120:123], v2, s[8:11], s40 offen offset:0 sc1
    v_mfma_f32_16x16x32_bf16 v[188:191], a[192:195], v[28:31], v[188:191]
    v_mfma_f32_16x16x32_bf16 v[192:195], a[196:199], v[16:19], v[192:195]
    v_mfma_f32_16x16x32_bf16 v[196:199], a[196:199], v[20:23], v[196:199]
    v_mfma_f32_16x16x32_bf16 v[200:203], a[196:199], v[24:27], v[200:203]
    buffer_load_dwordx4 a[124:127], v2, s[8:11], s40 offen offset:1024 sc1
    v_mfma_f32_16x16x32_bf16 v[204:207], a[196:199], v[28:31], v[204:207]
    s_waitcnt vmcnt(63)
    v_mfma_f32_16x16x32_bf16 v[208:211], a[200:203], v[16:19], v[208:211]
    v_mfma_f32_16x16x32_bf16 v[212:215], a[200:203], v[20:23], v[212:215]
    v_mfma_f32_16x16x32_bf16 v[216:219], a[200:203], v[24:27], v[216:219]
    buffer_load_dwordx4 a[128:131], v2, s[8:11], s40 offen offset:2048 sc1
    v_mfma_f32_16x16x32_bf16 v[220:223], a[200:203], v[28:31], v[220:223]
    s_add_u32 s40, s40, 9216
    v_mfma_f32_16x16x32_bf16 v[224:227], a[204:207], v[16:19], v[224:227]
    v_mfma_f32_16x16x32_bf16 v[228:231], a[204:207], v[20:23], v[228:231]
    v_mfma_f32_16x16x32_bf16 v[232:235], a[204:207], v[24:27], v[232:235]
    buffer_load_dwordx4 a[132:135], v2, s[8:11], s40 offen offset:0 sc1
    v_mfma_f32_16x16x32_bf16 v[236:239], a[204:207], v[28:31], v[236:239]
    v_mfma_f32_16x16x32_bf16 v[240:243], a[208:211], v[16:19], v[240:243]
    v_mfma_f32_16x16x32_bf16 v[244:247], a[208:211], v[20:23], v[244:247]
    v_mfma_f32_16x16x32_bf16 v[248:251], a[208:211], v[24:27], v[248:251]
    buffer_load_dwordx4 a[136:139], v2, s[8:11], s40 offen offset:1024 sc1
    v_mfma_f32_16x16x32_bf16 v[252:255], a[208:211], v[28:31], v[252:255]
    buffer_load_dword v11, v10, s[28:31], 0 offen sc1
    s_waitcnt vmcnt(63) lgkmcnt(0)
    v_mfma_f32_16x16x32_bf16 v[112:115], a[212:215], v[32:35], v[112:115]
    ds_read_b128 v[16:19], v2 offset:24576
    v_mfma_f32_16x16x32_bf16 v[116:119], a[212:215], v[36:39], v[116:119]
    v_mfma_f32_16x16x32_bf16 v[120:123], a[212:215], v[40:43], v[120:123]
    buffer_load_dwordx4 a[140:143], v2, s[8:11], s40 offen offset:2048 sc1
    v_mfma_f32_16x16x32_bf16 v[124:127], a[212:215], v[44:47], v[124:127]
    s_add_u32 s40, s40, 9216
    v_mfma_f32_16x16x32_bf16 v[128:131], a[216:219], v[32:35], v[128:131]
    ds_read_b128 v[20:23], v2 offset:25600
    v_mfma_f32_16x16x32_bf16 v[132:135], a[216:219], v[36:39], v[132:135]
    v_mfma_f32_16x16x32_bf16 v[136:139], a[216:219], v[40:43], v[136:139]
    buffer_load_dwordx4 a[144:147], v2, s[8:11], s40 offen offset:0 sc1
    v_mfma_f32_16x16x32_bf16 v[140:143], a[216:219], v[44:47], v[140:143]
    v_mfma_f32_16x16x32_bf16 v[144:147], a[220:223], v[32:35], v[144:147]
    ds_read_b128 v[24:27], v2 offset:26624
    v_mfma_f32_16x16x32_bf16 v[148:151], a[220:223], v[36:39], v[148:151]
    v_mfma_f32_16x16x32_bf16 v[152:155], a[220:223], v[40:43], v[152:155]
    buffer_load_dwordx4 a[148:151], v2, s[8:11], s40 offen offset:1024 sc1
    v_mfma_f32_16x16x32_bf16 v[156:159], a[220:223], v[44:47], v[156:159]
    s_waitcnt vmcnt(63)
    v_mfma_f32_16x16x32_bf16 v[160:163], a[224:227], v[32:35], v[160:163]
    ds_read_b128 v[28:31], v2 offset:27648
    v_mfma_f32_16x16x32_bf16 v[164:167], a[224:227], v[36:39], v[164:167]
    v_mfma_f32_16x16x32_bf16 v[168:171], a[224:227], v[40:43], v[168:171]
    buffer_load_dwordx4 a[152:155], v2, s[8:11], s40 offen offset:2048 sc1
    v_mfma_f32_16x16x32_bf16 v[172:175], a[224:227], v[44:47], v[172:175]
    s_add_u32 s40, s40, 9216
    v_mfma_f32_16x16x32_bf16 v[176:179], a[228:231], v[32:35], v[176:179]
    v_mfma_f32_16x16x32_bf16 v[180:183], a[228:231], v[36:39], v[180:183]
    v_mfma_f32_16x16x32_bf16 v[184:187], a[228:231], v[40:43], v[184:187]
    buffer_load_dwordx4 a[156:159], v2, s[8:11], s40 offen offset:0 sc1
    v_mfma_f32_16x16x32_bf16 v[188:191], a[228:231], v[44:47], v[188:191]
    v_mfma_f32_16x16x32_bf16 v[192:195], a[232:235], v[32:35], v[192:195]
    v_mfma_f32_16x16x32_bf16 v[196:199], a[232:235], v[36:39], v[196:199]
    v_mfma_f32_16x16x32_bf16 v[200:203], a[232:235], v[40:43], v[200:203]
    buffer_load_dwordx4 a[160:163], v2, s[8:11], s40 offen offset:1024 sc1
    v_mfma_f32_16x16x32_bf16 v[204:207], a[232:235], v[44:47], v[204:207]
    s_waitcnt vmcnt(63)
    v_mfma_f32_16x16x32_bf16 v[208:211], a[236:239], v[32:35], v[208:211]
    v_mfma_f32_16x16x32_bf16 v[212:215], a[236:239], v[36:39], v[212:215]
    v_mfma_f32_16x16x32_bf16 v[216:219], a[236:239], v[40:43], v[216:219]
    buffer_load_dwordx4 a[164:167], v2, s[8:11], s40 offen offset:2048 sc1
    v_mfma_f32_16x16x32_bf16 v[220:223], a[236:239], v[44:47], v[220:223]
    s_add_u32 s40, s40, 9216
    v_mfma_f32_16x16x32_bf16 v[224:227], a[240:243], v[32:35], v[224:227]
    v_mfma_f32_16x16x32_bf16 v[228:231], a[240:243], v[36:39], v[228:231]
    v_mfma_f32_16x16x32_bf16 v[232:235], a[240:243], v[40:43], v[232:235]
    buffer_load_dwordx4 a[192:195], v2, s[8:11], s40 offen offset:0 sc1
    v_mfma_f32_16x16x32_bf16 v[236:239], a[240:243], v[44:47], v[236:239]
    v_mfma_f32_16x16x32_bf16 v[240:243], a[244:247], v[32:35], v[240:243]
    v_mfma_f32_16x16x32_bf16 v[244:247], a[244:247], v[36:39], v[244:247]
    v_mfma_f32_16x16x32_bf16 v[248:251], a[244:247], v[40:43], v[248:251]
    buffer_load_dwordx4 a[196:199], v2, s[8:11], s40 offen offset:1024 sc1
    v_mfma_f32_16x16x32_bf16 v[252:255], a[244:247], v[44:47], v[252:255]
    s_waitcnt vmcnt(9)
    s_mov_b32 s3, 0
TPL_57:
    v_cmp_ne_u32 vcc, s63, v11
    s_nop 4
    s_cbranch_vccz TOK_56
    buffer_load_dword v11, v10, s[28:31], 0 offen sc1
    s_waitcnt vmcnt(0)
    s_add_u32 s3, s3, 1
    s_cmp_lt_u32 s3, 0x200000
    s_cbranch_scc1 TPL_57
TOK_56:
    s_mov_b32 m0, s47
    s_waitcnt vmcnt(63) lgkmcnt(0)
    v_mfma_f32_16x16x32_bf16 v[112:115], a[248:251], v[16:19], v[112:115]
    ds_read_b128 v[32:35], v2 offset:28672
    v_mfma_f32_16x16x32_bf16 v[116:119], a[248:251], v[20:23], v[116:119]
    v_mfma_f32_16x16x32_bf16 v[120:123], a[248:251], v[24:27], v[120:123]
    buffer_load_dwordx4 v2, s[20:23], s46 offen sc1 lds
    v_mfma_f32_16x16x32_bf16 v[124:127], a[248:251], v[28:31], v[124:127]
    s_add_u32 m0, m0, 4096
    s_add_u32 s46, s46, 4096
    v_mfma_f32_16x16x32_bf16 v[128:131], a[252:255], v[16:19], v[128:131]
    ds_read_b128 v[36:39], v2 offset:29696
    v_mfma_f32_16x16x32_bf16 v[132:135], a[252:255], v[20:23], v[132:135]
    v_mfma_f32_16x16x32_bf16 v[136:139], a[252:255], v[24:27], v[136:139]
    buffer_load_dwordx4 v2, s[20:23], s46 offen sc1 lds
    v_mfma_f32_16x16x32_bf16 v[140:143], a[252:255], v[28:31], v[140:143]
    s_add_u32 m0, m0, 4096
    s_add_u32 s46, s46, 4096
    v_mfma_f32_16x16x32_bf16 v[144:147], a[168:171], v[16:19], v[144:147]
    ds_read_b128 v[40:43], v2 offset:30720
    v_mfma_f32_16x16x32_bf16 v[148:151], a[168:171], v[20:23], v[148:151]
    v_mfma_f32_16x16x32_bf16 v[152:155], a[168:171], v[24:27], v[152:155]
    buffer_load_dwordx4 v2, s[20:23], s46 offen sc1 lds
    v_mfma_f32_16x16x32_bf16 v[156:159], a[168:171], v[28:31], v[156:159]
    s_add_u32 m0, m0, 4096
    s_waitcnt vmcnt(63)
    v_mfma_f32_16x16x32_bf16 v[160:163], a[172:175], v[16:19], v[160:163]
    ds_read_b128 v[44:47], v2 offset:31744
    s_add_u32 s46, s46, 4096
    v_mfma_f32_16x16x32_bf16 v[164:167], a[172:175], v[20:23], v[164:167]
    v_mfma_f32_16x16x32_bf16 v[168:171], a[172:175], v[24:27], v[168:171]
    buffer_load_dwordx4 v2, s[20:23], s46 offen sc1 lds
    v_mfma_f32_16x16x32_bf16 v[172:175], a[172:175], v[28:31], v[172:175]
    s_add_u32 m0, m0, 4096
    s_add_u32 s46, s46, 4096
    v_mfma_f32_16x16x32_bf16 v[176:179], a[176:179], v[16:19], v[176:179]
    v_mfma_f32_16x16x32_bf16 v[180:183], a[176:179], v[20:23], v[180:183]
    v_mfma_f32_16x16x32_bf16 v[184:187], a[176:179], v[24:27], v[184:187]
    buffer_load_dwordx4 v2, s[20:23], s46 offen sc1 lds
    v_mfma_f32_16x16x32_bf16 v[188:191], a[176:179], v[28:31], v[188:191]
    s_add_u32 m0, m0, 4096
    s_add_u32 s46, s46, 4096
    v_mfma_f32_16x16x32_bf16 v[192:195], a[180:183], v[16:19], v[192:195]
    v_mfma_f32_16x16x32_bf16 v[196:199], a[180:183], v[20:23], v[196:199]
    v_mfma_f32_16x16x32_bf16 v[200:203], a[180:183], v[24:27], v[200:203]
    buffer_load_dwordx4 v2, s[20:23], s46 offen sc1 lds
    v_mfma_f32_16x16x32_bf16 v[204:207], a[180:183], v[28:31], v[204:207]
    s_add_u32 m0, m0, 4096
    s_waitcnt vmcnt(63)
    v_mfma_f32_16x16x32_bf16 v[208:211], a[184:187], v[16:19], v[208:211]
    s_add_u32 s46, s46, 4096
    v_mfma_f32_16x16x32_bf16 v[212:215], a[184:187], v[20:23], v[212:215]
    v_mfma_f32_16x16x32_bf16 v[216:219], a[184:187], v[24:27], v[216:219]
    buffer_load_dwordx4 v2, s[20:23], s46 offen sc1 lds
    v_mfma_f32_16x16x32_bf16 v[220:223], a[184:187], v[28:31], v[220:223]
    s_add_u32 m0, m0, 4096
    s_add_u32 s46, s46, 4096
    v_mfma_f32_16x16x32_bf16 v[224:227], a[188:191], v[16:19], v[224:227]
    v_mfma_f32_16x16x32_bf16 v[228:231], a[188:191], v[20:23], v[228:231]
    v_mfma_f32_16x16x32_bf16 v[232:235], a[188:191], v[24:27], v[232:235]
    buffer_load_dwordx4 v2, s[20:23], s46 offen sc1 lds
    v_mfma_f32_16x16x32_bf16 v[236:239], a[188:191], v[28:31], v[236:239]
    s_add_u32 m0, m0, 4096
    s_add_u32 s46, s46, 4096
    v_mfma_f32_16x16x32_bf16 v[240:243], a[0:3], v[16:19], v[240:243]
    v_mfma_f32_16x16x32_bf16 v[244:247], a[0:3], v[20:23], v[244:247]
    v_mfma_f32_16x16x32_bf16 v[248:251], a[0:3], v[24:27], v[248:251]
    buffer_load_dwordx4 v2, s[20:23], s46 offen sc1 lds
    v_mfma_f32_16x16x32_bf16 v[252:255], a[0:3], v[28:31], v[252:255]
    s_waitcnt vmcnt(63) lgkmcnt(0)
    v_mfma_f32_16x16x32_bf16 v[112:115], a[4:7], v[32:35], v[112:115]
    ds_read_b128 v[16:19], v2 offset:32768
    v_mfma_f32_16x16x32_bf16 v[116:119], a[4:7], v[36:39], v[116:119]
    v_mfma_f32_16x16x32_bf16 v[120:123], a[4:7], v[40:43], v[120:123]
    v_mfma_f32_16x16x32_bf16 v[124:127], a[4:7], v[44:47], v[124:127]
    v_mfma_f32_16x16x32_bf16 v[128:131], a[8:11], v[32:35], v[128:131]
    ds_read_b128 v[20:23], v2 offset:33792
    v_mfma_f32_16x16x32_bf16 v[132:135], a[8:11], v[36:39], v[132:135]
    v_mfma_f32_16x16x32_bf16 v[136:139], a[8:11], v[40:43], v[136:139]
    v_mfma_f32_16x16x32_bf16 v[140:143], a[8:11], v[44:47], v[140:143]
    v_mfma_f32_16x16x32_bf16 v[144:147], a[12:15], v[32:35], v[144:147]
    ds_read_b128 v[24:27], v2 offset:34816
    v_mfma_f32_16x16x32_bf16 v[148:151], a[12:15], v[36:39], v[148:151]
    v_mfma_f32_16x16x32_bf16 v[152:155], a[12:15], v[40:43], v[152:155]
    v_mfma_f32_16x16x32_bf16 v[156:159], a[12:15], v[44:47], v[156:159]
    s_waitcnt vmcnt(63)
    v_mfma_f32_16x16x32_bf16 v[160:163], a[16:19], v[32:35], v[160:163]
    ds_read_b128 v[28:31], v2 offset:35840
    v_mfma_f32_16x16x32_bf16 v[164:167], a[16:19], v[36:39], v[164:167]
    v_mfma_f32_16x16x32_bf16 v[168:171], a[16:19], v[40:43], v[168:171]
    v_mfma_f32_16x16x32_bf16 v[172:175], a[16:19], v[44:47], v[172:175]
    v_mfma_f32_16x16x32_bf16 v[176:179], a[20:23], v[32:35], v[176:179]
    v_mfma_f32_16x16x32_bf16 v[180:183], a[20:23], v[36:39], v[180:183]
    v_mfma_f32_16x16x32_bf16 v[184:187], a[20:23], v[40:43], v[184:187]
    v_mfma_f32_16x16x32_bf16 v[188:191], a[20:23], v[44:47], v[188:191]
    v_mfma_f32_16x16x32_bf16 v[192:195], a[24:27], v[32:35], v[192:195]
    v_mfma_f32_16x16x32_bf16 v[196:199], a[24:27], v[36:39], v[196:199]
    v_mfma_f32_16x16x32_bf16 v[200:203], a[24:27], v[40:43], v[200:203]
    v_mfma_f32_16x16x32_bf16 v[204:207], a[24:27], v[44:47], v[204:207]
    s_waitcnt vmcnt(61)
    v_mfma_f32_16x16x32_bf16 v[208:211], a[28:31], v[32:35], v[208:211]
    v_mfma_f32_16x16x32_bf16 v[212:215], a[28:31], v[36:39], v[212:215]
    v_mfma_f32_16x16x32_bf16 v[216:219], a[28:31], v[40:43], v[216:219]
    v_mfma_f32_16x16x32_bf16 v[220:223], a[28:31], v[44:47], v[220:223]
    v_mfma_f32_16x16x32_bf16 v[224:227], a[32:35], v[32:35], v[224:227]
    v_mfma_f32_16x16x32_bf16 v[228:231], a[32:35], v[36:39], v[228:231]
    v_mfma_f32_16x16x32_bf16 v[232:235], a[32:35], v[40:43], v[232:235]
    v_mfma_f32_16x16x32_bf16 v[236:239], a[32:35], v[44:47], v[236:239]
    v_mfma_f32_16x16x32_bf16 v[240:243], a[36:39], v[32:35], v[240:243]
    v_mfma_f32_16x16x32_bf16 v[244:247], a[36:39], v[36:39], v[244:247]
    v_mfma_f32_16x16x32_bf16 v[248:251], a[36:39], v[40:43], v[248:251]
    v_mfma_f32_16x16x32_bf16 v[252:255], a[36:39], v[44:47], v[252:255]
    s_waitcnt vmcnt(58) lgkmcnt(0)
    v_mfma_f32_16x16x32_bf16 v[112:115], a[40:43], v[16:19], v[112:115]
    v_mfma_f32_16x16x32_bf16 v[116:119], a[40:43], v[20:23], v[116:119]
    v_mfma_f32_16x16x32_bf16 v[120:123], a[40:43], v[24:27], v[120:123]
    v_mfma_f32_16x16x32_bf16 v[124:127], a[40:43], v[28:31], v[124:127]
    v_mfma_f32_16x16x32_bf16 v[128:131], a[44:47], v[16:19], v[128:131]
    v_mfma_f32_16x16x32_bf16 v[132:135], a[44:47], v[20:23], v[132:135]
    v_mfma_f32_16x16x32_bf16 v[136:139], a[44:47], v[24:27], v[136:139]
    v_mfma_f32_16x16x32_bf16 v[140:143], a[44:47], v[28:31], v[140:143]
    v_mfma_f32_16x16x32_bf16 v[144:147], a[48:51], v[16:19], v[144:147]
    v_mfma_f32_16x16x32_bf16 v[148:151], a[48:51], v[20:23], v[148:151]
    v_mfma_f32_16x16x32_bf16 v[152:155], a[48:51], v[24:27], v[152:155]
    v_mfma_f32_16x16x32_bf16 v[156:159], a[48:51], v[28:31], v[156:159]
    s_waitcnt vmcnt(54)
    v_mfma_f32_16x16x32_bf16 v[160:163], a[52:55], v[16:19], v[160:163]
    v_mfma_f32_16x16x32_bf16 v[164:167], a[52:55], v[20:23], v[164:167]
    v_mfma_f32_16x16x32_bf16 v[168:171], a[52:55], v[24:27], v[168:171]
    v_mfma_f32_16x16x32_bf16 v[172:175], a[52:55], v[28:31], v[172:175]
    v_mfma_f32_16x16x32_bf16 v[176:179], v[48:51], v[16:19], v[176:179]
    v_mfma_f32_16x16x32_bf16 v[180:183], v[48:51], v[20:23], v[180:183]
    v_mfma_f32_16x16x32_bf16 v[184:187], v[48:51], v[24:27], v[184:187]
    v_mfma_f32_16x16x32_bf16 v[188:191], v[48:51], v[28:31], v[188:191]
    v_mfma_f32_16x16x32_bf16 v[192:195], v[52:55], v[16:19], v[192:195]
    v_mfma_f32_16x16x32_bf16 v[196:199], v[52:55], v[20:23], v[196:199]
    v_mfma_f32_16x16x32_bf16 v[200:203], v[52:55], v[24:27], v[200:203]
    v_mfma_f32_16x16x32_bf16 v[204:207], v[52:55], v[28:31], v[204:207]
    s_waitcnt vmcnt(0)
    s_barrier
    s_waitcnt vmcnt(51)
    v_mfma_f32_16x16x32_bf16 v[208:211], v[56:59], v[16:19], v[208:211]
    ds_read_b128 v[32:35], v2 offset:36864
    v_mfma_f32_16x16x32_bf16 v[212:215], v[56:59], v[20:23], v[212:215]
    ds_read_b128 v[36:39], v2 offset:37888
    v_mfma_f32_16x16x32_bf16 v[216:219], v[56:59], v[24:27], v[216:219]
    v_mfma_f32_16x16x32_bf16 v[220:223], v[56:59], v[28:31], v[220:223]
    v_mfma_f32_16x16x32_bf16 v[224:227], v[60:63], v[16:19], v[224:227]
    ds_read_b128 v[40:43], v2 offset:38912
    v_mfma_f32_16x16x32_bf16 v[228:231], v[60:63], v[20:23], v[228:231]
    ds_read_b128 v[44:47], v2 offset:39936
    v_mfma_f32_16x16x32_bf16 v[232:235], v[60:63], v[24:27], v[232:235]
    v_mfma_f32_16x16x32_bf16 v[236:239], v[60:63], v[28:31], v[236:239]
    v_mfma_f32_16x16x32_bf16 v[240:243], v[64:67], v[16:19], v[240:243]
    v_mfma_f32_16x16x32_bf16 v[244:247], v[64:67], v[20:23], v[244:247]
    v_mfma_f32_16x16x32_bf16 v[248:251], v[64:67], v[24:27], v[248:251]
    v_mfma_f32_16x16x32_bf16 v[252:255], v[64:67], v[28:31], v[252:255]
    s_waitcnt vmcnt(48) lgkmcnt(0)
    v_mfma_f32_16x16x32_bf16 v[112:115], v[68:71], v[32:35], v[112:115]
    ds_read_b128 v[16:19], v2 offset:40960
    v_mfma_f32_16x16x32_bf16 v[116:119], v[68:71], v[36:39], v[116:119]
    ds_read_b128 v[20:23], v2 offset:41984
    v_mfma_f32_16x16x32_bf16 v[120:123], v[68:71], v[40:43], v[120:123]
    buffer_load_dwordx4 a[200:203], v2, s[8:11], s40 offen offset:2048 sc1
    v_mfma_f32_16x16x32_bf16 v[124:127], v[68:71], v[44:47], v[124:127]
    s_add_u32 s40, s40, 9216
    v_mfma_f32_16x16x32_bf16 v[128:131], v[72:75], v[32:35], v[128:131]
    ds_read_b128 v[24:27], v2 offset:43008
    v_mfma_f32_16x16x32_bf16 v[132:135], v[72:75], v[36:39], v[132:135]
    ds_read_b128 v[28:31], v2 offset:44032
    v_mfma_f32_16x16x32_bf16 v[136:139], v[72:75], v[40:43], v[136:139]
    buffer_load_dwordx4 a[204:207], v2, s[8:11], s40 offen offset:0 sc1
    v_mfma_f32_16x16x32_bf16 v[140:143], v[72:75], v[44:47], v[140:143]
    v_mfma_f32_16x16x32_bf16 v[144:147], v[76:79], v[32:35], v[144:147]
    v_mfma_f32_16x16x32_bf16 v[148:151], v[76:79], v[36:39], v[148:151]
    v_mfma_f32_16x16x32_bf16 v[152:155], v[76:79], v[40:43], v[152:155]
    buffer_load_dwordx4 a[208:211], v2, s[8:11], s40 offen offset:1024 sc1
    v_mfma_f32_16x16x32_bf16 v[156:159], v[76:79], v[44:47], v[156:159]
    s_waitcnt vmcnt(48) lgkmcnt(0)
    v_mfma_f32_16x16x32_bf16 v[112:115], v[80:83], v[16:19], v[112:115]
    ds_read_b128 v[32:35], v2 offset:45056
    v_mfma_f32_16x16x32_bf16 v[116:119], v[80:83], v[20:23], v[116:119]
    ds_read_b128 v[36:39], v2 offset:46080
    v_mfma_f32_16x16x32_bf16 v[120:123], v[80:83], v[24:27], v[120:123]
    buffer_load_dwordx4 a[212:215], v2, s[8:11], s40 offen offset:2048 sc1
    v_mfma_f32_16x16x32_bf16 v[124:127], v[80:83], v[28:31], v[124:127]
    s_add_u32 s40, s40, 9216
    v_mfma_f32_16x16x32_bf16 v[128:131], v[84:87], v[16:19], v[128:131]
    ds_read_b128 v[40:43], v2 offset:47104
    v_mfma_f32_16x16x32_bf16 v[132:135], v[84:87], v[20:23], v[132:135]
    ds_read_b128 v[44:47], v2 offset:48128
    v_mfma_f32_16x16x32_bf16 v[136:139], v[84:87], v[24:27], v[136:139]
    buffer_load_dwordx4 a[216:219], v2, s[8:11], s40 offen offset:0 sc1
    v_mfma_f32_16x16x32_bf16 v[140:143], v[84:87], v[28:31], v[140:143]
    v_mfma_f32_16x16x32_bf16 v[144:147], v[88:91], v[16:19], v[144:147]
    v_mfma_f32_16x16x32_bf16 v[148:151], v[88:91], v[20:23], v[148:151]
    v_mfma_f32_16x16x32_bf16 v[152:155], v[88:91], v[24:27], v[152:155]
    buffer_load_dwordx4 a[220:223], v2, s[8:11], s40 offen offset:1024 sc1
    v_mfma_f32_16x16x32_bf16 v[156:159], v[88:91], v[28:31], v[156:159]
    s_waitcnt vmcnt(48) lgkmcnt(0)
    v_mfma_f32_16x16x32_bf16 v[112:115], v[92:95], v[32:35], v[112:115]
    ds_read_b128 v[16:19], v2 offset:49152
    v_mfma_f32_16x16x32_bf16 v[116:119], v[92:95], v[36:39], v[116:119]
    ds_read_b128 v[20:23], v2 offset:50176
    v_mfma_f32_16x16x32_bf16 v[120:123], v[92:95], v[40:43], v[120:123]
    buffer_load_dwordx4 a[224:227], v2, s[8:11], s40 offen offset:2048 sc1
    v_mfma_f32_16x16x32_bf16 v[124:127], v[92:95], v[44:47], v[124:127]
    s_add_u32 s40, s40, 9216
    v_mfma_f32_16x16x32_bf16 v[128:131], v[96:99], v[32:35], v[128:131]
    ds_read_b128 v[24:27], v2 offset:51200
    v_mfma_f32_16x16x32_bf16 v[132:135], v[96:99], v[36:39], v[132:135]
    ds_read_b128 v[28:31], v2 offset:52224
    v_mfma_f32_16x16x32_bf16 v[136:139], v[96:99], v[40:43], v[136:139]
    buffer_load_dwordx4 a[228:231], v2, s[8:11], s40 offen offset:0 sc1
    v_mfma_f32_16x16x32_bf16 v[140:143], v[96:99], v[44:47], v[140:143]
    v_mfma_f32_16x16x32_bf16 v[144:147], v[100:103], v[32:35], v[144:147]
    v_mfma_f32_16x16x32_bf16 v[148:151], v[100:103], v[36:39], v[148:151]
    v_mfma_f32_16x16x32_bf16 v[152:155], v[100:103], v[40:43], v[152:155]
    buffer_load_dwordx4 a[232:235], v2, s[8:11], s40 offen offset:1024 sc1
    v_mfma_f32_16x16x32_bf16 v[156:159], v[100:103], v[44:47], v[156:159]
    s_waitcnt vmcnt(48) lgkmcnt(0)
    v_mfma_f32_16x16x32_bf16 v[112:115], v[104:107], v[16:19], v[112:115]
    ds_read_b128 v[32:35], v2 offset:53248
    v_mfma_f32_16x16x32_bf16 v[116:119], v[104:107], v[20:23], v[116:119]
    ds_read_b128 v[36:39], v2 offset:54272
    v_mfma_f32_16x16x32_bf16 v[120:123], v[104:107], v[24:27], v[120:123]
    buffer_load_dwordx4 a[236:239], v2, s[8:11], s40 offen offset:2048 sc1
    v_mfma_f32_16x16x32_bf16 v[124:127], v[104:107], v[28:31], v[124:127]
    s_add_u32 s40, s40, 9216
    v_mfma_f32_16x16x32_bf16 v[128:131], v[108:111], v[16:19], v[128:131]
    ds_read_b128 v[40:43], v2 offset:55296
    v_mfma_f32_16x16x32_bf16 v[132:135], v[108:111], v[20:23], v[132:135]
    ds_read_b128 v[44:47], v2 offset:56320
    v_mfma_f32_16x16x32_bf16 v[136:139], v[108:111], v[24:27], v[136:139]
    buffer_load_dwordx4 a[240:243], v2, s[8:11], s40 offen offset:0 sc1
    v_mfma_f32_16x16x32_bf16 v[140:143], v[108:111], v[28:31], v[140:143]
    v_mfma_f32_16x16x32_bf16 v[144:147], a[56:59], v[16:19], v[144:147]
    v_mfma_f32_16x16x32_bf16 v[148:151], a[56:59], v[20:23], v[148:151]
    v_mfma_f32_16x16x32_bf16 v[152:155], a[56:59], v[24:27], v[152:155]
    buffer_load_dwordx4 a[244:247], v2, s[8:11], s40 offen offset:1024 sc1
    v_mfma_f32_16x16x32_bf16 v[156:159], a[56:59], v[28:31], v[156:159]
    s_waitcnt vmcnt(48) lgkmcnt(0)
    v_mfma_f32_16x16x32_bf16 v[112:115], a[60:63], v[32:35], v[112:115]
    ds_read_b128 v[16:19], v2 offset:57344
    v_mfma_f32_16x16x32_bf16 v[116:119], a[60:63], v[36:39], v[116:119]
    ds_read_b128 v[20:23], v2 offset:58368
    v_mfma_f32_16x16x32_bf16 v[120:123], a[60:63], v[40:43], v[120:123]
    buffer_load_dwordx4 a[248:251], v2, s[8:11], s40 offen offset:2048 sc1
    v_mfma_f32_16x16x32_bf16 v[124:127], a[60:63], v[44:47], v[124:127]
    s_add_u32 s40, s40, 4294896640
    v_mfma_f32_16x16x32_bf16 v[128:131], a[64:67], v[32:35], v[128:131]
    ds_read_b128 v[24:27], v2 offset:59392
    v_mfma_f32_16x16x32_bf16 v[132:135], a[64:67], v[36:39], v[132:135]
    ds_read_b128 v[28:31], v2 offset:60416
    v_mfma_f32_16x16x32_bf16 v[136:139], a[64:67], v[40:43], v[136:139]
    buffer_load_dwordx4 a[252:255], v2, s[8:11], s40 offen offset:0 sc1
    v_mfma_f32_16x16x32_bf16 v[140:143], a[64:67], v[44:47], v[140:143]
    v_mfma_f32_16x16x32_bf16 v[144:147], a[68:71], v[32:35], v[144:147]
    v_mfma_f32_16x16x32_bf16 v[148:151], a[68:71], v[36:39], v[148:151]
    v_mfma_f32_16x16x32_bf16 v[152:155], a[68:71], v[40:43], v[152:155]
    buffer_load_dwordx4 a[168:171], v2, s[8:11], s40 offen offset:1024 sc1
    v_mfma_f32_16x16x32_bf16 v[156:159], a[68:71], v[44:47], v[156:159]
    s_waitcnt vmcnt(48) lgkmcnt(0)
    v_mfma_f32_16x16x32_bf16 v[112:115], a[72:75], v[16:19], v[112:115]
    ds_read_b128 v[32:35], v2 offset:61440
    v_mfma_f32_16x16x32_bf16 v[116:119], a[72:75], v[20:23], v[116:119]
    ds_read_b128 v[36:39], v2 offset:62464
    v_mfma_f32_16x16x32_bf16 v[120:123], a[72:75], v[24:27], v[120:123]
    buffer_load_dwordx4 a[172:175], v2, s[8:11], s40 offen offset:2048 sc1
    v_mfma_f32_16x16x32_bf16 v[124:127], a[72:75], v[28:31], v[124:127]
    s_add_u32 s40, s40, 9216
    v_mfma_f32_16x16x32_bf16 v[128:131], a[76:79], v[16:19], v[128:131]
    ds_read_b128 v[40:43], v2 offset:63488
    v_mfma_f32_16x16x32_bf16 v[132:135], a[76:79], v[20:23], v[132:135]
    ds_read_b128 v[44:47], v2 offset:64512
    v_mfma_f32_16x16x32_bf16 v[136:139], a[76:79], v[24:27], v[136:139]
    buffer_load_dwordx4 a[176:179], v2, s[8:11], s40 offen offset:0 sc1
    v_mfma_f32_16x16x32_bf16 v[140:143], a[76:79], v[28:31], v[140:143]
    v_mfma_f32_16x16x32_bf16 v[144:147], a[80:83], v[16:19], v[144:147]
    v_mfma_f32_16x16x32_bf16 v[148:151], a[80:83], v[20:23], v[148:151]
    v_mfma_f32_16x16x32_bf16 v[152:155], a[80:83], v[24:27], v[152:155]
    buffer_load_dwordx4 a[180:183], v2, s[8:11], s40 offen offset:1024 sc1
    v_mfma_f32_16x16x32_bf16 v[156:159], a[80:83], v[28:31], v[156:159]
    s_waitcnt vmcnt(48) lgkmcnt(0)
    v_mfma_f32_16x16x32_bf16 v[112:115], a[84:87], v[32:35], v[112:115]
    ds_read_b128 v[16:19], v3 offset:0
    v_mfma_f32_16x16x32_bf16 v[116:119], a[84:87], v[36:39], v[116:119]
    ds_read_b128 v[20:23], v3 offset:1024
    v_mfma_f32_16x16x32_bf16 v[120:123], a[84:87], v[40:43], v[120:123]
    buffer_load_dwordx4 a[184:187], v2, s[8:11], s40 offen offset:2048 sc1
    v_mfma_f32_16x16x32_bf16 v[124:127], a[84:87], v[44:47], v[124:127]
    s_add_u32 s40, s40, 9216
    v_mfma_f32_16x16x32_bf16 v[128:131], a[88:91], v[32:35], v[128:131]
    ds_read_b128 v[24:27], v3 offset:2048
    v_mfma_f32_16x16x32_bf16 v[132:135], a[88:91], v[36:39], v[132:135]
    ds_read_b128 v[28:31], v3 offset:3072
    v_mfma_f32_16x16x32_bf16 v[136:139], a[88:91], v[40:43], v[136:139]
    buffer_load_dwordx4 a[188:191], v2, s[8:11], s40 offen offset:0 sc1
    v_mfma_f32_16x16x32_bf16 v[140:143], a[88:91], v[44:47], v[140:143]
    v_mfma_f32_16x16x32_bf16 v[144:147], a[92:95], v[32:35], v[144:147]
    v_mfma_f32_16x16x32_bf16 v[148:151], a[92:95], v[36:39], v[148:151]
    v_mfma_f32_16x16x32_bf16 v[152:155], a[92:95], v[40:43], v[152:155]
    buffer_load_dwordx4 a[0:3], v2, s[8:11], s40 offen offset:1024 sc1
    v_mfma_f32_16x16x32_bf16 v[156:159], a[92:95], v[44:47], v[156:159]
    s_waitcnt vmcnt(48) lgkmcnt(0)
    v_mfma_f32_16x16x32_bf16 v[112:115], a[96:99], v[16:19], v[112:115]
    ds_read_b128 v[32:35], v3 offset:4096
    v_mfma_f32_16x16x32_bf16 v[116:119], a[96:99], v[20:23], v[116:119]
    ds_read_b128 v[36:39], v3 offset:5120
    v_mfma_f32_16x16x32_bf16 v[120:123], a[96:99], v[24:27], v[120:123]
    buffer_load_dwordx4 a[4:7], v2, s[8:11], s40 offen offset:2048 sc1
    v_mfma_f32_16x16x32_bf16 v[124:127], a[96:99], v[28:31], v[124:127]
    s_add_u32 s40, s40, 9216
    v_mfma_f32_16x16x32_bf16 v[128:131], a[100:103], v[16:19], v[128:131]
    ds_read_b128 v[40:43], v3 offset:6144
    v_mfma_f32_16x16x32_bf16 v[132:135], a[100:103], v[20:23], v[132:135]
    ds_read_b128 v[44:47], v3 offset:7168
    v_mfma_f32_16x16x32_bf16 v[136:139], a[100:103], v[24:27], v[136:139]
    buffer_load_dwordx4 a[8:11], v2, s[8:11], s40 offen offset:0 sc1
    v_mfma_f32_16x16x32_bf16 v[140:143], a[100:103], v[28:31], v[140:143]
    v_mfma_f32_16x16x32_bf16 v[144:147], a[104:107], v[16:19], v[144:147]
    v_mfma_f32_16x16x32_bf16 v[148:151], a[104:107], v[20:23], v[148:151]
    v_mfma_f32_16x16x32_bf16 v[152:155], a[104:107], v[24:27], v[152:155]
    buffer_load_dwordx4 a[12:15], v2, s[8:11], s40 offen offset:1024 sc1
    v_mfma_f32_16x16x32_bf16 v[156:159], a[104:107], v[28:31], v[156:159]
    s_waitcnt vmcnt(48) lgkmcnt(0)
    v_mfma_f32_16x16x32_bf16 v[112:115], a[108:111], v[32:35], v[112:115]
    ds_read_b128 v[16:19], v2 offset:36864
    v_mfma_f32_16x16x32_bf16 v[116:119], a[108:111], v[36:39], v[116:119]
    ds_read_b128 v[20:23], v2 offset:37888
    v_mfma_f32_16x16x32_bf16 v[120:123], a[108:111], v[40:43], v[120:123]
    buffer_load_dwordx4 a[16:19], v2, s[8:11], s40 offen offset:2048 sc1
    v_mfma_f32_16x16x32_bf16 v[124:127], a[108:111], v[44:47], v[124:127]
    s_add_u32 s40, s40, 9216
    v_mfma_f32_16x16x32_bf16 v[128:131], a[112:115], v[32:35], v[128:131]
    ds_read_b128 v[24:27], v2 offset:38912
    v_mfma_f32_16x16x32_bf16 v[132:135], a[112:115], v[36:39], v[132:135]
    ds_read_b128 v[28:31], v2 offset:39936
    v_mfma_f32_16x16x32_bf16 v[136:139], a[112:115], v[40:43], v[136:139]
    buffer_load_dwordx4 a[20:23], v2, s[8:11], s40 offen offset:0 sc1
    v_mfma_f32_16x16x32_bf16 v[140:143], a[112:115], v[44:47], v[140:143]
    v_mfma_f32_16x16x32_bf16 v[144:147], a[116:119], v[32:35], v[144:147]
    v_mfma_f32_16x16x32_bf16 v[148:151], a[116:119], v[36:39], v[148:151]
    v_mfma_f32_16x16x32_bf16 v[152:155], a[116:119], v[40:43], v[152:155]
    buffer_load_dwordx4 a[24:27], v2, s[8:11], s40 offen offset:1024 sc1
    v_mfma_f32_16x16x32_bf16 v[156:159], a[116:119], v[44:47], v[156:159]
    s_waitcnt vmcnt(48) lgkmcnt(0)
    v_mfma_f32_16x16x32_bf16 v[160:163], a[120:123], v[16:19], v[160:163]
    ds_read_b128 v[32:35], v2 offset:40960
    s_mov_b32 s43, 0
    v_mfma_f32_16x16x32_bf16 v[164:167], a[120:123], v[20:23], v[164:167]
    ds_read_b128 v[36:39], v2 offset:41984
    s_mov_b32 s45, 4096
    v_mfma_f32_16x16x32_bf16 v[168:171], a[120:123], v[24:27], v[168:171]
    buffer_load_dwordx4 a[28:31], v2, s[8:11], s40 offen offset:2048 sc1
    v_mfma_f32_16x16x32_bf16 v[172:175], a[120:123], v[28:31], v[172:175]
    s_add_u32 s40, s40, 9216
    v_cvt_pk_bf16_f32 v112, v112, v113
    v_mfma_f32_16x16x32_bf16 v[176:179], a[124:127], v[16:19], v[176:179]
    ds_read_b128 v[40:43], v2 offset:43008
    v_cvt_pk_bf16_f32 v113, v114, v115
    v_mfma_f32_16x16x32_bf16 v[180:183], a[124:127], v[20:23], v[180:183]
    ds_read_b128 v[44:47], v2 offset:44032
    v_cvt_pk_bf16_f32 v114, v116, v117
    v_mfma_f32_16x16x32_bf16 v[184:187], a[124:127], v[24:27], v[184:187]
    buffer_load_dwordx4 a[32:35], v2, s[8:11], s40 offen offset:0 sc1
    v_mfma_f32_16x16x32_bf16 v[188:191], a[124:127], v[28:31], v[188:191]
    v_mfma_f32_16x16x32_bf16 v[192:195], a[128:131], v[16:19], v[192:195]
    v_mfma_f32_16x16x32_bf16 v[196:199], a[128:131], v[20:23], v[196:199]
    v_mfma_f32_16x16x32_bf16 v[200:203], a[128:131], v[24:27], v[200:203]
    buffer_load_dwordx4 a[36:39], v2, s[8:11], s40 offen offset:1024 sc1
    v_mfma_f32_16x16x32_bf16 v[204:207], a[128:131], v[28:31], v[204:207]
    s_waitcnt vmcnt(47) lgkmcnt(0)
    v_mfma_f32_16x16x32_bf16 v[160:163], a[132:135], v[32:35], v[160:163]
    ds_read_b128 v[16:19], v2 offset:45056
    v_cvt_pk_bf16_f32 v115, v118, v119
    v_mfma_f32_16x16x32_bf16 v[164:167], a[132:135], v[36:39], v[164:167]
    ds_read_b128 v[20:23], v2 offset:46080
    v_mfma_f32_16x16x32_bf16 v[168:171], a[132:135], v[40:43], v[168:171]
    buffer_load_dwordx4 a[40:43], v2, s[8:11], s40 offen offset:2048 sc1
    v_mfma_f32_16x16x32_bf16 v[172:175], a[132:135], v[44:47], v[172:175]
    s_add_u32 s40, s40, 9216
    v_mfma_f32_16x16x32_bf16 v[176:179], a[136:139], v[32:35], v[176:179]
    ds_read_b128 v[24:27], v2 offset:47104
    v_mfma_f32_16x16x32_bf16 v[180:183], a[136:139], v[36:39], v[180:183]
    ds_read_b128 v[28:31], v2 offset:48128
    v_mfma_f32_16x16x32_bf16 v[184:187], a[136:139], v[40:43], v[184:187]
    buffer_load_dwordx4 a[44:47], v2, s[8:11], s40 offen offset:0 sc1
    v_mfma_f32_16x16x32_bf16 v[188:191], a[136:139], v[44:47], v[188:191]
    buffer_store_dwordx4 v[112:115], v9, s[16:19], s43 offen offset:0 sc1
    v_mfma_f32_16x16x32_bf16 v[192:195], a[140:143], v[32:35], v[192:195]
    v_cvt_pk_bf16_f32 v120, v120, v121
    v_cvt_pk_bf16_f32 v121, v122, v123
    v_mfma_f32_16x16x32_bf16 v[196:199], a[140:143], v[36:39], v[196:199]
    v_cvt_pk_bf16_f32 v122, v124, v125
    v_mfma_f32_16x16x32_bf16 v[200:203], a[140:143], v[40:43], v[200:203]
    buffer_load_dwordx4 a[48:51], v2, s[8:11], s40 offen offset:1024 sc1
    v_mfma_f32_16x16x32_bf16 v[204:207], a[140:143], v[44:47], v[204:207]
    s_waitcnt vmcnt(48) lgkmcnt(0)
    v_mfma_f32_16x16x32_bf16 v[160:163], a[144:147], v[16:19], v[160:163]
    ds_read_b128 v[32:35], v2 offset:49152
    v_cvt_pk_bf16_f32 v123, v126, v127
    v_mfma_f32_16x16x32_bf16 v[164:167], a[144:147], v[20:23], v[164:167]
    ds_read_b128 v[36:39], v2 offset:50176
    v_mfma_f32_16x16x32_bf16 v[168:171], a[144:147], v[24:27], v[168:171]
    buffer_load_dwordx4 a[52:55], v2, s[8:11], s40 offen offset:2048 sc1
    v_mfma_f32_16x16x32_bf16 v[172:175], a[144:147], v[28:31], v[172:175]
    s_add_u32 s40, s40, 9216
    v_mfma_f32_16x16x32_bf16 v[176:179], a[148:151], v[16:19], v[176:179]
    ds_read_b128 v[40:43], v2 offset:51200
    v_mfma_f32_16x16x32_bf16 v[180:183], a[148:151], v[20:23], v[180:183]
    ds_read_b128 v[44:47], v2 offset:52224
    v_mfma_f32_16x16x32_bf16 v[184:187], a[148:151], v[24:27], v[184:187]
    buffer_load_dwordx4 v[48:51], v2, s[8:11], s40 offen offset:0 sc1
    v_mfma_f32_16x16x32_bf16 v[188:191], a[148:151], v[28:31], v[188:191]
    buffer_store_dwordx4 v[120:123], v9, s[16:19], s43 offen offset:1024 sc1
    v_mfma_f32_16x16x32_bf16 v[192:195], a[152:155], v[16:19], v[192:195]
    v_cvt_pk_bf16_f32 v128, v128, v129
    v_cvt_pk_bf16_f32 v129, v130, v131
    v_mfma_f32_16x16x32_bf16 v[196:199], a[152:155], v[20:23], v[196:199]
    v_cvt_pk_bf16_f32 v130, v132, v133
    v_mfma_f32_16x16x32_bf16 v[200:203], a[152:155], v[24:27], v[200:203]
    buffer_load_dwordx4 v[52:55], v2, s[8:11], s40 offen offset:1024 sc1
    v_mfma_f32_16x16x32_bf16 v[204:207], a[152:155], v[28:31], v[204:207]
    s_waitcnt vmcnt(49) lgkmcnt(0)
    v_mfma_f32_16x16x32_bf16 v[160:163], a[156:159], v[32:35], v[160:163]
    ds_read_b128 v[16:19], v2 offset:53248
    v_cvt_pk_bf16_f32 v131, v134, v135
    v_mfma_f32_16x16x32_bf16 v[164:167], a[156:159], v[36:39], v[164:167]
    ds_read_b128 v[20:23], v2 offset:54272
    v_mfma_f32_16x16x32_bf16 v[168:171], a[156:159], v[40:43], v[168:171]
    buffer_load_dwordx4 v[56:59], v2, s[8:11], s40 offen offset:2048 sc1
    v_mfma_f32_16x16x32_bf16 v[172:175], a[156:159], v[44:47], v[172:175]
    s_add_u32 s40, s40, 9216
    v_mfma_f32_16x16x32_bf16 v[176:179], a[160:163], v[32:35], v[176:179]
    ds_read_b128 v[24:27], v2 offset:55296
    v_mfma_f32_16x16x32_bf16 v[180:183], a[160:163], v[36:39], v[180:183]
    ds_read_b128 v[28:31], v2 offset:56320
    v_mfma_f32_16x16x32_bf16 v[184:187], a[160:163], v[40:43], v[184:187]
    buffer_load_dwordx4 v[60:63], v2, s[8:11], s40 offen offset:0 sc1
    v_mfma_f32_16x16x32_bf16 v[188:191], a[160:163], v[44:47], v[188:191]
    buffer_store_dwordx4 v[128:131], v9, s[16:19], s43 offen offset:2048 sc1
    v_mfma_f32_16x16x32_bf16 v[192:195], a[164:167], v[32:35], v[192:195]
    v_cvt_pk_bf16_f32 v136, v136, v137
    v_cvt_pk_bf16_f32 v137, v138, v139
    v_mfma_f32_16x16x32_bf16 v[196:199], a[164:167], v[36:39], v[196:199]
    v_cvt_pk_bf16_f32 v138, v140, v141
    v_mfma_f32_16x16x32_bf16 v[200:203], a[164:167], v[40:43], v[200:203]
    buffer_load_dwordx4 v[64:67], v2, s[8:11], s40 offen offset:1024 sc1
    v_mfma_f32_16x16x32_bf16 v[204:207], a[164:167], v[44:47], v[204:207]
    s_waitcnt vmcnt(41) lgkmcnt(0)
    v_mfma_f32_16x16x32_bf16 v[160:163], a[192:195], v[16:19], v[160:163]
    ds_read_b128 v[32:35], v2 offset:57344
    v_cvt_pk_bf16_f32 v139, v142, v143
    v_mfma_f32_16x16x32_bf16 v[164:167], a[192:195], v[20:23], v[164:167]
    ds_read_b128 v[36:39], v2 offset:58368
    v_mfma_f32_16x16x32_bf16 v[168:171], a[192:195], v[24:27], v[168:171]
    buffer_load_dwordx4 v[68:71], v2, s[8:11], s40 offen offset:2048 sc1
    v_mfma_f32_16x16x32_bf16 v[172:175], a[192:195], v[28:31], v[172:175]
    buffer_store_dwordx4 v[136:139], v9, s[16:19], s43 offen offset:3072 sc1
    v_mfma_f32_16x16x32_bf16 v[176:179], a[196:199], v[16:19], v[176:179]
    ds_read_b128 v[40:43], v2 offset:59392
    v_cvt_pk_bf16_f32 v144, v144, v145
    v_mfma_f32_16x16x32_bf16 v[180:183], a[196:199], v[20:23], v[180:183]
    ds_read_b128 v[44:47], v2 offset:60416
    v_cvt_pk_bf16_f32 v145, v146, v147
    v_mfma_f32_16x16x32_bf16 v[184:187], a[196:199], v[24:27], v[184:187]
    v_cvt_pk_bf16_f32 v146, v148, v149
    v_mfma_f32_16x16x32_bf16 v[188:191], a[196:199], v[28:31], v[188:191]
    v_mfma_f32_16x16x32_bf16 v[192:195], a[200:203], v[16:19], v[192:195]
    v_mfma_f32_16x16x32_bf16 v[196:199], a[200:203], v[20:23], v[196:199]
    v_mfma_f32_16x16x32_bf16 v[200:203], a[200:203], v[24:27], v[200:203]
    v_mfma_f32_16x16x32_bf16 v[204:207], a[200:203], v[28:31], v[204:207]
    s_waitcnt vmcnt(40) lgkmcnt(0)
    v_mfma_f32_16x16x32_bf16 v[160:163], a[204:207], v[32:35], v[160:163]
    ds_read_b128 v[16:19], v2 offset:61440
    v_cvt_pk_bf16_f32 v147, v150, v151
    v_mfma_f32_16x16x32_bf16 v[164:167], a[204:207], v[36:39], v[164:167]
    ds_read_b128 v[20:23], v2 offset:62464
    v_mfma_f32_16x16x32_bf16 v[168:171], a[204:207], v[40:43], v[168:171]
    buffer_store_dwordx4 v[144:147], v9, s[16:19], s45 offen offset:0 sc1
    v_mfma_f32_16x16x32_bf16 v[172:175], a[204:207], v[44:47], v[172:175]
    v_cvt_pk_bf16_f32 v152, v152, v153
    v_cvt_pk_bf16_f32 v153, v154, v155
    v_mfma_f32_16x16x32_bf16 v[176:179], a[208:211], v[32:35], v[176:179]
    ds_read_b128 v[24:27], v2 offset:63488
    v_cvt_pk_bf16_f32 v154, v156, v157
    v_mfma_f32_16x16x32_bf16 v[180:183], a[208:211], v[36:39], v[180:183]
    ds_read_b128 v[28:31], v2 offset:64512
    v_mfma_f32_16x16x32_bf16 v[184:187], a[208:211], v[40:43], v[184:187]
    v_mfma_f32_16x16x32_bf16 v[188:191], a[208:211], v[44:47], v[188:191]
    v_mfma_f32_16x16x32_bf16 v[192:195], a[212:215], v[32:35], v[192:195]
    v_mfma_f32_16x16x32_bf16 v[196:199], a[212:215], v[36:39], v[196:199]
    v_mfma_f32_16x16x32_bf16 v[200:203], a[212:215], v[40:43], v[200:203]
    v_mfma_f32_16x16x32_bf16 v[204:207], a[212:215], v[44:47], v[204:207]
    s_waitcnt vmcnt(38) lgkmcnt(0)
    v_mfma_f32_16x16x32_bf16 v[160:163], a[216:219], v[16:19], v[160:163]
    ds_read_b128 v[32:35], v3 offset:0
    v_cvt_pk_bf16_f32 v155, v158, v159
    v_mfma_f32_16x16x32_bf16 v[164:167], a[216:219], v[20:23], v[164:167]
    ds_read_b128 v[36:39], v3 offset:1024
    v_mfma_f32_16x16x32_bf16 v[168:171], a[216:219], v[24:27], v[168:171]
    buffer_store_dwordx4 v[152:155], v9, s[16:19], s45 offen offset:1024 sc1
    v_mfma_f32_16x16x32_bf16 v[172:175], a[216:219], v[28:31], v[172:175]
    v_mfma_f32_16x16x32_bf16 v[176:179], a[220:223], v[16:19], v[176:179]
    ds_read_b128 v[40:43], v3 offset:2048
    v_mfma_f32_16x16x32_bf16 v[180:183], a[220:223], v[20:23], v[180:183]
    ds_read_b128 v[44:47], v3 offset:3072
    v_mfma_f32_16x16x32_bf16 v[184:187], a[220:223], v[24:27], v[184:187]
    v_mfma_f32_16x16x32_bf16 v[188:191], a[220:223], v[28:31], v[188:191]
    v_mfma_f32_16x16x32_bf16 v[192:195], a[224:227], v[16:19], v[192:195]
    v_mfma_f32_16x16x32_bf16 v[196:199], a[224:227], v[20:23], v[196:199]
    v_mfma_f32_16x16x32_bf16 v[200:203], a[224:227], v[24:27], v[200:203]
    v_mfma_f32_16x16x32_bf16 v[204:207], a[224:227], v[28:31], v[204:207]
    s_waitcnt vmcnt(36) lgkmcnt(0)
    v_mfma_f32_16x16x32_bf16 v[160:163], a[228:231], v[32:35], v[160:163]
    ds_read_b128 v[16:19], v3 offset:4096
    v_mfma_f32_16x16x32_bf16 v[164:167], a[228:231], v[36:39], v[164:167]
    ds_read_b128 v[20:23], v3 offset:5120
    v_mfma_f32_16x16x32_bf16 v[168:171], a[228:231], v[40:43], v[168:171]
    v_mfma_f32_16x16x32_bf16 v[172:175], a[228:231], v[44:47], v[172:175]
    v_mfma_f32_16x16x32_bf16 v[176:179], a[232:235], v[32:35], v[176:179]
    ds_read_b128 v[24:27], v3 offset:6144
    v_mfma_f32_16x16x32_bf16 v[180:183], a[232:235], v[36:39], v[180:183]
    ds_read_b128 v[28:31], v3 offset:7168
    v_mfma_f32_16x16x32_bf16 v[184:187], a[232:235], v[40:43], v[184:187]
    v_mfma_f32_16x16x32_bf16 v[188:191], a[232:235], v[44:47], v[188:191]
    v_mfma_f32_16x16x32_bf16 v[192:195], a[236:239], v[32:35], v[192:195]
    v_mfma_f32_16x16x32_bf16 v[196:199], a[236:239], v[36:39], v[196:199]
    v_mfma_f32_16x16x32_bf16 v[200:203], a[236:239], v[40:43], v[200:203]
    v_mfma_f32_16x16x32_bf16 v[204:207], a[236:239], v[44:47], v[204:207]
    s_waitcnt vmcnt(33) lgkmcnt(0)
    v_mfma_f32_16x16x32_bf16 v[160:163], a[240:243], v[16:19], v[160:163]
    ds_read_b128 v[32:35], v2 offset:36864
    v_mfma_f32_16x16x32_bf16 v[164:167], a[240:243], v[20:23], v[164:167]
    ds_read_b128 v[36:39], v2 offset:37888
    v_mfma_f32_16x16x32_bf16 v[168:171], a[240:243], v[24:27], v[168:171]
    v_mfma_f32_16x16x32_bf16 v[172:175], a[240:243], v[28:31], v[172:175]
    v_mfma_f32_16x16x32_bf16 v[176:179], a[244:247], v[16:19], v[176:179]
    ds_read_b128 v[40:43], v2 offset:38912
    v_mfma_f32_16x16x32_bf16 v[180:183], a[244:247], v[20:23], v[180:183]
    ds_read_b128 v[44:47], v2 offset:39936
    v_mfma_f32_16x16x32_bf16 v[184:187], a[244:247], v[24:27], v[184:187]
    v_mfma_f32_16x16x32_bf16 v[188:191], a[244:247], v[28:31], v[188:191]
    v_mfma_f32_16x16x32_bf16 v[192:195], a[248:251], v[16:19], v[192:195]
    v_mfma_f32_16x16x32_bf16 v[196:199], a[248:251], v[20:23], v[196:199]
    v_mfma_f32_16x16x32_bf16 v[200:203], a[248:251], v[24:27], v[200:203]
    v_mfma_f32_16x16x32_bf16 v[204:207], a[248:251], v[28:31], v[204:207]
    s_waitcnt vmcnt(30) lgkmcnt(0)
    v_mfma_f32_16x16x32_bf16 v[208:211], a[252:255], v[32:35], v[208:211]
    ds_read_b128 v[16:19], v2 offset:40960
    s_mov_b32 s43, 24576
    v_mfma_f32_16x16x32_bf16 v[212:215], a[252:255], v[36:39], v[212:215]
    ds_read_b128 v[20:23], v2 offset:41984
    s_mov_b32 s45, 28672
    v_mfma_f32_16x16x32_bf16 v[216:219], a[252:255], v[40:43], v[216:219]
    v_cvt_pk_bf16_f32 v160, v160, v161
    v_cvt_pk_bf16_f32 v161, v162, v163
    v_mfma_f32_16x16x32_bf16 v[220:223], a[252:255], v[44:47], v[220:223]
    v_cvt_pk_bf16_f32 v162, v164, v165
    v_cvt_pk_bf16_f32 v163, v166, v167
    v_mfma_f32_16x16x32_bf16 v[224:227], a[168:171], v[32:35], v[224:227]
    ds_read_b128 v[24:27], v2 offset:43008
    v_mfma_f32_16x16x32_bf16 v[228:231], a[168:171], v[36:39], v[228:231]
    ds_read_b128 v[28:31], v2 offset:44032
    v_mfma_f32_16x16x32_bf16 v[232:235], a[168:171], v[40:43], v[232:235]
    buffer_store_dwordx4 v[160:163], v9, s[16:19], s43 offen offset:0 sc1
    v_mfma_f32_16x16x32_bf16 v[236:239], a[168:171], v[44:47], v[236:239]
    v_cvt_pk_bf16_f32 v168, v168, v169
    v_cvt_pk_bf16_f32 v169, v170, v171
    v_mfma_f32_16x16x32_bf16 v[240:243], a[172:175], v[32:35], v[240:243]
    v_cvt_pk_bf16_f32 v170, v172, v173
    v_cvt_pk_bf16_f32 v171, v174, v175
    v_mfma_f32_16x16x32_bf16 v[244:247], a[172:175], v[36:39], v[244:247]
    buffer_store_dwordx4 v[168:171], v9, s[16:19], s43 offen offset:1024 sc1
    v_mfma_f32_16x16x32_bf16 v[248:251], a[172:175], v[40:43], v[248:251]
    v_cvt_pk_bf16_f32 v176, v176, v177
    v_cvt_pk_bf16_f32 v177, v178, v179
    v_mfma_f32_16x16x32_bf16 v[252:255], a[172:175], v[44:47], v[252:255]
    v_cvt_pk_bf16_f32 v178, v180, v181
    s_waitcnt vmcnt(2)
    s_mov_b64 exec, 1
    buffer_store_dword v13, v12, s[28:31], 0 offen sc1
    s_mov_b64 exec, -1
    s_waitcnt vmcnt(30) lgkmcnt(0)
    v_mfma_f32_16x16x32_bf16 v[208:211], a[176:179], v[16:19], v[208:211]
    ds_read_b128 v[32:35], v2 offset:45056
    v_cvt_pk_bf16_f32 v179, v182, v183
    v_mfma_f32_16x16x32_bf16 v[212:215], a[176:179], v[20:23], v[212:215]
    ds_read_b128 v[36:39], v2 offset:46080
    v_mfma_f32_16x16x32_bf16 v[216:219], a[176:179], v[24:27], v[216:219]
    buffer_store_dwordx4 v[176:179], v9, s[16:19], s43 offen offset:2048 sc1
    v_mfma_f32_16x16x32_bf16 v[220:223], a[176:179], v[28:31], v[220:223]
    v_cvt_pk_bf16_f32 v184, v184, v185
    v_cvt_pk_bf16_f32 v185, v186, v187
    v_mfma_f32_16x16x32_bf16 v[224:227], a[180:183], v[16:19], v[224:227]
    ds_read_b128 v[40:43], v2 offset:47104
    v_cvt_pk_bf16_f32 v186, v188, v189
    v_mfma_f32_16x16x32_bf16 v[228:231], a[180:183], v[20:23], v[228:231]
    ds_read_b128 v[44:47], v2 offset:48128
    v_cvt_pk_bf16_f32 v187, v190, v191
    v_mfma_f32_16x16x32_bf16 v[232:235], a[180:183], v[24:27], v[232:235]
    buffer_store_dwordx4 v[184:187], v9, s[16:19], s43 offen offset:3072 sc1
    v_mfma_f32_16x16x32_bf16 v[236:239], a[180:183], v[28:31], v[236:239]
    v_cvt_pk_bf16_f32 v192, v192, v193
    v_cvt_pk_bf16_f32 v193, v194, v195
    v_mfma_f32_16x16x32_bf16 v[240:243], a[184:187], v[16:19], v[240:243]
    v_cvt_pk_bf16_f32 v194, v196, v197
    v_cvt_pk_bf16_f32 v195, v198, v199
    v_mfma_f32_16x16x32_bf16 v[244:247], a[184:187], v[20:23], v[244:247]
    buffer_store_dwordx4 v[192:195], v9, s[16:19], s45 offen offset:0 sc1
    v_mfma_f32_16x16x32_bf16 v[248:251], a[184:187], v[24:27], v[248:251]
    v_cvt_pk_bf16_f32 v200, v200, v201
    v_cvt_pk_bf16_f32 v201, v202, v203
    v_mfma_f32_16x16x32_bf16 v[252:255], a[184:187], v[28:31], v[252:255]
    v_cvt_pk_bf16_f32 v202, v204, v205
    s_waitcnt vmcnt(30) lgkmcnt(0)
    v_mfma_f32_16x16x32_bf16 v[208:211], a[188:191], v[32:35], v[208:211]
    ds_read_b128 v[16:19], v2 offset:49152
    v_cvt_pk_bf16_f32 v203, v206, v207
    v_mfma_f32_16x16x32_bf16 v[212:215], a[188:191], v[36:39], v[212:215]
    ds_read_b128 v[20:23], v2 offset:50176
    v_mfma_f32_16x16x32_bf16 v[216:219], a[188:191], v[40:43], v[216:219]
    buffer_store_dwordx4 v[200:203], v9, s[16:19], s45 offen offset:1024 sc1
    v_mfma_f32_16x16x32_bf16 v[220:223], a[188:191], v[44:47], v[220:223]
    s_add_u32 s64, s86, 9981952
    s_addc_u32 s65, s87, 0
    s_mov_b32 s66, 131072
    v_mfma_f32_16x16x32_bf16 v[224:227], a[0:3], v[32:35], v[224:227]
    ds_read_b128 v[24:27], v2 offset:51200
    s_mov_b32 s67, 0x20000
    v_mfma_f32_16x16x32_bf16 v[228:231], a[0:3], v[36:39], v[228:231]
    ds_read_b128 v[28:31], v2 offset:52224
    s_mov_b32 s68, s82
    v_mfma_f32_16x16x32_bf16 v[232:235], a[0:3], v[40:43], v[232:235]
    s_mov_b32 s69, s83
    s_mov_b32 s70, 2359296
    v_mfma_f32_16x16x32_bf16 v[236:239], a[0:3], v[44:47], v[236:239]
    s_mov_b32 s71, 0x20000
    v_and_b32 v118, 63, v0
    v_mfma_f32_16x16x32_bf16 v[240:243], a[4:7], v[32:35], v[240:243]
    s_and_b32 s33, s61, 1
    s_bfe_u32 s34, s61, 0x10001
    v_mfma_f32_16x16x32_bf16 v[244:247], a[4:7], v[36:39], v[244:247]
    s_min_u32 s36, s62, 2
    s_lshr_b32 s41, s61, 2
    v_mfma_f32_16x16x32_bf16 v[248:251], a[4:7], v[40:43], v[248:251]
    s_lshl_b32 s35, s36, 1
    s_add_u32 s35, s35, s41
    v_mfma_f32_16x16x32_bf16 v[252:255], a[4:7], v[44:47], v[252:255]
    v_and_b32 v117, 15, v118
    s_waitcnt vmcnt(28) lgkmcnt(0)
    v_mfma_f32_16x16x32_bf16 v[208:211], a[8:11], v[16:19], v[208:211]
    ds_read_b128 v[32:35], v2 offset:53248
    v_lshrrev_b32 v119, 4, v118
    v_mfma_f32_16x16x32_bf16 v[212:215], a[8:11], v[20:23], v[212:215]
    ds_read_b128 v[36:39], v2 offset:54272
    v_lshrrev_b32 v120, 3, v117
    v_mfma_f32_16x16x32_bf16 v[216:219], a[8:11], v[24:27], v[216:219]
    v_and_b32 v121, 7, v117
    s_mul_i32 s37, s60, 73728
    v_mfma_f32_16x16x32_bf16 v[220:223], a[8:11], v[28:31], v[220:223]
    s_mul_i32 s38, s35, 12288
    s_add_u32 s38, s38, s37
    v_mfma_f32_16x16x32_bf16 v[224:227], a[12:15], v[16:19], v[224:227]
    ds_read_b128 v[40:43], v2 offset:55296
    s_lshl_b32 s39, s33, 10
    v_mfma_f32_16x16x32_bf16 v[228:231], a[12:15], v[20:23], v[228:231]
    ds_read_b128 v[44:47], v2 offset:56320
    s_add_u32 s39, s39, s38
    v_mfma_f32_16x16x32_bf16 v[232:235], a[12:15], v[24:27], v[232:235]
    s_lshl_b32 s42, s34, 7
    s_add_u32 s39, s39, s42
    v_mfma_f32_16x16x32_bf16 v[236:239], a[12:15], v[28:31], v[236:239]
    v_lshlrev_b32 v112, 11, v120
    v_lshl_add_u32 v112, v119, 8, v112
    v_mfma_f32_16x16x32_bf16 v[240:243], a[16:19], v[16:19], v[240:243]
    v_lshl_add_u32 v112, v121, 4, v112
    v_add_u32 v112, s39, v112
    v_mfma_f32_16x16x32_bf16 v[244:247], a[16:19], v[20:23], v[244:247]
    s_lshl_b32 s39, s33, 11
    s_add_u32 s39, s39, s38
    v_mfma_f32_16x16x32_bf16 v[248:251], a[16:19], v[24:27], v[248:251]
    s_add_u32 s39, s39, s42
    v_and_b32 v122, 1, v119
    v_mfma_f32_16x16x32_bf16 v[252:255], a[16:19], v[28:31], v[252:255]
    s_waitcnt vmcnt(25) lgkmcnt(0)
    v_mfma_f32_16x16x32_bf16 v[208:211], a[20:23], v[32:35], v[208:211]
    ds_read_b128 v[16:19], v2 offset:57344
    v_lshlrev_b32 v113, 10, v122
    v_mfma_f32_16x16x32_bf16 v[212:215], a[20:23], v[36:39], v[212:215]
    ds_read_b128 v[20:23], v2 offset:58368
    v_lshl_add_u32 v113, v120, 9, v113
    v_mfma_f32_16x16x32_bf16 v[216:219], a[20:23], v[40:43], v[216:219]
    v_lshl_add_u32 v113, v121, 4, v113
    v_lshrrev_b32 v123, 1, v119
    v_mfma_f32_16x16x32_bf16 v[220:223], a[20:23], v[44:47], v[220:223]
    v_lshl_add_u32 v113, v123, 3, v113
    v_add_u32 v113, s39, v113
    v_mfma_f32_16x16x32_bf16 v[224:227], a[24:27], v[32:35], v[224:227]
    ds_read_b128 v[24:27], v2 offset:59392
    s_lshl_b32 s38, s60, 6
    v_mfma_f32_16x16x32_bf16 v[228:231], a[24:27], v[36:39], v[228:231]
    ds_read_b128 v[28:31], v2 offset:60416
    s_lshl_b32 s39, s33, 5
    v_mfma_f32_16x16x32_bf16 v[232:235], a[24:27], v[40:43], v[232:235]
    s_add_u32 s38, s38, s39
    s_lshl_b32 s39, s34, 3
    v_mfma_f32_16x16x32_bf16 v[236:239], a[24:27], v[44:47], v[236:239]
    s_add_u32 s38, s38, s39
    v_lshl_add_u32 v115, v122, 4, v121
    v_mfma_f32_16x16x32_bf16 v[240:243], a[28:31], v[32:35], v[240:243]
    v_add_u32 v115, s38, v115
    v_and_b32 v114, 63, v115
    v_mfma_f32_16x16x32_bf16 v[244:247], a[28:31], v[36:39], v[244:247]
    v_lshlrev_b32 v114, 2, v114
    s_lshl_b32 s39, s60, 12
    v_mfma_f32_16x16x32_bf16 v[248:251], a[28:31], v[40:43], v[248:251]
    v_add_u32 v114, s39, v114
    s_movk_i32 s50, 4096
    v_mfma_f32_16x16x32_bf16 v[252:255], a[28:31], v[44:47], v[252:255]
    s_waitcnt vmcnt(22) lgkmcnt(0)
    v_mfma_f32_16x16x32_bf16 v[208:211], a[32:35], v[16:19], v[208:211]
    ds_read_b128 v[32:35], v2 offset:61440
    s_movk_i32 s51, 8192
    v_mfma_f32_16x16x32_bf16 v[212:215], a[32:35], v[20:23], v[212:215]
    ds_read_b128 v[36:39], v2 offset:62464
    v_mfma_f32_16x16x32_bf16 v[216:219], a[32:35], v[24:27], v[216:219]
    ds_read_b128 v[160:163], v3 offset:0
    v_mfma_f32_16x16x32_bf16 v[220:223], a[32:35], v[28:31], v[220:223]
    ds_read_b128 v[164:167], v3 offset:1024
    v_mfma_f32_16x16x32_bf16 v[224:227], a[36:39], v[16:19], v[224:227]
    ds_read_b128 v[40:43], v2 offset:63488
    v_mfma_f32_16x16x32_bf16 v[228:231], a[36:39], v[20:23], v[228:231]
    ds_read_b128 v[44:47], v2 offset:64512
    v_mfma_f32_16x16x32_bf16 v[232:235], a[36:39], v[24:27], v[232:235]
    ds_read_b128 v[168:171], v3 offset:2048
    v_mfma_f32_16x16x32_bf16 v[236:239], a[36:39], v[28:31], v[236:239]
    ds_read_b128 v[172:175], v3 offset:3072
    v_mfma_f32_16x16x32_bf16 v[240:243], a[40:43], v[16:19], v[240:243]
    buffer_load_dwordx2 v[132:133], v113, s[12:15], 0 offen offset:0 sc1
    v_mfma_f32_16x16x32_bf16 v[244:247], a[40:43], v[20:23], v[244:247]
    buffer_load_dwordx2 v[134:135], v113, s[12:15], 0 offen offset:256 sc1
    v_mfma_f32_16x16x32_bf16 v[248:251], a[40:43], v[24:27], v[248:251]
    buffer_load_dwordx2 v[136:137], v113, s[12:15], s50 offen offset:0 sc1
    v_mfma_f32_16x16x32_bf16 v[252:255], a[40:43], v[28:31], v[252:255]
    s_waitcnt vmcnt(13)
    buffer_load_dwordx2 v[138:139], v113, s[12:15], s50 offen offset:256 sc1
    buffer_load_dwordx2 v[140:141], v113, s[12:15], s51 offen offset:0 sc1
    buffer_load_dwordx2 v[142:143], v113, s[12:15], s51 offen offset:256 sc1
    buffer_load_dword v144, v114, s[64:67], 0 offen offset:0 sc1
    buffer_load_dword v145, v114, s[64:67], 0 offen offset:256 sc1
    buffer_load_dword v146, v114, s[64:67], 0 offen offset:512 sc1
    buffer_load_dword v147, v114, s[64:67], 0 offen offset:768 sc1
    buffer_load_dword v148, v114, s[64:67], 0 offen offset:1024 sc1
    buffer_load_dword v149, v114, s[64:67], 0 offen offset:1280 sc1
    buffer_load_dword v150, v114, s[64:67], 0 offen offset:1536 sc1
    buffer_load_dword v151, v114, s[64:67], 0 offen offset:1792 sc1
    buffer_load_dword v152, v114, s[64:67], 0 offen offset:2048 sc1
    buffer_load_dword v153, v114, s[64:67], 0 offen offset:2304 sc1
    buffer_load_dword v154, v114, s[64:67], 0 offen offset:2560 sc1
    buffer_load_dword v155, v114, s[64:67], 0 offen offset:2816 sc1
    buffer_load_dword v156, v114, s[64:67], 0 offen offset:3072 sc1
    v_lshl_add_u32 v116, v120, 1, v123
    v_mul_u32_u24 v116, 48, v116
    s_mul_i32 s39, s35, 192
    v_add_u32 v116, s39, v116
    s_movk_i32 s38, 1152
    v_mad_u32_u24 v115, v115, s38, v116
    v_lshrrev_b32 v123, 1, v121
    v_and_b32 v122, 1, v121
    v_mov_b32 v121, 0x3f80
    v_lshlrev_b32 v122, 4, v122
    v_lshlrev_b32 v121, v122, v121
    v_add_u32 v122, 0, v120
    v_cmp_eq_u32 vcc, v122, v119
    s_nop 1
    v_cndmask_b32 v116, 0, v121, vcc
    v_cmp_eq_u32 vcc, 0, v123
    s_nop 1
    v_cndmask_b32 v124, 0, v116, vcc
    v_cmp_eq_u32 vcc, 1, v123
    s_nop 1
    v_cndmask_b32 v125, 0, v116, vcc
    v_cmp_eq_u32 vcc, 2, v123
    s_nop 1
    v_cndmask_b32 v126, 0, v116, vcc
    v_cmp_eq_u32 vcc, 3, v123
    s_nop 1
    v_cndmask_b32 v127, 0, v116, vcc
    v_add_u32 v122, 2, v120
    v_cmp_eq_u32 vcc, v122, v119
    s_nop 1
    v_cndmask_b32 v116, 0, v121, vcc
    v_cmp_eq_u32 vcc, 0, v123
    s_nop 1
    v_cndmask_b32 v128, 0, v116, vcc
    v_cmp_eq_u32 vcc, 1, v123
    s_nop 1
    v_cndmask_b32 v129, 0, v116, vcc
    v_cmp_eq_u32 vcc, 2, v123
    s_nop 1
    v_cndmask_b32 v130, 0, v116, vcc
    v_cmp_eq_u32 vcc, 3, v123
    s_nop 1
    v_cndmask_b32 v131, 0, v116, vcc
    s_lshl_b32 s38, s36, 8
    s_lshl_b32 s39, s60, 3
    s_add_u32 s38, s38, s39
    s_lshl_b32 s38, s38, 2
    s_lshl_b32 s39, s41, 1
    s_add_u32 s38, s38, s39
    v_bfe_u32 v116, v118, 1, 3
    v_lshlrev_b32 v116, 2, v116
    v_and_b32 v122, 1, v118
    v_add_u32 v116, v116, v122
    v_add_u32 v116, s38, v116
    v_lshlrev_b32 v116, 6, v116
    v_add_u32 v116, 98304, v116
    s_mov_b32 s43, 49152
    s_mov_b32 s45, 53248
    s_waitcnt lgkmcnt(2)
    v_mfma_f32_16x16x32_bf16 v[208:211], a[44:47], v[32:35], v[208:211]
    ds_read_b128 v[16:19], v3 offset:4096
    v_mfma_f32_16x16x32_bf16 v[212:215], a[44:47], v[36:39], v[212:215]
    ds_read_b128 v[20:23], v3 offset:5120
    v_mfma_f32_16x16x32_bf16 v[216:219], a[44:47], v[40:43], v[216:219]
    ds_read_b128 v[24:27], v3 offset:6144
    v_mfma_f32_16x16x32_bf16 v[220:223], a[44:47], v[44:47], v[220:223]
    ds_read_b128 v[28:31], v3 offset:7168
    s_waitcnt lgkmcnt(4)
    v_mfma_f32_16x16x32_bf16 v[208:211], v[48:51], v[160:163], v[208:211]
    v_mfma_f32_16x16x32_bf16 v[212:215], v[48:51], v[164:167], v[212:215]
    v_mfma_f32_16x16x32_bf16 v[216:219], v[48:51], v[168:171], v[216:219]
    v_mfma_f32_16x16x32_bf16 v[220:223], v[48:51], v[172:175], v[220:223]
    s_waitcnt lgkmcnt(0)
    v_mfma_f32_16x16x32_bf16 v[208:211], v[60:63], v[16:19], v[208:211]
    v_mfma_f32_16x16x32_bf16 v[212:215], v[60:63], v[20:23], v[212:215]
    v_mfma_f32_16x16x32_bf16 v[216:219], v[60:63], v[24:27], v[216:219]
    v_mfma_f32_16x16x32_bf16 v[220:223], v[60:63], v[28:31], v[220:223]
    v_mfma_f32_16x16x32_bf16 v[224:227], a[48:51], v[32:35], v[224:227]
    v_mfma_f32_16x16x32_bf16 v[228:231], a[48:51], v[36:39], v[228:231]
    s_nop 2
    v_cvt_pk_bf16_f32 v208, v208, v209
    v_cvt_pk_bf16_f32 v209, v210, v211
    v_mfma_f32_16x16x32_bf16 v[232:235], a[48:51], v[40:43], v[232:235]
    v_cvt_pk_bf16_f32 v210, v212, v213
    v_cvt_pk_bf16_f32 v211, v214, v215
    v_mfma_f32_16x16x32_bf16 v[236:239], a[48:51], v[44:47], v[236:239]
    buffer_store_dwordx4 v[208:211], v9, s[16:19], s43 offen offset:0 sc1
    v_mfma_f32_16x16x32_bf16 v[224:227], v[52:55], v[160:163], v[224:227]
    v_cvt_pk_bf16_f32 v216, v216, v217
    v_cvt_pk_bf16_f32 v217, v218, v219
    v_mfma_f32_16x16x32_bf16 v[228:231], v[52:55], v[164:167], v[228:231]
    v_cvt_pk_bf16_f32 v218, v220, v221
    v_cvt_pk_bf16_f32 v219, v222, v223
    v_mfma_f32_16x16x32_bf16 v[232:235], v[52:55], v[168:171], v[232:235]
    buffer_store_dwordx4 v[216:219], v9, s[16:19], s43 offen offset:1024 sc1
    v_mfma_f32_16x16x32_bf16 v[236:239], v[52:55], v[172:175], v[236:239]
    v_mfma_f32_16x16x32_bf16 v[224:227], v[64:67], v[16:19], v[224:227]
    v_mfma_f32_16x16x32_bf16 v[228:231], v[64:67], v[20:23], v[228:231]
    v_mfma_f32_16x16x32_bf16 v[232:235], v[64:67], v[24:27], v[232:235]
    v_mfma_f32_16x16x32_bf16 v[236:239], v[64:67], v[28:31], v[236:239]
    s_waitcnt vmcnt(21)
    s_mov_b32 s49, 65536
    s_mov_b64 exec, 1
    buffer_store_dword v13, v12, s[28:31], s49 offen sc1
    s_mov_b64 exec, -1
    v_mfma_f32_16x16x32_bf16 v[240:243], a[52:55], v[32:35], v[240:243]
    v_mfma_f32_16x16x32_bf16 v[244:247], a[52:55], v[36:39], v[244:247]
    v_cvt_pk_bf16_f32 v224, v224, v225
    v_cvt_pk_bf16_f32 v225, v226, v227
    v_mfma_f32_16x16x32_bf16 v[248:251], a[52:55], v[40:43], v[248:251]
    v_cvt_pk_bf16_f32 v226, v228, v229
    v_cvt_pk_bf16_f32 v227, v230, v231
    v_mfma_f32_16x16x32_bf16 v[252:255], a[52:55], v[44:47], v[252:255]
    buffer_store_dwordx4 v[224:227], v9, s[16:19], s43 offen offset:2048 sc1
    v_mfma_f32_16x16x32_bf16 v[240:243], v[56:59], v[160:163], v[240:243]
    v_cvt_pk_bf16_f32 v232, v232, v233
    v_cvt_pk_bf16_f32 v233, v234, v235
    v_mfma_f32_16x16x32_bf16 v[244:247], v[56:59], v[164:167], v[244:247]
    v_cvt_pk_bf16_f32 v234, v236, v237
    v_cvt_pk_bf16_f32 v235, v238, v239
    v_mfma_f32_16x16x32_bf16 v[248:251], v[56:59], v[168:171], v[248:251]
    buffer_store_dwordx4 v[232:235], v9, s[16:19], s43 offen offset:3072 sc1
    v_mfma_f32_16x16x32_bf16 v[252:255], v[56:59], v[172:175], v[252:255]
    v_mfma_f32_16x16x32_bf16 v[240:243], v[68:71], v[16:19], v[240:243]
    v_mfma_f32_16x16x32_bf16 v[244:247], v[68:71], v[20:23], v[244:247]
    v_mfma_f32_16x16x32_bf16 v[248:251], v[68:71], v[24:27], v[248:251]
    v_mfma_f32_16x16x32_bf16 v[252:255], v[68:71], v[28:31], v[252:255]
    s_nop 4
    v_cvt_pk_bf16_f32 v240, v240, v241
    v_cvt_pk_bf16_f32 v241, v242, v243
    v_cvt_pk_bf16_f32 v242, v244, v245
    v_cvt_pk_bf16_f32 v243, v246, v247
    buffer_store_dwordx4 v[240:243], v9, s[16:19], s45 offen offset:0 sc1
    v_cvt_pk_bf16_f32 v248, v248, v249
    v_cvt_pk_bf16_f32 v249, v250, v251
    v_cvt_pk_bf16_f32 v250, v252, v253
    v_cvt_pk_bf16_f32 v251, v254, v255
    buffer_store_dwordx4 v[248:251], v9, s[16:19], s45 offen offset:1024 sc1
    buffer_load_dword v118, v116, s[28:31], 0 offen sc1
    s_waitcnt vmcnt(1)
    s_mov_b32 s49, 131072
    s_mov_b64 exec, 1
    buffer_store_dword v13, v12, s[28:31], s49 offen sc1
    s_mov_b64 exec, -1
    s_cmp_ge_u32 s62, 3
    s_cbranch_scc1 RED_58
    v_add_f32 v144, v144, v145
    v_add_f32 v148, v148, v149
    v_add_f32 v152, v152, v153
    v_add_f32 v144, v144, v146
    v_add_f32 v148, v148, v150
    v_add_f32 v152, v152, v154
    v_add_f32 v144, v144, v147
    v_add_f32 v148, v148, v151
    v_add_f32 v152, v152, v155
    v_add_f32 v144, v144, v148
    v_add_f32 v144, v144, v152
    s_mov_b32 s40, 987991609
    v_mov_b32 v145, 925353388
    v_fma_f32 v144, v144, s40, v145
    v_rcp_f32 v144, v144
    v_lshlrev_b32 v184, 16, v132
    v_and_b32 v185, 0xffff0000, v132
    v_lshlrev_b32 v186, 16, v133
    v_and_b32 v187, 0xffff0000, v133
    v_add_f32 v184, v184, v156
    v_add_f32 v185, v185, v156
    v_add_f32 v186, v186, v156
    v_add_f32 v187, v187, v156
    v_lshlrev_b32 v188, 16, v134
    v_and_b32 v189, 0xffff0000, v134
    v_lshlrev_b32 v190, 16, v135
    v_and_b32 v191, 0xffff0000, v135
    v_add_f32 v188, v188, v156
    v_add_f32 v189, v189, v156
    v_add_f32 v190, v190, v156
    v_add_f32 v191, v191, v156
    v_lshlrev_b32 v192, 16, v136
    v_and_b32 v193, 0xffff0000, v136
    v_lshlrev_b32 v194, 16, v137
    v_and_b32 v195, 0xffff0000, v137
    v_add_f32 v192, v192, v156
    v_add_f32 v193, v193, v156
    v_add_f32 v194, v194, v156
    v_add_f32 v195, v195, v156
    v_lshlrev_b32 v196, 16, v138
    v_and_b32 v197, 0xffff0000, v138
    v_lshlrev_b32 v198, 16, v139
    v_and_b32 v199, 0xffff0000, v139
    v_add_f32 v196, v196, v156
    v_add_f32 v197, v197, v156
    v_add_f32 v198, v198, v156
    v_add_f32 v199, v199, v156
    v_lshlrev_b32 v200, 16, v140
    v_and_b32 v201, 0xffff0000, v140
    v_lshlrev_b32 v202, 16, v141
    v_and_b32 v203, 0xffff0000, v141
    v_add_f32 v200, v200, v156
    v_add_f32 v201, v201, v156
    v_add_f32 v202, v202, v156
    v_add_f32 v203, v203, v156
    v_lshlrev_b32 v204, 16, v142
    v_and_b32 v205, 0xffff0000, v142
    v_lshlrev_b32 v206, 16, v143
    v_and_b32 v207, 0xffff0000, v143
    v_add_f32 v204, v204, v156
    v_add_f32 v205, v205, v156
    v_add_f32 v206, v206, v156
    v_add_f32 v207, v207, v156
    s_mov_b32 s3, 0
    s_waitcnt vmcnt(1)
RPL_59:
    v_cmp_ne_u32 vcc, s63, v118
    s_nop 4
    s_cbranch_vccz RPE_60
    buffer_load_dword v118, v116, s[28:31], 0 offen sc1
    s_waitcnt vmcnt(0)
    s_add_u32 s3, s3, 1
    s_cmp_lt_u32 s3, 0x200000
    s_cbranch_scc1 RPL_59
RPE_60:
    s_mov_b32 s40, 0
    s_add_u32 s41, s40, 8192
    buffer_load_dwordx4 v[16:19], v112, s[16:19], s40 offen sc1
    s_add_u32 s42, s40, 4096
    buffer_load_dwordx4 v[20:23], v112, s[16:19], s42 offen sc1
    buffer_load_dwordx4 v[24:27], v112, s[16:19], s41 offen sc1
    s_mov_b32 s40, 2359296
    s_add_u32 s41, s40, 8192
    buffer_load_dwordx4 v[28:31], v112, s[16:19], s40 offen sc1
    s_add_u32 s42, s40, 4096
    buffer_load_dwordx4 v[32:35], v112, s[16:19], s42 offen sc1
    buffer_load_dwordx4 v[36:39], v112, s[16:19], s41 offen sc1
    s_mov_b32 s40, 4718592
    s_add_u32 s41, s40, 8192
    buffer_load_dwordx4 v[40:43], v112, s[16:19], s40 offen sc1
    s_add_u32 s42, s40, 4096
    buffer_load_dwordx4 v[44:47], v112, s[16:19], s42 offen sc1
    buffer_load_dwordx4 v[48:51], v112, s[16:19], s41 offen sc1
    s_mov_b32 s40, 7077888
    s_add_u32 s41, s40, 8192
    buffer_load_dwordx4 v[52:55], v112, s[16:19], s40 offen sc1
    s_add_u32 s42, s40, 4096
    buffer_load_dwordx4 v[56:59], v112, s[16:19], s42 offen sc1
    buffer_load_dwordx4 v[60:63], v112, s[16:19], s41 offen sc1
    s_mov_b32 s40, 9437184
    s_add_u32 s41, s40, 8192
    buffer_load_dwordx4 v[64:67], v112, s[16:19], s40 offen sc1
    s_add_u32 s42, s40, 4096
    buffer_load_dwordx4 v[68:71], v112, s[16:19], s42 offen sc1
    buffer_load_dwordx4 v[72:75], v112, s[16:19], s41 offen sc1
    s_mov_b32 s40, 11796480
    s_add_u32 s41, s40, 8192
    buffer_load_dwordx4 v[76:79], v112, s[16:19], s40 offen sc1
    s_add_u32 s42, s40, 4096
    buffer_load_dwordx4 v[80:83], v112, s[16:19], s42 offen sc1
    buffer_load_dwordx4 v[84:87], v112, s[16:19], s41 offen sc1
    s_mov_b32 s40, 14155776
    s_add_u32 s41, s40, 8192
    buffer_load_dwordx4 v[88:91], v112, s[16:19], s40 offen sc1
    s_add_u32 s42, s40, 4096
    buffer_load_dwordx4 v[92:95], v112, s[16:19], s42 offen sc1
    buffer_load_dwordx4 v[96:99], v112, s[16:19], s41 offen sc1
    s_mov_b32 s40, 16515072
    s_add_u32 s41, s40, 8192
    buffer_load_dwordx4 v[100:103], v112, s[16:19], s40 offen sc1
    s_add_u32 s42, s40, 4096
    buffer_load_dwordx4 v[104:107], v112, s[16:19], s42 offen sc1
    buffer_load_dwordx4 v[108:111], v112, s[16:19], s41 offen sc1
    s_waitcnt vmcnt(21)
    v_mfma_f32_16x16x32_bf16 v[160:163], v[124:127], v[16:19], 0
    v_mfma_f32_16x16x32_bf16 v[164:167], v[128:131], v[16:19], 0
    v_mfma_f32_16x16x32_bf16 v[168:171], v[124:127], v[20:23], 0
    v_mfma_f32_16x16x32_bf16 v[172:175], v[128:131], v[20:23], 0
    v_mfma_f32_16x16x32_bf16 v[176:179], v[124:127], v[24:27], 0
    v_mfma_f32_16x16x32_bf16 v[180:183], v[128:131], v[24:27], 0
    s_waitcnt vmcnt(18)
    v_mfma_f32_16x16x32_bf16 v[160:163], v[124:127], v[28:31], v[160:163]
    v_mfma_f32_16x16x32_bf16 v[164:167], v[128:131], v[28:31], v[164:167]
    v_mfma_f32_16x16x32_bf16 v[168:171], v[124:127], v[32:35], v[168:171]
    v_mfma_f32_16x16x32_bf16 v[172:175], v[128:131], v[32:35], v[172:175]
    v_mfma_f32_16x16x32_bf16 v[176:179], v[124:127], v[36:39], v[176:179]
    v_mfma_f32_16x16x32_bf16 v[180:183], v[128:131], v[36:39], v[180:183]
    s_waitcnt vmcnt(15)
    v_mfma_f32_16x16x32_bf16 v[160:163], v[124:127], v[40:43], v[160:163]
    v_mfma_f32_16x16x32_bf16 v[164:167], v[128:131], v[40:43], v[164:167]
    v_mfma_f32_16x16x32_bf16 v[168:171], v[124:127], v[44:47], v[168:171]
    v_mfma_f32_16x16x32_bf16 v[172:175], v[128:131], v[44:47], v[172:175]
    v_mfma_f32_16x16x32_bf16 v[176:179], v[124:127], v[48:51], v[176:179]
    v_mfma_f32_16x16x32_bf16 v[180:183], v[128:131], v[48:51], v[180:183]
    s_waitcnt vmcnt(12)
    v_mfma_f32_16x16x32_bf16 v[160:163], v[124:127], v[52:55], v[160:163]
    v_mfma_f32_16x16x32_bf16 v[164:167], v[128:131], v[52:55], v[164:167]
    v_mfma_f32_16x16x32_bf16 v[168:171], v[124:127], v[56:59], v[168:171]
    v_mfma_f32_16x16x32_bf16 v[172:175], v[128:131], v[56:59], v[172:175]
    v_mfma_f32_16x16x32_bf16 v[176:179], v[124:127], v[60:63], v[176:179]
    v_mfma_f32_16x16x32_bf16 v[180:183], v[128:131], v[60:63], v[180:183]
    s_waitcnt vmcnt(9)
    v_mfma_f32_16x16x32_bf16 v[160:163], v[124:127], v[64:67], v[160:163]
    v_mfma_f32_16x16x32_bf16 v[164:167], v[128:131], v[64:67], v[164:167]
    v_mfma_f32_16x16x32_bf16 v[168:171], v[124:127], v[68:71], v[168:171]
    v_mfma_f32_16x16x32_bf16 v[172:175], v[128:131], v[68:71], v[172:175]
    v_mfma_f32_16x16x32_bf16 v[176:179], v[124:127], v[72:75], v[176:179]
    v_mfma_f32_16x16x32_bf16 v[180:183], v[128:131], v[72:75], v[180:183]
    s_waitcnt vmcnt(6)
    v_mfma_f32_16x16x32_bf16 v[160:163], v[124:127], v[76:79], v[160:163]
    v_mfma_f32_16x16x32_bf16 v[164:167], v[128:131], v[76:79], v[164:167]
    v_mfma_f32_16x16x32_bf16 v[168:171], v[124:127], v[80:83], v[168:171]
    v_mfma_f32_16x16x32_bf16 v[172:175], v[128:131], v[80:83], v[172:175]
    v_mfma_f32_16x16x32_bf16 v[176:179], v[124:127], v[84:87], v[176:179]
    v_mfma_f32_16x16x32_bf16 v[180:183], v[128:131], v[84:87], v[180:183]
    s_waitcnt vmcnt(3)
    v_mfma_f32_16x16x32_bf16 v[160:163], v[124:127], v[88:91], v[160:163]
    v_mfma_f32_16x16x32_bf16 v[164:167], v[128:131], v[88:91], v[164:167]
    v_mfma_f32_16x16x32_bf16 v[168:171], v[124:127], v[92:95], v[168:171]
    v_mfma_f32_16x16x32_bf16 v[172:175], v[128:131], v[92:95], v[172:175]
    v_mfma_f32_16x16x32_bf16 v[176:179], v[124:127], v[96:99], v[176:179]
    v_mfma_f32_16x16x32_bf16 v[180:183], v[128:131], v[96:99], v[180:183]
    s_waitcnt vmcnt(0)
    v_mfma_f32_16x16x32_bf16 v[160:163], v[124:127], v[100:103], v[160:163]
    v_mfma_f32_16x16x32_bf16 v[164:167], v[128:131], v[100:103], v[164:167]
    v_mfma_f32_16x16x32_bf16 v[168:171], v[124:127], v[104:107], v[168:171]
    v_mfma_f32_16x16x32_bf16 v[172:175], v[128:131], v[104:107], v[172:175]
    v_mfma_f32_16x16x32_bf16 v[176:179], v[124:127], v[108:111], v[176:179]
    v_mfma_f32_16x16x32_bf16 v[180:183], v[128:131], v[108:111], v[180:183]
    s_nop 7
    v_fma_f32 v160, v160, v144, v184
    v_fma_f32 v161, v161, v144, v185
    v_fma_f32 v162, v162, v144, v186
    v_fma_f32 v163, v163, v144, v187
    v_fma_f32 v164, v164, v144, v188
    v_fma_f32 v165, v165, v144, v189
    v_fma_f32 v166, v166, v144, v190
    v_fma_f32 v167, v167, v144, v191
    v_fma_f32 v168, v168, v144, v192
    v_fma_f32 v169, v169, v144, v193
    v_fma_f32 v170, v170, v144, v194
    v_fma_f32 v171, v171, v144, v195
    v_fma_f32 v172, v172, v144, v196
    v_fma_f32 v173, v173, v144, v197
    v_fma_f32 v174, v174, v144, v198
    v_fma_f32 v175, v175, v144, v199
    v_fma_f32 v176, v176, v144, v200
    v_fma_f32 v177, v177, v144, v201
    v_fma_f32 v178, v178, v144, v202
    v_fma_f32 v179, v179, v144, v203
    v_fma_f32 v180, v180, v144, v204
    v_fma_f32 v181, v181, v144, v205
    v_fma_f32 v182, v182, v144, v206
    v_fma_f32 v183, v183, v144, v207
    v_cmp_gt_u32 vcc, 8, v117
    s_nop 1
    v_cndmask_b32 v220, v160, v164, vcc
    s_nop 1
    v_mov_b32_dpp v221, v220 row_ror:8 row_mask:0xf bank_mask:0xf
    v_cndmask_b32 v222, v221, v160, vcc
    v_cndmask_b32 v223, v164, v221, vcc
    v_cvt_pk_bf16_f32 v208, v222, v223
    v_cndmask_b32 v224, v168, v172, vcc
    s_nop 1
    v_mov_b32_dpp v225, v224 row_ror:8 row_mask:0xf bank_mask:0xf
    v_cndmask_b32 v226, v225, v168, vcc
    v_cndmask_b32 v227, v172, v225, vcc
    v_cvt_pk_bf16_f32 v209, v226, v227
    v_cndmask_b32 v220, v176, v180, vcc
    s_nop 1
    v_mov_b32_dpp v221, v220 row_ror:8 row_mask:0xf bank_mask:0xf
    v_cndmask_b32 v222, v221, v176, vcc
    v_cndmask_b32 v223, v180, v221, vcc
    v_cvt_pk_bf16_f32 v210, v222, v223
    v_cndmask_b32 v220, v161, v165, vcc
    s_nop 1
    v_mov_b32_dpp v221, v220 row_ror:8 row_mask:0xf bank_mask:0xf
    v_cndmask_b32 v222, v221, v161, vcc
    v_cndmask_b32 v223, v165, v221, vcc
    v_cvt_pk_bf16_f32 v211, v222, v223
    v_cndmask_b32 v224, v169, v173, vcc
    s_nop 1
    v_mov_b32_dpp v225, v224 row_ror:8 row_mask:0xf bank_mask:0xf
    v_cndmask_b32 v226, v225, v169, vcc
    v_cndmask_b32 v227, v173, v225, vcc
    v_cvt_pk_bf16_f32 v212, v226, v227
    v_cndmask_b32 v220, v177, v181, vcc
    s_nop 1
    v_mov_b32_dpp v221, v220 row_ror:8 row_mask:0xf bank_mask:0xf
    v_cndmask_b32 v222, v221, v177, vcc
    v_cndmask_b32 v223, v181, v221, vcc
    v_cvt_pk_bf16_f32 v213, v222, v223
    v_cndmask_b32 v220, v162, v166, vcc
    s_nop 1
    v_mov_b32_dpp v221, v220 row_ror:8 row_mask:0xf bank_mask:0xf
    v_cndmask_b32 v222, v221, v162, vcc
    v_cndmask_b32 v223, v166, v221, vcc
    v_cvt_pk_bf16_f32 v214, v222, v223
    v_cndmask_b32 v224, v170, v174, vcc
    s_nop 1
    v_mov_b32_dpp v225, v224 row_ror:8 row_mask:0xf bank_mask:0xf
    v_cndmask_b32 v226, v225, v170, vcc
    v_cndmask_b32 v227, v174, v225, vcc
    v_cvt_pk_bf16_f32 v215, v226, v227
    v_cndmask_b32 v220, v178, v182, vcc
    s_nop 1
    v_mov_b32_dpp v221, v220 row_ror:8 row_mask:0xf bank_mask:0xf
    v_cndmask_b32 v222, v221, v178, vcc
    v_cndmask_b32 v223, v182, v221, vcc
    v_cvt_pk_bf16_f32 v216, v222, v223
    v_cndmask_b32 v220, v163, v167, vcc
    s_nop 1
    v_mov_b32_dpp v221, v220 row_ror:8 row_mask:0xf bank_mask:0xf
    v_cndmask_b32 v222, v221, v163, vcc
    v_cndmask_b32 v223, v167, v221, vcc
    v_cvt_pk_bf16_f32 v217, v222, v223
    v_cndmask_b32 v224, v171, v175, vcc
    s_nop 1
    v_mov_b32_dpp v225, v224 row_ror:8 row_mask:0xf bank_mask:0xf
    v_cndmask_b32 v226, v225, v171, vcc
    v_cndmask_b32 v227, v175, v225, vcc
    v_cvt_pk_bf16_f32 v218, v226, v227
    v_cndmask_b32 v220, v179, v183, vcc
    s_nop 1
    v_mov_b32_dpp v221, v220 row_ror:8 row_mask:0xf bank_mask:0xf
    v_cndmask_b32 v222, v221, v179, vcc
    v_cndmask_b32 v223, v183, v221, vcc
    v_cvt_pk_bf16_f32 v219, v222, v223
    buffer_store_dwordx4 v[208:211], v115, s[68:71], 0 offen offset:0
    buffer_store_dwordx4 v[212:215], v115, s[68:71], 0 offen offset:16
    buffer_store_dwordx4 v[216:219], v115, s[68:71], 0 offen offset:32
RED_58:
MEGA_FIN:
MEGA_END:
    s_endpgm
.section .rodata,"a"
.p2align 6
.amdhsa_kernel sequential_preLN__grouped_kv_mqa__glu_gated_bilinear__prompt_kernel
  .amdhsa_next_free_vgpr 512
  .amdhsa_next_free_sgpr 102
  .amdhsa_accum_offset 256
  .amdhsa_group_segment_fixed_size 0
  .amdhsa_kernarg_size 96
  .amdhsa_user_sgpr_count 2
  .amdhsa_user_sgpr_kernarg_segment_ptr 1
  .amdhsa_system_sgpr_workgroup_id_x 1
.end_amdhsa_kernel
```
